```python
import torch

def _softmax(x, axis=-1):
    return torch.softmax(x, dim=axis)

def _gelu(x):
    return torch.nn.functional.gelu(x, approximate='tanh')

def _silu(x):
    return torch.nn.functional.silu(x)

def _sigmoid(x):
    return torch.sigmoid(x)

def _layernorm(x, axis=-1, eps=1e-05):
    m = x.mean(dim=axis, keepdim=True)
    v = x.var(dim=axis, keepdim=True, unbiased=False)
    return (x - m) / torch.sqrt(v + eps)

def _scatter_add(tgt, idx, src, axis=0):
    return tgt.clone().index_add_(axis, idx, src)

def _segment_sum(src, seg, n):
    out = torch.zeros((n,) + src.shape[1:], dtype=src.dtype)
    return out.index_add_(0, seg, src)

def _pad(x, pw):
    flat = tuple((v for pair in reversed(pw) for v in pair))
    return torch.nn.functional.pad(x, flat)
kernel_name = 'recurrent_scan__spectral_gfnet__mixer_gmlp__prompt'

def setup_inputs():

    _w = lambda a: (lambda t: t.to(torch.bfloat16) if t.is_floating_point() else t)(torch.as_tensor(a))

    def _A_setup():
        B, S, D = (1, 2048, 448)
        Df = D // 2 + 1
        return {'x': _w((lambda *s: torch.randn(*s, dtype=torch.bfloat16) * 0.05)(B, S, D)), 'w_r': _w((lambda *s: torch.randn(*s, dtype=torch.bfloat16) * 0.2)(S, Df) * 0.02), 'w_i': _w((lambda *s: torch.randn(*s, dtype=torch.bfloat16) * 0.2)(S, Df) * 0.02)}
    _A_in = _A_setup()

    def _B_setup():
        B, S, D, F = (1, 2048, 448, 1792)
        Fh = F // 2
        return {'x': _w((lambda *s: torch.randn(*s, dtype=torch.bfloat16) * 0.05)(B, S, D)), 'w_in': _w((lambda *s: torch.randn(*s, dtype=torch.bfloat16) * 0.4)(D, 2 * Fh)), 'w_sp': _w(0.01 * (lambda *s: torch.randn(*s, dtype=torch.bfloat16) * 0.4)(S, S)), 'b_sp': _w(1.0 + 0.01 * (lambda *s: torch.randn(*s, dtype=torch.bfloat16) * 0.1)(S)), 'w_out': _w((lambda *s: torch.randn(*s, dtype=torch.bfloat16) * 0.1)(Fh, D))}
    _B_in = _B_setup()
    return {'A_x': _A_in['x'], 'A_w_r': _A_in['w_r'], 'A_w_i': _A_in['w_i'], 'B_x': _B_in['x'], 'B_w_in': _B_in['w_in'], 'B_w_sp': _B_in['w_sp'], 'B_b_sp': _B_in['b_sp'], 'B_w_out': _B_in['w_out']}

def reference(A_x, A_w_r, A_w_i, B_x, B_w_in, B_w_sp, B_b_sp, B_w_out):

    def _A_ref(x, w_r, w_i):
        B, S, D = x.shape
        X = (lambda x, axes=(-2, -1): torch.fft.rfft2(x.float(), dim=axes))(x, axes=(-2, -1))
        W = w_r + 1j * w_i
        X = X * W
        y = (lambda x, s, axes=(-2, -1): torch.fft.irfft2(x, s=s, dim=axes).to(torch.bfloat16))(X, (S, D), axes=(-2, -1))
        return y

    def _B_ref(x, w_in, w_sp, b_sp, w_out):
        B, S, D = x.shape
        F = w_in.shape[-1]
        Fh = F // 2
        z = _gelu(torch.einsum('bsd,df->bsf', x, w_in))
        z1 = z[..., :Fh].clone()
        z2 = _layernorm(z[..., Fh:], axis=-1)
        g = torch.einsum('ts,bsf->btf', w_sp, z2) + b_sp[None, :, None]
        return torch.einsum('bsf,fd->bsd', z1 * g, w_out)
    x = A_x
    xn = _layernorm(x, axis=-1)
    s = _A_ref(xn, A_w_r, A_w_i)
    g = _silu(_B_ref(xn, B_w_in, B_w_sp, B_b_sp, B_w_out))
    return x + s * g
```

```asm
; @launch grid=(256,1,1) block=(512,1,1) lds=163840
.amdgcn_target "amdgcn-amd-amdhsa--gfx950"
.text
.globl recurrent_scan__spectral_gfnet__mixer_gmlp__prompt_kernel
.p2align 8
.type recurrent_scan__spectral_gfnet__mixer_gmlp__prompt_kernel,@function
recurrent_scan__spectral_gfnet__mixer_gmlp__prompt_kernel:
  s_cmp_ge_u32 s2, 256
  s_cbranch_scc1 MK_end
  s_load_dwordx16 s[48:63], s[0:1], 0
  s_load_dwordx4 s[84:87], s[0:1], 64
  s_load_dwordx2 s[88:89], s[0:1], 80
  v_lshrrev_b32 v1, 6, v0
  v_and_b32 v0, 63, v0
  v_readfirstlane_b32 s36, v1
  s_nop 1
  s_cmp_lg_u32 s36, 3
  s_cbranch_scc1 MK_nopf
  s_getpc_b64 s[4:5]
  s_add_u32 s4, s4, recurrent_scan__spectral_gfnet__mixer_gmlp__prompt_kernel@rel32@lo+4
  s_addc_u32 s5, s5, recurrent_scan__spectral_gfnet__mixer_gmlp__prompt_kernel@rel32@hi+12
  s_and_b32 s5, s5, 0xffff
  s_mov_b32 s6, MK_codeend-recurrent_scan__spectral_gfnet__mixer_gmlp__prompt_kernel
  s_mov_b32 s7, 0x20000
  s_lshr_b32 s8, s2, 3
  s_lshl_b32 s8, s8, 10
  s_add_u32 s9, s8, 32768
  v_lshlrev_b32 v1, 4, v0
  s_mov_b32 m0, 61440
  s_nop 0
  buffer_load_dwordx4 v1, s[4:7], s8 offen lds
  buffer_load_dwordx4 v1, s[4:7], s9 offen lds
  s_add_u32 s9, s8, 65536
  buffer_load_dwordx4 v1, s[4:7], s9 offen lds
MK_nopf:
  s_and_b32 s8, s2, 7
  s_lshr_b32 s9, s2, 3
  s_mul_hi_u32 s10, s9, 0x24924925
  s_mul_i32 s11, s10, 7
  s_sub_u32 s11, s9, s11
  s_and_b32 s12, s8, 1
  s_lshr_b32 s13, s8, 1
  s_mul_i32 s14, s12, 7
  s_add_u32 s37, s14, s11
  s_lshl_b32 s14, s13, 2
  s_add_u32 s38, s14, s10
  s_lshl_b32 s14, s10, 1
  s_add_u32 s95, s14, s11
  s_cmp_ge_u32 s95, 7
  s_cselect_b32 s14, 7, 0
  s_sub_u32 s40, s95, s14
  s_cmp_ge_u32 s2, 224
  s_cbranch_scc1 MK_common2
  s_cmp_lt_u32 s36, 4
  s_cbranch_scc1 MK_common2
  s_sub_u32 s97, s36, 4
  v_lshrrev_b32 v1, 3, v0
  v_mul_u32_u24 v1, 896, v1
  v_and_b32 v10, 7, v0
  v_lshrrev_b32 v11, 4, v0
  v_xor_b32 v10, v10, v11
  v_lshl_add_u32 v1, v10, 4, v1
  v_lshrrev_b32 v2, 3, v0
  v_mul_u32_u24 v2, 896, v2
  v_and_b32 v10, 7, v0
  v_lshrrev_b32 v11, 4, v0
  v_add_u32 v11, 4, v11
  v_xor_b32 v10, v10, v11
  v_lshl_add_u32 v2, v10, 4, v2
  s_lshl_b32 s14, s38, 7
  s_lshl_b32 s15, s97, 5
  s_add_u32 s14, s14, s15
  s_mul_i32 s14, s14, 896
  v_add_u32 v1, s14, v1
  s_add_u32 s14, s14, 7168
  v_add_u32 v2, s14, v2
  v_add_u32 v3, 14336, v1
  v_add_u32 v4, 14336, v2
  v_lshrrev_b32 v5, 3, v0
  v_mul_u32_u24 v5, 3584, v5
  v_and_b32 v10, 7, v0
  v_bfe_u32 v11, v0, 4, 1
  v_lshlrev_b32 v11, 2, v11
  v_xor_b32 v10, v10, v11
  v_lshl_add_u32 v5, v10, 4, v5
  s_mul_i32 s14, s97, 57344
  s_lshl_b32 s15, s37, 7
  s_add_u32 s14, s14, s15
  v_add_u32 v5, s14, v5
  v_add_u32 v6, 28672, v5
  s_lshl_b32 s64, s97, 11
  s_lshl_b32 s65, s97, 12
  s_lshl_b32 s66, s97, 10
  s_waitcnt lgkmcnt(0)
  s_mov_b32 s16, s48
  s_and_b32 s17, s49, 0xffff
  s_mov_b32 s18, 1835008
  s_mov_b32 s19, 0x20000
  s_mov_b32 s20, s56
  s_and_b32 s21, s57, 0xffff
  s_mov_b32 s22, 1605632
  s_mov_b32 s23, 0x20000
  s_lshl_b32 s54, s40, 7
  s_add_u32 m0, s65, 98304
  s_nop 0
  buffer_load_dwordx4 v1, s[16:19], s54 offen lds
  s_add_u32 m0, s65, 99328
  s_nop 0
  buffer_load_dwordx4 v2, s[16:19], s54 offen lds
  s_add_u32 m0, s65, 100352
  s_nop 0
  buffer_load_dwordx4 v3, s[16:19], s54 offen lds
  s_add_u32 m0, s65, 101376
  s_nop 0
  buffer_load_dwordx4 v4, s[16:19], s54 offen lds
  s_mul_i32 s54, s40, 229376
  s_add_u32 s54, s54, 1792
  s_add_u32 m0, s64, 0
  s_nop 0
  buffer_load_dwordx4 v5, s[20:23], s54 offen lds
  s_add_u32 m0, s64, 1024
  s_nop 0
  buffer_load_dwordx4 v6, s[20:23], s54 offen lds
  s_getpc_b64 s[28:29]
  s_add_u32 s28, s28, tab0@rel32@lo+4
  s_addc_u32 s29, s29, tab0@rel32@hi+12
  s_and_b32 s29, s29, 0xffff
  s_mov_b32 s30, 868352
  s_mov_b32 s31, 0x20000
  s_mov_b32 s96, 500000
  s_add_u32 s41, s40, 1
  s_cmp_eq_u32 s41, 7
  s_cselect_b32 s41, 0, s41
  s_add_u32 s42, s41, 1
  s_cmp_eq_u32 s42, 7
  s_cselect_b32 s42, 0, s42
  s_add_u32 s43, s42, 1
  s_cmp_eq_u32 s43, 7
  s_cselect_b32 s43, 0, s43
  s_add_u32 s44, s43, 1
  s_cmp_eq_u32 s44, 7
  s_cselect_b32 s44, 0, s44
  s_add_u32 s45, s44, 1
  s_cmp_eq_u32 s45, 7
  s_cselect_b32 s45, 0, s45
  s_add_u32 s46, s45, 1
  s_cmp_eq_u32 s46, 7
  s_cselect_b32 s46, 0, s46
  s_mul_i32 s14, s11, 9
  s_lshr_b32 s14, s14, 2
  s_lshl_b32 s15, s10, 2
  s_add_u32 s39, s14, s15
  s_mov_b32 s92, s11
  s_lshl_b32 s14, s12, 2
  s_lshl_b32 s15, s13, 3
  s_add_u32 s14, s14, s15
  s_add_u32 s93, s14, s10
  s_lshl_b32 s14, s11, 1
  s_mul_i32 s15, s10, 3
  s_add_u32 s94, s14, s15
  s_waitcnt lgkmcnt(0)
  s_mov_b32 s16, s48
  s_and_b32 s17, s49, 0xffff
  s_mov_b32 s18, 1835008
  s_mov_b32 s19, 0x20000
  s_mov_b32 s20, s56
  s_and_b32 s21, s57, 0xffff
  s_mov_b32 s22, 1605632
  s_mov_b32 s23, 0x20000
  s_mov_b32 s24, s88
  s_and_b32 s25, s89, 0xffff
  s_mov_b32 s26, 20971520
  s_mov_b32 s27, 0x20000
  s_mov_b32 s32, s86
  s_and_b32 s33, s87, 0xffff
  s_mov_b32 s34, 256
  s_mov_b32 s35, 0x20000
  s_mov_b32 s68, s58
  s_and_b32 s69, s59, 0xffff
  s_mov_b32 s70, 8388608
  s_mov_b32 s71, 0x20000
  s_mov_b32 s72, s60
  s_and_b32 s73, s61, 0xffff
  s_mov_b32 s74, 4096
  s_mov_b32 s75, 0x20000
  s_mov_b32 s76, s62
  s_and_b32 s77, s63, 0xffff
  s_mov_b32 s78, 802816
  s_mov_b32 s79, 0x20000
  s_mov_b32 s80, s84
  s_and_b32 s81, s85, 0xffff
  s_mov_b32 s82, 1835008
  s_mov_b32 s83, 0x20000
  s_mov_b32 s4, s50
  s_and_b32 s5, s51, 0xffff
  s_mov_b32 s6, 921600
  s_mov_b32 s7, 0x20000
  s_mov_b32 s84, s52
  s_and_b32 s85, s53, 0xffff
  s_mov_b32 s86, 921600
  s_mov_b32 s87, 0x20000
  s_mov_b32 s36, s97
  s_lshl_b32 s54, s41, 7
  s_add_u32 m0, s65, 114688
  s_nop 0
  buffer_load_dwordx4 v1, s[16:19], s54 offen lds
  s_add_u32 m0, s65, 115712
  s_nop 0
  buffer_load_dwordx4 v2, s[16:19], s54 offen lds
  s_add_u32 m0, s65, 116736
  s_nop 0
  buffer_load_dwordx4 v3, s[16:19], s54 offen lds
  s_add_u32 m0, s65, 117760
  s_nop 0
  buffer_load_dwordx4 v4, s[16:19], s54 offen lds
  s_mul_i32 s54, s41, 229376
  s_add_u32 s54, s54, 1792
  s_add_u32 m0, s64, 8192
  s_nop 0
  buffer_load_dwordx4 v5, s[20:23], s54 offen lds
  s_add_u32 m0, s64, 9216
  s_nop 0
  buffer_load_dwordx4 v6, s[20:23], s54 offen lds
  v_lshrrev_b32 v22, 3, v0
  v_mul_u32_u24 v22, 4096, v22
  v_and_b32 v10, 7, v0
  v_lshrrev_b32 v11, 4, v0
  v_xor_b32 v10, v10, v11
  v_lshl_add_u32 v22, v10, 4, v22
  v_lshrrev_b32 v23, 3, v0
  v_mul_u32_u24 v23, 4096, v23
  v_and_b32 v10, 7, v0
  v_lshrrev_b32 v11, 4, v0
  v_add_u32 v11, 4, v11
  v_xor_b32 v10, v10, v11
  v_lshl_add_u32 v23, v10, 4, v23
  s_lshl_b32 s8, s38, 7
  s_and_b32 s9, s36, 1
  s_lshl_b32 s59, s9, 13
  s_lshl_b32 s9, s9, 6
  s_add_u32 s8, s8, s9
  s_lshl_b32 s8, s8, 12
  v_add_u32 v22, s8, v22
  s_add_u32 s8, s8, 32768
  v_add_u32 v23, s8, v23
  s_cmp_lt_u32 s36, 2
  s_cbranch_scc1 MK_roleD
  v_lshlrev_b32 v10, 3, v0
  v_mov_b32 v12, 0
  v_mov_b32 v13, 0
  ds_write_b64 v12, v[12:13] offset:60928
  ds_write_b64 v12, v[12:13] offset:60936
  ds_write_b64 v12, v[12:13] offset:60944
  ds_write_b64 v12, v[12:13] offset:60952
  ds_write_b64 v12, v[12:13] offset:60960
  ds_write_b64 v12, v[12:13] offset:60968
  v_lshrrev_b32 v10, 5, v0
  v_bfe_u32 v11, v0, 2, 2
  v_lshl_add_u32 v17, v10, 3, v11
  v_lshlrev_b32 v17, 7, v17
  v_lshrrev_b32 v11, 1, v11
  v_lshl_add_u32 v17, v11, 6, v17
  v_bfe_u32 v11, v0, 4, 1
  v_lshl_add_u32 v17, v11, 5, v17
  v_and_b32 v11, 3, v0
  v_lshl_add_u32 v17, v11, 3, v17
  s_and_b32 s8, s36, 1
  s_lshl_b32 s8, s8, 6
  v_xor_b32 v17, s8, v17
  v_mov_b32 v18, 0
  v_mov_b32 v19, 0
  s_waitcnt lgkmcnt(0)
  s_add_u32 s60, s2, 224
  s_cmp_eq_u32 s36, 3
  s_cselect_b32 s60, s2, s60
  s_lshr_b32 s61, s60, 4
  s_bfe_u32 s62, s60, 0x20002
  s_lshl_b32 s62, s62, 3
  s_and_b32 s63, s60, 3
  s_lshl_b32 s63, s63, 6
  v_add_u32 v128, s63, v0
  v_lshlrev_b32 v128, 1, v128
  s_lshl_b32 s8, s61, 7
  s_add_u32 s8, s8, s62
  s_mul_i32 s8, s8, 450
  s_add_u32 s88, s8, 0
  s_add_u32 s89, s8, 14400
  s_add_u32 s90, s8, 28800
  s_add_u32 s91, s8, 43200
  s_waitcnt vmcnt(6)
  s_barrier
  ds_read_b64_tr_b16 v[24:25], v17 offset:0
  ds_read_b64_tr_b16 v[26:27], v17 offset:512
  ds_read_b64_tr_b16 v[28:29], v17 offset:2048
  ds_read_b64_tr_b16 v[30:31], v17 offset:2560
  ds_read_b64_tr_b16 v[32:33], v17 offset:4096
  ds_read_b64_tr_b16 v[34:35], v17 offset:4608
  ds_read_b64_tr_b16 v[36:37], v17 offset:6144
  ds_read_b64_tr_b16 v[38:39], v17 offset:6656
  s_waitcnt lgkmcnt(0)
  v_lshlrev_b32 v20, 16, v24
  v_and_b32 v21, 0xffff0000, v24
  v_add_f32 v18, v18, v20
  v_add_f32 v19, v19, v21
  v_lshlrev_b32 v20, 16, v25
  v_and_b32 v21, 0xffff0000, v25
  v_add_f32 v18, v18, v20
  v_add_f32 v19, v19, v21
  v_lshlrev_b32 v20, 16, v26
  v_and_b32 v21, 0xffff0000, v26
  v_add_f32 v18, v18, v20
  v_add_f32 v19, v19, v21
  v_lshlrev_b32 v20, 16, v27
  v_and_b32 v21, 0xffff0000, v27
  v_add_f32 v18, v18, v20
  v_add_f32 v19, v19, v21
  v_lshlrev_b32 v20, 16, v28
  v_and_b32 v21, 0xffff0000, v28
  v_add_f32 v18, v18, v20
  v_add_f32 v19, v19, v21
  v_lshlrev_b32 v20, 16, v29
  v_and_b32 v21, 0xffff0000, v29
  v_add_f32 v18, v18, v20
  v_add_f32 v19, v19, v21
  v_lshlrev_b32 v20, 16, v30
  v_and_b32 v21, 0xffff0000, v30
  v_add_f32 v18, v18, v20
  v_add_f32 v19, v19, v21
  v_lshlrev_b32 v20, 16, v31
  v_and_b32 v21, 0xffff0000, v31
  v_add_f32 v18, v18, v20
  v_add_f32 v19, v19, v21
  v_lshlrev_b32 v20, 16, v32
  v_and_b32 v21, 0xffff0000, v32
  v_add_f32 v18, v18, v20
  v_add_f32 v19, v19, v21
  v_lshlrev_b32 v20, 16, v33
  v_and_b32 v21, 0xffff0000, v33
  v_add_f32 v18, v18, v20
  v_add_f32 v19, v19, v21
  v_lshlrev_b32 v20, 16, v34
  v_and_b32 v21, 0xffff0000, v34
  v_add_f32 v18, v18, v20
  v_add_f32 v19, v19, v21
  v_lshlrev_b32 v20, 16, v35
  v_and_b32 v21, 0xffff0000, v35
  v_add_f32 v18, v18, v20
  v_add_f32 v19, v19, v21
  v_lshlrev_b32 v20, 16, v36
  v_and_b32 v21, 0xffff0000, v36
  v_add_f32 v18, v18, v20
  v_add_f32 v19, v19, v21
  v_lshlrev_b32 v20, 16, v37
  v_and_b32 v21, 0xffff0000, v37
  v_add_f32 v18, v18, v20
  v_add_f32 v19, v19, v21
  v_lshlrev_b32 v20, 16, v38
  v_and_b32 v21, 0xffff0000, v38
  v_add_f32 v18, v18, v20
  v_add_f32 v19, v19, v21
  v_lshlrev_b32 v20, 16, v39
  v_and_b32 v21, 0xffff0000, v39
  v_add_f32 v18, v18, v20
  v_add_f32 v19, v19, v21
  s_waitcnt vmcnt(0)
  s_barrier
  ds_read_b64_tr_b16 v[24:25], v17 offset:8192
  ds_read_b64_tr_b16 v[26:27], v17 offset:8704
  ds_read_b64_tr_b16 v[28:29], v17 offset:10240
  ds_read_b64_tr_b16 v[30:31], v17 offset:10752
  ds_read_b64_tr_b16 v[32:33], v17 offset:12288
  ds_read_b64_tr_b16 v[34:35], v17 offset:12800
  ds_read_b64_tr_b16 v[36:37], v17 offset:14336
  ds_read_b64_tr_b16 v[38:39], v17 offset:14848
  s_waitcnt lgkmcnt(0)
  v_lshlrev_b32 v20, 16, v24
  v_and_b32 v21, 0xffff0000, v24
  v_add_f32 v18, v18, v20
  v_add_f32 v19, v19, v21
  v_lshlrev_b32 v20, 16, v25
  v_and_b32 v21, 0xffff0000, v25
  v_add_f32 v18, v18, v20
  v_add_f32 v19, v19, v21
  v_lshlrev_b32 v20, 16, v26
  v_and_b32 v21, 0xffff0000, v26
  v_add_f32 v18, v18, v20
  v_add_f32 v19, v19, v21
  v_lshlrev_b32 v20, 16, v27
  v_and_b32 v21, 0xffff0000, v27
  v_add_f32 v18, v18, v20
  v_add_f32 v19, v19, v21
  v_lshlrev_b32 v20, 16, v28
  v_and_b32 v21, 0xffff0000, v28
  v_add_f32 v18, v18, v20
  v_add_f32 v19, v19, v21
  v_lshlrev_b32 v20, 16, v29
  v_and_b32 v21, 0xffff0000, v29
  v_add_f32 v18, v18, v20
  v_add_f32 v19, v19, v21
  v_lshlrev_b32 v20, 16, v30
  v_and_b32 v21, 0xffff0000, v30
  v_add_f32 v18, v18, v20
  v_add_f32 v19, v19, v21
  v_lshlrev_b32 v20, 16, v31
  v_and_b32 v21, 0xffff0000, v31
  v_add_f32 v18, v18, v20
  v_add_f32 v19, v19, v21
  v_lshlrev_b32 v20, 16, v32
  v_and_b32 v21, 0xffff0000, v32
  v_add_f32 v18, v18, v20
  v_add_f32 v19, v19, v21
  v_lshlrev_b32 v20, 16, v33
  v_and_b32 v21, 0xffff0000, v33
  v_add_f32 v18, v18, v20
  v_add_f32 v19, v19, v21
  v_lshlrev_b32 v20, 16, v34
  v_and_b32 v21, 0xffff0000, v34
  v_add_f32 v18, v18, v20
  v_add_f32 v19, v19, v21
  v_lshlrev_b32 v20, 16, v35
  v_and_b32 v21, 0xffff0000, v35
  v_add_f32 v18, v18, v20
  v_add_f32 v19, v19, v21
  v_lshlrev_b32 v20, 16, v36
  v_and_b32 v21, 0xffff0000, v36
  v_add_f32 v18, v18, v20
  v_add_f32 v19, v19, v21
  v_lshlrev_b32 v20, 16, v37
  v_and_b32 v21, 0xffff0000, v37
  v_add_f32 v18, v18, v20
  v_add_f32 v19, v19, v21
  v_lshlrev_b32 v20, 16, v38
  v_and_b32 v21, 0xffff0000, v38
  v_add_f32 v18, v18, v20
  v_add_f32 v19, v19, v21
  v_lshlrev_b32 v20, 16, v39
  v_and_b32 v21, 0xffff0000, v39
  v_add_f32 v18, v18, v20
  v_add_f32 v19, v19, v21
  s_barrier
  ds_read_b64_tr_b16 v[24:25], v17 offset:16384
  ds_read_b64_tr_b16 v[26:27], v17 offset:16896
  ds_read_b64_tr_b16 v[28:29], v17 offset:18432
  ds_read_b64_tr_b16 v[30:31], v17 offset:18944
  ds_read_b64_tr_b16 v[32:33], v17 offset:20480
  ds_read_b64_tr_b16 v[34:35], v17 offset:20992
  ds_read_b64_tr_b16 v[36:37], v17 offset:22528
  ds_read_b64_tr_b16 v[38:39], v17 offset:23040
  s_waitcnt lgkmcnt(0)
  v_lshlrev_b32 v20, 16, v24
  v_and_b32 v21, 0xffff0000, v24
  v_add_f32 v18, v18, v20
  v_add_f32 v19, v19, v21
  v_lshlrev_b32 v20, 16, v25
  v_and_b32 v21, 0xffff0000, v25
  v_add_f32 v18, v18, v20
  v_add_f32 v19, v19, v21
  v_lshlrev_b32 v20, 16, v26
  v_and_b32 v21, 0xffff0000, v26
  v_add_f32 v18, v18, v20
  v_add_f32 v19, v19, v21
  v_lshlrev_b32 v20, 16, v27
  v_and_b32 v21, 0xffff0000, v27
  v_add_f32 v18, v18, v20
  v_add_f32 v19, v19, v21
  v_lshlrev_b32 v20, 16, v28
  v_and_b32 v21, 0xffff0000, v28
  v_add_f32 v18, v18, v20
  v_add_f32 v19, v19, v21
  v_lshlrev_b32 v20, 16, v29
  v_and_b32 v21, 0xffff0000, v29
  v_add_f32 v18, v18, v20
  v_add_f32 v19, v19, v21
  v_lshlrev_b32 v20, 16, v30
  v_and_b32 v21, 0xffff0000, v30
  v_add_f32 v18, v18, v20
  v_add_f32 v19, v19, v21
  v_lshlrev_b32 v20, 16, v31
  v_and_b32 v21, 0xffff0000, v31
  v_add_f32 v18, v18, v20
  v_add_f32 v19, v19, v21
  v_lshlrev_b32 v20, 16, v32
  v_and_b32 v21, 0xffff0000, v32
  v_add_f32 v18, v18, v20
  v_add_f32 v19, v19, v21
  v_lshlrev_b32 v20, 16, v33
  v_and_b32 v21, 0xffff0000, v33
  v_add_f32 v18, v18, v20
  v_add_f32 v19, v19, v21
  v_lshlrev_b32 v20, 16, v34
  v_and_b32 v21, 0xffff0000, v34
  v_add_f32 v18, v18, v20
  v_add_f32 v19, v19, v21
  v_lshlrev_b32 v20, 16, v35
  v_and_b32 v21, 0xffff0000, v35
  v_add_f32 v18, v18, v20
  v_add_f32 v19, v19, v21
  v_lshlrev_b32 v20, 16, v36
  v_and_b32 v21, 0xffff0000, v36
  v_add_f32 v18, v18, v20
  v_add_f32 v19, v19, v21
  v_lshlrev_b32 v20, 16, v37
  v_and_b32 v21, 0xffff0000, v37
  v_add_f32 v18, v18, v20
  v_add_f32 v19, v19, v21
  v_lshlrev_b32 v20, 16, v38
  v_and_b32 v21, 0xffff0000, v38
  v_add_f32 v18, v18, v20
  v_add_f32 v19, v19, v21
  v_lshlrev_b32 v20, 16, v39
  v_and_b32 v21, 0xffff0000, v39
  v_add_f32 v18, v18, v20
  v_add_f32 v19, v19, v21
  s_barrier
  ds_read_b64_tr_b16 v[24:25], v17 offset:24576
  ds_read_b64_tr_b16 v[26:27], v17 offset:25088
  ds_read_b64_tr_b16 v[28:29], v17 offset:26624
  ds_read_b64_tr_b16 v[30:31], v17 offset:27136
  ds_read_b64_tr_b16 v[32:33], v17 offset:28672
  ds_read_b64_tr_b16 v[34:35], v17 offset:29184
  ds_read_b64_tr_b16 v[36:37], v17 offset:30720
  ds_read_b64_tr_b16 v[38:39], v17 offset:31232
  s_waitcnt lgkmcnt(0)
  v_lshlrev_b32 v20, 16, v24
  v_and_b32 v21, 0xffff0000, v24
  v_add_f32 v18, v18, v20
  v_add_f32 v19, v19, v21
  v_lshlrev_b32 v20, 16, v25
  v_and_b32 v21, 0xffff0000, v25
  v_add_f32 v18, v18, v20
  v_add_f32 v19, v19, v21
  v_lshlrev_b32 v20, 16, v26
  v_and_b32 v21, 0xffff0000, v26
  v_add_f32 v18, v18, v20
  v_add_f32 v19, v19, v21
  v_lshlrev_b32 v20, 16, v27
  v_and_b32 v21, 0xffff0000, v27
  v_add_f32 v18, v18, v20
  v_add_f32 v19, v19, v21
  v_lshlrev_b32 v20, 16, v28
  v_and_b32 v21, 0xffff0000, v28
  v_add_f32 v18, v18, v20
  v_add_f32 v19, v19, v21
  v_lshlrev_b32 v20, 16, v29
  v_and_b32 v21, 0xffff0000, v29
  v_add_f32 v18, v18, v20
  v_add_f32 v19, v19, v21
  v_lshlrev_b32 v20, 16, v30
  v_and_b32 v21, 0xffff0000, v30
  v_add_f32 v18, v18, v20
  v_add_f32 v19, v19, v21
  v_lshlrev_b32 v20, 16, v31
  v_and_b32 v21, 0xffff0000, v31
  v_add_f32 v18, v18, v20
  v_add_f32 v19, v19, v21
  v_lshlrev_b32 v20, 16, v32
  v_and_b32 v21, 0xffff0000, v32
  v_add_f32 v18, v18, v20
  v_add_f32 v19, v19, v21
  v_lshlrev_b32 v20, 16, v33
  v_and_b32 v21, 0xffff0000, v33
  v_add_f32 v18, v18, v20
  v_add_f32 v19, v19, v21
  v_lshlrev_b32 v20, 16, v34
  v_and_b32 v21, 0xffff0000, v34
  v_add_f32 v18, v18, v20
  v_add_f32 v19, v19, v21
  v_lshlrev_b32 v20, 16, v35
  v_and_b32 v21, 0xffff0000, v35
  v_add_f32 v18, v18, v20
  v_add_f32 v19, v19, v21
  v_lshlrev_b32 v20, 16, v36
  v_and_b32 v21, 0xffff0000, v36
  v_add_f32 v18, v18, v20
  v_add_f32 v19, v19, v21
  v_lshlrev_b32 v20, 16, v37
  v_and_b32 v21, 0xffff0000, v37
  v_add_f32 v18, v18, v20
  v_add_f32 v19, v19, v21
  v_lshlrev_b32 v20, 16, v38
  v_and_b32 v21, 0xffff0000, v38
  v_add_f32 v18, v18, v20
  v_add_f32 v19, v19, v21
  v_lshlrev_b32 v20, 16, v39
  v_and_b32 v21, 0xffff0000, v39
  v_add_f32 v18, v18, v20
  v_add_f32 v19, v19, v21
  s_barrier
  ds_read_b64_tr_b16 v[24:25], v17 offset:32768
  ds_read_b64_tr_b16 v[26:27], v17 offset:33280
  ds_read_b64_tr_b16 v[28:29], v17 offset:34816
  ds_read_b64_tr_b16 v[30:31], v17 offset:35328
  ds_read_b64_tr_b16 v[32:33], v17 offset:36864
  ds_read_b64_tr_b16 v[34:35], v17 offset:37376
  ds_read_b64_tr_b16 v[36:37], v17 offset:38912
  ds_read_b64_tr_b16 v[38:39], v17 offset:39424
  s_waitcnt lgkmcnt(0)
  v_lshlrev_b32 v20, 16, v24
  v_and_b32 v21, 0xffff0000, v24
  v_add_f32 v18, v18, v20
  v_add_f32 v19, v19, v21
  v_lshlrev_b32 v20, 16, v25
  v_and_b32 v21, 0xffff0000, v25
  v_add_f32 v18, v18, v20
  v_add_f32 v19, v19, v21
  v_lshlrev_b32 v20, 16, v26
  v_and_b32 v21, 0xffff0000, v26
  v_add_f32 v18, v18, v20
  v_add_f32 v19, v19, v21
  v_lshlrev_b32 v20, 16, v27
  v_and_b32 v21, 0xffff0000, v27
  v_add_f32 v18, v18, v20
  v_add_f32 v19, v19, v21
  v_lshlrev_b32 v20, 16, v28
  v_and_b32 v21, 0xffff0000, v28
  v_add_f32 v18, v18, v20
  v_add_f32 v19, v19, v21
  v_lshlrev_b32 v20, 16, v29
  v_and_b32 v21, 0xffff0000, v29
  v_add_f32 v18, v18, v20
  v_add_f32 v19, v19, v21
  v_lshlrev_b32 v20, 16, v30
  v_and_b32 v21, 0xffff0000, v30
  v_add_f32 v18, v18, v20
  v_add_f32 v19, v19, v21
  v_lshlrev_b32 v20, 16, v31
  v_and_b32 v21, 0xffff0000, v31
  v_add_f32 v18, v18, v20
  v_add_f32 v19, v19, v21
  v_lshlrev_b32 v20, 16, v32
  v_and_b32 v21, 0xffff0000, v32
  v_add_f32 v18, v18, v20
  v_add_f32 v19, v19, v21
  v_lshlrev_b32 v20, 16, v33
  v_and_b32 v21, 0xffff0000, v33
  v_add_f32 v18, v18, v20
  v_add_f32 v19, v19, v21
  v_lshlrev_b32 v20, 16, v34
  v_and_b32 v21, 0xffff0000, v34
  v_add_f32 v18, v18, v20
  v_add_f32 v19, v19, v21
  v_lshlrev_b32 v20, 16, v35
  v_and_b32 v21, 0xffff0000, v35
  v_add_f32 v18, v18, v20
  v_add_f32 v19, v19, v21
  v_lshlrev_b32 v20, 16, v36
  v_and_b32 v21, 0xffff0000, v36
  v_add_f32 v18, v18, v20
  v_add_f32 v19, v19, v21
  v_lshlrev_b32 v20, 16, v37
  v_and_b32 v21, 0xffff0000, v37
  v_add_f32 v18, v18, v20
  v_add_f32 v19, v19, v21
  v_lshlrev_b32 v20, 16, v38
  v_and_b32 v21, 0xffff0000, v38
  v_add_f32 v18, v18, v20
  v_add_f32 v19, v19, v21
  v_lshlrev_b32 v20, 16, v39
  v_and_b32 v21, 0xffff0000, v39
  v_add_f32 v18, v18, v20
  v_add_f32 v19, v19, v21
  s_barrier
  ds_read_b64_tr_b16 v[24:25], v17 offset:40960
  ds_read_b64_tr_b16 v[26:27], v17 offset:41472
  ds_read_b64_tr_b16 v[28:29], v17 offset:43008
  ds_read_b64_tr_b16 v[30:31], v17 offset:43520
  ds_read_b64_tr_b16 v[32:33], v17 offset:45056
  ds_read_b64_tr_b16 v[34:35], v17 offset:45568
  ds_read_b64_tr_b16 v[36:37], v17 offset:47104
  ds_read_b64_tr_b16 v[38:39], v17 offset:47616
  s_waitcnt lgkmcnt(0)
  v_lshlrev_b32 v20, 16, v24
  v_and_b32 v21, 0xffff0000, v24
  v_add_f32 v18, v18, v20
  v_add_f32 v19, v19, v21
  v_lshlrev_b32 v20, 16, v25
  v_and_b32 v21, 0xffff0000, v25
  v_add_f32 v18, v18, v20
  v_add_f32 v19, v19, v21
  v_lshlrev_b32 v20, 16, v26
  v_and_b32 v21, 0xffff0000, v26
  v_add_f32 v18, v18, v20
  v_add_f32 v19, v19, v21
  v_lshlrev_b32 v20, 16, v27
  v_and_b32 v21, 0xffff0000, v27
  v_add_f32 v18, v18, v20
  v_add_f32 v19, v19, v21
  v_lshlrev_b32 v20, 16, v28
  v_and_b32 v21, 0xffff0000, v28
  v_add_f32 v18, v18, v20
  v_add_f32 v19, v19, v21
  v_lshlrev_b32 v20, 16, v29
  v_and_b32 v21, 0xffff0000, v29
  v_add_f32 v18, v18, v20
  v_add_f32 v19, v19, v21
  v_lshlrev_b32 v20, 16, v30
  v_and_b32 v21, 0xffff0000, v30
  v_add_f32 v18, v18, v20
  v_add_f32 v19, v19, v21
  v_lshlrev_b32 v20, 16, v31
  v_and_b32 v21, 0xffff0000, v31
  v_add_f32 v18, v18, v20
  v_add_f32 v19, v19, v21
  v_lshlrev_b32 v20, 16, v32
  v_and_b32 v21, 0xffff0000, v32
  v_add_f32 v18, v18, v20
  v_add_f32 v19, v19, v21
  v_lshlrev_b32 v20, 16, v33
  v_and_b32 v21, 0xffff0000, v33
  v_add_f32 v18, v18, v20
  v_add_f32 v19, v19, v21
  v_lshlrev_b32 v20, 16, v34
  v_and_b32 v21, 0xffff0000, v34
  v_add_f32 v18, v18, v20
  v_add_f32 v19, v19, v21
  v_lshlrev_b32 v20, 16, v35
  v_and_b32 v21, 0xffff0000, v35
  v_add_f32 v18, v18, v20
  v_add_f32 v19, v19, v21
  v_lshlrev_b32 v20, 16, v36
  v_and_b32 v21, 0xffff0000, v36
  v_add_f32 v18, v18, v20
  v_add_f32 v19, v19, v21
  v_lshlrev_b32 v20, 16, v37
  v_and_b32 v21, 0xffff0000, v37
  v_add_f32 v18, v18, v20
  v_add_f32 v19, v19, v21
  v_lshlrev_b32 v20, 16, v38
  v_and_b32 v21, 0xffff0000, v38
  v_add_f32 v18, v18, v20
  v_add_f32 v19, v19, v21
  v_lshlrev_b32 v20, 16, v39
  v_and_b32 v21, 0xffff0000, v39
  v_add_f32 v18, v18, v20
  v_add_f32 v19, v19, v21
  s_barrier
  ds_read_b64_tr_b16 v[24:25], v17 offset:49152
  ds_read_b64_tr_b16 v[26:27], v17 offset:49664
  ds_read_b64_tr_b16 v[28:29], v17 offset:51200
  ds_read_b64_tr_b16 v[30:31], v17 offset:51712
  ds_read_b64_tr_b16 v[32:33], v17 offset:53248
  ds_read_b64_tr_b16 v[34:35], v17 offset:53760
  ds_read_b64_tr_b16 v[36:37], v17 offset:55296
  ds_read_b64_tr_b16 v[38:39], v17 offset:55808
  s_waitcnt lgkmcnt(0)
  v_lshlrev_b32 v20, 16, v24
  v_and_b32 v21, 0xffff0000, v24
  v_add_f32 v18, v18, v20
  v_add_f32 v19, v19, v21
  v_lshlrev_b32 v20, 16, v25
  v_and_b32 v21, 0xffff0000, v25
  v_add_f32 v18, v18, v20
  v_add_f32 v19, v19, v21
  v_lshlrev_b32 v20, 16, v26
  v_and_b32 v21, 0xffff0000, v26
  v_add_f32 v18, v18, v20
  v_add_f32 v19, v19, v21
  v_lshlrev_b32 v20, 16, v27
  v_and_b32 v21, 0xffff0000, v27
  v_add_f32 v18, v18, v20
  v_add_f32 v19, v19, v21
  v_lshlrev_b32 v20, 16, v28
  v_and_b32 v21, 0xffff0000, v28
  v_add_f32 v18, v18, v20
  v_add_f32 v19, v19, v21
  v_lshlrev_b32 v20, 16, v29
  v_and_b32 v21, 0xffff0000, v29
  v_add_f32 v18, v18, v20
  v_add_f32 v19, v19, v21
  v_lshlrev_b32 v20, 16, v30
  v_and_b32 v21, 0xffff0000, v30
  v_add_f32 v18, v18, v20
  v_add_f32 v19, v19, v21
  v_lshlrev_b32 v20, 16, v31
  v_and_b32 v21, 0xffff0000, v31
  v_add_f32 v18, v18, v20
  v_add_f32 v19, v19, v21
  v_lshlrev_b32 v20, 16, v32
  v_and_b32 v21, 0xffff0000, v32
  v_add_f32 v18, v18, v20
  v_add_f32 v19, v19, v21
  v_lshlrev_b32 v20, 16, v33
  v_and_b32 v21, 0xffff0000, v33
  v_add_f32 v18, v18, v20
  v_add_f32 v19, v19, v21
  v_lshlrev_b32 v20, 16, v34
  v_and_b32 v21, 0xffff0000, v34
  v_add_f32 v18, v18, v20
  v_add_f32 v19, v19, v21
  v_lshlrev_b32 v20, 16, v35
  v_and_b32 v21, 0xffff0000, v35
  v_add_f32 v18, v18, v20
  v_add_f32 v19, v19, v21
  v_lshlrev_b32 v20, 16, v36
  v_and_b32 v21, 0xffff0000, v36
  v_add_f32 v18, v18, v20
  v_add_f32 v19, v19, v21
  v_lshlrev_b32 v20, 16, v37
  v_and_b32 v21, 0xffff0000, v37
  v_add_f32 v18, v18, v20
  v_add_f32 v19, v19, v21
  v_lshlrev_b32 v20, 16, v38
  v_and_b32 v21, 0xffff0000, v38
  v_add_f32 v18, v18, v20
  v_add_f32 v19, v19, v21
  v_lshlrev_b32 v20, 16, v39
  v_and_b32 v21, 0xffff0000, v39
  v_add_f32 v18, v18, v20
  v_add_f32 v19, v19, v21
  v_add_f32 v19, v18, v19
  v_mov_b32 v21, v19
  s_nop 1
  v_permlane32_swap_b32 v19, v21
  v_add_f32 v19, v19, v21
  v_and_b32 v21, 31, v0
  v_lshlrev_b32 v21, 2, v21
  s_and_b32 s8, s36, 1
  s_lshl_b32 s8, s8, 7
  v_add_u32 v21, s8, v21
  ds_write_b32 v21, v19 offset:57344
  v_mov_b32 v14, v5
  v_mov_b32 v15, v6
  v_subrev_u32 v16, 114688, v14
  v_subrev_u32 v7, 114688, v15
  v_lshrrev_b32 v1, 3, v0
  v_mul_u32_u24 v1, 1792, v1
  v_and_b32 v10, 7, v0
  v_bfe_u32 v11, v0, 4, 1
  v_lshlrev_b32 v11, 2, v11
  v_xor_b32 v10, v10, v11
  v_lshl_add_u32 v1, v10, 4, v1
  s_mul_i32 s8, s36, 28672
  s_lshl_b32 s9, s37, 7
  s_add_u32 s8, s8, s9
  s_add_u32 s8, s8, 4194304
  v_add_u32 v1, s8, v1
  v_add_u32 v2, 14336, v1
  s_lshr_b32 s8, s36, 1
  s_lshl_b32 s9, s8, 12
  s_add_u32 s58, s59, s9
  s_lshl_b32 s8, s8, 17
  v_add_u32 v3, s8, v22
  v_add_u32 v4, s8, v23
  v_add_u32 v5, 65536, v3
  v_add_u32 v6, 65536, v4
  v_lshlrev_b32 v12, 4, v0
  v_add_u32 v12, s59, v12
  v_add_u32 v13, 98304, v12
  s_waitcnt lgkmcnt(0)
  s_barrier
  s_mul_i32 s54, s40, 229376
  s_add_u32 m0, s64, 0
  s_nop 0
  buffer_load_dwordx4 v14, s[20:23], s54 offen lds
  s_add_u32 m0, s64, 1024
  s_nop 0
  buffer_load_dwordx4 v15, s[20:23], s54 offen lds
  s_add_u32 m0, s64, -4096
  s_nop 0
  buffer_load_dwordx4 v16, s[20:23], s54 offen lds
  s_add_u32 m0, s64, -3072
  s_nop 0
  buffer_load_dwordx4 v7, s[20:23], s54 offen lds
  s_mul_i32 s54, s41, 229376
  s_add_u32 m0, s64, 8192
  s_nop 0
  buffer_load_dwordx4 v14, s[20:23], s54 offen lds
  s_add_u32 m0, s64, 9216
  s_nop 0
  buffer_load_dwordx4 v15, s[20:23], s54 offen lds
  s_add_u32 m0, s64, 4096
  s_nop 0
  buffer_load_dwordx4 v16, s[20:23], s54 offen lds
  s_add_u32 m0, s64, 5120
  s_nop 0
  buffer_load_dwordx4 v7, s[20:23], s54 offen lds
  s_mul_i32 s54, s42, 229376
  s_add_u32 m0, s64, 16384
  s_nop 0
  buffer_load_dwordx4 v14, s[20:23], s54 offen lds
  s_add_u32 m0, s64, 17408
  s_nop 0
  buffer_load_dwordx4 v15, s[20:23], s54 offen lds
  s_add_u32 m0, s64, 12288
  s_nop 0
  buffer_load_dwordx4 v16, s[20:23], s54 offen lds
  s_add_u32 m0, s64, 13312
  s_nop 0
  buffer_load_dwordx4 v7, s[20:23], s54 offen lds
  s_mul_i32 s54, s43, 229376
  s_add_u32 m0, s64, 24576
  s_nop 0
  buffer_load_dwordx4 v14, s[20:23], s54 offen lds
  s_add_u32 m0, s64, 25600
  s_nop 0
  buffer_load_dwordx4 v15, s[20:23], s54 offen lds
  s_add_u32 m0, s64, 20480
  s_nop 0
  buffer_load_dwordx4 v16, s[20:23], s54 offen lds
  s_add_u32 m0, s64, 21504
  s_nop 0
  buffer_load_dwordx4 v7, s[20:23], s54 offen lds
  s_mul_i32 s54, s44, 229376
  s_add_u32 m0, s64, 32768
  s_nop 0
  buffer_load_dwordx4 v14, s[20:23], s54 offen lds
  s_add_u32 m0, s64, 33792
  s_nop 0
  buffer_load_dwordx4 v15, s[20:23], s54 offen lds
  s_add_u32 m0, s64, 28672
  s_nop 0
  buffer_load_dwordx4 v16, s[20:23], s54 offen lds
  s_add_u32 m0, s64, 29696
  s_nop 0
  buffer_load_dwordx4 v7, s[20:23], s54 offen lds
  s_mul_i32 s54, s45, 229376
  s_add_u32 m0, s64, 40960
  s_nop 0
  buffer_load_dwordx4 v14, s[20:23], s54 offen lds
  s_add_u32 m0, s64, 41984
  s_nop 0
  buffer_load_dwordx4 v15, s[20:23], s54 offen lds
  s_add_u32 m0, s64, 36864
  s_nop 0
  buffer_load_dwordx4 v16, s[20:23], s54 offen lds
  s_add_u32 m0, s64, 37888
  s_nop 0
  buffer_load_dwordx4 v7, s[20:23], s54 offen lds
  s_mul_i32 s54, s46, 229376
  s_add_u32 m0, s64, 49152
  s_nop 0
  buffer_load_dwordx4 v14, s[20:23], s54 offen lds
  s_add_u32 m0, s64, 50176
  s_nop 0
  buffer_load_dwordx4 v15, s[20:23], s54 offen lds
  s_add_u32 m0, s64, 45056
  s_nop 0
  buffer_load_dwordx4 v16, s[20:23], s54 offen lds
  s_add_u32 m0, s64, 46080
  s_nop 0
  buffer_load_dwordx4 v7, s[20:23], s54 offen lds
  s_waitcnt vmcnt(0)
  s_lshl_b32 s9, s36, 2
  v_mov_b32 v21, s9
  v_mov_b32 v9, 1
  ds_write_b32 v21, v9 offset:60936
  v_mov_b32 v8, 0
MK_bw1:
  ds_read_b64 v[10:11], v8 offset:60944
  s_waitcnt lgkmcnt(0)
  v_and_b32 v10, v10, v11
  v_cmp_ne_u32 vcc, 1, v10
  s_nop 4
  s_cbranch_vccz MK_bw1_ok
  s_sub_u32 s96, s96, 1
  s_cmp_eq_u32 s96, 0
  s_cbranch_scc1 MK_end
  s_sleep 1
  s_branch MK_bw1
MK_bw1_ok:
  v_mov_b32 v18, 0
  v_mov_b32 v19, 0
  ds_read_b64_tr_b16 v[24:25], v17 offset:0
  ds_read_b64_tr_b16 v[26:27], v17 offset:512
  ds_read_b64_tr_b16 v[28:29], v17 offset:2048
  ds_read_b64_tr_b16 v[30:31], v17 offset:2560
  ds_read_b64_tr_b16 v[32:33], v17 offset:4096
  ds_read_b64_tr_b16 v[34:35], v17 offset:4608
  ds_read_b64_tr_b16 v[36:37], v17 offset:6144
  ds_read_b64_tr_b16 v[38:39], v17 offset:6656
  ds_read_b64_tr_b16 v[40:41], v17 offset:8192
  ds_read_b64_tr_b16 v[42:43], v17 offset:8704
  ds_read_b64_tr_b16 v[44:45], v17 offset:10240
  ds_read_b64_tr_b16 v[46:47], v17 offset:10752
  ds_read_b64_tr_b16 v[48:49], v17 offset:12288
  ds_read_b64_tr_b16 v[50:51], v17 offset:12800
  ds_read_b64_tr_b16 v[52:53], v17 offset:14336
  ds_read_b64_tr_b16 v[54:55], v17 offset:14848
  s_waitcnt lgkmcnt(8)
  v_lshlrev_b32 v20, 16, v24
  v_and_b32 v21, 0xffff0000, v24
  v_add_f32 v18, v18, v20
  v_add_f32 v19, v19, v21
  v_lshlrev_b32 v20, 16, v25
  v_and_b32 v21, 0xffff0000, v25
  v_add_f32 v18, v18, v20
  v_add_f32 v19, v19, v21
  v_lshlrev_b32 v20, 16, v26
  v_and_b32 v21, 0xffff0000, v26
  v_add_f32 v18, v18, v20
  v_add_f32 v19, v19, v21
  v_lshlrev_b32 v20, 16, v27
  v_and_b32 v21, 0xffff0000, v27
  v_add_f32 v18, v18, v20
  v_add_f32 v19, v19, v21
  v_lshlrev_b32 v20, 16, v28
  v_and_b32 v21, 0xffff0000, v28
  v_add_f32 v18, v18, v20
  v_add_f32 v19, v19, v21
  v_lshlrev_b32 v20, 16, v29
  v_and_b32 v21, 0xffff0000, v29
  v_add_f32 v18, v18, v20
  v_add_f32 v19, v19, v21
  v_lshlrev_b32 v20, 16, v30
  v_and_b32 v21, 0xffff0000, v30
  v_add_f32 v18, v18, v20
  v_add_f32 v19, v19, v21
  v_lshlrev_b32 v20, 16, v31
  v_and_b32 v21, 0xffff0000, v31
  v_add_f32 v18, v18, v20
  v_add_f32 v19, v19, v21
  v_lshlrev_b32 v20, 16, v32
  v_and_b32 v21, 0xffff0000, v32
  v_add_f32 v18, v18, v20
  v_add_f32 v19, v19, v21
  v_lshlrev_b32 v20, 16, v33
  v_and_b32 v21, 0xffff0000, v33
  v_add_f32 v18, v18, v20
  v_add_f32 v19, v19, v21
  v_lshlrev_b32 v20, 16, v34
  v_and_b32 v21, 0xffff0000, v34
  v_add_f32 v18, v18, v20
  v_add_f32 v19, v19, v21
  v_lshlrev_b32 v20, 16, v35
  v_and_b32 v21, 0xffff0000, v35
  v_add_f32 v18, v18, v20
  v_add_f32 v19, v19, v21
  v_lshlrev_b32 v20, 16, v36
  v_and_b32 v21, 0xffff0000, v36
  v_add_f32 v18, v18, v20
  v_add_f32 v19, v19, v21
  v_lshlrev_b32 v20, 16, v37
  v_and_b32 v21, 0xffff0000, v37
  v_add_f32 v18, v18, v20
  v_add_f32 v19, v19, v21
  v_lshlrev_b32 v20, 16, v38
  v_and_b32 v21, 0xffff0000, v38
  v_add_f32 v18, v18, v20
  v_add_f32 v19, v19, v21
  v_lshlrev_b32 v20, 16, v39
  v_and_b32 v21, 0xffff0000, v39
  v_add_f32 v18, v18, v20
  v_add_f32 v19, v19, v21
  ds_read_b64_tr_b16 v[24:25], v17 offset:16384
  ds_read_b64_tr_b16 v[26:27], v17 offset:16896
  ds_read_b64_tr_b16 v[28:29], v17 offset:18432
  ds_read_b64_tr_b16 v[30:31], v17 offset:18944
  ds_read_b64_tr_b16 v[32:33], v17 offset:20480
  ds_read_b64_tr_b16 v[34:35], v17 offset:20992
  ds_read_b64_tr_b16 v[36:37], v17 offset:22528
  ds_read_b64_tr_b16 v[38:39], v17 offset:23040
  s_waitcnt lgkmcnt(8)
  v_lshlrev_b32 v20, 16, v40
  v_and_b32 v21, 0xffff0000, v40
  v_add_f32 v18, v18, v20
  v_add_f32 v19, v19, v21
  v_lshlrev_b32 v20, 16, v41
  v_and_b32 v21, 0xffff0000, v41
  v_add_f32 v18, v18, v20
  v_add_f32 v19, v19, v21
  v_lshlrev_b32 v20, 16, v42
  v_and_b32 v21, 0xffff0000, v42
  v_add_f32 v18, v18, v20
  v_add_f32 v19, v19, v21
  v_lshlrev_b32 v20, 16, v43
  v_and_b32 v21, 0xffff0000, v43
  v_add_f32 v18, v18, v20
  v_add_f32 v19, v19, v21
  v_lshlrev_b32 v20, 16, v44
  v_and_b32 v21, 0xffff0000, v44
  v_add_f32 v18, v18, v20
  v_add_f32 v19, v19, v21
  v_lshlrev_b32 v20, 16, v45
  v_and_b32 v21, 0xffff0000, v45
  v_add_f32 v18, v18, v20
  v_add_f32 v19, v19, v21
  v_lshlrev_b32 v20, 16, v46
  v_and_b32 v21, 0xffff0000, v46
  v_add_f32 v18, v18, v20
  v_add_f32 v19, v19, v21
  v_lshlrev_b32 v20, 16, v47
  v_and_b32 v21, 0xffff0000, v47
  v_add_f32 v18, v18, v20
  v_add_f32 v19, v19, v21
  v_lshlrev_b32 v20, 16, v48
  v_and_b32 v21, 0xffff0000, v48
  v_add_f32 v18, v18, v20
  v_add_f32 v19, v19, v21
  v_lshlrev_b32 v20, 16, v49
  v_and_b32 v21, 0xffff0000, v49
  v_add_f32 v18, v18, v20
  v_add_f32 v19, v19, v21
  v_lshlrev_b32 v20, 16, v50
  v_and_b32 v21, 0xffff0000, v50
  v_add_f32 v18, v18, v20
  v_add_f32 v19, v19, v21
  v_lshlrev_b32 v20, 16, v51
  v_and_b32 v21, 0xffff0000, v51
  v_add_f32 v18, v18, v20
  v_add_f32 v19, v19, v21
  v_lshlrev_b32 v20, 16, v52
  v_and_b32 v21, 0xffff0000, v52
  v_add_f32 v18, v18, v20
  v_add_f32 v19, v19, v21
  v_lshlrev_b32 v20, 16, v53
  v_and_b32 v21, 0xffff0000, v53
  v_add_f32 v18, v18, v20
  v_add_f32 v19, v19, v21
  v_lshlrev_b32 v20, 16, v54
  v_and_b32 v21, 0xffff0000, v54
  v_add_f32 v18, v18, v20
  v_add_f32 v19, v19, v21
  v_lshlrev_b32 v20, 16, v55
  v_and_b32 v21, 0xffff0000, v55
  v_add_f32 v18, v18, v20
  v_add_f32 v19, v19, v21
  ds_read_b64_tr_b16 v[40:41], v17 offset:24576
  ds_read_b64_tr_b16 v[42:43], v17 offset:25088
  ds_read_b64_tr_b16 v[44:45], v17 offset:26624
  ds_read_b64_tr_b16 v[46:47], v17 offset:27136
  ds_read_b64_tr_b16 v[48:49], v17 offset:28672
  ds_read_b64_tr_b16 v[50:51], v17 offset:29184
  ds_read_b64_tr_b16 v[52:53], v17 offset:30720
  ds_read_b64_tr_b16 v[54:55], v17 offset:31232
  s_waitcnt lgkmcnt(8)
  v_lshlrev_b32 v20, 16, v24
  v_and_b32 v21, 0xffff0000, v24
  v_add_f32 v18, v18, v20
  v_add_f32 v19, v19, v21
  v_lshlrev_b32 v20, 16, v25
  v_and_b32 v21, 0xffff0000, v25
  v_add_f32 v18, v18, v20
  v_add_f32 v19, v19, v21
  v_lshlrev_b32 v20, 16, v26
  v_and_b32 v21, 0xffff0000, v26
  v_add_f32 v18, v18, v20
  v_add_f32 v19, v19, v21
  v_lshlrev_b32 v20, 16, v27
  v_and_b32 v21, 0xffff0000, v27
  v_add_f32 v18, v18, v20
  v_add_f32 v19, v19, v21
  v_lshlrev_b32 v20, 16, v28
  v_and_b32 v21, 0xffff0000, v28
  v_add_f32 v18, v18, v20
  v_add_f32 v19, v19, v21
  v_lshlrev_b32 v20, 16, v29
  v_and_b32 v21, 0xffff0000, v29
  v_add_f32 v18, v18, v20
  v_add_f32 v19, v19, v21
  v_lshlrev_b32 v20, 16, v30
  v_and_b32 v21, 0xffff0000, v30
  v_add_f32 v18, v18, v20
  v_add_f32 v19, v19, v21
  v_lshlrev_b32 v20, 16, v31
  v_and_b32 v21, 0xffff0000, v31
  v_add_f32 v18, v18, v20
  v_add_f32 v19, v19, v21
  v_lshlrev_b32 v20, 16, v32
  v_and_b32 v21, 0xffff0000, v32
  v_add_f32 v18, v18, v20
  v_add_f32 v19, v19, v21
  v_lshlrev_b32 v20, 16, v33
  v_and_b32 v21, 0xffff0000, v33
  v_add_f32 v18, v18, v20
  v_add_f32 v19, v19, v21
  v_lshlrev_b32 v20, 16, v34
  v_and_b32 v21, 0xffff0000, v34
  v_add_f32 v18, v18, v20
  v_add_f32 v19, v19, v21
  v_lshlrev_b32 v20, 16, v35
  v_and_b32 v21, 0xffff0000, v35
  v_add_f32 v18, v18, v20
  v_add_f32 v19, v19, v21
  v_lshlrev_b32 v20, 16, v36
  v_and_b32 v21, 0xffff0000, v36
  v_add_f32 v18, v18, v20
  v_add_f32 v19, v19, v21
  v_lshlrev_b32 v20, 16, v37
  v_and_b32 v21, 0xffff0000, v37
  v_add_f32 v18, v18, v20
  v_add_f32 v19, v19, v21
  v_lshlrev_b32 v20, 16, v38
  v_and_b32 v21, 0xffff0000, v38
  v_add_f32 v18, v18, v20
  v_add_f32 v19, v19, v21
  v_lshlrev_b32 v20, 16, v39
  v_and_b32 v21, 0xffff0000, v39
  v_add_f32 v18, v18, v20
  v_add_f32 v19, v19, v21
  ds_read_b64_tr_b16 v[24:25], v17 offset:32768
  ds_read_b64_tr_b16 v[26:27], v17 offset:33280
  ds_read_b64_tr_b16 v[28:29], v17 offset:34816
  ds_read_b64_tr_b16 v[30:31], v17 offset:35328
  ds_read_b64_tr_b16 v[32:33], v17 offset:36864
  ds_read_b64_tr_b16 v[34:35], v17 offset:37376
  ds_read_b64_tr_b16 v[36:37], v17 offset:38912
  ds_read_b64_tr_b16 v[38:39], v17 offset:39424
  s_waitcnt lgkmcnt(8)
  v_lshlrev_b32 v20, 16, v40
  v_and_b32 v21, 0xffff0000, v40
  v_add_f32 v18, v18, v20
  v_add_f32 v19, v19, v21
  v_lshlrev_b32 v20, 16, v41
  v_and_b32 v21, 0xffff0000, v41
  v_add_f32 v18, v18, v20
  v_add_f32 v19, v19, v21
  v_lshlrev_b32 v20, 16, v42
  v_and_b32 v21, 0xffff0000, v42
  v_add_f32 v18, v18, v20
  v_add_f32 v19, v19, v21
  v_lshlrev_b32 v20, 16, v43
  v_and_b32 v21, 0xffff0000, v43
  v_add_f32 v18, v18, v20
  v_add_f32 v19, v19, v21
  v_lshlrev_b32 v20, 16, v44
  v_and_b32 v21, 0xffff0000, v44
  v_add_f32 v18, v18, v20
  v_add_f32 v19, v19, v21
  v_lshlrev_b32 v20, 16, v45
  v_and_b32 v21, 0xffff0000, v45
  v_add_f32 v18, v18, v20
  v_add_f32 v19, v19, v21
  v_lshlrev_b32 v20, 16, v46
  v_and_b32 v21, 0xffff0000, v46
  v_add_f32 v18, v18, v20
  v_add_f32 v19, v19, v21
  v_lshlrev_b32 v20, 16, v47
  v_and_b32 v21, 0xffff0000, v47
  v_add_f32 v18, v18, v20
  v_add_f32 v19, v19, v21
  v_lshlrev_b32 v20, 16, v48
  v_and_b32 v21, 0xffff0000, v48
  v_add_f32 v18, v18, v20
  v_add_f32 v19, v19, v21
  v_lshlrev_b32 v20, 16, v49
  v_and_b32 v21, 0xffff0000, v49
  v_add_f32 v18, v18, v20
  v_add_f32 v19, v19, v21
  v_lshlrev_b32 v20, 16, v50
  v_and_b32 v21, 0xffff0000, v50
  v_add_f32 v18, v18, v20
  v_add_f32 v19, v19, v21
  v_lshlrev_b32 v20, 16, v51
  v_and_b32 v21, 0xffff0000, v51
  v_add_f32 v18, v18, v20
  v_add_f32 v19, v19, v21
  v_lshlrev_b32 v20, 16, v52
  v_and_b32 v21, 0xffff0000, v52
  v_add_f32 v18, v18, v20
  v_add_f32 v19, v19, v21
  v_lshlrev_b32 v20, 16, v53
  v_and_b32 v21, 0xffff0000, v53
  v_add_f32 v18, v18, v20
  v_add_f32 v19, v19, v21
  v_lshlrev_b32 v20, 16, v54
  v_and_b32 v21, 0xffff0000, v54
  v_add_f32 v18, v18, v20
  v_add_f32 v19, v19, v21
  v_lshlrev_b32 v20, 16, v55
  v_and_b32 v21, 0xffff0000, v55
  v_add_f32 v18, v18, v20
  v_add_f32 v19, v19, v21
  ds_read_b64_tr_b16 v[40:41], v17 offset:40960
  ds_read_b64_tr_b16 v[42:43], v17 offset:41472
  ds_read_b64_tr_b16 v[44:45], v17 offset:43008
  ds_read_b64_tr_b16 v[46:47], v17 offset:43520
  ds_read_b64_tr_b16 v[48:49], v17 offset:45056
  ds_read_b64_tr_b16 v[50:51], v17 offset:45568
  ds_read_b64_tr_b16 v[52:53], v17 offset:47104
  ds_read_b64_tr_b16 v[54:55], v17 offset:47616
  s_waitcnt lgkmcnt(8)
  v_lshlrev_b32 v20, 16, v24
  v_and_b32 v21, 0xffff0000, v24
  v_add_f32 v18, v18, v20
  v_add_f32 v19, v19, v21
  v_lshlrev_b32 v20, 16, v25
  v_and_b32 v21, 0xffff0000, v25
  v_add_f32 v18, v18, v20
  v_add_f32 v19, v19, v21
  v_lshlrev_b32 v20, 16, v26
  v_and_b32 v21, 0xffff0000, v26
  v_add_f32 v18, v18, v20
  v_add_f32 v19, v19, v21
  v_lshlrev_b32 v20, 16, v27
  v_and_b32 v21, 0xffff0000, v27
  v_add_f32 v18, v18, v20
  v_add_f32 v19, v19, v21
  v_lshlrev_b32 v20, 16, v28
  v_and_b32 v21, 0xffff0000, v28
  v_add_f32 v18, v18, v20
  v_add_f32 v19, v19, v21
  v_lshlrev_b32 v20, 16, v29
  v_and_b32 v21, 0xffff0000, v29
  v_add_f32 v18, v18, v20
  v_add_f32 v19, v19, v21
  v_lshlrev_b32 v20, 16, v30
  v_and_b32 v21, 0xffff0000, v30
  v_add_f32 v18, v18, v20
  v_add_f32 v19, v19, v21
  v_lshlrev_b32 v20, 16, v31
  v_and_b32 v21, 0xffff0000, v31
  v_add_f32 v18, v18, v20
  v_add_f32 v19, v19, v21
  v_lshlrev_b32 v20, 16, v32
  v_and_b32 v21, 0xffff0000, v32
  v_add_f32 v18, v18, v20
  v_add_f32 v19, v19, v21
  v_lshlrev_b32 v20, 16, v33
  v_and_b32 v21, 0xffff0000, v33
  v_add_f32 v18, v18, v20
  v_add_f32 v19, v19, v21
  v_lshlrev_b32 v20, 16, v34
  v_and_b32 v21, 0xffff0000, v34
  v_add_f32 v18, v18, v20
  v_add_f32 v19, v19, v21
  v_lshlrev_b32 v20, 16, v35
  v_and_b32 v21, 0xffff0000, v35
  v_add_f32 v18, v18, v20
  v_add_f32 v19, v19, v21
  v_lshlrev_b32 v20, 16, v36
  v_and_b32 v21, 0xffff0000, v36
  v_add_f32 v18, v18, v20
  v_add_f32 v19, v19, v21
  v_lshlrev_b32 v20, 16, v37
  v_and_b32 v21, 0xffff0000, v37
  v_add_f32 v18, v18, v20
  v_add_f32 v19, v19, v21
  v_lshlrev_b32 v20, 16, v38
  v_and_b32 v21, 0xffff0000, v38
  v_add_f32 v18, v18, v20
  v_add_f32 v19, v19, v21
  v_lshlrev_b32 v20, 16, v39
  v_and_b32 v21, 0xffff0000, v39
  v_add_f32 v18, v18, v20
  v_add_f32 v19, v19, v21
  ds_read_b64_tr_b16 v[24:25], v17 offset:49152
  ds_read_b64_tr_b16 v[26:27], v17 offset:49664
  ds_read_b64_tr_b16 v[28:29], v17 offset:51200
  ds_read_b64_tr_b16 v[30:31], v17 offset:51712
  ds_read_b64_tr_b16 v[32:33], v17 offset:53248
  ds_read_b64_tr_b16 v[34:35], v17 offset:53760
  ds_read_b64_tr_b16 v[36:37], v17 offset:55296
  ds_read_b64_tr_b16 v[38:39], v17 offset:55808
  s_waitcnt lgkmcnt(8)
  v_lshlrev_b32 v20, 16, v40
  v_and_b32 v21, 0xffff0000, v40
  v_add_f32 v18, v18, v20
  v_add_f32 v19, v19, v21
  v_lshlrev_b32 v20, 16, v41
  v_and_b32 v21, 0xffff0000, v41
  v_add_f32 v18, v18, v20
  v_add_f32 v19, v19, v21
  v_lshlrev_b32 v20, 16, v42
  v_and_b32 v21, 0xffff0000, v42
  v_add_f32 v18, v18, v20
  v_add_f32 v19, v19, v21
  v_lshlrev_b32 v20, 16, v43
  v_and_b32 v21, 0xffff0000, v43
  v_add_f32 v18, v18, v20
  v_add_f32 v19, v19, v21
  v_lshlrev_b32 v20, 16, v44
  v_and_b32 v21, 0xffff0000, v44
  v_add_f32 v18, v18, v20
  v_add_f32 v19, v19, v21
  v_lshlrev_b32 v20, 16, v45
  v_and_b32 v21, 0xffff0000, v45
  v_add_f32 v18, v18, v20
  v_add_f32 v19, v19, v21
  v_lshlrev_b32 v20, 16, v46
  v_and_b32 v21, 0xffff0000, v46
  v_add_f32 v18, v18, v20
  v_add_f32 v19, v19, v21
  v_lshlrev_b32 v20, 16, v47
  v_and_b32 v21, 0xffff0000, v47
  v_add_f32 v18, v18, v20
  v_add_f32 v19, v19, v21
  v_lshlrev_b32 v20, 16, v48
  v_and_b32 v21, 0xffff0000, v48
  v_add_f32 v18, v18, v20
  v_add_f32 v19, v19, v21
  v_lshlrev_b32 v20, 16, v49
  v_and_b32 v21, 0xffff0000, v49
  v_add_f32 v18, v18, v20
  v_add_f32 v19, v19, v21
  v_lshlrev_b32 v20, 16, v50
  v_and_b32 v21, 0xffff0000, v50
  v_add_f32 v18, v18, v20
  v_add_f32 v19, v19, v21
  v_lshlrev_b32 v20, 16, v51
  v_and_b32 v21, 0xffff0000, v51
  v_add_f32 v18, v18, v20
  v_add_f32 v19, v19, v21
  v_lshlrev_b32 v20, 16, v52
  v_and_b32 v21, 0xffff0000, v52
  v_add_f32 v18, v18, v20
  v_add_f32 v19, v19, v21
  v_lshlrev_b32 v20, 16, v53
  v_and_b32 v21, 0xffff0000, v53
  v_add_f32 v18, v18, v20
  v_add_f32 v19, v19, v21
  v_lshlrev_b32 v20, 16, v54
  v_and_b32 v21, 0xffff0000, v54
  v_add_f32 v18, v18, v20
  v_add_f32 v19, v19, v21
  v_lshlrev_b32 v20, 16, v55
  v_and_b32 v21, 0xffff0000, v55
  v_add_f32 v18, v18, v20
  v_add_f32 v19, v19, v21
  s_waitcnt lgkmcnt(0)
  v_lshlrev_b32 v20, 16, v24
  v_and_b32 v21, 0xffff0000, v24
  v_add_f32 v18, v18, v20
  v_add_f32 v19, v19, v21
  v_lshlrev_b32 v20, 16, v25
  v_and_b32 v21, 0xffff0000, v25
  v_add_f32 v18, v18, v20
  v_add_f32 v19, v19, v21
  v_lshlrev_b32 v20, 16, v26
  v_and_b32 v21, 0xffff0000, v26
  v_add_f32 v18, v18, v20
  v_add_f32 v19, v19, v21
  v_lshlrev_b32 v20, 16, v27
  v_and_b32 v21, 0xffff0000, v27
  v_add_f32 v18, v18, v20
  v_add_f32 v19, v19, v21
  v_lshlrev_b32 v20, 16, v28
  v_and_b32 v21, 0xffff0000, v28
  v_add_f32 v18, v18, v20
  v_add_f32 v19, v19, v21
  v_lshlrev_b32 v20, 16, v29
  v_and_b32 v21, 0xffff0000, v29
  v_add_f32 v18, v18, v20
  v_add_f32 v19, v19, v21
  v_lshlrev_b32 v20, 16, v30
  v_and_b32 v21, 0xffff0000, v30
  v_add_f32 v18, v18, v20
  v_add_f32 v19, v19, v21
  v_lshlrev_b32 v20, 16, v31
  v_and_b32 v21, 0xffff0000, v31
  v_add_f32 v18, v18, v20
  v_add_f32 v19, v19, v21
  v_lshlrev_b32 v20, 16, v32
  v_and_b32 v21, 0xffff0000, v32
  v_add_f32 v18, v18, v20
  v_add_f32 v19, v19, v21
  v_lshlrev_b32 v20, 16, v33
  v_and_b32 v21, 0xffff0000, v33
  v_add_f32 v18, v18, v20
  v_add_f32 v19, v19, v21
  v_lshlrev_b32 v20, 16, v34
  v_and_b32 v21, 0xffff0000, v34
  v_add_f32 v18, v18, v20
  v_add_f32 v19, v19, v21
  v_lshlrev_b32 v20, 16, v35
  v_and_b32 v21, 0xffff0000, v35
  v_add_f32 v18, v18, v20
  v_add_f32 v19, v19, v21
  v_lshlrev_b32 v20, 16, v36
  v_and_b32 v21, 0xffff0000, v36
  v_add_f32 v18, v18, v20
  v_add_f32 v19, v19, v21
  v_lshlrev_b32 v20, 16, v37
  v_and_b32 v21, 0xffff0000, v37
  v_add_f32 v18, v18, v20
  v_add_f32 v19, v19, v21
  v_lshlrev_b32 v20, 16, v38
  v_and_b32 v21, 0xffff0000, v38
  v_add_f32 v18, v18, v20
  v_add_f32 v19, v19, v21
  v_lshlrev_b32 v20, 16, v39
  v_and_b32 v21, 0xffff0000, v39
  v_add_f32 v18, v18, v20
  v_add_f32 v19, v19, v21
  v_add_f32 v19, v18, v19
  v_mov_b32 v21, v19
  s_nop 1
  v_permlane32_swap_b32 v19, v21
  v_add_f32 v19, v19, v21
  v_and_b32 v21, 31, v0
  v_lshlrev_b32 v21, 2, v21
  s_and_b32 s8, s36, 1
  s_lshl_b32 s8, s8, 7
  v_add_u32 v21, s8, v21
  ds_write_b32 v21, v19 offset:57600
  s_lshl_b32 s9, s36, 2
  v_mov_b32 v21, s9
  v_mov_b32 v9, 1
  ds_write_b32 v21, v9 offset:60952
  s_add_u32 s53, s39, 0
  s_and_b32 s53, s53, 15
  s_lshl_b32 s55, s53, 7
  s_add_u32 m0, s59, 98304
  s_nop 0
  buffer_load_dwordx4 v22, s[68:71], s55 offen lds
  s_add_u32 m0, s59, 99328
  s_nop 0
  buffer_load_dwordx4 v23, s[68:71], s55 offen lds
  s_add_u32 s55, s55, 65536
  s_add_u32 m0, s59, 100352
  s_nop 0
  buffer_load_dwordx4 v22, s[68:71], s55 offen lds
  s_add_u32 m0, s59, 101376
  s_nop 0
  buffer_load_dwordx4 v23, s[68:71], s55 offen lds
  s_add_u32 s55, s55, 65536
  s_add_u32 m0, s59, 102400
  s_nop 0
  buffer_load_dwordx4 v22, s[68:71], s55 offen lds
  s_add_u32 m0, s59, 103424
  s_nop 0
  buffer_load_dwordx4 v23, s[68:71], s55 offen lds
  s_add_u32 s55, s55, 65536
  s_add_u32 m0, s59, 104448
  s_nop 0
  buffer_load_dwordx4 v22, s[68:71], s55 offen lds
  s_add_u32 m0, s59, 105472
  s_nop 0
  buffer_load_dwordx4 v23, s[68:71], s55 offen lds
  s_add_u32 s53, s39, 1
  s_and_b32 s53, s53, 15
  s_lshl_b32 s55, s53, 7
  s_add_u32 m0, s59, 114688
  s_nop 0
  buffer_load_dwordx4 v22, s[68:71], s55 offen lds
  s_add_u32 m0, s59, 115712
  s_nop 0
  buffer_load_dwordx4 v23, s[68:71], s55 offen lds
  s_add_u32 s55, s55, 65536
  s_add_u32 m0, s59, 116736
  s_nop 0
  buffer_load_dwordx4 v22, s[68:71], s55 offen lds
  s_add_u32 m0, s59, 117760
  s_nop 0
  buffer_load_dwordx4 v23, s[68:71], s55 offen lds
  s_add_u32 s55, s55, 65536
  s_add_u32 m0, s59, 118784
  s_nop 0
  buffer_load_dwordx4 v22, s[68:71], s55 offen lds
  s_add_u32 m0, s59, 119808
  s_nop 0
  buffer_load_dwordx4 v23, s[68:71], s55 offen lds
  s_add_u32 s55, s55, 65536
  s_add_u32 m0, s59, 120832
  s_nop 0
  buffer_load_dwordx4 v22, s[68:71], s55 offen lds
  s_add_u32 m0, s59, 121856
  s_nop 0
  buffer_load_dwordx4 v23, s[68:71], s55 offen lds
  s_lshr_b32 s57, s59, 1
  v_lshrrev_b32 v24, 3, v0
  v_mul_u32_u24 v24, 896, v24
  v_and_b32 v10, 7, v0
  v_bfe_u32 v11, v0, 4, 1
  v_lshlrev_b32 v11, 2, v11
  v_xor_b32 v10, v10, v11
  v_lshl_add_u32 v24, v10, 4, v24
  s_and_b32 s8, s36, 1
  s_mul_i32 s8, s8, 28672
  s_lshl_b32 s9, s92, 7
  s_add_u32 s8, s8, s9
  v_add_u32 v24, s8, v24
  v_add_u32 v25, 7168, v24
  v_add_u32 v26, 14336, v24
  v_add_u32 v27, 21504, v24
  v_lshlrev_b32 v28, 4, v0
  s_mul_i32 s8, s92, 57344
  s_add_u32 s8, s8, s57
  s_add_u32 s8, s8, 401408
  v_add_u32 v28, s8, v28
  s_waitcnt lgkmcnt(0)
  s_barrier
  s_add_u32 s53, s39, 0
  s_and_b32 s53, s53, 15
  s_mul_i32 s54, s53, 114688
  s_add_u32 m0, s64, 65536
  s_nop 0
  buffer_load_dwordx4 v1, s[24:27], s54 offen sc1 lds
  s_add_u32 m0, s64, 66560
  s_nop 0
  buffer_load_dwordx4 v2, s[24:27], s54 offen sc1 lds
  s_add_u32 s53, s39, 1
  s_and_b32 s53, s53, 15
  s_mul_i32 s54, s53, 114688
  s_add_u32 m0, s64, 73728
  s_nop 0
  buffer_load_dwordx4 v1, s[24:27], s54 offen sc1 lds
  s_add_u32 m0, s64, 74752
  s_nop 0
  buffer_load_dwordx4 v2, s[24:27], s54 offen sc1 lds
  s_add_u32 s53, s39, 2
  s_and_b32 s53, s53, 15
  s_mul_i32 s54, s53, 114688
  s_add_u32 m0, s64, 81920
  s_nop 0
  buffer_load_dwordx4 v1, s[24:27], s54 offen sc1 lds
  s_add_u32 m0, s64, 82944
  s_nop 0
  buffer_load_dwordx4 v2, s[24:27], s54 offen sc1 lds
  s_add_u32 s53, s39, 3
  s_and_b32 s53, s53, 15
  s_mul_i32 s54, s53, 114688
  s_add_u32 m0, s64, 90112
  s_nop 0
  buffer_load_dwordx4 v1, s[24:27], s54 offen sc1 lds
  s_add_u32 m0, s64, 91136
  s_nop 0
  buffer_load_dwordx4 v2, s[24:27], s54 offen sc1 lds
  s_add_u32 s53, s39, 2
  s_and_b32 s53, s53, 15
  s_lshl_b32 s55, s53, 7
  s_add_u32 m0, s58, 131072
  s_nop 0
  buffer_load_dwordx4 v3, s[68:71], s55 offen lds
  s_add_u32 m0, s58, 132096
  s_nop 0
  buffer_load_dwordx4 v4, s[68:71], s55 offen lds
  s_add_u32 m0, s58, 133120
  s_nop 0
  buffer_load_dwordx4 v5, s[68:71], s55 offen lds
  s_add_u32 m0, s58, 134144
  s_nop 0
  buffer_load_dwordx4 v6, s[68:71], s55 offen lds
  s_add_u32 s53, s39, 3
  s_and_b32 s53, s53, 15
  s_lshl_b32 s55, s53, 7
  s_add_u32 m0, s58, 147456
  s_nop 0
  buffer_load_dwordx4 v3, s[68:71], s55 offen lds
  s_add_u32 m0, s58, 148480
  s_nop 0
  buffer_load_dwordx4 v4, s[68:71], s55 offen lds
  s_add_u32 m0, s58, 149504
  s_nop 0
  buffer_load_dwordx4 v5, s[68:71], s55 offen lds
  s_add_u32 m0, s58, 150528
  s_nop 0
  buffer_load_dwordx4 v6, s[68:71], s55 offen lds
  s_waitcnt vmcnt(14)
  s_barrier
  s_add_u32 s53, s39, 4
  s_and_b32 s53, s53, 15
  s_lshl_b32 s55, s53, 7
  s_add_u32 m0, s58, 32768
  s_nop 0
  buffer_load_dwordx4 v3, s[68:71], s55 offen lds
  s_add_u32 m0, s58, 33792
  s_nop 0
  buffer_load_dwordx4 v4, s[68:71], s55 offen lds
  s_add_u32 m0, s58, 34816
  s_nop 0
  buffer_load_dwordx4 v5, s[68:71], s55 offen lds
  s_add_u32 m0, s58, 35840
  s_nop 0
  buffer_load_dwordx4 v6, s[68:71], s55 offen lds
  s_waitcnt vmcnt(16)
  s_barrier
  s_waitcnt vmcnt(8)
  s_barrier
  s_add_u32 s53, s39, 4
  s_and_b32 s53, s53, 15
  s_mul_i32 s54, s53, 114688
  s_add_u32 m0, s64, 0
  s_nop 0
  buffer_load_dwordx4 v1, s[24:27], s54 offen sc1 lds
  s_add_u32 m0, s64, 1024
  s_nop 0
  buffer_load_dwordx4 v2, s[24:27], s54 offen sc1 lds
  s_add_u32 s53, s39, 5
  s_and_b32 s53, s53, 15
  s_mul_i32 s54, s53, 114688
  s_add_u32 m0, s64, 8192
  s_nop 0
  buffer_load_dwordx4 v1, s[24:27], s54 offen sc1 lds
  s_add_u32 m0, s64, 9216
  s_nop 0
  buffer_load_dwordx4 v2, s[24:27], s54 offen sc1 lds
  s_add_u32 s53, s39, 6
  s_and_b32 s53, s53, 15
  s_mul_i32 s54, s53, 114688
  s_add_u32 m0, s64, 16384
  s_nop 0
  buffer_load_dwordx4 v1, s[24:27], s54 offen sc1 lds
  s_add_u32 m0, s64, 17408
  s_nop 0
  buffer_load_dwordx4 v2, s[24:27], s54 offen sc1 lds
  s_add_u32 s53, s39, 5
  s_and_b32 s53, s53, 15
  s_lshl_b32 s55, s53, 7
  s_add_u32 m0, s58, 98304
  s_nop 0
  buffer_load_dwordx4 v3, s[68:71], s55 offen lds
  s_add_u32 m0, s58, 99328
  s_nop 0
  buffer_load_dwordx4 v4, s[68:71], s55 offen lds
  s_add_u32 m0, s58, 100352
  s_nop 0
  buffer_load_dwordx4 v5, s[68:71], s55 offen lds
  s_add_u32 m0, s58, 101376
  s_nop 0
  buffer_load_dwordx4 v6, s[68:71], s55 offen lds
  s_waitcnt vmcnt(14)
  s_barrier
  s_add_u32 s53, s39, 7
  s_and_b32 s53, s53, 15
  s_mul_i32 s54, s53, 114688
  s_add_u32 m0, s64, 24576
  s_nop 0
  buffer_load_dwordx4 v1, s[24:27], s54 offen sc1 lds
  s_add_u32 m0, s64, 25600
  s_nop 0
  buffer_load_dwordx4 v2, s[24:27], s54 offen sc1 lds
  s_add_u32 s53, s39, 8
  s_and_b32 s53, s53, 15
  s_mul_i32 s54, s53, 114688
  s_add_u32 m0, s64, 65536
  s_nop 0
  buffer_load_dwordx4 v1, s[24:27], s54 offen sc1 lds
  s_add_u32 m0, s64, 66560
  s_nop 0
  buffer_load_dwordx4 v2, s[24:27], s54 offen sc1 lds
  s_add_u32 s53, s39, 9
  s_and_b32 s53, s53, 15
  s_mul_i32 s54, s53, 114688
  s_add_u32 m0, s64, 73728
  s_nop 0
  buffer_load_dwordx4 v1, s[24:27], s54 offen sc1 lds
  s_add_u32 m0, s64, 74752
  s_nop 0
  buffer_load_dwordx4 v2, s[24:27], s54 offen sc1 lds
  s_add_u32 s53, s39, 6
  s_and_b32 s53, s53, 15
  s_lshl_b32 s55, s53, 7
  s_add_u32 m0, s58, 114688
  s_nop 0
  buffer_load_dwordx4 v3, s[68:71], s55 offen lds
  s_add_u32 m0, s58, 115712
  s_nop 0
  buffer_load_dwordx4 v4, s[68:71], s55 offen lds
  s_add_u32 m0, s58, 116736
  s_nop 0
  buffer_load_dwordx4 v5, s[68:71], s55 offen lds
  s_add_u32 m0, s58, 117760
  s_nop 0
  buffer_load_dwordx4 v6, s[68:71], s55 offen lds
  s_waitcnt vmcnt(18)
  s_barrier
  s_add_u32 s53, s39, 10
  s_and_b32 s53, s53, 15
  s_mul_i32 s54, s53, 114688
  s_add_u32 m0, s64, 81920
  s_nop 0
  buffer_load_dwordx4 v1, s[24:27], s54 offen sc1 lds
  s_add_u32 m0, s64, 82944
  s_nop 0
  buffer_load_dwordx4 v2, s[24:27], s54 offen sc1 lds
  s_add_u32 s53, s39, 7
  s_and_b32 s53, s53, 15
  s_lshl_b32 s55, s53, 7
  s_add_u32 m0, s58, 131072
  s_nop 0
  buffer_load_dwordx4 v3, s[68:71], s55 offen lds
  s_add_u32 m0, s58, 132096
  s_nop 0
  buffer_load_dwordx4 v4, s[68:71], s55 offen lds
  s_add_u32 m0, s58, 133120
  s_nop 0
  buffer_load_dwordx4 v5, s[68:71], s55 offen lds
  s_add_u32 m0, s58, 134144
  s_nop 0
  buffer_load_dwordx4 v6, s[68:71], s55 offen lds
  s_waitcnt vmcnt(16)
  s_barrier
  s_add_u32 s53, s39, 11
  s_and_b32 s53, s53, 15
  s_mul_i32 s54, s53, 114688
  s_add_u32 m0, s64, 90112
  s_nop 0
  buffer_load_dwordx4 v1, s[24:27], s54 offen sc1 lds
  s_add_u32 m0, s64, 91136
  s_nop 0
  buffer_load_dwordx4 v2, s[24:27], s54 offen sc1 lds
  s_add_u32 s53, s39, 8
  s_and_b32 s53, s53, 15
  s_lshl_b32 s55, s53, 7
  s_add_u32 m0, s58, 147456
  s_nop 0
  buffer_load_dwordx4 v3, s[68:71], s55 offen lds
  s_add_u32 m0, s58, 148480
  s_nop 0
  buffer_load_dwordx4 v4, s[68:71], s55 offen lds
  s_add_u32 m0, s58, 149504
  s_nop 0
  buffer_load_dwordx4 v5, s[68:71], s55 offen lds
  s_add_u32 m0, s58, 150528
  s_nop 0
  buffer_load_dwordx4 v6, s[68:71], s55 offen lds
  s_waitcnt vmcnt(12)
  s_barrier
  s_add_u32 s53, s39, 12
  s_and_b32 s53, s53, 15
  s_mul_i32 s54, s53, 114688
  s_add_u32 m0, s64, 0
  s_nop 0
  buffer_load_dwordx4 v1, s[24:27], s54 offen sc1 lds
  s_add_u32 m0, s64, 1024
  s_nop 0
  buffer_load_dwordx4 v2, s[24:27], s54 offen sc1 lds
  s_add_u32 s53, s39, 9
  s_and_b32 s53, s53, 15
  s_lshl_b32 s55, s53, 7
  s_add_u32 m0, s58, 32768
  s_nop 0
  buffer_load_dwordx4 v3, s[68:71], s55 offen lds
  s_add_u32 m0, s58, 33792
  s_nop 0
  buffer_load_dwordx4 v4, s[68:71], s55 offen lds
  s_add_u32 m0, s58, 34816
  s_nop 0
  buffer_load_dwordx4 v5, s[68:71], s55 offen lds
  s_add_u32 m0, s58, 35840
  s_nop 0
  buffer_load_dwordx4 v6, s[68:71], s55 offen lds
  s_waitcnt vmcnt(12)
  s_barrier
  s_add_u32 s53, s39, 13
  s_and_b32 s53, s53, 15
  s_mul_i32 s54, s53, 114688
  s_add_u32 m0, s64, 8192
  s_nop 0
  buffer_load_dwordx4 v1, s[24:27], s54 offen sc1 lds
  s_add_u32 m0, s64, 9216
  s_nop 0
  buffer_load_dwordx4 v2, s[24:27], s54 offen sc1 lds
  s_add_u32 s53, s39, 10
  s_and_b32 s53, s53, 15
  s_lshl_b32 s55, s53, 7
  s_add_u32 m0, s58, 98304
  s_nop 0
  buffer_load_dwordx4 v3, s[68:71], s55 offen lds
  s_add_u32 m0, s58, 99328
  s_nop 0
  buffer_load_dwordx4 v4, s[68:71], s55 offen lds
  s_add_u32 m0, s58, 100352
  s_nop 0
  buffer_load_dwordx4 v5, s[68:71], s55 offen lds
  s_add_u32 m0, s58, 101376
  s_nop 0
  buffer_load_dwordx4 v6, s[68:71], s55 offen lds
  s_waitcnt vmcnt(12)
  s_barrier
  s_add_u32 s53, s39, 14
  s_and_b32 s53, s53, 15
  s_mul_i32 s54, s53, 114688
  s_add_u32 m0, s64, 16384
  s_nop 0
  buffer_load_dwordx4 v1, s[24:27], s54 offen sc1 lds
  s_add_u32 m0, s64, 17408
  s_nop 0
  buffer_load_dwordx4 v2, s[24:27], s54 offen sc1 lds
  s_add_u32 s53, s39, 11
  s_and_b32 s53, s53, 15
  s_lshl_b32 s55, s53, 7
  s_add_u32 m0, s58, 114688
  s_nop 0
  buffer_load_dwordx4 v3, s[68:71], s55 offen lds
  s_add_u32 m0, s58, 115712
  s_nop 0
  buffer_load_dwordx4 v4, s[68:71], s55 offen lds
  s_add_u32 m0, s58, 116736
  s_nop 0
  buffer_load_dwordx4 v5, s[68:71], s55 offen lds
  s_add_u32 m0, s58, 117760
  s_nop 0
  buffer_load_dwordx4 v6, s[68:71], s55 offen lds
  s_waitcnt vmcnt(12)
  s_barrier
  s_add_u32 s53, s39, 15
  s_and_b32 s53, s53, 15
  s_mul_i32 s54, s53, 114688
  s_add_u32 m0, s64, 24576
  s_nop 0
  buffer_load_dwordx4 v1, s[24:27], s54 offen sc1 lds
  s_add_u32 m0, s64, 25600
  s_nop 0
  buffer_load_dwordx4 v2, s[24:27], s54 offen sc1 lds
  s_add_u32 s53, s39, 12
  s_and_b32 s53, s53, 15
  s_lshl_b32 s55, s53, 7
  s_add_u32 m0, s58, 131072
  s_nop 0
  buffer_load_dwordx4 v3, s[68:71], s55 offen lds
  s_add_u32 m0, s58, 132096
  s_nop 0
  buffer_load_dwordx4 v4, s[68:71], s55 offen lds
  s_add_u32 m0, s58, 133120
  s_nop 0
  buffer_load_dwordx4 v5, s[68:71], s55 offen lds
  s_add_u32 m0, s58, 134144
  s_nop 0
  buffer_load_dwordx4 v6, s[68:71], s55 offen lds
  s_waitcnt vmcnt(12)
  s_barrier
  s_add_u32 s53, s39, 0
  s_and_b32 s53, s53, 15
  s_or_b32 s53, s53, 16
  s_mul_i32 s54, s53, 114688
  s_add_u32 m0, s64, 65536
  s_nop 0
  buffer_load_dwordx4 v1, s[24:27], s54 offen sc1 lds
  s_add_u32 m0, s64, 66560
  s_nop 0
  buffer_load_dwordx4 v2, s[24:27], s54 offen sc1 lds
  s_add_u32 s53, s39, 13
  s_and_b32 s53, s53, 15
  s_lshl_b32 s55, s53, 7
  s_add_u32 m0, s58, 147456
  s_nop 0
  buffer_load_dwordx4 v3, s[68:71], s55 offen lds
  s_add_u32 m0, s58, 148480
  s_nop 0
  buffer_load_dwordx4 v4, s[68:71], s55 offen lds
  s_add_u32 m0, s58, 149504
  s_nop 0
  buffer_load_dwordx4 v5, s[68:71], s55 offen lds
  s_add_u32 m0, s58, 150528
  s_nop 0
  buffer_load_dwordx4 v6, s[68:71], s55 offen lds
  s_waitcnt vmcnt(12)
  s_barrier
  s_add_u32 s53, s39, 1
  s_and_b32 s53, s53, 15
  s_or_b32 s53, s53, 16
  s_mul_i32 s54, s53, 114688
  s_add_u32 m0, s64, 73728
  s_nop 0
  buffer_load_dwordx4 v1, s[24:27], s54 offen sc1 lds
  s_add_u32 m0, s64, 74752
  s_nop 0
  buffer_load_dwordx4 v2, s[24:27], s54 offen sc1 lds
  s_add_u32 s53, s39, 14
  s_and_b32 s53, s53, 15
  s_lshl_b32 s55, s53, 7
  s_add_u32 m0, s58, 32768
  s_nop 0
  buffer_load_dwordx4 v3, s[68:71], s55 offen lds
  s_add_u32 m0, s58, 33792
  s_nop 0
  buffer_load_dwordx4 v4, s[68:71], s55 offen lds
  s_add_u32 m0, s58, 34816
  s_nop 0
  buffer_load_dwordx4 v5, s[68:71], s55 offen lds
  s_add_u32 m0, s58, 35840
  s_nop 0
  buffer_load_dwordx4 v6, s[68:71], s55 offen lds
  s_waitcnt vmcnt(12)
  s_barrier
  s_add_u32 s53, s39, 2
  s_and_b32 s53, s53, 15
  s_or_b32 s53, s53, 16
  s_mul_i32 s54, s53, 114688
  s_add_u32 m0, s64, 81920
  s_nop 0
  buffer_load_dwordx4 v1, s[24:27], s54 offen sc1 lds
  s_add_u32 m0, s64, 82944
  s_nop 0
  buffer_load_dwordx4 v2, s[24:27], s54 offen sc1 lds
  s_add_u32 s53, s39, 15
  s_and_b32 s53, s53, 15
  s_lshl_b32 s55, s53, 7
  s_add_u32 m0, s58, 98304
  s_nop 0
  buffer_load_dwordx4 v3, s[68:71], s55 offen lds
  s_add_u32 m0, s58, 99328
  s_nop 0
  buffer_load_dwordx4 v4, s[68:71], s55 offen lds
  s_add_u32 m0, s58, 100352
  s_nop 0
  buffer_load_dwordx4 v5, s[68:71], s55 offen lds
  s_add_u32 m0, s58, 101376
  s_nop 0
  buffer_load_dwordx4 v6, s[68:71], s55 offen lds
  s_waitcnt vmcnt(12)
  s_barrier
  s_add_u32 s53, s39, 3
  s_and_b32 s53, s53, 15
  s_or_b32 s53, s53, 16
  s_mul_i32 s54, s53, 114688
  s_add_u32 m0, s64, 90112
  s_nop 0
  buffer_load_dwordx4 v1, s[24:27], s54 offen sc1 lds
  s_add_u32 m0, s64, 91136
  s_nop 0
  buffer_load_dwordx4 v2, s[24:27], s54 offen sc1 lds
  s_add_u32 s53, s39, 0
  s_and_b32 s53, s53, 15
  s_or_b32 s53, s53, 16
  s_lshl_b32 s55, s53, 7
  s_add_u32 m0, s58, 114688
  s_nop 0
  buffer_load_dwordx4 v3, s[68:71], s55 offen lds
  s_add_u32 m0, s58, 115712
  s_nop 0
  buffer_load_dwordx4 v4, s[68:71], s55 offen lds
  s_add_u32 m0, s58, 116736
  s_nop 0
  buffer_load_dwordx4 v5, s[68:71], s55 offen lds
  s_add_u32 m0, s58, 117760
  s_nop 0
  buffer_load_dwordx4 v6, s[68:71], s55 offen lds
  s_waitcnt vmcnt(12)
  s_barrier
  s_add_u32 s53, s39, 4
  s_and_b32 s53, s53, 15
  s_or_b32 s53, s53, 16
  s_mul_i32 s54, s53, 114688
  s_add_u32 m0, s64, 0
  s_nop 0
  buffer_load_dwordx4 v1, s[24:27], s54 offen sc1 lds
  s_add_u32 m0, s64, 1024
  s_nop 0
  buffer_load_dwordx4 v2, s[24:27], s54 offen sc1 lds
  s_add_u32 s53, s39, 1
  s_and_b32 s53, s53, 15
  s_or_b32 s53, s53, 16
  s_lshl_b32 s55, s53, 7
  s_add_u32 m0, s58, 131072
  s_nop 0
  buffer_load_dwordx4 v3, s[68:71], s55 offen lds
  s_add_u32 m0, s58, 132096
  s_nop 0
  buffer_load_dwordx4 v4, s[68:71], s55 offen lds
  s_add_u32 m0, s58, 133120
  s_nop 0
  buffer_load_dwordx4 v5, s[68:71], s55 offen lds
  s_add_u32 m0, s58, 134144
  s_nop 0
  buffer_load_dwordx4 v6, s[68:71], s55 offen lds
  s_waitcnt vmcnt(12)
  s_barrier
  s_add_u32 s53, s39, 5
  s_and_b32 s53, s53, 15
  s_or_b32 s53, s53, 16
  s_mul_i32 s54, s53, 114688
  s_add_u32 m0, s64, 8192
  s_nop 0
  buffer_load_dwordx4 v1, s[24:27], s54 offen sc1 lds
  s_add_u32 m0, s64, 9216
  s_nop 0
  buffer_load_dwordx4 v2, s[24:27], s54 offen sc1 lds
  s_add_u32 s53, s39, 2
  s_and_b32 s53, s53, 15
  s_or_b32 s53, s53, 16
  s_lshl_b32 s55, s53, 7
  s_add_u32 m0, s58, 147456
  s_nop 0
  buffer_load_dwordx4 v3, s[68:71], s55 offen lds
  s_add_u32 m0, s58, 148480
  s_nop 0
  buffer_load_dwordx4 v4, s[68:71], s55 offen lds
  s_add_u32 m0, s58, 149504
  s_nop 0
  buffer_load_dwordx4 v5, s[68:71], s55 offen lds
  s_add_u32 m0, s58, 150528
  s_nop 0
  buffer_load_dwordx4 v6, s[68:71], s55 offen lds
  s_waitcnt vmcnt(12)
  s_barrier
  s_add_u32 s53, s39, 6
  s_and_b32 s53, s53, 15
  s_or_b32 s53, s53, 16
  s_mul_i32 s54, s53, 114688
  s_add_u32 m0, s64, 16384
  s_nop 0
  buffer_load_dwordx4 v1, s[24:27], s54 offen sc1 lds
  s_add_u32 m0, s64, 17408
  s_nop 0
  buffer_load_dwordx4 v2, s[24:27], s54 offen sc1 lds
  s_add_u32 s53, s39, 3
  s_and_b32 s53, s53, 15
  s_or_b32 s53, s53, 16
  s_lshl_b32 s55, s53, 7
  s_add_u32 m0, s58, 32768
  s_nop 0
  buffer_load_dwordx4 v3, s[68:71], s55 offen lds
  s_add_u32 m0, s58, 33792
  s_nop 0
  buffer_load_dwordx4 v4, s[68:71], s55 offen lds
  s_add_u32 m0, s58, 34816
  s_nop 0
  buffer_load_dwordx4 v5, s[68:71], s55 offen lds
  s_add_u32 m0, s58, 35840
  s_nop 0
  buffer_load_dwordx4 v6, s[68:71], s55 offen lds
  s_waitcnt vmcnt(12)
  s_barrier
  s_add_u32 s53, s39, 7
  s_and_b32 s53, s53, 15
  s_or_b32 s53, s53, 16
  s_mul_i32 s54, s53, 114688
  s_add_u32 m0, s64, 24576
  s_nop 0
  buffer_load_dwordx4 v1, s[24:27], s54 offen sc1 lds
  s_add_u32 m0, s64, 25600
  s_nop 0
  buffer_load_dwordx4 v2, s[24:27], s54 offen sc1 lds
  s_add_u32 s53, s39, 4
  s_and_b32 s53, s53, 15
  s_or_b32 s53, s53, 16
  s_lshl_b32 s55, s53, 7
  s_add_u32 m0, s58, 98304
  s_nop 0
  buffer_load_dwordx4 v3, s[68:71], s55 offen lds
  s_add_u32 m0, s58, 99328
  s_nop 0
  buffer_load_dwordx4 v4, s[68:71], s55 offen lds
  s_add_u32 m0, s58, 100352
  s_nop 0
  buffer_load_dwordx4 v5, s[68:71], s55 offen lds
  s_add_u32 m0, s58, 101376
  s_nop 0
  buffer_load_dwordx4 v6, s[68:71], s55 offen lds
  s_waitcnt vmcnt(12)
  s_barrier
  s_add_u32 s53, s39, 8
  s_and_b32 s53, s53, 15
  s_or_b32 s53, s53, 16
  s_mul_i32 s54, s53, 114688
  s_add_u32 m0, s64, 65536
  s_nop 0
  buffer_load_dwordx4 v1, s[24:27], s54 offen sc1 lds
  s_add_u32 m0, s64, 66560
  s_nop 0
  buffer_load_dwordx4 v2, s[24:27], s54 offen sc1 lds
  s_add_u32 s53, s39, 5
  s_and_b32 s53, s53, 15
  s_or_b32 s53, s53, 16
  s_lshl_b32 s55, s53, 7
  s_add_u32 m0, s58, 114688
  s_nop 0
  buffer_load_dwordx4 v3, s[68:71], s55 offen lds
  s_add_u32 m0, s58, 115712
  s_nop 0
  buffer_load_dwordx4 v4, s[68:71], s55 offen lds
  s_add_u32 m0, s58, 116736
  s_nop 0
  buffer_load_dwordx4 v5, s[68:71], s55 offen lds
  s_add_u32 m0, s58, 117760
  s_nop 0
  buffer_load_dwordx4 v6, s[68:71], s55 offen lds
  s_waitcnt vmcnt(12)
  s_barrier
  s_add_u32 s53, s39, 9
  s_and_b32 s53, s53, 15
  s_or_b32 s53, s53, 16
  s_mul_i32 s54, s53, 114688
  s_add_u32 m0, s64, 73728
  s_nop 0
  buffer_load_dwordx4 v1, s[24:27], s54 offen sc1 lds
  s_add_u32 m0, s64, 74752
  s_nop 0
  buffer_load_dwordx4 v2, s[24:27], s54 offen sc1 lds
  s_add_u32 s53, s39, 6
  s_and_b32 s53, s53, 15
  s_or_b32 s53, s53, 16
  s_lshl_b32 s55, s53, 7
  s_add_u32 m0, s58, 131072
  s_nop 0
  buffer_load_dwordx4 v3, s[68:71], s55 offen lds
  s_add_u32 m0, s58, 132096
  s_nop 0
  buffer_load_dwordx4 v4, s[68:71], s55 offen lds
  s_add_u32 m0, s58, 133120
  s_nop 0
  buffer_load_dwordx4 v5, s[68:71], s55 offen lds
  s_add_u32 m0, s58, 134144
  s_nop 0
  buffer_load_dwordx4 v6, s[68:71], s55 offen lds
  s_waitcnt vmcnt(12)
  s_barrier
  s_add_u32 s53, s39, 10
  s_and_b32 s53, s53, 15
  s_or_b32 s53, s53, 16
  s_mul_i32 s54, s53, 114688
  s_add_u32 m0, s64, 81920
  s_nop 0
  buffer_load_dwordx4 v1, s[24:27], s54 offen sc1 lds
  s_add_u32 m0, s64, 82944
  s_nop 0
  buffer_load_dwordx4 v2, s[24:27], s54 offen sc1 lds
  s_add_u32 s53, s39, 7
  s_and_b32 s53, s53, 15
  s_or_b32 s53, s53, 16
  s_lshl_b32 s55, s53, 7
  s_add_u32 m0, s58, 147456
  s_nop 0
  buffer_load_dwordx4 v3, s[68:71], s55 offen lds
  s_add_u32 m0, s58, 148480
  s_nop 0
  buffer_load_dwordx4 v4, s[68:71], s55 offen lds
  s_add_u32 m0, s58, 149504
  s_nop 0
  buffer_load_dwordx4 v5, s[68:71], s55 offen lds
  s_add_u32 m0, s58, 150528
  s_nop 0
  buffer_load_dwordx4 v6, s[68:71], s55 offen lds
  s_waitcnt vmcnt(12)
  s_barrier
  s_add_u32 s53, s39, 11
  s_and_b32 s53, s53, 15
  s_or_b32 s53, s53, 16
  s_mul_i32 s54, s53, 114688
  s_add_u32 m0, s64, 90112
  s_nop 0
  buffer_load_dwordx4 v1, s[24:27], s54 offen sc1 lds
  s_add_u32 m0, s64, 91136
  s_nop 0
  buffer_load_dwordx4 v2, s[24:27], s54 offen sc1 lds
  s_add_u32 s53, s39, 8
  s_and_b32 s53, s53, 15
  s_or_b32 s53, s53, 16
  s_lshl_b32 s55, s53, 7
  s_add_u32 m0, s58, 32768
  s_nop 0
  buffer_load_dwordx4 v3, s[68:71], s55 offen lds
  s_add_u32 m0, s58, 33792
  s_nop 0
  buffer_load_dwordx4 v4, s[68:71], s55 offen lds
  s_add_u32 m0, s58, 34816
  s_nop 0
  buffer_load_dwordx4 v5, s[68:71], s55 offen lds
  s_add_u32 m0, s58, 35840
  s_nop 0
  buffer_load_dwordx4 v6, s[68:71], s55 offen lds
  s_waitcnt vmcnt(12)
  s_barrier
  s_add_u32 s53, s39, 12
  s_and_b32 s53, s53, 15
  s_or_b32 s53, s53, 16
  s_mul_i32 s54, s53, 114688
  s_add_u32 m0, s64, 0
  s_nop 0
  buffer_load_dwordx4 v1, s[24:27], s54 offen sc1 lds
  s_add_u32 m0, s64, 1024
  s_nop 0
  buffer_load_dwordx4 v2, s[24:27], s54 offen sc1 lds
  s_add_u32 s53, s39, 9
  s_and_b32 s53, s53, 15
  s_or_b32 s53, s53, 16
  s_lshl_b32 s55, s53, 7
  s_add_u32 m0, s58, 98304
  s_nop 0
  buffer_load_dwordx4 v3, s[68:71], s55 offen lds
  s_add_u32 m0, s58, 99328
  s_nop 0
  buffer_load_dwordx4 v4, s[68:71], s55 offen lds
  s_add_u32 m0, s58, 100352
  s_nop 0
  buffer_load_dwordx4 v5, s[68:71], s55 offen lds
  s_add_u32 m0, s58, 101376
  s_nop 0
  buffer_load_dwordx4 v6, s[68:71], s55 offen lds
  s_waitcnt vmcnt(12)
  s_barrier
  s_add_u32 s53, s39, 13
  s_and_b32 s53, s53, 15
  s_or_b32 s53, s53, 16
  s_mul_i32 s54, s53, 114688
  s_add_u32 m0, s64, 8192
  s_nop 0
  buffer_load_dwordx4 v1, s[24:27], s54 offen sc1 lds
  s_add_u32 m0, s64, 9216
  s_nop 0
  buffer_load_dwordx4 v2, s[24:27], s54 offen sc1 lds
  s_add_u32 s53, s39, 10
  s_and_b32 s53, s53, 15
  s_or_b32 s53, s53, 16
  s_lshl_b32 s55, s53, 7
  s_add_u32 m0, s58, 114688
  s_nop 0
  buffer_load_dwordx4 v3, s[68:71], s55 offen lds
  s_add_u32 m0, s58, 115712
  s_nop 0
  buffer_load_dwordx4 v4, s[68:71], s55 offen lds
  s_add_u32 m0, s58, 116736
  s_nop 0
  buffer_load_dwordx4 v5, s[68:71], s55 offen lds
  s_add_u32 m0, s58, 117760
  s_nop 0
  buffer_load_dwordx4 v6, s[68:71], s55 offen lds
  s_waitcnt vmcnt(12)
  s_barrier
  s_add_u32 s53, s39, 14
  s_and_b32 s53, s53, 15
  s_or_b32 s53, s53, 16
  s_mul_i32 s54, s53, 114688
  s_add_u32 m0, s64, 16384
  s_nop 0
  buffer_load_dwordx4 v1, s[24:27], s54 offen sc1 lds
  s_add_u32 m0, s64, 17408
  s_nop 0
  buffer_load_dwordx4 v2, s[24:27], s54 offen sc1 lds
  s_add_u32 s53, s39, 11
  s_and_b32 s53, s53, 15
  s_or_b32 s53, s53, 16
  s_lshl_b32 s55, s53, 7
  s_add_u32 m0, s58, 131072
  s_nop 0
  buffer_load_dwordx4 v3, s[68:71], s55 offen lds
  s_add_u32 m0, s58, 132096
  s_nop 0
  buffer_load_dwordx4 v4, s[68:71], s55 offen lds
  s_add_u32 m0, s58, 133120
  s_nop 0
  buffer_load_dwordx4 v5, s[68:71], s55 offen lds
  s_add_u32 m0, s58, 134144
  s_nop 0
  buffer_load_dwordx4 v6, s[68:71], s55 offen lds
  s_waitcnt vmcnt(12)
  s_barrier
  s_add_u32 s53, s39, 15
  s_and_b32 s53, s53, 15
  s_or_b32 s53, s53, 16
  s_mul_i32 s54, s53, 114688
  s_add_u32 m0, s64, 24576
  s_nop 0
  buffer_load_dwordx4 v1, s[24:27], s54 offen sc1 lds
  s_add_u32 m0, s64, 25600
  s_nop 0
  buffer_load_dwordx4 v2, s[24:27], s54 offen sc1 lds
  s_add_u32 s53, s39, 12
  s_and_b32 s53, s53, 15
  s_or_b32 s53, s53, 16
  s_lshl_b32 s55, s53, 7
  s_add_u32 m0, s58, 147456
  s_nop 0
  buffer_load_dwordx4 v3, s[68:71], s55 offen lds
  s_add_u32 m0, s58, 148480
  s_nop 0
  buffer_load_dwordx4 v4, s[68:71], s55 offen lds
  s_add_u32 m0, s58, 149504
  s_nop 0
  buffer_load_dwordx4 v5, s[68:71], s55 offen lds
  s_add_u32 m0, s58, 150528
  s_nop 0
  buffer_load_dwordx4 v6, s[68:71], s55 offen lds
  s_waitcnt vmcnt(12)
  s_barrier
  s_add_u32 s53, s39, 13
  s_and_b32 s53, s53, 15
  s_or_b32 s53, s53, 16
  s_lshl_b32 s55, s53, 7
  s_add_u32 m0, s58, 32768
  s_nop 0
  buffer_load_dwordx4 v3, s[68:71], s55 offen lds
  s_add_u32 m0, s58, 33792
  s_nop 0
  buffer_load_dwordx4 v4, s[68:71], s55 offen lds
  s_add_u32 m0, s58, 34816
  s_nop 0
  buffer_load_dwordx4 v5, s[68:71], s55 offen lds
  s_add_u32 m0, s58, 35840
  s_nop 0
  buffer_load_dwordx4 v6, s[68:71], s55 offen lds
  s_waitcnt vmcnt(10)
  s_barrier
  s_add_u32 s53, s39, 14
  s_and_b32 s53, s53, 15
  s_or_b32 s53, s53, 16
  s_lshl_b32 s55, s53, 7
  s_add_u32 m0, s58, 98304
  s_nop 0
  buffer_load_dwordx4 v3, s[68:71], s55 offen lds
  s_add_u32 m0, s58, 99328
  s_nop 0
  buffer_load_dwordx4 v4, s[68:71], s55 offen lds
  s_add_u32 m0, s58, 100352
  s_nop 0
  buffer_load_dwordx4 v5, s[68:71], s55 offen lds
  s_add_u32 m0, s58, 101376
  s_nop 0
  buffer_load_dwordx4 v6, s[68:71], s55 offen lds
  s_waitcnt vmcnt(8)
  s_barrier
  s_add_u32 s53, s39, 15
  s_and_b32 s53, s53, 15
  s_or_b32 s53, s53, 16
  s_lshl_b32 s55, s53, 7
  s_add_u32 m0, s58, 114688
  s_nop 0
  buffer_load_dwordx4 v3, s[68:71], s55 offen lds
  s_add_u32 m0, s58, 115712
  s_nop 0
  buffer_load_dwordx4 v4, s[68:71], s55 offen lds
  s_add_u32 m0, s58, 116736
  s_nop 0
  buffer_load_dwordx4 v5, s[68:71], s55 offen lds
  s_add_u32 m0, s58, 117760
  s_nop 0
  buffer_load_dwordx4 v6, s[68:71], s55 offen lds
  s_waitcnt vmcnt(8)
  s_barrier
  s_add_u32 s53, s95, 0
  s_cmp_ge_u32 s53, 14
  s_cselect_b32 s54, 14, 0
  s_sub_u32 s53, s53, s54
  s_cmp_ge_u32 s53, 7
  s_cselect_b32 s54, 7, 0
  s_sub_u32 s53, s53, s54
  s_lshl_b32 s54, s53, 13
  s_add_u32 m0, s57, 49152
  s_nop 0
  buffer_load_dwordx4 v28, s[28:31], s54 offen offset:0 lds
  buffer_load_dwordx4 v28, s[28:31], s54 offen offset:1024 lds
  buffer_load_dwordx4 v28, s[28:31], s54 offen offset:2048 lds
  buffer_load_dwordx4 v28, s[28:31], s54 offen offset:3072 lds
  s_add_u32 s53, s95, 1
  s_cmp_ge_u32 s53, 14
  s_cselect_b32 s54, 14, 0
  s_sub_u32 s53, s53, s54
  s_cmp_ge_u32 s53, 7
  s_cselect_b32 s54, 7, 0
  s_sub_u32 s53, s53, s54
  s_lshl_b32 s54, s53, 13
  s_add_u32 m0, s57, 65536
  s_nop 0
  buffer_load_dwordx4 v28, s[28:31], s54 offen offset:0 lds
  buffer_load_dwordx4 v28, s[28:31], s54 offen offset:1024 lds
  buffer_load_dwordx4 v28, s[28:31], s54 offen offset:2048 lds
  buffer_load_dwordx4 v28, s[28:31], s54 offen offset:3072 lds
  s_add_u32 s53, s95, 2
  s_cmp_ge_u32 s53, 14
  s_cselect_b32 s54, 14, 0
  s_sub_u32 s53, s53, s54
  s_cmp_ge_u32 s53, 7
  s_cselect_b32 s54, 7, 0
  s_sub_u32 s53, s53, s54
  s_lshl_b32 s54, s53, 13
  s_add_u32 m0, s57, 73728
  s_nop 0
  buffer_load_dwordx4 v28, s[28:31], s54 offen offset:0 lds
  buffer_load_dwordx4 v28, s[28:31], s54 offen offset:1024 lds
  buffer_load_dwordx4 v28, s[28:31], s54 offen offset:2048 lds
  buffer_load_dwordx4 v28, s[28:31], s54 offen offset:3072 lds
  s_waitcnt vmcnt(16)
  s_barrier
  s_add_u32 s53, s95, 3
  s_cmp_ge_u32 s53, 14
  s_cselect_b32 s54, 14, 0
  s_sub_u32 s53, s53, s54
  s_cmp_ge_u32 s53, 7
  s_cselect_b32 s54, 7, 0
  s_sub_u32 s53, s53, s54
  s_lshl_b32 s54, s53, 13
  s_add_u32 m0, s57, 81920
  s_nop 0
  buffer_load_dwordx4 v28, s[28:31], s54 offen offset:0 lds
  buffer_load_dwordx4 v28, s[28:31], s54 offen offset:1024 lds
  buffer_load_dwordx4 v28, s[28:31], s54 offen offset:2048 lds
  buffer_load_dwordx4 v28, s[28:31], s54 offen offset:3072 lds
  s_add_u32 s53, s95, 4
  s_cmp_ge_u32 s53, 14
  s_cselect_b32 s54, 14, 0
  s_sub_u32 s53, s53, s54
  s_cmp_ge_u32 s53, 7
  s_cselect_b32 s54, 7, 0
  s_sub_u32 s53, s53, s54
  s_lshl_b32 s54, s53, 13
  s_add_u32 m0, s57, 90112
  s_nop 0
  buffer_load_dwordx4 v28, s[28:31], s54 offen offset:0 lds
  buffer_load_dwordx4 v28, s[28:31], s54 offen offset:1024 lds
  buffer_load_dwordx4 v28, s[28:31], s54 offen offset:2048 lds
  buffer_load_dwordx4 v28, s[28:31], s54 offen offset:3072 lds
  s_add_u32 s53, s95, 5
  s_cmp_ge_u32 s53, 14
  s_cselect_b32 s54, 14, 0
  s_sub_u32 s53, s53, s54
  s_cmp_ge_u32 s53, 7
  s_cselect_b32 s54, 7, 0
  s_sub_u32 s53, s53, s54
  s_lshl_b32 s54, s53, 13
  s_add_u32 m0, s57, 131072
  s_nop 0
  buffer_load_dwordx4 v28, s[28:31], s54 offen offset:0 lds
  buffer_load_dwordx4 v28, s[28:31], s54 offen offset:1024 lds
  buffer_load_dwordx4 v28, s[28:31], s54 offen offset:2048 lds
  buffer_load_dwordx4 v28, s[28:31], s54 offen offset:3072 lds
  s_waitcnt vmcnt(24)
  s_barrier
  s_add_u32 s53, s95, 6
  s_cmp_ge_u32 s53, 14
  s_cselect_b32 s54, 14, 0
  s_sub_u32 s53, s53, s54
  s_cmp_ge_u32 s53, 7
  s_cselect_b32 s54, 7, 0
  s_sub_u32 s53, s53, s54
  s_lshl_b32 s54, s53, 13
  s_add_u32 m0, s57, 8192
  s_nop 0
  buffer_load_dwordx4 v28, s[28:31], s54 offen offset:0 lds
  buffer_load_dwordx4 v28, s[28:31], s54 offen offset:1024 lds
  buffer_load_dwordx4 v28, s[28:31], s54 offen offset:2048 lds
  buffer_load_dwordx4 v28, s[28:31], s54 offen offset:3072 lds
  s_add_u32 s53, s94, 0
  s_cmp_ge_u32 s53, 28
  s_cselect_b32 s54, 28, 0
  s_sub_u32 s53, s53, s54
  s_cmp_ge_u32 s53, 14
  s_cselect_b32 s54, 14, 0
  s_sub_u32 s53, s53, s54
  s_mul_i32 s54, s53, 57344
  s_add_u32 m0, s57, 32768
  s_nop 0
  buffer_load_dwordx4 v24, s[76:79], s54 offen lds
  s_add_u32 m0, s57, 33792
  s_nop 0
  buffer_load_dwordx4 v25, s[76:79], s54 offen lds
  s_add_u32 m0, s57, 34816
  s_nop 0
  buffer_load_dwordx4 v26, s[76:79], s54 offen lds
  s_add_u32 m0, s57, 35840
  s_nop 0
  buffer_load_dwordx4 v27, s[76:79], s54 offen lds
  s_add_u32 s53, s94, 1
  s_cmp_ge_u32 s53, 28
  s_cselect_b32 s54, 28, 0
  s_sub_u32 s53, s53, s54
  s_cmp_ge_u32 s53, 14
  s_cselect_b32 s54, 14, 0
  s_sub_u32 s53, s53, s54
  s_mul_i32 s54, s53, 57344
  s_add_u32 m0, s57, 40960
  s_nop 0
  buffer_load_dwordx4 v24, s[76:79], s54 offen lds
  s_add_u32 m0, s57, 41984
  s_nop 0
  buffer_load_dwordx4 v25, s[76:79], s54 offen lds
  s_add_u32 m0, s57, 43008
  s_nop 0
  buffer_load_dwordx4 v26, s[76:79], s54 offen lds
  s_add_u32 m0, s57, 44032
  s_nop 0
  buffer_load_dwordx4 v27, s[76:79], s54 offen lds
  s_waitcnt vmcnt(32)
  s_barrier
  s_add_u32 s53, s94, 2
  s_cmp_ge_u32 s53, 28
  s_cselect_b32 s54, 28, 0
  s_sub_u32 s53, s53, s54
  s_cmp_ge_u32 s53, 14
  s_cselect_b32 s54, 14, 0
  s_sub_u32 s53, s53, s54
  s_mul_i32 s54, s53, 57344
  s_add_u32 m0, s57, 24576
  s_nop 0
  buffer_load_dwordx4 v24, s[76:79], s54 offen lds
  s_add_u32 m0, s57, 25600
  s_nop 0
  buffer_load_dwordx4 v25, s[76:79], s54 offen lds
  s_add_u32 m0, s57, 26624
  s_nop 0
  buffer_load_dwordx4 v26, s[76:79], s54 offen lds
  s_add_u32 m0, s57, 27648
  s_nop 0
  buffer_load_dwordx4 v27, s[76:79], s54 offen lds
  s_add_u32 s53, s94, 3
  s_cmp_ge_u32 s53, 28
  s_cselect_b32 s54, 28, 0
  s_sub_u32 s53, s53, s54
  s_cmp_ge_u32 s53, 14
  s_cselect_b32 s54, 14, 0
  s_sub_u32 s53, s53, s54
  s_mul_i32 s54, s53, 57344
  s_add_u32 m0, s57, 98304
  s_nop 0
  buffer_load_dwordx4 v24, s[76:79], s54 offen lds
  s_add_u32 m0, s57, 99328
  s_nop 0
  buffer_load_dwordx4 v25, s[76:79], s54 offen lds
  s_add_u32 m0, s57, 100352
  s_nop 0
  buffer_load_dwordx4 v26, s[76:79], s54 offen lds
  s_add_u32 m0, s57, 101376
  s_nop 0
  buffer_load_dwordx4 v27, s[76:79], s54 offen lds
  s_waitcnt vmcnt(36)
  s_barrier
  s_add_u32 s53, s94, 4
  s_cmp_ge_u32 s53, 28
  s_cselect_b32 s54, 28, 0
  s_sub_u32 s53, s53, s54
  s_cmp_ge_u32 s53, 14
  s_cselect_b32 s54, 14, 0
  s_sub_u32 s53, s53, s54
  s_mul_i32 s54, s53, 57344
  s_add_u32 m0, s57, 114688
  s_nop 0
  buffer_load_dwordx4 v24, s[76:79], s54 offen lds
  s_add_u32 m0, s57, 115712
  s_nop 0
  buffer_load_dwordx4 v25, s[76:79], s54 offen lds
  s_add_u32 m0, s57, 116736
  s_nop 0
  buffer_load_dwordx4 v26, s[76:79], s54 offen lds
  s_add_u32 m0, s57, 117760
  s_nop 0
  buffer_load_dwordx4 v27, s[76:79], s54 offen lds
  s_add_u32 s53, s94, 5
  s_cmp_ge_u32 s53, 28
  s_cselect_b32 s54, 28, 0
  s_sub_u32 s53, s53, s54
  s_cmp_ge_u32 s53, 14
  s_cselect_b32 s54, 14, 0
  s_sub_u32 s53, s53, s54
  s_mul_i32 s54, s53, 57344
  s_add_u32 m0, s57, 122880
  s_nop 0
  buffer_load_dwordx4 v24, s[76:79], s54 offen lds
  s_add_u32 m0, s57, 123904
  s_nop 0
  buffer_load_dwordx4 v25, s[76:79], s54 offen lds
  s_add_u32 m0, s57, 124928
  s_nop 0
  buffer_load_dwordx4 v26, s[76:79], s54 offen lds
  s_add_u32 m0, s57, 125952
  s_nop 0
  buffer_load_dwordx4 v27, s[76:79], s54 offen lds
  s_waitcnt vmcnt(40)
  s_barrier
  s_add_u32 s53, s94, 6
  s_cmp_ge_u32 s53, 28
  s_cselect_b32 s54, 28, 0
  s_sub_u32 s53, s53, s54
  s_cmp_ge_u32 s53, 14
  s_cselect_b32 s54, 14, 0
  s_sub_u32 s53, s53, s54
  s_mul_i32 s54, s53, 57344
  s_add_u32 m0, s57, 139264
  s_nop 0
  buffer_load_dwordx4 v24, s[76:79], s54 offen lds
  s_add_u32 m0, s57, 140288
  s_nop 0
  buffer_load_dwordx4 v25, s[76:79], s54 offen lds
  s_add_u32 m0, s57, 141312
  s_nop 0
  buffer_load_dwordx4 v26, s[76:79], s54 offen lds
  s_add_u32 m0, s57, 142336
  s_nop 0
  buffer_load_dwordx4 v27, s[76:79], s54 offen lds
  s_waitcnt vmcnt(40)
  s_barrier
  s_add_u32 s53, s94, 7
  s_cmp_ge_u32 s53, 28
  s_cselect_b32 s54, 28, 0
  s_sub_u32 s53, s53, s54
  s_cmp_ge_u32 s53, 14
  s_cselect_b32 s54, 14, 0
  s_sub_u32 s53, s53, s54
  s_mul_i32 s54, s53, 57344
  s_add_u32 m0, s57, 65536
  s_nop 0
  buffer_load_dwordx4 v24, s[76:79], s54 offen lds
  s_add_u32 m0, s57, 66560
  s_nop 0
  buffer_load_dwordx4 v25, s[76:79], s54 offen lds
  s_add_u32 m0, s57, 67584
  s_nop 0
  buffer_load_dwordx4 v26, s[76:79], s54 offen lds
  s_add_u32 m0, s57, 68608
  s_nop 0
  buffer_load_dwordx4 v27, s[76:79], s54 offen lds
  s_add_u32 s53, s94, 8
  s_cmp_ge_u32 s53, 28
  s_cselect_b32 s54, 28, 0
  s_sub_u32 s53, s53, s54
  s_cmp_ge_u32 s53, 14
  s_cselect_b32 s54, 14, 0
  s_sub_u32 s53, s53, s54
  s_mul_i32 s54, s53, 57344
  s_add_u32 m0, s57, 0
  s_nop 0
  buffer_load_dwordx4 v24, s[76:79], s54 offen lds
  s_add_u32 m0, s57, 1024
  s_nop 0
  buffer_load_dwordx4 v25, s[76:79], s54 offen lds
  s_add_u32 m0, s57, 2048
  s_nop 0
  buffer_load_dwordx4 v26, s[76:79], s54 offen lds
  s_add_u32 m0, s57, 3072
  s_nop 0
  buffer_load_dwordx4 v27, s[76:79], s54 offen lds
  s_waitcnt vmcnt(44)
  s_barrier
  s_add_u32 s53, s94, 9
  s_cmp_ge_u32 s53, 28
  s_cselect_b32 s54, 28, 0
  s_sub_u32 s53, s53, s54
  s_cmp_ge_u32 s53, 14
  s_cselect_b32 s54, 14, 0
  s_sub_u32 s53, s53, s54
  s_mul_i32 s54, s53, 57344
  s_add_u32 m0, s57, 73728
  s_nop 0
  buffer_load_dwordx4 v24, s[76:79], s54 offen lds
  s_add_u32 m0, s57, 74752
  s_nop 0
  buffer_load_dwordx4 v25, s[76:79], s54 offen lds
  s_add_u32 m0, s57, 75776
  s_nop 0
  buffer_load_dwordx4 v26, s[76:79], s54 offen lds
  s_add_u32 m0, s57, 76800
  s_nop 0
  buffer_load_dwordx4 v27, s[76:79], s54 offen lds
  s_add_u32 s53, s94, 10
  s_cmp_ge_u32 s53, 28
  s_cselect_b32 s54, 28, 0
  s_sub_u32 s53, s53, s54
  s_cmp_ge_u32 s53, 14
  s_cselect_b32 s54, 14, 0
  s_sub_u32 s53, s53, s54
  s_mul_i32 s54, s53, 57344
  s_add_u32 m0, s57, 147456
  s_nop 0
  buffer_load_dwordx4 v24, s[76:79], s54 offen lds
  s_add_u32 m0, s57, 148480
  s_nop 0
  buffer_load_dwordx4 v25, s[76:79], s54 offen lds
  s_add_u32 m0, s57, 149504
  s_nop 0
  buffer_load_dwordx4 v26, s[76:79], s54 offen lds
  s_add_u32 m0, s57, 150528
  s_nop 0
  buffer_load_dwordx4 v27, s[76:79], s54 offen lds
  s_waitcnt vmcnt(48)
  s_barrier
  s_waitcnt vmcnt(44)
  s_barrier
  s_waitcnt vmcnt(36)
  s_barrier
  s_waitcnt vmcnt(28)
  s_barrier
  s_add_u32 s53, s94, 11
  s_cmp_ge_u32 s53, 28
  s_cselect_b32 s54, 28, 0
  s_sub_u32 s53, s53, s54
  s_cmp_ge_u32 s53, 14
  s_cselect_b32 s54, 14, 0
  s_sub_u32 s53, s53, s54
  s_mul_i32 s54, s53, 57344
  s_add_u32 m0, s57, 8192
  s_nop 0
  buffer_load_dwordx4 v24, s[76:79], s54 offen lds
  s_add_u32 m0, s57, 9216
  s_nop 0
  buffer_load_dwordx4 v25, s[76:79], s54 offen lds
  s_add_u32 m0, s57, 10240
  s_nop 0
  buffer_load_dwordx4 v26, s[76:79], s54 offen lds
  s_add_u32 m0, s57, 11264
  s_nop 0
  buffer_load_dwordx4 v27, s[76:79], s54 offen lds
  s_add_u32 s53, s94, 12
  s_cmp_ge_u32 s53, 28
  s_cselect_b32 s54, 28, 0
  s_sub_u32 s53, s53, s54
  s_cmp_ge_u32 s53, 14
  s_cselect_b32 s54, 14, 0
  s_sub_u32 s53, s53, s54
  s_mul_i32 s54, s53, 57344
  s_add_u32 m0, s57, 32768
  s_nop 0
  buffer_load_dwordx4 v24, s[76:79], s54 offen lds
  s_add_u32 m0, s57, 33792
  s_nop 0
  buffer_load_dwordx4 v25, s[76:79], s54 offen lds
  s_add_u32 m0, s57, 34816
  s_nop 0
  buffer_load_dwordx4 v26, s[76:79], s54 offen lds
  s_add_u32 m0, s57, 35840
  s_nop 0
  buffer_load_dwordx4 v27, s[76:79], s54 offen lds
  s_waitcnt vmcnt(28)
  s_barrier
  s_add_u32 s53, s94, 13
  s_cmp_ge_u32 s53, 28
  s_cselect_b32 s54, 28, 0
  s_sub_u32 s53, s53, s54
  s_cmp_ge_u32 s53, 14
  s_cselect_b32 s54, 14, 0
  s_sub_u32 s53, s53, s54
  s_mul_i32 s54, s53, 57344
  s_add_u32 m0, s57, 155648
  s_nop 0
  buffer_load_dwordx4 v24, s[76:79], s54 offen lds
  s_add_u32 m0, s57, 156672
  s_nop 0
  buffer_load_dwordx4 v25, s[76:79], s54 offen lds
  s_add_u32 m0, s57, 157696
  s_nop 0
  buffer_load_dwordx4 v26, s[76:79], s54 offen lds
  s_add_u32 m0, s57, 158720
  s_nop 0
  buffer_load_dwordx4 v27, s[76:79], s54 offen lds
  s_waitcnt vmcnt(24)
  s_barrier
  s_waitcnt vmcnt(16)
  s_barrier
  s_waitcnt vmcnt(8)
  s_barrier
  s_waitcnt vmcnt(0)
  s_barrier
  s_endpgm
MK_roleD:
  v_lshlrev_b32 v7, 4, v0
  s_mul_i32 s52, s37, 28672
  s_add_u32 s52, s52, s66
  s_waitcnt vmcnt(6)
  s_barrier
  s_lshl_b32 s54, s42, 7
  s_add_u32 m0, s65, 131072
  s_nop 0
  buffer_load_dwordx4 v1, s[16:19], s54 offen lds
  s_add_u32 m0, s65, 132096
  s_nop 0
  buffer_load_dwordx4 v2, s[16:19], s54 offen lds
  s_add_u32 m0, s65, 133120
  s_nop 0
  buffer_load_dwordx4 v3, s[16:19], s54 offen lds
  s_add_u32 m0, s65, 134144
  s_nop 0
  buffer_load_dwordx4 v4, s[16:19], s54 offen lds
  s_lshl_b32 s54, s42, 7
  s_add_u32 s54, s54, 57344
  s_add_u32 m0, s65, 139264
  s_nop 0
  buffer_load_dwordx4 v1, s[16:19], s54 offen lds
  s_add_u32 m0, s65, 140288
  s_nop 0
  buffer_load_dwordx4 v2, s[16:19], s54 offen lds
  s_add_u32 m0, s65, 141312
  s_nop 0
  buffer_load_dwordx4 v3, s[16:19], s54 offen lds
  s_add_u32 m0, s65, 142336
  s_nop 0
  buffer_load_dwordx4 v4, s[16:19], s54 offen lds
  s_mul_i32 s54, s42, 229376
  s_add_u32 s54, s54, 1792
  s_add_u32 m0, s64, 16384
  s_nop 0
  buffer_load_dwordx4 v5, s[20:23], s54 offen lds
  s_add_u32 m0, s64, 17408
  s_nop 0
  buffer_load_dwordx4 v6, s[20:23], s54 offen lds
  s_mul_i32 s54, s42, 229376
  s_add_u32 s54, s54, 116480
  s_add_u32 m0, s64, 20480
  s_nop 0
  buffer_load_dwordx4 v5, s[20:23], s54 offen lds
  s_add_u32 m0, s64, 21504
  s_nop 0
  buffer_load_dwordx4 v6, s[20:23], s54 offen lds
  s_waitcnt vmcnt(12)
  s_barrier
  s_lshl_b32 s54, s43, 7
  s_add_u32 m0, s65, 147456
  s_nop 0
  buffer_load_dwordx4 v1, s[16:19], s54 offen lds
  s_add_u32 m0, s65, 148480
  s_nop 0
  buffer_load_dwordx4 v2, s[16:19], s54 offen lds
  s_add_u32 m0, s65, 149504
  s_nop 0
  buffer_load_dwordx4 v3, s[16:19], s54 offen lds
  s_add_u32 m0, s65, 150528
  s_nop 0
  buffer_load_dwordx4 v4, s[16:19], s54 offen lds
  s_lshl_b32 s54, s43, 7
  s_add_u32 s54, s54, 57344
  s_add_u32 m0, s65, 155648
  s_nop 0
  buffer_load_dwordx4 v1, s[16:19], s54 offen lds
  s_add_u32 m0, s65, 156672
  s_nop 0
  buffer_load_dwordx4 v2, s[16:19], s54 offen lds
  s_add_u32 m0, s65, 157696
  s_nop 0
  buffer_load_dwordx4 v3, s[16:19], s54 offen lds
  s_add_u32 m0, s65, 158720
  s_nop 0
  buffer_load_dwordx4 v4, s[16:19], s54 offen lds
  s_mul_i32 s54, s43, 229376
  s_add_u32 s54, s54, 1792
  s_add_u32 m0, s64, 24576
  s_nop 0
  buffer_load_dwordx4 v5, s[20:23], s54 offen lds
  s_add_u32 m0, s64, 25600
  s_nop 0
  buffer_load_dwordx4 v6, s[20:23], s54 offen lds
  s_mul_i32 s54, s43, 229376
  s_add_u32 s54, s54, 116480
  s_add_u32 m0, s64, 28672
  s_nop 0
  buffer_load_dwordx4 v5, s[20:23], s54 offen lds
  s_add_u32 m0, s64, 29696
  s_nop 0
  buffer_load_dwordx4 v6, s[20:23], s54 offen lds
  s_waitcnt vmcnt(12)
  s_barrier
  s_lshl_b32 s54, s44, 7
  s_add_u32 m0, s65, 98304
  s_nop 0
  buffer_load_dwordx4 v1, s[16:19], s54 offen lds
  s_add_u32 m0, s65, 99328
  s_nop 0
  buffer_load_dwordx4 v2, s[16:19], s54 offen lds
  s_add_u32 m0, s65, 100352
  s_nop 0
  buffer_load_dwordx4 v3, s[16:19], s54 offen lds
  s_add_u32 m0, s65, 101376
  s_nop 0
  buffer_load_dwordx4 v4, s[16:19], s54 offen lds
  s_lshl_b32 s54, s44, 7
  s_add_u32 s54, s54, 57344
  s_add_u32 m0, s65, 106496
  s_nop 0
  buffer_load_dwordx4 v1, s[16:19], s54 offen lds
  s_add_u32 m0, s65, 107520
  s_nop 0
  buffer_load_dwordx4 v2, s[16:19], s54 offen lds
  s_add_u32 m0, s65, 108544
  s_nop 0
  buffer_load_dwordx4 v3, s[16:19], s54 offen lds
  s_add_u32 m0, s65, 109568
  s_nop 0
  buffer_load_dwordx4 v4, s[16:19], s54 offen lds
  s_mul_i32 s54, s44, 229376
  s_add_u32 s54, s54, 1792
  s_add_u32 m0, s64, 32768
  s_nop 0
  buffer_load_dwordx4 v5, s[20:23], s54 offen lds
  s_add_u32 m0, s64, 33792
  s_nop 0
  buffer_load_dwordx4 v6, s[20:23], s54 offen lds
  s_mul_i32 s54, s44, 229376
  s_add_u32 s54, s54, 116480
  s_add_u32 m0, s64, 36864
  s_nop 0
  buffer_load_dwordx4 v5, s[20:23], s54 offen lds
  s_add_u32 m0, s64, 37888
  s_nop 0
  buffer_load_dwordx4 v6, s[20:23], s54 offen lds
  s_waitcnt vmcnt(12)
  s_barrier
  s_lshl_b32 s54, s45, 7
  s_add_u32 m0, s65, 114688
  s_nop 0
  buffer_load_dwordx4 v1, s[16:19], s54 offen lds
  s_add_u32 m0, s65, 115712
  s_nop 0
  buffer_load_dwordx4 v2, s[16:19], s54 offen lds
  s_add_u32 m0, s65, 116736
  s_nop 0
  buffer_load_dwordx4 v3, s[16:19], s54 offen lds
  s_add_u32 m0, s65, 117760
  s_nop 0
  buffer_load_dwordx4 v4, s[16:19], s54 offen lds
  s_lshl_b32 s54, s45, 7
  s_add_u32 s54, s54, 57344
  s_add_u32 m0, s65, 122880
  s_nop 0
  buffer_load_dwordx4 v1, s[16:19], s54 offen lds
  s_add_u32 m0, s65, 123904
  s_nop 0
  buffer_load_dwordx4 v2, s[16:19], s54 offen lds
  s_add_u32 m0, s65, 124928
  s_nop 0
  buffer_load_dwordx4 v3, s[16:19], s54 offen lds
  s_add_u32 m0, s65, 125952
  s_nop 0
  buffer_load_dwordx4 v4, s[16:19], s54 offen lds
  s_mul_i32 s54, s45, 229376
  s_add_u32 s54, s54, 1792
  s_add_u32 m0, s64, 40960
  s_nop 0
  buffer_load_dwordx4 v5, s[20:23], s54 offen lds
  s_add_u32 m0, s64, 41984
  s_nop 0
  buffer_load_dwordx4 v6, s[20:23], s54 offen lds
  s_mul_i32 s54, s45, 229376
  s_add_u32 s54, s54, 116480
  s_add_u32 m0, s64, 45056
  s_nop 0
  buffer_load_dwordx4 v5, s[20:23], s54 offen lds
  s_add_u32 m0, s64, 46080
  s_nop 0
  buffer_load_dwordx4 v6, s[20:23], s54 offen lds
  s_waitcnt vmcnt(12)
  s_barrier
  s_lshl_b32 s54, s46, 7
  s_add_u32 m0, s65, 131072
  s_nop 0
  buffer_load_dwordx4 v1, s[16:19], s54 offen lds
  s_add_u32 m0, s65, 132096
  s_nop 0
  buffer_load_dwordx4 v2, s[16:19], s54 offen lds
  s_add_u32 m0, s65, 133120
  s_nop 0
  buffer_load_dwordx4 v3, s[16:19], s54 offen lds
  s_add_u32 m0, s65, 134144
  s_nop 0
  buffer_load_dwordx4 v4, s[16:19], s54 offen lds
  s_lshl_b32 s54, s46, 7
  s_add_u32 s54, s54, 57344
  s_add_u32 m0, s65, 139264
  s_nop 0
  buffer_load_dwordx4 v1, s[16:19], s54 offen lds
  s_add_u32 m0, s65, 140288
  s_nop 0
  buffer_load_dwordx4 v2, s[16:19], s54 offen lds
  s_add_u32 m0, s65, 141312
  s_nop 0
  buffer_load_dwordx4 v3, s[16:19], s54 offen lds
  s_add_u32 m0, s65, 142336
  s_nop 0
  buffer_load_dwordx4 v4, s[16:19], s54 offen lds
  s_mul_i32 s54, s46, 229376
  s_add_u32 s54, s54, 1792
  s_add_u32 m0, s64, 49152
  s_nop 0
  buffer_load_dwordx4 v5, s[20:23], s54 offen lds
  s_add_u32 m0, s64, 50176
  s_nop 0
  buffer_load_dwordx4 v6, s[20:23], s54 offen lds
  s_mul_i32 s54, s46, 229376
  s_add_u32 s54, s54, 116480
  s_add_u32 m0, s64, 53248
  s_nop 0
  buffer_load_dwordx4 v5, s[20:23], s54 offen lds
  s_add_u32 m0, s64, 54272
  s_nop 0
  buffer_load_dwordx4 v6, s[20:23], s54 offen lds
  s_waitcnt vmcnt(12)
  s_barrier
  s_lshl_b32 s54, s40, 12
  s_add_u32 s54, s54, s52
  s_add_u32 m0, s66, 65536
  s_nop 0
  buffer_load_dwordx4 v7, s[28:31], s54 offen lds
  buffer_load_dwordx4 v7, s[28:31], s54 offen offset:2048 lds
  s_lshl_b32 s54, s41, 12
  s_add_u32 s54, s54, s52
  s_add_u32 m0, s66, 69632
  s_nop 0
  buffer_load_dwordx4 v7, s[28:31], s54 offen lds
  buffer_load_dwordx4 v7, s[28:31], s54 offen offset:2048 lds
  s_lshl_b32 s54, s42, 12
  s_add_u32 s54, s54, s52
  s_add_u32 m0, s66, 73728
  s_nop 0
  buffer_load_dwordx4 v7, s[28:31], s54 offen lds
  buffer_load_dwordx4 v7, s[28:31], s54 offen offset:2048 lds
  s_lshl_b32 s54, s43, 12
  s_add_u32 s54, s54, s52
  s_add_u32 m0, s66, 77824
  s_nop 0
  buffer_load_dwordx4 v7, s[28:31], s54 offen lds
  buffer_load_dwordx4 v7, s[28:31], s54 offen offset:2048 lds
  s_lshl_b32 s54, s44, 12
  s_add_u32 s54, s54, s52
  s_add_u32 m0, s66, 81920
  s_nop 0
  buffer_load_dwordx4 v7, s[28:31], s54 offen lds
  buffer_load_dwordx4 v7, s[28:31], s54 offen offset:2048 lds
  s_lshl_b32 s54, s45, 12
  s_add_u32 s54, s54, s52
  s_add_u32 m0, s66, 86016
  s_nop 0
  buffer_load_dwordx4 v7, s[28:31], s54 offen lds
  buffer_load_dwordx4 v7, s[28:31], s54 offen offset:2048 lds
  s_lshl_b32 s54, s46, 12
  s_add_u32 s54, s54, s52
  s_add_u32 m0, s66, 90112
  s_nop 0
  buffer_load_dwordx4 v7, s[28:31], s54 offen lds
  buffer_load_dwordx4 v7, s[28:31], s54 offen offset:2048 lds
  s_waitcnt vmcnt(14)
  s_barrier
  v_lshrrev_b32 v1, 3, v0
  v_mul_u32_u24 v1, 1792, v1
  v_and_b32 v10, 7, v0
  v_bfe_u32 v11, v0, 4, 1
  v_lshlrev_b32 v11, 2, v11
  v_xor_b32 v10, v10, v11
  v_lshl_add_u32 v1, v10, 4, v1
  s_mul_i32 s8, s36, 28672
  s_lshl_b32 s9, s37, 7
  s_add_u32 s8, s8, s9
  s_add_u32 s8, s8, 4194304
  v_add_u32 v1, s8, v1
  v_add_u32 v2, 14336, v1
  s_lshr_b32 s8, s36, 1
  s_lshl_b32 s9, s8, 12
  s_add_u32 s58, s59, s9
  s_lshl_b32 s8, s8, 17
  v_add_u32 v3, s8, v22
  v_add_u32 v4, s8, v23
  v_add_u32 v5, 65536, v3
  v_add_u32 v6, 65536, v4
  v_lshlrev_b32 v12, 4, v0
  v_add_u32 v12, s59, v12
  v_add_u32 v13, 98304, v12
  s_waitcnt vmcnt(0)
  s_barrier
  s_lshr_b32 s57, s59, 1
  v_lshrrev_b32 v24, 3, v0
  v_mul_u32_u24 v24, 1792, v24
  v_and_b32 v10, 7, v0
  v_lshrrev_b32 v11, 4, v0
  v_xor_b32 v10, v10, v11
  v_lshl_add_u32 v24, v10, 4, v24
  v_lshrrev_b32 v25, 3, v0
  v_mul_u32_u24 v25, 1792, v25
  v_and_b32 v10, 7, v0
  v_lshrrev_b32 v11, 4, v0
  v_add_u32 v11, 4, v11
  v_xor_b32 v10, v10, v11
  v_lshl_add_u32 v25, v10, 4, v25
  s_lshl_b32 s8, s93, 6
  s_lshl_b32 s9, s36, 5
  s_add_u32 s8, s8, s9
  s_mul_i32 s8, s8, 1792
  s_add_u32 s8, s8, 12582912
  v_add_u32 v24, s8, v24
  s_add_u32 s8, s8, 14336
  v_add_u32 v25, s8, v25
  v_add_u32 v26, 28672, v24
  v_add_u32 v27, 28672, v25
  v_lshrrev_b32 v14, 3, v0
  v_mul_u32_u24 v14, 4224, v14
  v_and_b32 v10, 7, v0
  v_bfe_u32 v11, v0, 4, 1
  v_lshlrev_b32 v11, 2, v11
  v_xor_b32 v10, v10, v11
  v_lshl_add_u32 v14, v10, 4, v14
  s_mul_i32 s8, s36, 135168
  s_lshl_b32 s9, s93, 7
  s_add_u32 s8, s8, s9
  s_add_u32 s8, s8, 16777216
  v_add_u32 v14, s8, v14
  v_add_u32 v15, 33792, v14
  v_add_u32 v16, 67584, v14
  v_add_u32 v17, 101376, v14
  v_and_b32 v8, 31, v0
  v_lshlrev_b32 v8, 3, v8
MK_pollf:
  buffer_load_dword v9, v8, s[32:35], 0 offen sc1
  s_waitcnt vmcnt(0)
  v_cmp_ne_u32 vcc, 1, v9
  s_nop 4
  s_cbranch_vccz MK_pollf_ok
  s_sub_u32 s96, s96, 1
  s_cmp_eq_u32 s96, 0
  s_cbranch_scc1 MK_end
  s_sleep 4
  s_branch MK_pollf
MK_pollf_ok:
  v_lshlrev_b32 v8, 3, v0
  s_mul_i32 s8, s38, 14336
  s_lshl_b32 s9, s36, 9
  s_add_u32 s8, s8, s9
  s_add_u32 s8, s8, 18874368
  s_add_u32 s9, s8, 4096
  s_add_u32 s10, s8, 8192
  s_add_u32 s11, s8, 12288
MK_polls:
  buffer_load_dwordx2 v[28:29], v8, s[24:27], s8 offen offset:0 sc1
  buffer_load_dwordx2 v[30:31], v8, s[24:27], s8 offen offset:1024 sc1
  buffer_load_dwordx2 v[32:33], v8, s[24:27], s8 offen offset:2048 sc1
  buffer_load_dwordx2 v[34:35], v8, s[24:27], s8 offen offset:3072 sc1
  buffer_load_dwordx2 v[36:37], v8, s[24:27], s9 offen offset:0 sc1
  buffer_load_dwordx2 v[38:39], v8, s[24:27], s9 offen offset:1024 sc1
  buffer_load_dwordx2 v[40:41], v8, s[24:27], s9 offen offset:2048 sc1
  buffer_load_dwordx2 v[42:43], v8, s[24:27], s9 offen offset:3072 sc1
  buffer_load_dwordx2 v[44:45], v8, s[24:27], s10 offen offset:0 sc1
  buffer_load_dwordx2 v[46:47], v8, s[24:27], s10 offen offset:1024 sc1
  buffer_load_dwordx2 v[48:49], v8, s[24:27], s10 offen offset:2048 sc1
  buffer_load_dwordx2 v[50:51], v8, s[24:27], s10 offen offset:3072 sc1
  buffer_load_dwordx2 v[52:53], v8, s[24:27], s11 offen offset:0 sc1
  buffer_load_dwordx2 v[54:55], v8, s[24:27], s11 offen offset:1024 sc1
  s_waitcnt vmcnt(0)
  v_or3_b32 v9, v28, v29, v30
  v_or3_b32 v9, v9, v31, v32
  v_or3_b32 v9, v9, v33, v34
  v_or3_b32 v9, v9, v35, v36
  v_or3_b32 v9, v9, v37, v38
  v_or3_b32 v9, v9, v39, v40
  v_or3_b32 v9, v9, v41, v42
  v_or3_b32 v9, v9, v43, v44
  v_or3_b32 v9, v9, v45, v46
  v_or3_b32 v9, v9, v47, v48
  v_or3_b32 v9, v9, v49, v50
  v_or3_b32 v9, v9, v51, v52
  v_or3_b32 v9, v9, v53, v54
  v_or_b32 v9, v9, v55
  v_and_b32 v9, 1, v9
  v_cmp_ne_u32 vcc, 0, v9
  s_nop 4
  s_cbranch_vccz MK_polls_ok
  s_sub_u32 s96, s96, 1
  s_cmp_eq_u32 s96, 0
  s_cbranch_scc1 MK_end
  s_sleep 1
  s_branch MK_polls
MK_polls_ok:
  v_pk_add_f32 v[28:29], v[28:29], v[30:31]
  v_pk_add_f32 v[32:33], v[32:33], v[34:35]
  v_pk_add_f32 v[36:37], v[36:37], v[38:39]
  v_pk_add_f32 v[40:41], v[40:41], v[42:43]
  v_pk_add_f32 v[44:45], v[44:45], v[46:47]
  v_pk_add_f32 v[48:49], v[48:49], v[50:51]
  v_pk_add_f32 v[52:53], v[52:53], v[54:55]
  v_pk_add_f32 v[28:29], v[28:29], v[32:33]
  v_pk_add_f32 v[36:37], v[36:37], v[40:41]
  v_pk_add_f32 v[44:45], v[44:45], v[48:49]
  v_pk_add_f32 v[28:29], v[28:29], v[36:37]
  v_pk_add_f32 v[44:45], v[44:45], v[52:53]
  v_pk_add_f32 v[28:29], v[28:29], v[44:45]
  v_mul_f32 v9, 0x3a924925, v28
  v_mul_f32 v10, 0x3a924925, v29
  v_fma_f32 v10, -v9, v9, v10
  v_max_f32 v10, 0, v10
  v_cvt_pk_bf16_f32 v18, v9, v9
  v_lshlrev_b32 v18, 16, v18
  v_cvt_pk_bf16_f32 v10, v10, v10
  v_lshlrev_b32 v10, 16, v10
  v_add_f32 v10, 0x3727c5ac, v10
  v_cvt_pk_bf16_f32 v10, v10, v10
  v_lshlrev_b32 v10, 16, v10
  v_sqrt_f32 v10, v10
  s_nop 0
  v_cvt_pk_bf16_f32 v10, v10, v10
  v_lshlrev_b32 v10, 16, v10
  v_rcp_f32 v19, v10
  s_nop 0
  v_mul_f32 v18, v18, v19
  v_sub_f32 v18, 0, v18
  s_lshl_b32 s9, s36, 9
  v_add_u32 v21, s9, v8
  ds_write_b64 v21, v[18:19] offset:59904
  s_lshl_b32 s9, s36, 2
  v_mov_b32 v21, s9
  v_mov_b32 v9, 1
  ds_write_b32 v21, v9 offset:60932
  v_lshrrev_b32 v8, 2, v0
  v_lshlrev_b32 v8, 7, v8
  v_and_b32 v9, 3, v0
  v_lshl_add_u32 v8, v9, 2, v8
  v_mov_b32 v20, v8
  s_cmp_lg_u32 s36, 0
  s_cbranch_scc1 MK_djoin
  s_lshl_b32 s54, s37, 11
  s_add_u32 s54, s54, 19103744
  s_mov_b32 s62, s54
  v_mov_b32 v20, v8
  s_mov_b64 s[60:61], -1
  v_lshrrev_b32 v10, 2, v0
  s_mov_b64 s[60:61], 0
  s_add_u32 s53, s39, 0
  s_and_b32 s53, s53, 15
  s_lshr_b32 s53, s53, 1
  v_cmp_eq_u32 vcc, s53, v10
  s_nop 1
  s_or_b64 s[60:61], s[60:61], vcc
  s_add_u32 s53, s39, 1
  s_and_b32 s53, s53, 15
  s_lshr_b32 s53, s53, 1
  v_cmp_eq_u32 vcc, s53, v10
  s_nop 1
  s_or_b64 s[60:61], s[60:61], vcc
  s_add_u32 s53, s39, 2
  s_and_b32 s53, s53, 15
  s_lshr_b32 s53, s53, 1
  v_cmp_eq_u32 vcc, s53, v10
  s_nop 1
  s_or_b64 s[60:61], s[60:61], vcc
  s_add_u32 s53, s39, 3
  s_and_b32 s53, s53, 15
  s_lshr_b32 s53, s53, 1
  v_cmp_eq_u32 vcc, s53, v10
  s_nop 1
  s_or_b64 s[60:61], s[60:61], vcc
MK_pollA:
  buffer_load_dword v9, v8, s[24:27], s62 offen sc1
  s_waitcnt vmcnt(0)
  v_cmp_ne_u32 vcc, 1, v9
  s_nop 1
  s_and_b64 vcc, vcc, s[60:61]
  s_nop 1
  s_cbranch_vccz MK_pollA_ok
  s_sub_u32 s96, s96, 1
  s_cmp_eq_u32 s96, 0
  s_cbranch_scc1 MK_end
  s_sleep 1
  s_branch MK_pollA
MK_pollA_ok:
MK_djoin:
  s_waitcnt lgkmcnt(0)
  s_barrier
  s_add_u32 s53, s39, 0
  s_and_b32 s53, s53, 15
  s_mul_i32 s54, s53, 114688
  s_add_u32 m0, s64, 65536
  s_nop 0
  buffer_load_dwordx4 v1, s[24:27], s54 offen sc1 lds
  s_add_u32 m0, s64, 66560
  s_nop 0
  buffer_load_dwordx4 v2, s[24:27], s54 offen sc1 lds
  s_add_u32 s53, s39, 1
  s_and_b32 s53, s53, 15
  s_mul_i32 s54, s53, 114688
  s_add_u32 m0, s64, 73728
  s_nop 0
  buffer_load_dwordx4 v1, s[24:27], s54 offen sc1 lds
  s_add_u32 m0, s64, 74752
  s_nop 0
  buffer_load_dwordx4 v2, s[24:27], s54 offen sc1 lds
  s_add_u32 s53, s39, 2
  s_and_b32 s53, s53, 15
  s_mul_i32 s54, s53, 114688
  s_add_u32 m0, s64, 81920
  s_nop 0
  buffer_load_dwordx4 v1, s[24:27], s54 offen sc1 lds
  s_add_u32 m0, s64, 82944
  s_nop 0
  buffer_load_dwordx4 v2, s[24:27], s54 offen sc1 lds
  s_add_u32 s53, s39, 3
  s_and_b32 s53, s53, 15
  s_mul_i32 s54, s53, 114688
  s_add_u32 m0, s64, 90112
  s_nop 0
  buffer_load_dwordx4 v1, s[24:27], s54 offen sc1 lds
  s_add_u32 m0, s64, 91136
  s_nop 0
  buffer_load_dwordx4 v2, s[24:27], s54 offen sc1 lds
  s_add_u32 s53, s39, 2
  s_and_b32 s53, s53, 15
  s_lshl_b32 s55, s53, 7
  s_add_u32 m0, s58, 131072
  s_nop 0
  buffer_load_dwordx4 v3, s[68:71], s55 offen lds
  s_add_u32 m0, s58, 132096
  s_nop 0
  buffer_load_dwordx4 v4, s[68:71], s55 offen lds
  s_add_u32 m0, s58, 133120
  s_nop 0
  buffer_load_dwordx4 v5, s[68:71], s55 offen lds
  s_add_u32 m0, s58, 134144
  s_nop 0
  buffer_load_dwordx4 v6, s[68:71], s55 offen lds
  s_add_u32 s53, s39, 3
  s_and_b32 s53, s53, 15
  s_lshl_b32 s55, s53, 7
  s_add_u32 m0, s58, 147456
  s_nop 0
  buffer_load_dwordx4 v3, s[68:71], s55 offen lds
  s_add_u32 m0, s58, 148480
  s_nop 0
  buffer_load_dwordx4 v4, s[68:71], s55 offen lds
  s_add_u32 m0, s58, 149504
  s_nop 0
  buffer_load_dwordx4 v5, s[68:71], s55 offen lds
  s_add_u32 m0, s58, 150528
  s_nop 0
  buffer_load_dwordx4 v6, s[68:71], s55 offen lds
  s_waitcnt vmcnt(14)
  s_barrier
  s_add_u32 s53, s39, 4
  s_and_b32 s53, s53, 15
  s_lshl_b32 s55, s53, 7
  s_add_u32 m0, s58, 32768
  s_nop 0
  buffer_load_dwordx4 v3, s[68:71], s55 offen lds
  s_add_u32 m0, s58, 33792
  s_nop 0
  buffer_load_dwordx4 v4, s[68:71], s55 offen lds
  s_add_u32 m0, s58, 34816
  s_nop 0
  buffer_load_dwordx4 v5, s[68:71], s55 offen lds
  s_add_u32 m0, s58, 35840
  s_nop 0
  buffer_load_dwordx4 v6, s[68:71], s55 offen lds
  s_waitcnt vmcnt(16)
  s_barrier
  s_waitcnt vmcnt(8)
  s_cmp_lg_u32 s36, 0
  s_cbranch_scc1 MK_pA2_ok
  v_cmp_ne_u32 vcc, 1, v9
  s_nop 4
  s_cbranch_vccz MK_pA2_ok
MK_pA2:
  buffer_load_dword v9, v20, s[24:27], s62 offen sc1
  s_waitcnt vmcnt(0)
  v_cmp_ne_u32 vcc, 1, v9
  s_nop 4
  s_cbranch_vccz MK_pA2_ok
  s_sub_u32 s96, s96, 1
  s_cmp_eq_u32 s96, 0
  s_cbranch_scc1 MK_end
  s_sleep 0
  s_branch MK_pA2
MK_pA2_ok:
  s_barrier
  s_add_u32 s53, s39, 4
  s_and_b32 s53, s53, 15
  s_mul_i32 s54, s53, 114688
  s_add_u32 m0, s64, 0
  s_nop 0
  buffer_load_dwordx4 v1, s[24:27], s54 offen sc1 lds
  s_add_u32 m0, s64, 1024
  s_nop 0
  buffer_load_dwordx4 v2, s[24:27], s54 offen sc1 lds
  s_add_u32 s53, s39, 5
  s_and_b32 s53, s53, 15
  s_mul_i32 s54, s53, 114688
  s_add_u32 m0, s64, 8192
  s_nop 0
  buffer_load_dwordx4 v1, s[24:27], s54 offen sc1 lds
  s_add_u32 m0, s64, 9216
  s_nop 0
  buffer_load_dwordx4 v2, s[24:27], s54 offen sc1 lds
  s_add_u32 s53, s39, 6
  s_and_b32 s53, s53, 15
  s_mul_i32 s54, s53, 114688
  s_add_u32 m0, s64, 16384
  s_nop 0
  buffer_load_dwordx4 v1, s[24:27], s54 offen sc1 lds
  s_add_u32 m0, s64, 17408
  s_nop 0
  buffer_load_dwordx4 v2, s[24:27], s54 offen sc1 lds
  s_add_u32 s53, s39, 5
  s_and_b32 s53, s53, 15
  s_lshl_b32 s55, s53, 7
  s_add_u32 m0, s58, 98304
  s_nop 0
  buffer_load_dwordx4 v3, s[68:71], s55 offen lds
  s_add_u32 m0, s58, 99328
  s_nop 0
  buffer_load_dwordx4 v4, s[68:71], s55 offen lds
  s_add_u32 m0, s58, 100352
  s_nop 0
  buffer_load_dwordx4 v5, s[68:71], s55 offen lds
  s_add_u32 m0, s58, 101376
  s_nop 0
  buffer_load_dwordx4 v6, s[68:71], s55 offen lds
  s_waitcnt vmcnt(14)
  s_barrier
  s_add_u32 s53, s39, 7
  s_and_b32 s53, s53, 15
  s_mul_i32 s54, s53, 114688
  s_add_u32 m0, s64, 24576
  s_nop 0
  buffer_load_dwordx4 v1, s[24:27], s54 offen sc1 lds
  s_add_u32 m0, s64, 25600
  s_nop 0
  buffer_load_dwordx4 v2, s[24:27], s54 offen sc1 lds
  s_add_u32 s53, s39, 8
  s_and_b32 s53, s53, 15
  s_mul_i32 s54, s53, 114688
  s_add_u32 m0, s64, 65536
  s_nop 0
  buffer_load_dwordx4 v1, s[24:27], s54 offen sc1 lds
  s_add_u32 m0, s64, 66560
  s_nop 0
  buffer_load_dwordx4 v2, s[24:27], s54 offen sc1 lds
  s_add_u32 s53, s39, 9
  s_and_b32 s53, s53, 15
  s_mul_i32 s54, s53, 114688
  s_add_u32 m0, s64, 73728
  s_nop 0
  buffer_load_dwordx4 v1, s[24:27], s54 offen sc1 lds
  s_add_u32 m0, s64, 74752
  s_nop 0
  buffer_load_dwordx4 v2, s[24:27], s54 offen sc1 lds
  s_add_u32 s53, s39, 6
  s_and_b32 s53, s53, 15
  s_lshl_b32 s55, s53, 7
  s_add_u32 m0, s58, 114688
  s_nop 0
  buffer_load_dwordx4 v3, s[68:71], s55 offen lds
  s_add_u32 m0, s58, 115712
  s_nop 0
  buffer_load_dwordx4 v4, s[68:71], s55 offen lds
  s_add_u32 m0, s58, 116736
  s_nop 0
  buffer_load_dwordx4 v5, s[68:71], s55 offen lds
  s_add_u32 m0, s58, 117760
  s_nop 0
  buffer_load_dwordx4 v6, s[68:71], s55 offen lds
  s_waitcnt vmcnt(18)
  s_barrier
  s_add_u32 s53, s39, 10
  s_and_b32 s53, s53, 15
  s_mul_i32 s54, s53, 114688
  s_add_u32 m0, s64, 81920
  s_nop 0
  buffer_load_dwordx4 v1, s[24:27], s54 offen sc1 lds
  s_add_u32 m0, s64, 82944
  s_nop 0
  buffer_load_dwordx4 v2, s[24:27], s54 offen sc1 lds
  s_add_u32 s53, s39, 7
  s_and_b32 s53, s53, 15
  s_lshl_b32 s55, s53, 7
  s_add_u32 m0, s58, 131072
  s_nop 0
  buffer_load_dwordx4 v3, s[68:71], s55 offen lds
  s_add_u32 m0, s58, 132096
  s_nop 0
  buffer_load_dwordx4 v4, s[68:71], s55 offen lds
  s_add_u32 m0, s58, 133120
  s_nop 0
  buffer_load_dwordx4 v5, s[68:71], s55 offen lds
  s_add_u32 m0, s58, 134144
  s_nop 0
  buffer_load_dwordx4 v6, s[68:71], s55 offen lds
  s_waitcnt vmcnt(16)
  s_barrier
  s_add_u32 s53, s39, 11
  s_and_b32 s53, s53, 15
  s_mul_i32 s54, s53, 114688
  s_add_u32 m0, s64, 90112
  s_nop 0
  buffer_load_dwordx4 v1, s[24:27], s54 offen sc1 lds
  s_add_u32 m0, s64, 91136
  s_nop 0
  buffer_load_dwordx4 v2, s[24:27], s54 offen sc1 lds
  s_add_u32 s53, s39, 8
  s_and_b32 s53, s53, 15
  s_lshl_b32 s55, s53, 7
  s_add_u32 m0, s58, 147456
  s_nop 0
  buffer_load_dwordx4 v3, s[68:71], s55 offen lds
  s_add_u32 m0, s58, 148480
  s_nop 0
  buffer_load_dwordx4 v4, s[68:71], s55 offen lds
  s_add_u32 m0, s58, 149504
  s_nop 0
  buffer_load_dwordx4 v5, s[68:71], s55 offen lds
  s_add_u32 m0, s58, 150528
  s_nop 0
  buffer_load_dwordx4 v6, s[68:71], s55 offen lds
  s_waitcnt vmcnt(12)
  s_barrier
  s_add_u32 s53, s39, 12
  s_and_b32 s53, s53, 15
  s_mul_i32 s54, s53, 114688
  s_add_u32 m0, s64, 0
  s_nop 0
  buffer_load_dwordx4 v1, s[24:27], s54 offen sc1 lds
  s_add_u32 m0, s64, 1024
  s_nop 0
  buffer_load_dwordx4 v2, s[24:27], s54 offen sc1 lds
  s_add_u32 s53, s39, 9
  s_and_b32 s53, s53, 15
  s_lshl_b32 s55, s53, 7
  s_add_u32 m0, s58, 32768
  s_nop 0
  buffer_load_dwordx4 v3, s[68:71], s55 offen lds
  s_add_u32 m0, s58, 33792
  s_nop 0
  buffer_load_dwordx4 v4, s[68:71], s55 offen lds
  s_add_u32 m0, s58, 34816
  s_nop 0
  buffer_load_dwordx4 v5, s[68:71], s55 offen lds
  s_add_u32 m0, s58, 35840
  s_nop 0
  buffer_load_dwordx4 v6, s[68:71], s55 offen lds
  s_waitcnt vmcnt(12)
  s_barrier
  s_add_u32 s53, s39, 13
  s_and_b32 s53, s53, 15
  s_mul_i32 s54, s53, 114688
  s_add_u32 m0, s64, 8192
  s_nop 0
  buffer_load_dwordx4 v1, s[24:27], s54 offen sc1 lds
  s_add_u32 m0, s64, 9216
  s_nop 0
  buffer_load_dwordx4 v2, s[24:27], s54 offen sc1 lds
  s_add_u32 s53, s39, 10
  s_and_b32 s53, s53, 15
  s_lshl_b32 s55, s53, 7
  s_add_u32 m0, s58, 98304
  s_nop 0
  buffer_load_dwordx4 v3, s[68:71], s55 offen lds
  s_add_u32 m0, s58, 99328
  s_nop 0
  buffer_load_dwordx4 v4, s[68:71], s55 offen lds
  s_add_u32 m0, s58, 100352
  s_nop 0
  buffer_load_dwordx4 v5, s[68:71], s55 offen lds
  s_add_u32 m0, s58, 101376
  s_nop 0
  buffer_load_dwordx4 v6, s[68:71], s55 offen lds
  s_waitcnt vmcnt(12)
  s_barrier
  s_add_u32 s53, s39, 14
  s_and_b32 s53, s53, 15
  s_mul_i32 s54, s53, 114688
  s_add_u32 m0, s64, 16384
  s_nop 0
  buffer_load_dwordx4 v1, s[24:27], s54 offen sc1 lds
  s_add_u32 m0, s64, 17408
  s_nop 0
  buffer_load_dwordx4 v2, s[24:27], s54 offen sc1 lds
  s_add_u32 s53, s39, 11
  s_and_b32 s53, s53, 15
  s_lshl_b32 s55, s53, 7
  s_add_u32 m0, s58, 114688
  s_nop 0
  buffer_load_dwordx4 v3, s[68:71], s55 offen lds
  s_add_u32 m0, s58, 115712
  s_nop 0
  buffer_load_dwordx4 v4, s[68:71], s55 offen lds
  s_add_u32 m0, s58, 116736
  s_nop 0
  buffer_load_dwordx4 v5, s[68:71], s55 offen lds
  s_add_u32 m0, s58, 117760
  s_nop 0
  buffer_load_dwordx4 v6, s[68:71], s55 offen lds
  s_waitcnt vmcnt(12)
  s_barrier
  s_add_u32 s53, s39, 15
  s_and_b32 s53, s53, 15
  s_mul_i32 s54, s53, 114688
  s_add_u32 m0, s64, 24576
  s_nop 0
  buffer_load_dwordx4 v1, s[24:27], s54 offen sc1 lds
  s_add_u32 m0, s64, 25600
  s_nop 0
  buffer_load_dwordx4 v2, s[24:27], s54 offen sc1 lds
  s_add_u32 s53, s39, 12
  s_and_b32 s53, s53, 15
  s_lshl_b32 s55, s53, 7
  s_add_u32 m0, s58, 131072
  s_nop 0
  buffer_load_dwordx4 v3, s[68:71], s55 offen lds
  s_add_u32 m0, s58, 132096
  s_nop 0
  buffer_load_dwordx4 v4, s[68:71], s55 offen lds
  s_add_u32 m0, s58, 133120
  s_nop 0
  buffer_load_dwordx4 v5, s[68:71], s55 offen lds
  s_add_u32 m0, s58, 134144
  s_nop 0
  buffer_load_dwordx4 v6, s[68:71], s55 offen lds
  s_waitcnt vmcnt(12)
  s_barrier
  s_add_u32 s53, s39, 0
  s_and_b32 s53, s53, 15
  s_or_b32 s53, s53, 16
  s_mul_i32 s54, s53, 114688
  s_add_u32 m0, s64, 65536
  s_nop 0
  buffer_load_dwordx4 v1, s[24:27], s54 offen sc1 lds
  s_add_u32 m0, s64, 66560
  s_nop 0
  buffer_load_dwordx4 v2, s[24:27], s54 offen sc1 lds
  s_add_u32 s53, s39, 13
  s_and_b32 s53, s53, 15
  s_lshl_b32 s55, s53, 7
  s_add_u32 m0, s58, 147456
  s_nop 0
  buffer_load_dwordx4 v3, s[68:71], s55 offen lds
  s_add_u32 m0, s58, 148480
  s_nop 0
  buffer_load_dwordx4 v4, s[68:71], s55 offen lds
  s_add_u32 m0, s58, 149504
  s_nop 0
  buffer_load_dwordx4 v5, s[68:71], s55 offen lds
  s_add_u32 m0, s58, 150528
  s_nop 0
  buffer_load_dwordx4 v6, s[68:71], s55 offen lds
  s_waitcnt vmcnt(12)
  s_barrier
  s_add_u32 s53, s39, 1
  s_and_b32 s53, s53, 15
  s_or_b32 s53, s53, 16
  s_mul_i32 s54, s53, 114688
  s_add_u32 m0, s64, 73728
  s_nop 0
  buffer_load_dwordx4 v1, s[24:27], s54 offen sc1 lds
  s_add_u32 m0, s64, 74752
  s_nop 0
  buffer_load_dwordx4 v2, s[24:27], s54 offen sc1 lds
  s_add_u32 s53, s39, 14
  s_and_b32 s53, s53, 15
  s_lshl_b32 s55, s53, 7
  s_add_u32 m0, s58, 32768
  s_nop 0
  buffer_load_dwordx4 v3, s[68:71], s55 offen lds
  s_add_u32 m0, s58, 33792
  s_nop 0
  buffer_load_dwordx4 v4, s[68:71], s55 offen lds
  s_add_u32 m0, s58, 34816
  s_nop 0
  buffer_load_dwordx4 v5, s[68:71], s55 offen lds
  s_add_u32 m0, s58, 35840
  s_nop 0
  buffer_load_dwordx4 v6, s[68:71], s55 offen lds
  s_waitcnt vmcnt(12)
  s_barrier
  s_add_u32 s53, s39, 2
  s_and_b32 s53, s53, 15
  s_or_b32 s53, s53, 16
  s_mul_i32 s54, s53, 114688
  s_add_u32 m0, s64, 81920
  s_nop 0
  buffer_load_dwordx4 v1, s[24:27], s54 offen sc1 lds
  s_add_u32 m0, s64, 82944
  s_nop 0
  buffer_load_dwordx4 v2, s[24:27], s54 offen sc1 lds
  s_add_u32 s53, s39, 15
  s_and_b32 s53, s53, 15
  s_lshl_b32 s55, s53, 7
  s_add_u32 m0, s58, 98304
  s_nop 0
  buffer_load_dwordx4 v3, s[68:71], s55 offen lds
  s_add_u32 m0, s58, 99328
  s_nop 0
  buffer_load_dwordx4 v4, s[68:71], s55 offen lds
  s_add_u32 m0, s58, 100352
  s_nop 0
  buffer_load_dwordx4 v5, s[68:71], s55 offen lds
  s_add_u32 m0, s58, 101376
  s_nop 0
  buffer_load_dwordx4 v6, s[68:71], s55 offen lds
  s_waitcnt vmcnt(12)
  s_barrier
  s_add_u32 s53, s39, 3
  s_and_b32 s53, s53, 15
  s_or_b32 s53, s53, 16
  s_mul_i32 s54, s53, 114688
  s_add_u32 m0, s64, 90112
  s_nop 0
  buffer_load_dwordx4 v1, s[24:27], s54 offen sc1 lds
  s_add_u32 m0, s64, 91136
  s_nop 0
  buffer_load_dwordx4 v2, s[24:27], s54 offen sc1 lds
  s_add_u32 s53, s39, 0
  s_and_b32 s53, s53, 15
  s_or_b32 s53, s53, 16
  s_lshl_b32 s55, s53, 7
  s_add_u32 m0, s58, 114688
  s_nop 0
  buffer_load_dwordx4 v3, s[68:71], s55 offen lds
  s_add_u32 m0, s58, 115712
  s_nop 0
  buffer_load_dwordx4 v4, s[68:71], s55 offen lds
  s_add_u32 m0, s58, 116736
  s_nop 0
  buffer_load_dwordx4 v5, s[68:71], s55 offen lds
  s_add_u32 m0, s58, 117760
  s_nop 0
  buffer_load_dwordx4 v6, s[68:71], s55 offen lds
  s_waitcnt vmcnt(12)
  s_barrier
  s_add_u32 s53, s39, 4
  s_and_b32 s53, s53, 15
  s_or_b32 s53, s53, 16
  s_mul_i32 s54, s53, 114688
  s_add_u32 m0, s64, 0
  s_nop 0
  buffer_load_dwordx4 v1, s[24:27], s54 offen sc1 lds
  s_add_u32 m0, s64, 1024
  s_nop 0
  buffer_load_dwordx4 v2, s[24:27], s54 offen sc1 lds
  s_add_u32 s53, s39, 1
  s_and_b32 s53, s53, 15
  s_or_b32 s53, s53, 16
  s_lshl_b32 s55, s53, 7
  s_add_u32 m0, s58, 131072
  s_nop 0
  buffer_load_dwordx4 v3, s[68:71], s55 offen lds
  s_add_u32 m0, s58, 132096
  s_nop 0
  buffer_load_dwordx4 v4, s[68:71], s55 offen lds
  s_add_u32 m0, s58, 133120
  s_nop 0
  buffer_load_dwordx4 v5, s[68:71], s55 offen lds
  s_add_u32 m0, s58, 134144
  s_nop 0
  buffer_load_dwordx4 v6, s[68:71], s55 offen lds
  s_waitcnt vmcnt(12)
  s_barrier
  s_add_u32 s53, s39, 5
  s_and_b32 s53, s53, 15
  s_or_b32 s53, s53, 16
  s_mul_i32 s54, s53, 114688
  s_add_u32 m0, s64, 8192
  s_nop 0
  buffer_load_dwordx4 v1, s[24:27], s54 offen sc1 lds
  s_add_u32 m0, s64, 9216
  s_nop 0
  buffer_load_dwordx4 v2, s[24:27], s54 offen sc1 lds
  s_add_u32 s53, s39, 2
  s_and_b32 s53, s53, 15
  s_or_b32 s53, s53, 16
  s_lshl_b32 s55, s53, 7
  s_add_u32 m0, s58, 147456
  s_nop 0
  buffer_load_dwordx4 v3, s[68:71], s55 offen lds
  s_add_u32 m0, s58, 148480
  s_nop 0
  buffer_load_dwordx4 v4, s[68:71], s55 offen lds
  s_add_u32 m0, s58, 149504
  s_nop 0
  buffer_load_dwordx4 v5, s[68:71], s55 offen lds
  s_add_u32 m0, s58, 150528
  s_nop 0
  buffer_load_dwordx4 v6, s[68:71], s55 offen lds
  s_waitcnt vmcnt(12)
  s_barrier
  s_add_u32 s53, s39, 6
  s_and_b32 s53, s53, 15
  s_or_b32 s53, s53, 16
  s_mul_i32 s54, s53, 114688
  s_add_u32 m0, s64, 16384
  s_nop 0
  buffer_load_dwordx4 v1, s[24:27], s54 offen sc1 lds
  s_add_u32 m0, s64, 17408
  s_nop 0
  buffer_load_dwordx4 v2, s[24:27], s54 offen sc1 lds
  s_add_u32 s53, s39, 3
  s_and_b32 s53, s53, 15
  s_or_b32 s53, s53, 16
  s_lshl_b32 s55, s53, 7
  s_add_u32 m0, s58, 32768
  s_nop 0
  buffer_load_dwordx4 v3, s[68:71], s55 offen lds
  s_add_u32 m0, s58, 33792
  s_nop 0
  buffer_load_dwordx4 v4, s[68:71], s55 offen lds
  s_add_u32 m0, s58, 34816
  s_nop 0
  buffer_load_dwordx4 v5, s[68:71], s55 offen lds
  s_add_u32 m0, s58, 35840
  s_nop 0
  buffer_load_dwordx4 v6, s[68:71], s55 offen lds
  s_waitcnt vmcnt(12)
  s_barrier
  s_add_u32 s53, s39, 7
  s_and_b32 s53, s53, 15
  s_or_b32 s53, s53, 16
  s_mul_i32 s54, s53, 114688
  s_add_u32 m0, s64, 24576
  s_nop 0
  buffer_load_dwordx4 v1, s[24:27], s54 offen sc1 lds
  s_add_u32 m0, s64, 25600
  s_nop 0
  buffer_load_dwordx4 v2, s[24:27], s54 offen sc1 lds
  s_add_u32 s53, s39, 4
  s_and_b32 s53, s53, 15
  s_or_b32 s53, s53, 16
  s_lshl_b32 s55, s53, 7
  s_add_u32 m0, s58, 98304
  s_nop 0
  buffer_load_dwordx4 v3, s[68:71], s55 offen lds
  s_add_u32 m0, s58, 99328
  s_nop 0
  buffer_load_dwordx4 v4, s[68:71], s55 offen lds
  s_add_u32 m0, s58, 100352
  s_nop 0
  buffer_load_dwordx4 v5, s[68:71], s55 offen lds
  s_add_u32 m0, s58, 101376
  s_nop 0
  buffer_load_dwordx4 v6, s[68:71], s55 offen lds
  s_waitcnt vmcnt(12)
  s_barrier
  s_add_u32 s53, s39, 8
  s_and_b32 s53, s53, 15
  s_or_b32 s53, s53, 16
  s_mul_i32 s54, s53, 114688
  s_add_u32 m0, s64, 65536
  s_nop 0
  buffer_load_dwordx4 v1, s[24:27], s54 offen sc1 lds
  s_add_u32 m0, s64, 66560
  s_nop 0
  buffer_load_dwordx4 v2, s[24:27], s54 offen sc1 lds
  s_add_u32 s53, s39, 5
  s_and_b32 s53, s53, 15
  s_or_b32 s53, s53, 16
  s_lshl_b32 s55, s53, 7
  s_add_u32 m0, s58, 114688
  s_nop 0
  buffer_load_dwordx4 v3, s[68:71], s55 offen lds
  s_add_u32 m0, s58, 115712
  s_nop 0
  buffer_load_dwordx4 v4, s[68:71], s55 offen lds
  s_add_u32 m0, s58, 116736
  s_nop 0
  buffer_load_dwordx4 v5, s[68:71], s55 offen lds
  s_add_u32 m0, s58, 117760
  s_nop 0
  buffer_load_dwordx4 v6, s[68:71], s55 offen lds
  s_waitcnt vmcnt(12)
  s_barrier
  s_add_u32 s53, s39, 9
  s_and_b32 s53, s53, 15
  s_or_b32 s53, s53, 16
  s_mul_i32 s54, s53, 114688
  s_add_u32 m0, s64, 73728
  s_nop 0
  buffer_load_dwordx4 v1, s[24:27], s54 offen sc1 lds
  s_add_u32 m0, s64, 74752
  s_nop 0
  buffer_load_dwordx4 v2, s[24:27], s54 offen sc1 lds
  s_add_u32 s53, s39, 6
  s_and_b32 s53, s53, 15
  s_or_b32 s53, s53, 16
  s_lshl_b32 s55, s53, 7
  s_add_u32 m0, s58, 131072
  s_nop 0
  buffer_load_dwordx4 v3, s[68:71], s55 offen lds
  s_add_u32 m0, s58, 132096
  s_nop 0
  buffer_load_dwordx4 v4, s[68:71], s55 offen lds
  s_add_u32 m0, s58, 133120
  s_nop 0
  buffer_load_dwordx4 v5, s[68:71], s55 offen lds
  s_add_u32 m0, s58, 134144
  s_nop 0
  buffer_load_dwordx4 v6, s[68:71], s55 offen lds
  s_waitcnt vmcnt(12)
  s_barrier
  s_add_u32 s53, s39, 10
  s_and_b32 s53, s53, 15
  s_or_b32 s53, s53, 16
  s_mul_i32 s54, s53, 114688
  s_add_u32 m0, s64, 81920
  s_nop 0
  buffer_load_dwordx4 v1, s[24:27], s54 offen sc1 lds
  s_add_u32 m0, s64, 82944
  s_nop 0
  buffer_load_dwordx4 v2, s[24:27], s54 offen sc1 lds
  s_add_u32 s53, s39, 7
  s_and_b32 s53, s53, 15
  s_or_b32 s53, s53, 16
  s_lshl_b32 s55, s53, 7
  s_add_u32 m0, s58, 147456
  s_nop 0
  buffer_load_dwordx4 v3, s[68:71], s55 offen lds
  s_add_u32 m0, s58, 148480
  s_nop 0
  buffer_load_dwordx4 v4, s[68:71], s55 offen lds
  s_add_u32 m0, s58, 149504
  s_nop 0
  buffer_load_dwordx4 v5, s[68:71], s55 offen lds
  s_add_u32 m0, s58, 150528
  s_nop 0
  buffer_load_dwordx4 v6, s[68:71], s55 offen lds
  s_waitcnt vmcnt(12)
  s_barrier
  s_add_u32 s53, s39, 11
  s_and_b32 s53, s53, 15
  s_or_b32 s53, s53, 16
  s_mul_i32 s54, s53, 114688
  s_add_u32 m0, s64, 90112
  s_nop 0
  buffer_load_dwordx4 v1, s[24:27], s54 offen sc1 lds
  s_add_u32 m0, s64, 91136
  s_nop 0
  buffer_load_dwordx4 v2, s[24:27], s54 offen sc1 lds
  s_add_u32 s53, s39, 8
  s_and_b32 s53, s53, 15
  s_or_b32 s53, s53, 16
  s_lshl_b32 s55, s53, 7
  s_add_u32 m0, s58, 32768
  s_nop 0
  buffer_load_dwordx4 v3, s[68:71], s55 offen lds
  s_add_u32 m0, s58, 33792
  s_nop 0
  buffer_load_dwordx4 v4, s[68:71], s55 offen lds
  s_add_u32 m0, s58, 34816
  s_nop 0
  buffer_load_dwordx4 v5, s[68:71], s55 offen lds
  s_add_u32 m0, s58, 35840
  s_nop 0
  buffer_load_dwordx4 v6, s[68:71], s55 offen lds
  s_waitcnt vmcnt(12)
  s_barrier
  s_add_u32 s53, s39, 12
  s_and_b32 s53, s53, 15
  s_or_b32 s53, s53, 16
  s_mul_i32 s54, s53, 114688
  s_add_u32 m0, s64, 0
  s_nop 0
  buffer_load_dwordx4 v1, s[24:27], s54 offen sc1 lds
  s_add_u32 m0, s64, 1024
  s_nop 0
  buffer_load_dwordx4 v2, s[24:27], s54 offen sc1 lds
  s_add_u32 s53, s39, 9
  s_and_b32 s53, s53, 15
  s_or_b32 s53, s53, 16
  s_lshl_b32 s55, s53, 7
  s_add_u32 m0, s58, 98304
  s_nop 0
  buffer_load_dwordx4 v3, s[68:71], s55 offen lds
  s_add_u32 m0, s58, 99328
  s_nop 0
  buffer_load_dwordx4 v4, s[68:71], s55 offen lds
  s_add_u32 m0, s58, 100352
  s_nop 0
  buffer_load_dwordx4 v5, s[68:71], s55 offen lds
  s_add_u32 m0, s58, 101376
  s_nop 0
  buffer_load_dwordx4 v6, s[68:71], s55 offen lds
  s_waitcnt vmcnt(12)
  s_barrier
  s_add_u32 s53, s39, 13
  s_and_b32 s53, s53, 15
  s_or_b32 s53, s53, 16
  s_mul_i32 s54, s53, 114688
  s_add_u32 m0, s64, 8192
  s_nop 0
  buffer_load_dwordx4 v1, s[24:27], s54 offen sc1 lds
  s_add_u32 m0, s64, 9216
  s_nop 0
  buffer_load_dwordx4 v2, s[24:27], s54 offen sc1 lds
  s_add_u32 s53, s39, 10
  s_and_b32 s53, s53, 15
  s_or_b32 s53, s53, 16
  s_lshl_b32 s55, s53, 7
  s_add_u32 m0, s58, 114688
  s_nop 0
  buffer_load_dwordx4 v3, s[68:71], s55 offen lds
  s_add_u32 m0, s58, 115712
  s_nop 0
  buffer_load_dwordx4 v4, s[68:71], s55 offen lds
  s_add_u32 m0, s58, 116736
  s_nop 0
  buffer_load_dwordx4 v5, s[68:71], s55 offen lds
  s_add_u32 m0, s58, 117760
  s_nop 0
  buffer_load_dwordx4 v6, s[68:71], s55 offen lds
  s_waitcnt vmcnt(12)
  s_barrier
  s_add_u32 s53, s39, 14
  s_and_b32 s53, s53, 15
  s_or_b32 s53, s53, 16
  s_mul_i32 s54, s53, 114688
  s_add_u32 m0, s64, 16384
  s_nop 0
  buffer_load_dwordx4 v1, s[24:27], s54 offen sc1 lds
  s_add_u32 m0, s64, 17408
  s_nop 0
  buffer_load_dwordx4 v2, s[24:27], s54 offen sc1 lds
  s_add_u32 s53, s39, 11
  s_and_b32 s53, s53, 15
  s_or_b32 s53, s53, 16
  s_lshl_b32 s55, s53, 7
  s_add_u32 m0, s58, 131072
  s_nop 0
  buffer_load_dwordx4 v3, s[68:71], s55 offen lds
  s_add_u32 m0, s58, 132096
  s_nop 0
  buffer_load_dwordx4 v4, s[68:71], s55 offen lds
  s_add_u32 m0, s58, 133120
  s_nop 0
  buffer_load_dwordx4 v5, s[68:71], s55 offen lds
  s_add_u32 m0, s58, 134144
  s_nop 0
  buffer_load_dwordx4 v6, s[68:71], s55 offen lds
  s_waitcnt vmcnt(12)
  s_barrier
  s_add_u32 s53, s39, 15
  s_and_b32 s53, s53, 15
  s_or_b32 s53, s53, 16
  s_mul_i32 s54, s53, 114688
  s_add_u32 m0, s64, 24576
  s_nop 0
  buffer_load_dwordx4 v1, s[24:27], s54 offen sc1 lds
  s_add_u32 m0, s64, 25600
  s_nop 0
  buffer_load_dwordx4 v2, s[24:27], s54 offen sc1 lds
  s_add_u32 s53, s39, 12
  s_and_b32 s53, s53, 15
  s_or_b32 s53, s53, 16
  s_lshl_b32 s55, s53, 7
  s_add_u32 m0, s58, 147456
  s_nop 0
  buffer_load_dwordx4 v3, s[68:71], s55 offen lds
  s_add_u32 m0, s58, 148480
  s_nop 0
  buffer_load_dwordx4 v4, s[68:71], s55 offen lds
  s_add_u32 m0, s58, 149504
  s_nop 0
  buffer_load_dwordx4 v5, s[68:71], s55 offen lds
  s_add_u32 m0, s58, 150528
  s_nop 0
  buffer_load_dwordx4 v6, s[68:71], s55 offen lds
  s_waitcnt vmcnt(12)
  s_barrier
  s_add_u32 s53, s39, 13
  s_and_b32 s53, s53, 15
  s_or_b32 s53, s53, 16
  s_lshl_b32 s55, s53, 7
  s_add_u32 m0, s58, 32768
  s_nop 0
  buffer_load_dwordx4 v3, s[68:71], s55 offen lds
  s_add_u32 m0, s58, 33792
  s_nop 0
  buffer_load_dwordx4 v4, s[68:71], s55 offen lds
  s_add_u32 m0, s58, 34816
  s_nop 0
  buffer_load_dwordx4 v5, s[68:71], s55 offen lds
  s_add_u32 m0, s58, 35840
  s_nop 0
  buffer_load_dwordx4 v6, s[68:71], s55 offen lds
  s_waitcnt vmcnt(10)
  s_barrier
  s_add_u32 s53, s39, 14
  s_and_b32 s53, s53, 15
  s_or_b32 s53, s53, 16
  s_lshl_b32 s55, s53, 7
  s_add_u32 m0, s58, 98304
  s_nop 0
  buffer_load_dwordx4 v3, s[68:71], s55 offen lds
  s_add_u32 m0, s58, 99328
  s_nop 0
  buffer_load_dwordx4 v4, s[68:71], s55 offen lds
  s_add_u32 m0, s58, 100352
  s_nop 0
  buffer_load_dwordx4 v5, s[68:71], s55 offen lds
  s_add_u32 m0, s58, 101376
  s_nop 0
  buffer_load_dwordx4 v6, s[68:71], s55 offen lds
  s_waitcnt vmcnt(8)
  s_barrier
  s_add_u32 s53, s39, 15
  s_and_b32 s53, s53, 15
  s_or_b32 s53, s53, 16
  s_lshl_b32 s55, s53, 7
  s_add_u32 m0, s58, 114688
  s_nop 0
  buffer_load_dwordx4 v3, s[68:71], s55 offen lds
  s_add_u32 m0, s58, 115712
  s_nop 0
  buffer_load_dwordx4 v4, s[68:71], s55 offen lds
  s_add_u32 m0, s58, 116736
  s_nop 0
  buffer_load_dwordx4 v5, s[68:71], s55 offen lds
  s_add_u32 m0, s58, 117760
  s_nop 0
  buffer_load_dwordx4 v6, s[68:71], s55 offen lds
  s_waitcnt vmcnt(8)
  s_barrier
  s_waitcnt vmcnt(4)
  s_barrier
  s_waitcnt vmcnt(0)
  s_barrier
  v_and_b32 v8, 31, v0
  v_lshlrev_b32 v8, 7, v8
  s_mov_b32 s54, 19464192
MK_pollZ:
  buffer_load_dword v9, v8, s[24:27], s54 offen sc1
  s_waitcnt vmcnt(0)
  v_cmp_ne_u32 vcc, 1, v9
  s_nop 4
  s_cbranch_vccz MK_pollZ_ok
  s_sub_u32 s96, s96, 1
  s_cmp_eq_u32 s96, 0
  s_cbranch_scc1 MK_end
  s_sleep 4
  s_branch MK_pollZ
MK_pollZ_ok:
  s_add_u32 s53, s95, 0
  s_cmp_ge_u32 s53, 14
  s_cselect_b32 s54, 14, 0
  s_sub_u32 s53, s53, s54
  s_cmp_ge_u32 s53, 7
  s_cselect_b32 s54, 7, 0
  s_sub_u32 s53, s53, s54
  s_mul_i32 s54, s53, 270336
  s_add_u32 m0, s57, 139264
  s_nop 0
  buffer_load_dwordx4 v14, s[24:27], s54 offen sc1 lds
  s_add_u32 m0, s57, 140288
  s_nop 0
  buffer_load_dwordx4 v15, s[24:27], s54 offen sc1 lds
  s_add_u32 m0, s57, 141312
  s_nop 0
  buffer_load_dwordx4 v16, s[24:27], s54 offen sc1 lds
  s_add_u32 m0, s57, 142336
  s_nop 0
  buffer_load_dwordx4 v17, s[24:27], s54 offen sc1 lds
  s_add_u32 s53, s95, 1
  s_cmp_ge_u32 s53, 14
  s_cselect_b32 s54, 14, 0
  s_sub_u32 s53, s53, s54
  s_cmp_ge_u32 s53, 7
  s_cselect_b32 s54, 7, 0
  s_sub_u32 s53, s53, s54
  s_mul_i32 s54, s53, 270336
  s_add_u32 m0, s57, 0
  s_nop 0
  buffer_load_dwordx4 v14, s[24:27], s54 offen sc1 lds
  s_add_u32 m0, s57, 1024
  s_nop 0
  buffer_load_dwordx4 v15, s[24:27], s54 offen sc1 lds
  s_add_u32 m0, s57, 2048
  s_nop 0
  buffer_load_dwordx4 v16, s[24:27], s54 offen sc1 lds
  s_add_u32 m0, s57, 3072
  s_nop 0
  buffer_load_dwordx4 v17, s[24:27], s54 offen sc1 lds
  s_add_u32 s53, s95, 2
  s_cmp_ge_u32 s53, 14
  s_cselect_b32 s54, 14, 0
  s_sub_u32 s53, s53, s54
  s_cmp_ge_u32 s53, 7
  s_cselect_b32 s54, 7, 0
  s_sub_u32 s53, s53, s54
  s_mul_i32 s54, s53, 270336
  s_add_u32 m0, s57, 147456
  s_nop 0
  buffer_load_dwordx4 v14, s[24:27], s54 offen sc1 lds
  s_add_u32 m0, s57, 148480
  s_nop 0
  buffer_load_dwordx4 v15, s[24:27], s54 offen sc1 lds
  s_add_u32 m0, s57, 149504
  s_nop 0
  buffer_load_dwordx4 v16, s[24:27], s54 offen sc1 lds
  s_add_u32 m0, s57, 150528
  s_nop 0
  buffer_load_dwordx4 v17, s[24:27], s54 offen sc1 lds
  s_add_u32 s53, s95, 3
  s_cmp_ge_u32 s53, 14
  s_cselect_b32 s54, 14, 0
  s_sub_u32 s53, s53, s54
  s_cmp_ge_u32 s53, 7
  s_cselect_b32 s54, 7, 0
  s_sub_u32 s53, s53, s54
  s_mul_i32 s54, s53, 270336
  s_add_u32 m0, s57, 155648
  s_nop 0
  buffer_load_dwordx4 v14, s[24:27], s54 offen sc1 lds
  s_add_u32 m0, s57, 156672
  s_nop 0
  buffer_load_dwordx4 v15, s[24:27], s54 offen sc1 lds
  s_add_u32 m0, s57, 157696
  s_nop 0
  buffer_load_dwordx4 v16, s[24:27], s54 offen sc1 lds
  s_add_u32 m0, s57, 158720
  s_nop 0
  buffer_load_dwordx4 v17, s[24:27], s54 offen sc1 lds
  s_waitcnt vmcnt(12)
  s_barrier
  s_add_u32 s53, s95, 4
  s_cmp_ge_u32 s53, 14
  s_cselect_b32 s54, 14, 0
  s_sub_u32 s53, s53, s54
  s_cmp_ge_u32 s53, 7
  s_cselect_b32 s54, 7, 0
  s_sub_u32 s53, s53, s54
  s_mul_i32 s54, s53, 270336
  s_add_u32 m0, s57, 16384
  s_nop 0
  buffer_load_dwordx4 v14, s[24:27], s54 offen sc1 lds
  s_add_u32 m0, s57, 17408
  s_nop 0
  buffer_load_dwordx4 v15, s[24:27], s54 offen sc1 lds
  s_add_u32 m0, s57, 18432
  s_nop 0
  buffer_load_dwordx4 v16, s[24:27], s54 offen sc1 lds
  s_add_u32 m0, s57, 19456
  s_nop 0
  buffer_load_dwordx4 v17, s[24:27], s54 offen sc1 lds
  s_waitcnt vmcnt(12)
  s_barrier
  s_add_u32 s53, s95, 5
  s_cmp_ge_u32 s53, 14
  s_cselect_b32 s54, 14, 0
  s_sub_u32 s53, s53, s54
  s_cmp_ge_u32 s53, 7
  s_cselect_b32 s54, 7, 0
  s_sub_u32 s53, s53, s54
  s_mul_i32 s54, s53, 270336
  s_add_u32 m0, s57, 106496
  s_nop 0
  buffer_load_dwordx4 v14, s[24:27], s54 offen sc1 lds
  s_add_u32 m0, s57, 107520
  s_nop 0
  buffer_load_dwordx4 v15, s[24:27], s54 offen sc1 lds
  s_add_u32 m0, s57, 108544
  s_nop 0
  buffer_load_dwordx4 v16, s[24:27], s54 offen sc1 lds
  s_add_u32 m0, s57, 109568
  s_nop 0
  buffer_load_dwordx4 v17, s[24:27], s54 offen sc1 lds
  s_waitcnt vmcnt(12)
  s_barrier
  s_add_u32 s53, s95, 6
  s_cmp_ge_u32 s53, 14
  s_cselect_b32 s54, 14, 0
  s_sub_u32 s53, s53, s54
  s_cmp_ge_u32 s53, 7
  s_cselect_b32 s54, 7, 0
  s_sub_u32 s53, s53, s54
  s_mul_i32 s54, s53, 270336
  s_add_u32 m0, s57, 49152
  s_nop 0
  buffer_load_dwordx4 v14, s[24:27], s54 offen sc1 lds
  s_add_u32 m0, s57, 50176
  s_nop 0
  buffer_load_dwordx4 v15, s[24:27], s54 offen sc1 lds
  s_add_u32 m0, s57, 51200
  s_nop 0
  buffer_load_dwordx4 v16, s[24:27], s54 offen sc1 lds
  s_add_u32 m0, s57, 52224
  s_nop 0
  buffer_load_dwordx4 v17, s[24:27], s54 offen sc1 lds
  s_waitcnt vmcnt(12)
  s_barrier
  s_waitcnt vmcnt(8)
  s_barrier
  s_waitcnt vmcnt(4)
  s_barrier
  s_waitcnt vmcnt(0)
  s_barrier
  v_lshrrev_b32 v8, 2, v0
  v_lshlrev_b32 v8, 7, v8
  v_and_b32 v9, 3, v0
  v_lshl_add_u32 v8, v9, 2, v8
  s_lshr_b32 s54, s93, 1
  s_lshl_b32 s54, s54, 11
  s_add_u32 s54, s54, 19333120
  s_and_b32 s55, s93, 1
  v_bfe_u32 v10, v0, 1, 1
  v_cmp_eq_u32 s[8:9], s55, v10
  v_cmp_gt_u32 s[10:11], 56, v0
  s_nop 1
  s_and_b64 s[8:9], s[8:9], s[10:11]
MK_pollB:
  buffer_load_dword v9, v8, s[24:27], s54 offen sc1
  s_waitcnt vmcnt(0)
  v_cmp_ne_u32 vcc, 1, v9
  s_nop 1
  s_and_b64 vcc, vcc, s[8:9]
  s_nop 1
  s_cbranch_vccz MK_pollB_ok
  s_sub_u32 s96, s96, 1
  s_cmp_eq_u32 s96, 0
  s_cbranch_scc1 MK_end
  s_sleep 1
  s_branch MK_pollB
MK_pollB_ok:
  s_add_u32 s53, s94, 0
  s_cmp_ge_u32 s53, 28
  s_cselect_b32 s54, 28, 0
  s_sub_u32 s53, s53, s54
  s_cmp_ge_u32 s53, 14
  s_cselect_b32 s54, 14, 0
  s_sub_u32 s53, s53, s54
  s_lshl_b32 s54, s53, 7
  s_add_u32 m0, s57, 81920
  s_nop 0
  buffer_load_dwordx4 v24, s[24:27], s54 offen sc1 lds
  s_add_u32 m0, s57, 82944
  s_nop 0
  buffer_load_dwordx4 v25, s[24:27], s54 offen sc1 lds
  s_add_u32 m0, s57, 83968
  s_nop 0
  buffer_load_dwordx4 v26, s[24:27], s54 offen sc1 lds
  s_add_u32 m0, s57, 84992
  s_nop 0
  buffer_load_dwordx4 v27, s[24:27], s54 offen sc1 lds
  s_add_u32 s53, s94, 1
  s_cmp_ge_u32 s53, 28
  s_cselect_b32 s54, 28, 0
  s_sub_u32 s53, s53, s54
  s_cmp_ge_u32 s53, 14
  s_cselect_b32 s54, 14, 0
  s_sub_u32 s53, s53, s54
  s_lshl_b32 s54, s53, 7
  s_add_u32 m0, s57, 155648
  s_nop 0
  buffer_load_dwordx4 v24, s[24:27], s54 offen sc1 lds
  s_add_u32 m0, s57, 156672
  s_nop 0
  buffer_load_dwordx4 v25, s[24:27], s54 offen sc1 lds
  s_add_u32 m0, s57, 157696
  s_nop 0
  buffer_load_dwordx4 v26, s[24:27], s54 offen sc1 lds
  s_add_u32 m0, s57, 158720
  s_nop 0
  buffer_load_dwordx4 v27, s[24:27], s54 offen sc1 lds
  s_add_u32 s53, s94, 2
  s_cmp_ge_u32 s53, 28
  s_cselect_b32 s54, 28, 0
  s_sub_u32 s53, s53, s54
  s_cmp_ge_u32 s53, 14
  s_cselect_b32 s54, 14, 0
  s_sub_u32 s53, s53, s54
  s_lshl_b32 s54, s53, 7
  s_add_u32 m0, s57, 90112
  s_nop 0
  buffer_load_dwordx4 v24, s[24:27], s54 offen sc1 lds
  s_add_u32 m0, s57, 91136
  s_nop 0
  buffer_load_dwordx4 v25, s[24:27], s54 offen sc1 lds
  s_add_u32 m0, s57, 92160
  s_nop 0
  buffer_load_dwordx4 v26, s[24:27], s54 offen sc1 lds
  s_add_u32 m0, s57, 93184
  s_nop 0
  buffer_load_dwordx4 v27, s[24:27], s54 offen sc1 lds
  s_add_u32 s53, s94, 3
  s_cmp_ge_u32 s53, 28
  s_cselect_b32 s54, 28, 0
  s_sub_u32 s53, s53, s54
  s_cmp_ge_u32 s53, 14
  s_cselect_b32 s54, 14, 0
  s_sub_u32 s53, s53, s54
  s_lshl_b32 s54, s53, 7
  s_add_u32 m0, s57, 16384
  s_nop 0
  buffer_load_dwordx4 v24, s[24:27], s54 offen sc1 lds
  s_add_u32 m0, s57, 17408
  s_nop 0
  buffer_load_dwordx4 v25, s[24:27], s54 offen sc1 lds
  s_add_u32 m0, s57, 18432
  s_nop 0
  buffer_load_dwordx4 v26, s[24:27], s54 offen sc1 lds
  s_add_u32 m0, s57, 19456
  s_nop 0
  buffer_load_dwordx4 v27, s[24:27], s54 offen sc1 lds
  s_waitcnt vmcnt(8)
  s_barrier
  s_add_u32 s53, s94, 4
  s_cmp_ge_u32 s53, 28
  s_cselect_b32 s54, 28, 0
  s_sub_u32 s53, s53, s54
  s_cmp_ge_u32 s53, 14
  s_cselect_b32 s54, 14, 0
  s_sub_u32 s53, s53, s54
  s_lshl_b32 s54, s53, 7
  s_add_u32 m0, s57, 106496
  s_nop 0
  buffer_load_dwordx4 v24, s[24:27], s54 offen sc1 lds
  s_add_u32 m0, s57, 107520
  s_nop 0
  buffer_load_dwordx4 v25, s[24:27], s54 offen sc1 lds
  s_add_u32 m0, s57, 108544
  s_nop 0
  buffer_load_dwordx4 v26, s[24:27], s54 offen sc1 lds
  s_add_u32 m0, s57, 109568
  s_nop 0
  buffer_load_dwordx4 v27, s[24:27], s54 offen sc1 lds
  s_add_u32 s53, s94, 5
  s_cmp_ge_u32 s53, 28
  s_cselect_b32 s54, 28, 0
  s_sub_u32 s53, s53, s54
  s_cmp_ge_u32 s53, 14
  s_cselect_b32 s54, 14, 0
  s_sub_u32 s53, s53, s54
  s_lshl_b32 s54, s53, 7
  s_add_u32 m0, s57, 131072
  s_nop 0
  buffer_load_dwordx4 v24, s[24:27], s54 offen sc1 lds
  s_add_u32 m0, s57, 132096
  s_nop 0
  buffer_load_dwordx4 v25, s[24:27], s54 offen sc1 lds
  s_add_u32 m0, s57, 133120
  s_nop 0
  buffer_load_dwordx4 v26, s[24:27], s54 offen sc1 lds
  s_add_u32 m0, s57, 134144
  s_nop 0
  buffer_load_dwordx4 v27, s[24:27], s54 offen sc1 lds
  s_waitcnt vmcnt(8)
  s_barrier
  s_add_u32 s53, s94, 6
  s_cmp_ge_u32 s53, 28
  s_cselect_b32 s54, 28, 0
  s_sub_u32 s53, s53, s54
  s_cmp_ge_u32 s53, 14
  s_cselect_b32 s54, 14, 0
  s_sub_u32 s53, s53, s54
  s_lshl_b32 s54, s53, 7
  s_add_u32 m0, s57, 49152
  s_nop 0
  buffer_load_dwordx4 v24, s[24:27], s54 offen sc1 lds
  s_add_u32 m0, s57, 50176
  s_nop 0
  buffer_load_dwordx4 v25, s[24:27], s54 offen sc1 lds
  s_add_u32 m0, s57, 51200
  s_nop 0
  buffer_load_dwordx4 v26, s[24:27], s54 offen sc1 lds
  s_add_u32 m0, s57, 52224
  s_nop 0
  buffer_load_dwordx4 v27, s[24:27], s54 offen sc1 lds
  s_add_u32 s53, s94, 7
  s_cmp_ge_u32 s53, 28
  s_cselect_b32 s54, 28, 0
  s_sub_u32 s53, s53, s54
  s_cmp_ge_u32 s53, 14
  s_cselect_b32 s54, 14, 0
  s_sub_u32 s53, s53, s54
  s_lshl_b32 s54, s53, 7
  s_add_u32 m0, s57, 81920
  s_nop 0
  buffer_load_dwordx4 v24, s[24:27], s54 offen sc1 lds
  s_add_u32 m0, s57, 82944
  s_nop 0
  buffer_load_dwordx4 v25, s[24:27], s54 offen sc1 lds
  s_add_u32 m0, s57, 83968
  s_nop 0
  buffer_load_dwordx4 v26, s[24:27], s54 offen sc1 lds
  s_add_u32 m0, s57, 84992
  s_nop 0
  buffer_load_dwordx4 v27, s[24:27], s54 offen sc1 lds
  s_waitcnt vmcnt(8)
  s_barrier
  s_add_u32 s53, s94, 8
  s_cmp_ge_u32 s53, 28
  s_cselect_b32 s54, 28, 0
  s_sub_u32 s53, s53, s54
  s_cmp_ge_u32 s53, 14
  s_cselect_b32 s54, 14, 0
  s_sub_u32 s53, s53, s54
  s_lshl_b32 s54, s53, 7
  s_add_u32 m0, s57, 90112
  s_nop 0
  buffer_load_dwordx4 v24, s[24:27], s54 offen sc1 lds
  s_add_u32 m0, s57, 91136
  s_nop 0
  buffer_load_dwordx4 v25, s[24:27], s54 offen sc1 lds
  s_add_u32 m0, s57, 92160
  s_nop 0
  buffer_load_dwordx4 v26, s[24:27], s54 offen sc1 lds
  s_add_u32 m0, s57, 93184
  s_nop 0
  buffer_load_dwordx4 v27, s[24:27], s54 offen sc1 lds
  s_add_u32 s53, s94, 9
  s_cmp_ge_u32 s53, 28
  s_cselect_b32 s54, 28, 0
  s_sub_u32 s53, s53, s54
  s_cmp_ge_u32 s53, 14
  s_cselect_b32 s54, 14, 0
  s_sub_u32 s53, s53, s54
  s_lshl_b32 s54, s53, 7
  s_add_u32 m0, s57, 24576
  s_nop 0
  buffer_load_dwordx4 v24, s[24:27], s54 offen sc1 lds
  s_add_u32 m0, s57, 25600
  s_nop 0
  buffer_load_dwordx4 v25, s[24:27], s54 offen sc1 lds
  s_add_u32 m0, s57, 26624
  s_nop 0
  buffer_load_dwordx4 v26, s[24:27], s54 offen sc1 lds
  s_add_u32 m0, s57, 27648
  s_nop 0
  buffer_load_dwordx4 v27, s[24:27], s54 offen sc1 lds
  s_waitcnt vmcnt(8)
  s_barrier
  s_add_u32 s53, s94, 10
  s_cmp_ge_u32 s53, 28
  s_cselect_b32 s54, 28, 0
  s_sub_u32 s53, s53, s54
  s_cmp_ge_u32 s53, 14
  s_cselect_b32 s54, 14, 0
  s_sub_u32 s53, s53, s54
  s_lshl_b32 s54, s53, 7
  s_add_u32 m0, s57, 40960
  s_nop 0
  buffer_load_dwordx4 v24, s[24:27], s54 offen sc1 lds
  s_add_u32 m0, s57, 41984
  s_nop 0
  buffer_load_dwordx4 v25, s[24:27], s54 offen sc1 lds
  s_add_u32 m0, s57, 43008
  s_nop 0
  buffer_load_dwordx4 v26, s[24:27], s54 offen sc1 lds
  s_add_u32 m0, s57, 44032
  s_nop 0
  buffer_load_dwordx4 v27, s[24:27], s54 offen sc1 lds
  s_add_u32 s53, s94, 11
  s_cmp_ge_u32 s53, 28
  s_cselect_b32 s54, 28, 0
  s_sub_u32 s53, s53, s54
  s_cmp_ge_u32 s53, 14
  s_cselect_b32 s54, 14, 0
  s_sub_u32 s53, s53, s54
  s_lshl_b32 s54, s53, 7
  s_add_u32 m0, s57, 16384
  s_nop 0
  buffer_load_dwordx4 v24, s[24:27], s54 offen sc1 lds
  s_add_u32 m0, s57, 17408
  s_nop 0
  buffer_load_dwordx4 v25, s[24:27], s54 offen sc1 lds
  s_add_u32 m0, s57, 18432
  s_nop 0
  buffer_load_dwordx4 v26, s[24:27], s54 offen sc1 lds
  s_add_u32 m0, s57, 19456
  s_nop 0
  buffer_load_dwordx4 v27, s[24:27], s54 offen sc1 lds
  s_waitcnt vmcnt(8)
  s_barrier
  s_add_u32 s53, s94, 12
  s_cmp_ge_u32 s53, 28
  s_cselect_b32 s54, 28, 0
  s_sub_u32 s53, s53, s54
  s_cmp_ge_u32 s53, 14
  s_cselect_b32 s54, 14, 0
  s_sub_u32 s53, s53, s54
  s_lshl_b32 s54, s53, 7
  s_add_u32 m0, s57, 98304
  s_nop 0
  buffer_load_dwordx4 v24, s[24:27], s54 offen sc1 lds
  s_add_u32 m0, s57, 99328
  s_nop 0
  buffer_load_dwordx4 v25, s[24:27], s54 offen sc1 lds
  s_add_u32 m0, s57, 100352
  s_nop 0
  buffer_load_dwordx4 v26, s[24:27], s54 offen sc1 lds
  s_add_u32 m0, s57, 101376
  s_nop 0
  buffer_load_dwordx4 v27, s[24:27], s54 offen sc1 lds
  s_add_u32 s53, s94, 13
  s_cmp_ge_u32 s53, 28
  s_cselect_b32 s54, 28, 0
  s_sub_u32 s53, s53, s54
  s_cmp_ge_u32 s53, 14
  s_cselect_b32 s54, 14, 0
  s_sub_u32 s53, s53, s54
  s_lshl_b32 s54, s53, 7
  s_add_u32 m0, s57, 106496
  s_nop 0
  buffer_load_dwordx4 v24, s[24:27], s54 offen sc1 lds
  s_add_u32 m0, s57, 107520
  s_nop 0
  buffer_load_dwordx4 v25, s[24:27], s54 offen sc1 lds
  s_add_u32 m0, s57, 108544
  s_nop 0
  buffer_load_dwordx4 v26, s[24:27], s54 offen sc1 lds
  s_add_u32 m0, s57, 109568
  s_nop 0
  buffer_load_dwordx4 v27, s[24:27], s54 offen sc1 lds
  s_waitcnt vmcnt(8)
  s_barrier
  s_waitcnt vmcnt(0)
  s_barrier
  s_endpgm
MK_common2:
  s_getpc_b64 s[28:29]
  s_add_u32 s28, s28, tab0@rel32@lo+4
  s_addc_u32 s29, s29, tab0@rel32@hi+12
  s_and_b32 s29, s29, 0xffff
  s_mov_b32 s30, 868352
  s_mov_b32 s31, 0x20000
  s_mov_b32 s96, 500000
  s_add_u32 s41, s40, 1
  s_cmp_eq_u32 s41, 7
  s_cselect_b32 s41, 0, s41
  s_add_u32 s42, s41, 1
  s_cmp_eq_u32 s42, 7
  s_cselect_b32 s42, 0, s42
  s_add_u32 s43, s42, 1
  s_cmp_eq_u32 s43, 7
  s_cselect_b32 s43, 0, s43
  s_add_u32 s44, s43, 1
  s_cmp_eq_u32 s44, 7
  s_cselect_b32 s44, 0, s44
  s_add_u32 s45, s44, 1
  s_cmp_eq_u32 s45, 7
  s_cselect_b32 s45, 0, s45
  s_add_u32 s46, s45, 1
  s_cmp_eq_u32 s46, 7
  s_cselect_b32 s46, 0, s46
  s_mul_i32 s14, s11, 9
  s_lshr_b32 s14, s14, 2
  s_lshl_b32 s15, s10, 2
  s_add_u32 s39, s14, s15
  s_mov_b32 s92, s11
  s_lshl_b32 s14, s12, 2
  s_lshl_b32 s15, s13, 3
  s_add_u32 s14, s14, s15
  s_add_u32 s93, s14, s10
  s_lshl_b32 s14, s11, 1
  s_mul_i32 s15, s10, 3
  s_add_u32 s94, s14, s15
  s_waitcnt lgkmcnt(0)
  s_mov_b32 s16, s48
  s_and_b32 s17, s49, 0xffff
  s_mov_b32 s18, 1835008
  s_mov_b32 s19, 0x20000
  s_mov_b32 s20, s56
  s_and_b32 s21, s57, 0xffff
  s_mov_b32 s22, 1605632
  s_mov_b32 s23, 0x20000
  s_mov_b32 s24, s88
  s_and_b32 s25, s89, 0xffff
  s_mov_b32 s26, 20971520
  s_mov_b32 s27, 0x20000
  s_mov_b32 s32, s86
  s_and_b32 s33, s87, 0xffff
  s_mov_b32 s34, 256
  s_mov_b32 s35, 0x20000
  s_mov_b32 s68, s58
  s_and_b32 s69, s59, 0xffff
  s_mov_b32 s70, 8388608
  s_mov_b32 s71, 0x20000
  s_mov_b32 s72, s60
  s_and_b32 s73, s61, 0xffff
  s_mov_b32 s74, 4096
  s_mov_b32 s75, 0x20000
  s_mov_b32 s76, s62
  s_and_b32 s77, s63, 0xffff
  s_mov_b32 s78, 802816
  s_mov_b32 s79, 0x20000
  s_mov_b32 s80, s84
  s_and_b32 s81, s85, 0xffff
  s_mov_b32 s82, 1835008
  s_mov_b32 s83, 0x20000
  s_mov_b32 s4, s50
  s_and_b32 s5, s51, 0xffff
  s_mov_b32 s6, 921600
  s_mov_b32 s7, 0x20000
  s_mov_b32 s84, s52
  s_and_b32 s85, s53, 0xffff
  s_mov_b32 s86, 921600
  s_mov_b32 s87, 0x20000
  s_cmp_ge_u32 s2, 224
  s_cbranch_scc1 MK_side
  s_lshl_b32 s55, s38, 7
  s_lshl_b32 s56, s36, 5
  s_add_u32 s55, s55, s56
  v_lshrrev_b32 v232, 5, v0
  v_bfe_u32 v233, v0, 2, 2
  v_lshl_add_u32 v1, v232, 3, v233
  v_lshlrev_b32 v1, 7, v1
  v_lshrrev_b32 v233, 1, v233
  v_lshl_add_u32 v1, v233, 6, v1
  v_bfe_u32 v233, v0, 4, 1
  v_lshl_add_u32 v1, v233, 5, v1
  v_and_b32 v233, 3, v0
  v_lshl_add_u32 v1, v233, 3, v1
  v_xor_b32 v2, 64, v1
  v_and_b32 v232, 31, v0
  v_bfe_u32 v233, v0, 1, 3
  v_lshrrev_b32 v3, 5, v0
  v_xor_b32 v233, v233, v3
  v_xor_b32 v3, 0, v233
  v_lshlrev_b32 v3, 4, v3
  v_lshl_add_u32 v3, v232, 7, v3
  v_xor_b32 v4, 2, v233
  v_lshlrev_b32 v4, 4, v4
  v_lshl_add_u32 v4, v232, 7, v4
  v_xor_b32 v5, 4, v233
  v_lshlrev_b32 v5, 4, v5
  v_lshl_add_u32 v5, v232, 7, v5
  v_xor_b32 v6, 6, v233
  v_lshlrev_b32 v6, 4, v6
  v_lshl_add_u32 v6, v232, 7, v6
  s_lshl_b32 s8, s36, 12
  s_add_u32 s8, s8, 98304
  v_add_u32 v3, s8, v3
  v_add_u32 v4, s8, v4
  v_add_u32 v5, s8, v5
  v_add_u32 v6, s8, v6
  v_and_b32 v232, 31, v0
  v_lshlrev_b32 v233, 2, v232
  s_lshl_b32 s8, s37, 7
  s_add_u32 s9, s8, 802816
  buffer_load_dword v12, v233, s[28:31], s9 offen
  v_add_u32 v233, s55, v232
  v_lshlrev_b32 v235, 1, v233
  buffer_load_ushort v13, v235, s[72:75], 0 offen
  v_and_b32 v233, 15, v0
  v_add_u32 v233, s55, v233
  v_mul_u32_u24 v233, 1792, v233
  v_bfe_u32 v15, v0, 4, 1
  v_lshlrev_b32 v15, 5, v15
  v_lshrrev_b32 v234, 5, v0
  v_lshl_add_u32 v15, v234, 4, v15
  v_add3_u32 v10, v15, v233, s8
  v_add_u32 v14, 28672, v10
  v_lshlrev_b32 v11, 4, v234
  v_mov_b32 v9, 0x3f803f80
  v_mov_b32 v7, 0
  v_mov_b32 v8, 0
  s_barrier
  ds_read_b128 v[16:19], v3 offset:0
  ds_read_b64_tr_b16 v[160:161], v1 offset:0
  ds_read_b64_tr_b16 v[162:163], v1 offset:512
  ds_read_b64_tr_b16 v[164:165], v2 offset:0
  ds_read_b64_tr_b16 v[166:167], v2 offset:512
  ds_read_b128 v[20:23], v4 offset:0
  ds_read_b64_tr_b16 v[168:169], v1 offset:2048
  ds_read_b64_tr_b16 v[170:171], v1 offset:2560
  ds_read_b64_tr_b16 v[172:173], v2 offset:2048
  ds_read_b64_tr_b16 v[174:175], v2 offset:2560
  ds_read_b128 v[24:27], v5 offset:0
  ds_read_b64_tr_b16 v[176:177], v1 offset:4096
  ds_read_b64_tr_b16 v[178:179], v1 offset:4608
  ds_read_b64_tr_b16 v[180:181], v2 offset:4096
  ds_read_b64_tr_b16 v[182:183], v2 offset:4608
  ds_read_b128 v[28:31], v6 offset:0
  ds_read_b64_tr_b16 v[184:185], v1 offset:6144
  ds_read_b64_tr_b16 v[186:187], v1 offset:6656
  ds_read_b64_tr_b16 v[188:189], v2 offset:6144
  ds_read_b64_tr_b16 v[190:191], v2 offset:6656
  s_barrier
  s_waitcnt lgkmcnt(15)
  v_mfma_f32_32x32x16_bf16 v[128:143], v[160:163], v[16:19], 0
  ds_read_b128 v[32:35], v3 offset:16384
  ds_read_b64_tr_b16 v[192:193], v1 offset:8192
  ds_read_b64_tr_b16 v[194:195], v1 offset:8704
  v_mfma_f32_32x32x16_bf16 v[144:159], v[164:167], v[16:19], 0
  ds_read_b64_tr_b16 v[196:197], v2 offset:8192
  ds_read_b64_tr_b16 v[198:199], v2 offset:8704
  s_waitcnt lgkmcnt(15)
  v_mfma_f32_32x32x16_bf16 v[128:143], v[168:171], v[20:23], v[128:143]
  ds_read_b128 v[36:39], v4 offset:16384
  ds_read_b64_tr_b16 v[200:201], v1 offset:10240
  ds_read_b64_tr_b16 v[202:203], v1 offset:10752
  v_mfma_f32_32x32x16_bf16 v[144:159], v[172:175], v[20:23], v[144:159]
  ds_read_b64_tr_b16 v[204:205], v2 offset:10240
  ds_read_b64_tr_b16 v[206:207], v2 offset:10752
  s_waitcnt lgkmcnt(15)
  v_mfma_f32_32x32x16_bf16 v[128:143], v[176:179], v[24:27], v[128:143]
  ds_read_b128 v[40:43], v5 offset:16384
  ds_read_b64_tr_b16 v[208:209], v1 offset:12288
  ds_read_b64_tr_b16 v[210:211], v1 offset:12800
  v_mfma_f32_32x32x16_bf16 v[144:159], v[180:183], v[24:27], v[144:159]
  ds_read_b64_tr_b16 v[212:213], v2 offset:12288
  ds_read_b64_tr_b16 v[214:215], v2 offset:12800
  s_waitcnt lgkmcnt(15)
  v_mfma_f32_32x32x16_bf16 v[128:143], v[184:187], v[28:31], v[128:143]
  ds_read_b128 v[44:47], v6 offset:16384
  ds_read_b64_tr_b16 v[216:217], v1 offset:14336
  ds_read_b64_tr_b16 v[218:219], v1 offset:14848
  v_mfma_f32_32x32x16_bf16 v[144:159], v[188:191], v[28:31], v[144:159]
  ds_read_b64_tr_b16 v[220:221], v2 offset:14336
  ds_read_b64_tr_b16 v[222:223], v2 offset:14848
  v_dot2_f32_bf16 v7, v16, v9, v7
  v_dot2_f32_bf16 v8, v16, v16, v8
  v_dot2_f32_bf16 v7, v17, v9, v7
  v_dot2_f32_bf16 v8, v17, v17, v8
  v_dot2_f32_bf16 v7, v18, v9, v7
  v_dot2_f32_bf16 v8, v18, v18, v8
  v_dot2_f32_bf16 v7, v19, v9, v7
  v_dot2_f32_bf16 v8, v19, v19, v8
  v_dot2_f32_bf16 v7, v20, v9, v7
  v_dot2_f32_bf16 v8, v20, v20, v8
  v_dot2_f32_bf16 v7, v21, v9, v7
  v_dot2_f32_bf16 v8, v21, v21, v8
  v_dot2_f32_bf16 v7, v22, v9, v7
  v_dot2_f32_bf16 v8, v22, v22, v8
  v_dot2_f32_bf16 v7, v23, v9, v7
  v_dot2_f32_bf16 v8, v23, v23, v8
  v_dot2_f32_bf16 v7, v24, v9, v7
  v_dot2_f32_bf16 v8, v24, v24, v8
  v_dot2_f32_bf16 v7, v25, v9, v7
  v_dot2_f32_bf16 v8, v25, v25, v8
  v_dot2_f32_bf16 v7, v26, v9, v7
  v_dot2_f32_bf16 v8, v26, v26, v8
  v_dot2_f32_bf16 v7, v27, v9, v7
  v_dot2_f32_bf16 v8, v27, v27, v8
  v_dot2_f32_bf16 v7, v28, v9, v7
  v_dot2_f32_bf16 v8, v28, v28, v8
  v_dot2_f32_bf16 v7, v29, v9, v7
  v_dot2_f32_bf16 v8, v29, v29, v8
  v_dot2_f32_bf16 v7, v30, v9, v7
  v_dot2_f32_bf16 v8, v30, v30, v8
  v_dot2_f32_bf16 v7, v31, v9, v7
  v_dot2_f32_bf16 v8, v31, v31, v8
  s_barrier
  s_waitcnt lgkmcnt(15)
  v_mfma_f32_32x32x16_bf16 v[128:143], v[192:195], v[32:35], v[128:143]
  ds_read_b128 v[48:51], v3 offset:32768
  ds_read_b64_tr_b16 v[160:161], v1 offset:16384
  ds_read_b64_tr_b16 v[162:163], v1 offset:16896
  v_mfma_f32_32x32x16_bf16 v[144:159], v[196:199], v[32:35], v[144:159]
  ds_read_b64_tr_b16 v[164:165], v2 offset:16384
  ds_read_b64_tr_b16 v[166:167], v2 offset:16896
  s_waitcnt lgkmcnt(15)
  v_mfma_f32_32x32x16_bf16 v[128:143], v[200:203], v[36:39], v[128:143]
  ds_read_b128 v[52:55], v4 offset:32768
  ds_read_b64_tr_b16 v[168:169], v1 offset:18432
  ds_read_b64_tr_b16 v[170:171], v1 offset:18944
  v_mfma_f32_32x32x16_bf16 v[144:159], v[204:207], v[36:39], v[144:159]
  ds_read_b64_tr_b16 v[172:173], v2 offset:18432
  ds_read_b64_tr_b16 v[174:175], v2 offset:18944
  s_waitcnt lgkmcnt(15)
  v_mfma_f32_32x32x16_bf16 v[128:143], v[208:211], v[40:43], v[128:143]
  ds_read_b128 v[56:59], v5 offset:32768
  ds_read_b64_tr_b16 v[176:177], v1 offset:20480
  ds_read_b64_tr_b16 v[178:179], v1 offset:20992
  v_mfma_f32_32x32x16_bf16 v[144:159], v[212:215], v[40:43], v[144:159]
  ds_read_b64_tr_b16 v[180:181], v2 offset:20480
  ds_read_b64_tr_b16 v[182:183], v2 offset:20992
  s_waitcnt lgkmcnt(15)
  v_mfma_f32_32x32x16_bf16 v[128:143], v[216:219], v[44:47], v[128:143]
  ds_read_b128 v[60:63], v6 offset:32768
  ds_read_b64_tr_b16 v[184:185], v1 offset:22528
  ds_read_b64_tr_b16 v[186:187], v1 offset:23040
  v_mfma_f32_32x32x16_bf16 v[144:159], v[220:223], v[44:47], v[144:159]
  ds_read_b64_tr_b16 v[188:189], v2 offset:22528
  ds_read_b64_tr_b16 v[190:191], v2 offset:23040
  v_dot2_f32_bf16 v7, v32, v9, v7
  v_dot2_f32_bf16 v8, v32, v32, v8
  v_dot2_f32_bf16 v7, v33, v9, v7
  v_dot2_f32_bf16 v8, v33, v33, v8
  v_dot2_f32_bf16 v7, v34, v9, v7
  v_dot2_f32_bf16 v8, v34, v34, v8
  v_dot2_f32_bf16 v7, v35, v9, v7
  v_dot2_f32_bf16 v8, v35, v35, v8
  v_dot2_f32_bf16 v7, v36, v9, v7
  v_dot2_f32_bf16 v8, v36, v36, v8
  v_dot2_f32_bf16 v7, v37, v9, v7
  v_dot2_f32_bf16 v8, v37, v37, v8
  v_dot2_f32_bf16 v7, v38, v9, v7
  v_dot2_f32_bf16 v8, v38, v38, v8
  v_dot2_f32_bf16 v7, v39, v9, v7
  v_dot2_f32_bf16 v8, v39, v39, v8
  v_dot2_f32_bf16 v7, v40, v9, v7
  v_dot2_f32_bf16 v8, v40, v40, v8
  v_dot2_f32_bf16 v7, v41, v9, v7
  v_dot2_f32_bf16 v8, v41, v41, v8
  v_dot2_f32_bf16 v7, v42, v9, v7
  v_dot2_f32_bf16 v8, v42, v42, v8
  v_dot2_f32_bf16 v7, v43, v9, v7
  v_dot2_f32_bf16 v8, v43, v43, v8
  v_dot2_f32_bf16 v7, v44, v9, v7
  v_dot2_f32_bf16 v8, v44, v44, v8
  v_dot2_f32_bf16 v7, v45, v9, v7
  v_dot2_f32_bf16 v8, v45, v45, v8
  v_dot2_f32_bf16 v7, v46, v9, v7
  v_dot2_f32_bf16 v8, v46, v46, v8
  v_dot2_f32_bf16 v7, v47, v9, v7
  v_dot2_f32_bf16 v8, v47, v47, v8
  s_barrier
  s_waitcnt lgkmcnt(15)
  v_mfma_f32_32x32x16_bf16 v[128:143], v[160:163], v[48:51], v[128:143]
  ds_read_b128 v[64:67], v3 offset:49152
  ds_read_b64_tr_b16 v[192:193], v1 offset:24576
  ds_read_b64_tr_b16 v[194:195], v1 offset:25088
  v_mfma_f32_32x32x16_bf16 v[144:159], v[164:167], v[48:51], v[144:159]
  ds_read_b64_tr_b16 v[196:197], v2 offset:24576
  ds_read_b64_tr_b16 v[198:199], v2 offset:25088
  s_waitcnt lgkmcnt(15)
  v_mfma_f32_32x32x16_bf16 v[128:143], v[168:171], v[52:55], v[128:143]
  ds_read_b128 v[68:71], v4 offset:49152
  ds_read_b64_tr_b16 v[200:201], v1 offset:26624
  ds_read_b64_tr_b16 v[202:203], v1 offset:27136
  v_mfma_f32_32x32x16_bf16 v[144:159], v[172:175], v[52:55], v[144:159]
  ds_read_b64_tr_b16 v[204:205], v2 offset:26624
  ds_read_b64_tr_b16 v[206:207], v2 offset:27136
  s_waitcnt lgkmcnt(15)
  v_mfma_f32_32x32x16_bf16 v[128:143], v[176:179], v[56:59], v[128:143]
  ds_read_b128 v[72:75], v5 offset:49152
  ds_read_b64_tr_b16 v[208:209], v1 offset:28672
  ds_read_b64_tr_b16 v[210:211], v1 offset:29184
  v_mfma_f32_32x32x16_bf16 v[144:159], v[180:183], v[56:59], v[144:159]
  ds_read_b64_tr_b16 v[212:213], v2 offset:28672
  ds_read_b64_tr_b16 v[214:215], v2 offset:29184
  s_waitcnt lgkmcnt(15)
  v_mfma_f32_32x32x16_bf16 v[128:143], v[184:187], v[60:63], v[128:143]
  ds_read_b128 v[76:79], v6 offset:49152
  ds_read_b64_tr_b16 v[216:217], v1 offset:30720
  ds_read_b64_tr_b16 v[218:219], v1 offset:31232
  v_mfma_f32_32x32x16_bf16 v[144:159], v[188:191], v[60:63], v[144:159]
  ds_read_b64_tr_b16 v[220:221], v2 offset:30720
  ds_read_b64_tr_b16 v[222:223], v2 offset:31232
  v_dot2_f32_bf16 v7, v48, v9, v7
  v_dot2_f32_bf16 v8, v48, v48, v8
  v_dot2_f32_bf16 v7, v49, v9, v7
  v_dot2_f32_bf16 v8, v49, v49, v8
  v_dot2_f32_bf16 v7, v50, v9, v7
  v_dot2_f32_bf16 v8, v50, v50, v8
  v_dot2_f32_bf16 v7, v51, v9, v7
  v_dot2_f32_bf16 v8, v51, v51, v8
  v_dot2_f32_bf16 v7, v52, v9, v7
  v_dot2_f32_bf16 v8, v52, v52, v8
  v_dot2_f32_bf16 v7, v53, v9, v7
  v_dot2_f32_bf16 v8, v53, v53, v8
  v_dot2_f32_bf16 v7, v54, v9, v7
  v_dot2_f32_bf16 v8, v54, v54, v8
  v_dot2_f32_bf16 v7, v55, v9, v7
  v_dot2_f32_bf16 v8, v55, v55, v8
  v_dot2_f32_bf16 v7, v56, v9, v7
  v_dot2_f32_bf16 v8, v56, v56, v8
  v_dot2_f32_bf16 v7, v57, v9, v7
  v_dot2_f32_bf16 v8, v57, v57, v8
  v_dot2_f32_bf16 v7, v58, v9, v7
  v_dot2_f32_bf16 v8, v58, v58, v8
  v_dot2_f32_bf16 v7, v59, v9, v7
  v_dot2_f32_bf16 v8, v59, v59, v8
  v_dot2_f32_bf16 v7, v60, v9, v7
  v_dot2_f32_bf16 v8, v60, v60, v8
  v_dot2_f32_bf16 v7, v61, v9, v7
  v_dot2_f32_bf16 v8, v61, v61, v8
  v_dot2_f32_bf16 v7, v62, v9, v7
  v_dot2_f32_bf16 v8, v62, v62, v8
  v_dot2_f32_bf16 v7, v63, v9, v7
  v_dot2_f32_bf16 v8, v63, v63, v8
  s_barrier
  s_waitcnt lgkmcnt(15)
  v_mfma_f32_32x32x16_bf16 v[128:143], v[192:195], v[64:67], v[128:143]
  ds_read_b128 v[80:83], v3 offset:0
  ds_read_b64_tr_b16 v[160:161], v1 offset:32768
  ds_read_b64_tr_b16 v[162:163], v1 offset:33280
  v_mfma_f32_32x32x16_bf16 v[144:159], v[196:199], v[64:67], v[144:159]
  ds_read_b64_tr_b16 v[164:165], v2 offset:32768
  ds_read_b64_tr_b16 v[166:167], v2 offset:33280
  s_waitcnt lgkmcnt(15)
  v_mfma_f32_32x32x16_bf16 v[128:143], v[200:203], v[68:71], v[128:143]
  ds_read_b128 v[84:87], v4 offset:0
  ds_read_b64_tr_b16 v[168:169], v1 offset:34816
  ds_read_b64_tr_b16 v[170:171], v1 offset:35328
  v_mfma_f32_32x32x16_bf16 v[144:159], v[204:207], v[68:71], v[144:159]
  ds_read_b64_tr_b16 v[172:173], v2 offset:34816
  ds_read_b64_tr_b16 v[174:175], v2 offset:35328
  s_waitcnt lgkmcnt(15)
  v_mfma_f32_32x32x16_bf16 v[128:143], v[208:211], v[72:75], v[128:143]
  ds_read_b128 v[88:91], v5 offset:0
  ds_read_b64_tr_b16 v[176:177], v1 offset:36864
  ds_read_b64_tr_b16 v[178:179], v1 offset:37376
  v_mfma_f32_32x32x16_bf16 v[144:159], v[212:215], v[72:75], v[144:159]
  ds_read_b64_tr_b16 v[180:181], v2 offset:36864
  ds_read_b64_tr_b16 v[182:183], v2 offset:37376
  s_waitcnt lgkmcnt(15)
  v_mfma_f32_32x32x16_bf16 v[128:143], v[216:219], v[76:79], v[128:143]
  ds_read_b128 v[92:95], v6 offset:0
  ds_read_b64_tr_b16 v[184:185], v1 offset:38912
  ds_read_b64_tr_b16 v[186:187], v1 offset:39424
  v_mfma_f32_32x32x16_bf16 v[144:159], v[220:223], v[76:79], v[144:159]
  ds_read_b64_tr_b16 v[188:189], v2 offset:38912
  ds_read_b64_tr_b16 v[190:191], v2 offset:39424
  v_dot2_f32_bf16 v7, v64, v9, v7
  v_dot2_f32_bf16 v8, v64, v64, v8
  v_dot2_f32_bf16 v7, v65, v9, v7
  v_dot2_f32_bf16 v8, v65, v65, v8
  v_dot2_f32_bf16 v7, v66, v9, v7
  v_dot2_f32_bf16 v8, v66, v66, v8
  v_dot2_f32_bf16 v7, v67, v9, v7
  v_dot2_f32_bf16 v8, v67, v67, v8
  v_dot2_f32_bf16 v7, v68, v9, v7
  v_dot2_f32_bf16 v8, v68, v68, v8
  v_dot2_f32_bf16 v7, v69, v9, v7
  v_dot2_f32_bf16 v8, v69, v69, v8
  v_dot2_f32_bf16 v7, v70, v9, v7
  v_dot2_f32_bf16 v8, v70, v70, v8
  v_dot2_f32_bf16 v7, v71, v9, v7
  v_dot2_f32_bf16 v8, v71, v71, v8
  v_dot2_f32_bf16 v7, v72, v9, v7
  v_dot2_f32_bf16 v8, v72, v72, v8
  v_dot2_f32_bf16 v7, v73, v9, v7
  v_dot2_f32_bf16 v8, v73, v73, v8
  v_dot2_f32_bf16 v7, v74, v9, v7
  v_dot2_f32_bf16 v8, v74, v74, v8
  v_dot2_f32_bf16 v7, v75, v9, v7
  v_dot2_f32_bf16 v8, v75, v75, v8
  v_dot2_f32_bf16 v7, v76, v9, v7
  v_dot2_f32_bf16 v8, v76, v76, v8
  v_dot2_f32_bf16 v7, v77, v9, v7
  v_dot2_f32_bf16 v8, v77, v77, v8
  v_dot2_f32_bf16 v7, v78, v9, v7
  v_dot2_f32_bf16 v8, v78, v78, v8
  v_dot2_f32_bf16 v7, v79, v9, v7
  v_dot2_f32_bf16 v8, v79, v79, v8
  s_barrier
  s_waitcnt lgkmcnt(15)
  v_mfma_f32_32x32x16_bf16 v[128:143], v[160:163], v[80:83], v[128:143]
  ds_read_b128 v[96:99], v3 offset:16384
  ds_read_b64_tr_b16 v[192:193], v1 offset:40960
  ds_read_b64_tr_b16 v[194:195], v1 offset:41472
  v_mfma_f32_32x32x16_bf16 v[144:159], v[164:167], v[80:83], v[144:159]
  ds_read_b64_tr_b16 v[196:197], v2 offset:40960
  ds_read_b64_tr_b16 v[198:199], v2 offset:41472
  s_waitcnt lgkmcnt(15)
  v_mfma_f32_32x32x16_bf16 v[128:143], v[168:171], v[84:87], v[128:143]
  ds_read_b128 v[100:103], v4 offset:16384
  ds_read_b64_tr_b16 v[200:201], v1 offset:43008
  ds_read_b64_tr_b16 v[202:203], v1 offset:43520
  v_mfma_f32_32x32x16_bf16 v[144:159], v[172:175], v[84:87], v[144:159]
  ds_read_b64_tr_b16 v[204:205], v2 offset:43008
  ds_read_b64_tr_b16 v[206:207], v2 offset:43520
  s_waitcnt lgkmcnt(15)
  v_mfma_f32_32x32x16_bf16 v[128:143], v[176:179], v[88:91], v[128:143]
  ds_read_b128 v[104:107], v5 offset:16384
  ds_read_b64_tr_b16 v[208:209], v1 offset:45056
  ds_read_b64_tr_b16 v[210:211], v1 offset:45568
  v_mfma_f32_32x32x16_bf16 v[144:159], v[180:183], v[88:91], v[144:159]
  ds_read_b64_tr_b16 v[212:213], v2 offset:45056
  ds_read_b64_tr_b16 v[214:215], v2 offset:45568
  s_waitcnt lgkmcnt(15)
  v_mfma_f32_32x32x16_bf16 v[128:143], v[184:187], v[92:95], v[128:143]
  ds_read_b128 v[108:111], v6 offset:16384
  ds_read_b64_tr_b16 v[216:217], v1 offset:47104
  ds_read_b64_tr_b16 v[218:219], v1 offset:47616
  v_mfma_f32_32x32x16_bf16 v[144:159], v[188:191], v[92:95], v[144:159]
  ds_read_b64_tr_b16 v[220:221], v2 offset:47104
  ds_read_b64_tr_b16 v[222:223], v2 offset:47616
  v_dot2_f32_bf16 v7, v80, v9, v7
  v_dot2_f32_bf16 v8, v80, v80, v8
  v_dot2_f32_bf16 v7, v81, v9, v7
  v_dot2_f32_bf16 v8, v81, v81, v8
  v_dot2_f32_bf16 v7, v82, v9, v7
  v_dot2_f32_bf16 v8, v82, v82, v8
  v_dot2_f32_bf16 v7, v83, v9, v7
  v_dot2_f32_bf16 v8, v83, v83, v8
  v_dot2_f32_bf16 v7, v84, v9, v7
  v_dot2_f32_bf16 v8, v84, v84, v8
  v_dot2_f32_bf16 v7, v85, v9, v7
  v_dot2_f32_bf16 v8, v85, v85, v8
  v_dot2_f32_bf16 v7, v86, v9, v7
  v_dot2_f32_bf16 v8, v86, v86, v8
  v_dot2_f32_bf16 v7, v87, v9, v7
  v_dot2_f32_bf16 v8, v87, v87, v8
  v_dot2_f32_bf16 v7, v88, v9, v7
  v_dot2_f32_bf16 v8, v88, v88, v8
  v_dot2_f32_bf16 v7, v89, v9, v7
  v_dot2_f32_bf16 v8, v89, v89, v8
  v_dot2_f32_bf16 v7, v90, v9, v7
  v_dot2_f32_bf16 v8, v90, v90, v8
  v_dot2_f32_bf16 v7, v91, v9, v7
  v_dot2_f32_bf16 v8, v91, v91, v8
  v_dot2_f32_bf16 v7, v92, v9, v7
  v_dot2_f32_bf16 v8, v92, v92, v8
  v_dot2_f32_bf16 v7, v93, v9, v7
  v_dot2_f32_bf16 v8, v93, v93, v8
  v_dot2_f32_bf16 v7, v94, v9, v7
  v_dot2_f32_bf16 v8, v94, v94, v8
  v_dot2_f32_bf16 v7, v95, v9, v7
  v_dot2_f32_bf16 v8, v95, v95, v8
  s_barrier
  s_waitcnt lgkmcnt(15)
  v_mfma_f32_32x32x16_bf16 v[128:143], v[192:195], v[96:99], v[128:143]
  ds_read_b128 v[112:115], v3 offset:32768
  ds_read_b64_tr_b16 v[160:161], v1 offset:49152
  ds_read_b64_tr_b16 v[162:163], v1 offset:49664
  v_mfma_f32_32x32x16_bf16 v[144:159], v[196:199], v[96:99], v[144:159]
  ds_read_b64_tr_b16 v[164:165], v2 offset:49152
  ds_read_b64_tr_b16 v[166:167], v2 offset:49664
  s_waitcnt lgkmcnt(15)
  v_mfma_f32_32x32x16_bf16 v[128:143], v[200:203], v[100:103], v[128:143]
  ds_read_b128 v[116:119], v4 offset:32768
  ds_read_b64_tr_b16 v[168:169], v1 offset:51200
  ds_read_b64_tr_b16 v[170:171], v1 offset:51712
  v_mfma_f32_32x32x16_bf16 v[144:159], v[204:207], v[100:103], v[144:159]
  ds_read_b64_tr_b16 v[172:173], v2 offset:51200
  ds_read_b64_tr_b16 v[174:175], v2 offset:51712
  s_waitcnt lgkmcnt(15)
  v_mfma_f32_32x32x16_bf16 v[128:143], v[208:211], v[104:107], v[128:143]
  ds_read_b128 v[120:123], v5 offset:32768
  ds_read_b64_tr_b16 v[176:177], v1 offset:53248
  ds_read_b64_tr_b16 v[178:179], v1 offset:53760
  v_mfma_f32_32x32x16_bf16 v[144:159], v[212:215], v[104:107], v[144:159]
  ds_read_b64_tr_b16 v[180:181], v2 offset:53248
  ds_read_b64_tr_b16 v[182:183], v2 offset:53760
  s_waitcnt lgkmcnt(15)
  v_mfma_f32_32x32x16_bf16 v[128:143], v[216:219], v[108:111], v[128:143]
  ds_read_b128 v[124:127], v6 offset:32768
  ds_read_b64_tr_b16 v[184:185], v1 offset:55296
  ds_read_b64_tr_b16 v[186:187], v1 offset:55808
  v_mfma_f32_32x32x16_bf16 v[144:159], v[220:223], v[108:111], v[144:159]
  ds_read_b64_tr_b16 v[188:189], v2 offset:55296
  ds_read_b64_tr_b16 v[190:191], v2 offset:55808
  v_dot2_f32_bf16 v7, v96, v9, v7
  v_dot2_f32_bf16 v8, v96, v96, v8
  v_dot2_f32_bf16 v7, v97, v9, v7
  v_dot2_f32_bf16 v8, v97, v97, v8
  v_dot2_f32_bf16 v7, v98, v9, v7
  v_dot2_f32_bf16 v8, v98, v98, v8
  v_dot2_f32_bf16 v7, v99, v9, v7
  v_dot2_f32_bf16 v8, v99, v99, v8
  v_dot2_f32_bf16 v7, v100, v9, v7
  v_dot2_f32_bf16 v8, v100, v100, v8
  v_dot2_f32_bf16 v7, v101, v9, v7
  v_dot2_f32_bf16 v8, v101, v101, v8
  v_dot2_f32_bf16 v7, v102, v9, v7
  v_dot2_f32_bf16 v8, v102, v102, v8
  v_dot2_f32_bf16 v7, v103, v9, v7
  v_dot2_f32_bf16 v8, v103, v103, v8
  v_dot2_f32_bf16 v7, v104, v9, v7
  v_dot2_f32_bf16 v8, v104, v104, v8
  v_dot2_f32_bf16 v7, v105, v9, v7
  v_dot2_f32_bf16 v8, v105, v105, v8
  v_dot2_f32_bf16 v7, v106, v9, v7
  v_dot2_f32_bf16 v8, v106, v106, v8
  v_dot2_f32_bf16 v7, v107, v9, v7
  v_dot2_f32_bf16 v8, v107, v107, v8
  v_dot2_f32_bf16 v7, v108, v9, v7
  v_dot2_f32_bf16 v8, v108, v108, v8
  v_dot2_f32_bf16 v7, v109, v9, v7
  v_dot2_f32_bf16 v8, v109, v109, v8
  v_dot2_f32_bf16 v7, v110, v9, v7
  v_dot2_f32_bf16 v8, v110, v110, v8
  v_dot2_f32_bf16 v7, v111, v9, v7
  v_dot2_f32_bf16 v8, v111, v111, v8
  s_waitcnt lgkmcnt(15)
  v_mfma_f32_32x32x16_bf16 v[128:143], v[160:163], v[112:115], v[128:143]
  v_mfma_f32_32x32x16_bf16 v[144:159], v[164:167], v[112:115], v[144:159]
  s_waitcnt lgkmcnt(12)
  v_mfma_f32_32x32x16_bf16 v[128:143], v[168:171], v[116:119], v[128:143]
  s_waitcnt lgkmcnt(10)
  v_mfma_f32_32x32x16_bf16 v[144:159], v[172:175], v[116:119], v[144:159]
  s_waitcnt lgkmcnt(7)
  v_mfma_f32_32x32x16_bf16 v[128:143], v[176:179], v[120:123], v[128:143]
  s_waitcnt lgkmcnt(5)
  v_mfma_f32_32x32x16_bf16 v[144:159], v[180:183], v[120:123], v[144:159]
  s_waitcnt lgkmcnt(2)
  v_mfma_f32_32x32x16_bf16 v[128:143], v[184:187], v[124:127], v[128:143]
  s_waitcnt lgkmcnt(0)
  v_mfma_f32_32x32x16_bf16 v[144:159], v[188:191], v[124:127], v[144:159]
  v_dot2_f32_bf16 v7, v112, v9, v7
  v_dot2_f32_bf16 v8, v112, v112, v8
  v_dot2_f32_bf16 v7, v113, v9, v7
  v_dot2_f32_bf16 v8, v113, v113, v8
  v_dot2_f32_bf16 v7, v114, v9, v7
  v_dot2_f32_bf16 v8, v114, v114, v8
  v_dot2_f32_bf16 v7, v115, v9, v7
  v_dot2_f32_bf16 v8, v115, v115, v8
  v_dot2_f32_bf16 v7, v116, v9, v7
  v_dot2_f32_bf16 v8, v116, v116, v8
  v_dot2_f32_bf16 v7, v117, v9, v7
  v_dot2_f32_bf16 v8, v117, v117, v8
  v_dot2_f32_bf16 v7, v118, v9, v7
  v_dot2_f32_bf16 v8, v118, v118, v8
  v_dot2_f32_bf16 v7, v119, v9, v7
  v_dot2_f32_bf16 v8, v119, v119, v8
  v_dot2_f32_bf16 v7, v120, v9, v7
  v_dot2_f32_bf16 v8, v120, v120, v8
  v_dot2_f32_bf16 v7, v121, v9, v7
  v_dot2_f32_bf16 v8, v121, v121, v8
  v_dot2_f32_bf16 v7, v122, v9, v7
  v_dot2_f32_bf16 v8, v122, v122, v8
  v_dot2_f32_bf16 v7, v123, v9, v7
  v_dot2_f32_bf16 v8, v123, v123, v8
  v_dot2_f32_bf16 v7, v124, v9, v7
  v_dot2_f32_bf16 v8, v124, v124, v8
  v_dot2_f32_bf16 v7, v125, v9, v7
  v_dot2_f32_bf16 v8, v125, v125, v8
  v_dot2_f32_bf16 v7, v126, v9, v7
  v_dot2_f32_bf16 v8, v126, v126, v8
  v_dot2_f32_bf16 v7, v127, v9, v7
  v_dot2_f32_bf16 v8, v127, v127, v8
  s_nop 1
  v_mov_b32 v232, v7
  s_nop 1
  v_permlane32_swap_b32 v7, v232
  v_add_f32 v7, v7, v232
  v_mov_b32 v233, v8
  s_nop 1
  v_permlane32_swap_b32 v8, v233
  v_add_f32 v8, v8, v233
  v_mul_f32 v232, 0x3b124925, v7
  v_mul_f32 v233, 0x3b124925, v8
  v_fma_f32 v233, -v232, v232, v233
  v_max_f32 v233, 0, v233
  v_cvt_pk_bf16_f32 v234, v232, v232
  v_lshlrev_b32 v234, 16, v234
  v_cvt_pk_bf16_f32 v233, v233, v233
  v_lshlrev_b32 v233, 16, v233
  v_add_f32 v233, 0x3727c5ac, v233
  v_cvt_pk_bf16_f32 v233, v233, v233
  v_lshlrev_b32 v233, 16, v233
  v_sqrt_f32 v233, v233
  s_nop 0
  v_cvt_pk_bf16_f32 v233, v233, v233
  v_lshlrev_b32 v233, 16, v233
  v_rcp_f32 v253, v233
  v_sub_f32 v234, 0, v234
  v_mul_f32 v252, v234, v253
  v_mul_f32 v235, 0x3d800000, v253
  v_and_b32 v232, 31, v0
  v_lshlrev_b32 v232, 2, v232
  s_lshl_b32 s8, s36, 9
  v_add_u32 v232, s8, v232
  ds_write_b32 v232, v234 offset:57856
  ds_write_b32 v232, v235 offset:57984
  v_mov_b32 v192, v252
  v_mov_b32 v193, v252
  v_mov_b32 v194, v253
  v_mov_b32 v195, v253
  v_mov_b32 v196, 0xc0135761
  v_mov_b32 v197, 0xc0135761
  v_mov_b32 v198, 0xbdd2d3e8
  v_mov_b32 v199, 0xbdd2d3e8
  v_mov_b32 v200, 0x3f800000
  v_mov_b32 v201, 0x3f800000
  v_and_b32 v254, 31, v0
  v_lshlrev_b32 v254, 3, v254
  buffer_load_dword v254, v254, s[32:35], 0 offen sc1
  s_barrier
  ds_read_b128 v[232:235], v11 offset:57344
  ds_read_b128 v[236:239], v11 offset:57376
  s_waitcnt lgkmcnt(1)
  v_pk_mul_f32 v[240:241], v[192:193], v[232:233]
  v_pk_mul_f32 v[242:243], v[192:193], v[234:235]
  ds_read_b128 v[232:235], v11 offset:57408
  v_pk_fma_f32 v[240:241], v[128:129], v[194:195], v[240:241]
  v_pk_fma_f32 v[242:243], v[130:131], v[194:195], v[242:243]
  v_pk_mul_f32 v[244:245], v[240:241], v[240:241]
  v_pk_mul_f32 v[246:247], v[242:243], v[242:243]
  v_pk_fma_f32 v[244:245], v[244:245], v[198:199], v[196:197]
  v_pk_fma_f32 v[246:247], v[246:247], v[198:199], v[196:197]
  v_pk_mul_f32 v[244:245], v[244:245], v[240:241]
  v_pk_mul_f32 v[246:247], v[246:247], v[242:243]
  v_exp_f32 v248, v244
  v_exp_f32 v249, v245
  v_exp_f32 v250, v246
  v_exp_f32 v251, v247
  v_pk_add_f32 v[248:249], v[248:249], v[200:201]
  v_pk_add_f32 v[250:251], v[250:251], v[200:201]
  v_rcp_f32 v248, v248
  v_rcp_f32 v249, v249
  v_rcp_f32 v250, v250
  v_rcp_f32 v251, v251
  v_pk_mul_f32 v[240:241], v[240:241], v[248:249]
  v_pk_mul_f32 v[242:243], v[242:243], v[250:251]
  v_cvt_pk_bf16_f32 v216, v240, v241
  v_cvt_pk_bf16_f32 v217, v242, v243
  s_waitcnt lgkmcnt(1)
  v_pk_mul_f32 v[240:241], v[192:193], v[236:237]
  v_pk_mul_f32 v[242:243], v[192:193], v[238:239]
  ds_read_b128 v[236:239], v11 offset:57440
  v_pk_fma_f32 v[240:241], v[132:133], v[194:195], v[240:241]
  v_pk_fma_f32 v[242:243], v[134:135], v[194:195], v[242:243]
  v_pk_mul_f32 v[244:245], v[240:241], v[240:241]
  v_pk_mul_f32 v[246:247], v[242:243], v[242:243]
  v_pk_fma_f32 v[244:245], v[244:245], v[198:199], v[196:197]
  v_pk_fma_f32 v[246:247], v[246:247], v[198:199], v[196:197]
  v_pk_mul_f32 v[244:245], v[244:245], v[240:241]
  v_pk_mul_f32 v[246:247], v[246:247], v[242:243]
  v_exp_f32 v248, v244
  v_exp_f32 v249, v245
  v_exp_f32 v250, v246
  v_exp_f32 v251, v247
  v_pk_add_f32 v[248:249], v[248:249], v[200:201]
  v_pk_add_f32 v[250:251], v[250:251], v[200:201]
  v_rcp_f32 v248, v248
  v_rcp_f32 v249, v249
  v_rcp_f32 v250, v250
  v_rcp_f32 v251, v251
  v_pk_mul_f32 v[240:241], v[240:241], v[248:249]
  v_pk_mul_f32 v[242:243], v[242:243], v[250:251]
  v_cvt_pk_bf16_f32 v218, v240, v241
  v_cvt_pk_bf16_f32 v219, v242, v243
  s_waitcnt lgkmcnt(1)
  v_pk_mul_f32 v[240:241], v[192:193], v[232:233]
  v_pk_mul_f32 v[242:243], v[192:193], v[234:235]
  ds_read_b128 v[232:235], v11 offset:57472
  v_pk_fma_f32 v[240:241], v[136:137], v[194:195], v[240:241]
  v_pk_fma_f32 v[242:243], v[138:139], v[194:195], v[242:243]
  v_pk_mul_f32 v[244:245], v[240:241], v[240:241]
  v_pk_mul_f32 v[246:247], v[242:243], v[242:243]
  v_pk_fma_f32 v[244:245], v[244:245], v[198:199], v[196:197]
  v_pk_fma_f32 v[246:247], v[246:247], v[198:199], v[196:197]
  v_pk_mul_f32 v[244:245], v[244:245], v[240:241]
  v_pk_mul_f32 v[246:247], v[246:247], v[242:243]
  v_exp_f32 v248, v244
  v_exp_f32 v249, v245
  v_exp_f32 v250, v246
  v_exp_f32 v251, v247
  v_pk_add_f32 v[248:249], v[248:249], v[200:201]
  v_pk_add_f32 v[250:251], v[250:251], v[200:201]
  v_rcp_f32 v248, v248
  v_rcp_f32 v249, v249
  v_rcp_f32 v250, v250
  v_rcp_f32 v251, v251
  v_pk_mul_f32 v[240:241], v[240:241], v[248:249]
  v_pk_mul_f32 v[242:243], v[242:243], v[250:251]
  v_cvt_pk_bf16_f32 v220, v240, v241
  v_cvt_pk_bf16_f32 v221, v242, v243
  s_waitcnt lgkmcnt(1)
  v_pk_mul_f32 v[240:241], v[192:193], v[236:237]
  v_pk_mul_f32 v[242:243], v[192:193], v[238:239]
  ds_read_b128 v[236:239], v11 offset:57504
  v_pk_fma_f32 v[240:241], v[140:141], v[194:195], v[240:241]
  v_pk_fma_f32 v[242:243], v[142:143], v[194:195], v[242:243]
  v_pk_mul_f32 v[244:245], v[240:241], v[240:241]
  v_pk_mul_f32 v[246:247], v[242:243], v[242:243]
  v_pk_fma_f32 v[244:245], v[244:245], v[198:199], v[196:197]
  v_pk_fma_f32 v[246:247], v[246:247], v[198:199], v[196:197]
  v_pk_mul_f32 v[244:245], v[244:245], v[240:241]
  v_pk_mul_f32 v[246:247], v[246:247], v[242:243]
  v_exp_f32 v248, v244
  v_exp_f32 v249, v245
  v_exp_f32 v250, v246
  v_exp_f32 v251, v247
  v_pk_add_f32 v[248:249], v[248:249], v[200:201]
  v_pk_add_f32 v[250:251], v[250:251], v[200:201]
  v_rcp_f32 v248, v248
  v_rcp_f32 v249, v249
  v_rcp_f32 v250, v250
  v_rcp_f32 v251, v251
  v_pk_mul_f32 v[240:241], v[240:241], v[248:249]
  v_pk_mul_f32 v[242:243], v[242:243], v[250:251]
  v_cvt_pk_bf16_f32 v222, v240, v241
  v_cvt_pk_bf16_f32 v223, v242, v243
  s_waitcnt lgkmcnt(1)
  v_pk_mul_f32 v[240:241], v[192:193], v[232:233]
  v_pk_mul_f32 v[242:243], v[192:193], v[234:235]
  ds_read_b128 v[232:235], v11 offset:57536
  v_pk_fma_f32 v[240:241], v[144:145], v[194:195], v[240:241]
  v_pk_fma_f32 v[242:243], v[146:147], v[194:195], v[242:243]
  v_pk_mul_f32 v[244:245], v[240:241], v[240:241]
  v_pk_mul_f32 v[246:247], v[242:243], v[242:243]
  v_pk_fma_f32 v[244:245], v[244:245], v[198:199], v[196:197]
  v_pk_fma_f32 v[246:247], v[246:247], v[198:199], v[196:197]
  v_pk_mul_f32 v[244:245], v[244:245], v[240:241]
  v_pk_mul_f32 v[246:247], v[246:247], v[242:243]
  v_exp_f32 v248, v244
  v_exp_f32 v249, v245
  v_exp_f32 v250, v246
  v_exp_f32 v251, v247
  v_pk_add_f32 v[248:249], v[248:249], v[200:201]
  v_pk_add_f32 v[250:251], v[250:251], v[200:201]
  v_rcp_f32 v248, v248
  v_rcp_f32 v249, v249
  v_rcp_f32 v250, v250
  v_rcp_f32 v251, v251
  v_pk_mul_f32 v[240:241], v[240:241], v[248:249]
  v_pk_mul_f32 v[242:243], v[242:243], v[250:251]
  v_cvt_pk_bf16_f32 v224, v240, v241
  v_cvt_pk_bf16_f32 v225, v242, v243
  s_waitcnt lgkmcnt(1)
  v_pk_mul_f32 v[240:241], v[192:193], v[236:237]
  v_pk_mul_f32 v[242:243], v[192:193], v[238:239]
  ds_read_b128 v[236:239], v11 offset:57568
  v_pk_fma_f32 v[240:241], v[148:149], v[194:195], v[240:241]
  v_pk_fma_f32 v[242:243], v[150:151], v[194:195], v[242:243]
  v_pk_mul_f32 v[244:245], v[240:241], v[240:241]
  v_pk_mul_f32 v[246:247], v[242:243], v[242:243]
  v_pk_fma_f32 v[244:245], v[244:245], v[198:199], v[196:197]
  v_pk_fma_f32 v[246:247], v[246:247], v[198:199], v[196:197]
  v_pk_mul_f32 v[244:245], v[244:245], v[240:241]
  v_pk_mul_f32 v[246:247], v[246:247], v[242:243]
  v_exp_f32 v248, v244
  v_exp_f32 v249, v245
  v_exp_f32 v250, v246
  v_exp_f32 v251, v247
  v_pk_add_f32 v[248:249], v[248:249], v[200:201]
  v_pk_add_f32 v[250:251], v[250:251], v[200:201]
  v_rcp_f32 v248, v248
  v_rcp_f32 v249, v249
  v_rcp_f32 v250, v250
  v_rcp_f32 v251, v251
  v_pk_mul_f32 v[240:241], v[240:241], v[248:249]
  v_pk_mul_f32 v[242:243], v[242:243], v[250:251]
  v_cvt_pk_bf16_f32 v226, v240, v241
  v_cvt_pk_bf16_f32 v227, v242, v243
  s_waitcnt lgkmcnt(1)
  v_pk_mul_f32 v[240:241], v[192:193], v[232:233]
  v_pk_mul_f32 v[242:243], v[192:193], v[234:235]
  v_pk_fma_f32 v[240:241], v[152:153], v[194:195], v[240:241]
  v_pk_fma_f32 v[242:243], v[154:155], v[194:195], v[242:243]
  v_pk_mul_f32 v[244:245], v[240:241], v[240:241]
  v_pk_mul_f32 v[246:247], v[242:243], v[242:243]
  v_pk_fma_f32 v[244:245], v[244:245], v[198:199], v[196:197]
  v_pk_fma_f32 v[246:247], v[246:247], v[198:199], v[196:197]
  v_pk_mul_f32 v[244:245], v[244:245], v[240:241]
  v_pk_mul_f32 v[246:247], v[246:247], v[242:243]
  v_exp_f32 v248, v244
  v_exp_f32 v249, v245
  v_exp_f32 v250, v246
  v_exp_f32 v251, v247
  v_pk_add_f32 v[248:249], v[248:249], v[200:201]
  v_pk_add_f32 v[250:251], v[250:251], v[200:201]
  v_rcp_f32 v248, v248
  v_rcp_f32 v249, v249
  v_rcp_f32 v250, v250
  v_rcp_f32 v251, v251
  v_pk_mul_f32 v[240:241], v[240:241], v[248:249]
  v_pk_mul_f32 v[242:243], v[242:243], v[250:251]
  v_cvt_pk_bf16_f32 v228, v240, v241
  v_cvt_pk_bf16_f32 v229, v242, v243
  s_waitcnt lgkmcnt(0)
  v_pk_mul_f32 v[240:241], v[192:193], v[236:237]
  v_pk_mul_f32 v[242:243], v[192:193], v[238:239]
  v_pk_fma_f32 v[240:241], v[156:157], v[194:195], v[240:241]
  v_pk_fma_f32 v[242:243], v[158:159], v[194:195], v[242:243]
  v_pk_mul_f32 v[244:245], v[240:241], v[240:241]
  v_pk_mul_f32 v[246:247], v[242:243], v[242:243]
  v_pk_fma_f32 v[244:245], v[244:245], v[198:199], v[196:197]
  v_pk_fma_f32 v[246:247], v[246:247], v[198:199], v[196:197]
  v_pk_mul_f32 v[244:245], v[244:245], v[240:241]
  v_pk_mul_f32 v[246:247], v[246:247], v[242:243]
  v_exp_f32 v248, v244
  v_exp_f32 v249, v245
  v_exp_f32 v250, v246
  v_exp_f32 v251, v247
  v_pk_add_f32 v[248:249], v[248:249], v[200:201]
  v_pk_add_f32 v[250:251], v[250:251], v[200:201]
  v_rcp_f32 v248, v248
  v_rcp_f32 v249, v249
  v_rcp_f32 v250, v250
  v_rcp_f32 v251, v251
  v_pk_mul_f32 v[240:241], v[240:241], v[248:249]
  v_pk_mul_f32 v[242:243], v[242:243], v[250:251]
  v_cvt_pk_bf16_f32 v230, v240, v241
  v_cvt_pk_bf16_f32 v231, v242, v243
  v_mov_b32 v7, 0
  v_mov_b32 v8, 0
  v_dot2_f32_bf16 v7, v216, v9, v7
  v_dot2_f32_bf16 v8, v216, v216, v8
  v_dot2_f32_bf16 v7, v217, v9, v7
  v_dot2_f32_bf16 v8, v217, v217, v8
  v_dot2_f32_bf16 v7, v218, v9, v7
  v_dot2_f32_bf16 v8, v218, v218, v8
  v_dot2_f32_bf16 v7, v219, v9, v7
  v_dot2_f32_bf16 v8, v219, v219, v8
  v_dot2_f32_bf16 v7, v220, v9, v7
  v_dot2_f32_bf16 v8, v220, v220, v8
  v_dot2_f32_bf16 v7, v221, v9, v7
  v_dot2_f32_bf16 v8, v221, v221, v8
  v_dot2_f32_bf16 v7, v222, v9, v7
  v_dot2_f32_bf16 v8, v222, v222, v8
  v_dot2_f32_bf16 v7, v223, v9, v7
  v_dot2_f32_bf16 v8, v223, v223, v8
  v_dot2_f32_bf16 v7, v224, v9, v7
  v_dot2_f32_bf16 v8, v224, v224, v8
  v_dot2_f32_bf16 v7, v225, v9, v7
  v_dot2_f32_bf16 v8, v225, v225, v8
  v_dot2_f32_bf16 v7, v226, v9, v7
  v_dot2_f32_bf16 v8, v226, v226, v8
  v_dot2_f32_bf16 v7, v227, v9, v7
  v_dot2_f32_bf16 v8, v227, v227, v8
  v_dot2_f32_bf16 v7, v228, v9, v7
  v_dot2_f32_bf16 v8, v228, v228, v8
  v_dot2_f32_bf16 v7, v229, v9, v7
  v_dot2_f32_bf16 v8, v229, v229, v8
  v_dot2_f32_bf16 v7, v230, v9, v7
  v_dot2_f32_bf16 v8, v230, v230, v8
  v_dot2_f32_bf16 v7, v231, v9, v7
  v_dot2_f32_bf16 v8, v231, v231, v8
  s_nop 1
  v_mov_b32 v232, v7
  s_nop 1
  v_permlane32_swap_b32 v7, v232
  v_add_f32 v7, v7, v232
  v_mov_b32 v233, v8
  s_nop 1
  v_permlane32_swap_b32 v8, v233
  v_add_f32 v8, v8, v233
  v_and_b32 v234, -2, v7
  v_and_b32 v235, -2, v8
  s_mul_i32 s8, s38, 14
  s_add_u32 s8, s8, s37
  s_lshl_b32 s8, s8, 10
  s_lshl_b32 s9, s36, 8
  s_add_u32 s8, s8, s9
  s_add_u32 s8, s8, 18874368
  v_and_b32 v232, 31, v0
  v_lshlrev_b32 v232, 3, v232
  s_waitcnt vmcnt(0)
  v_cmp_ne_u32 vcc, 1, v254
  s_nop 4
  s_cbranch_vccz MK_chs_done
  v_and_b32 v236, 31, v0
  v_lshlrev_b32 v236, 3, v236
MK_chs:
  buffer_load_dword v237, v236, s[32:35], 0 offen sc1
  s_waitcnt vmcnt(0)
  v_cmp_ne_u32 vcc, 1, v237
  s_nop 4
  s_cbranch_vccz MK_chs_ok
  s_sub_u32 s96, s96, 1
  s_cmp_eq_u32 s96, 0
  s_cbranch_scc1 MK_end
  s_sleep 4
  s_branch MK_chs
MK_chs_ok:
MK_chs_done:
  buffer_store_dwordx2 v[234:235], v232, s[24:27], s8 offen sc1
  v_lshlrev_b32 v236, 4, v0
  v_add_u32 v236, 65536, v236
  ds_read_b128 v[192:195], v236 offset:0
  ds_read_b128 v[196:199], v236 offset:1024
  ds_read_b128 v[200:203], v236 offset:2048
  ds_read_b128 v[204:207], v236 offset:3072
  ds_read_b128 v[208:211], v236 offset:4096
  s_lshl_b32 s9, s36, 9
  v_add_u32 v233, s9, v11
  s_waitcnt lgkmcnt(4)
  v_mfma_f32_32x32x16_bf16 v[128:143], v[16:19], v[192:195], 0
  ds_read_b128 v[212:215], v236 offset:5120
  s_waitcnt lgkmcnt(4)
  v_mfma_f32_32x32x16_bf16 v[128:143], v[20:23], v[196:199], v[128:143]
  ds_read_b128 v[192:195], v236 offset:6144
  s_waitcnt lgkmcnt(4)
  v_mfma_f32_32x32x16_bf16 v[128:143], v[24:27], v[200:203], v[128:143]
  ds_read_b128 v[196:199], v236 offset:7168
  s_waitcnt lgkmcnt(4)
  v_mfma_f32_32x32x16_bf16 v[128:143], v[28:31], v[204:207], v[128:143]
  ds_read_b128 v[200:203], v236 offset:8192
  s_waitcnt lgkmcnt(4)
  v_mfma_f32_32x32x16_bf16 v[128:143], v[32:35], v[208:211], v[128:143]
  ds_read_b128 v[204:207], v236 offset:9216
  s_waitcnt lgkmcnt(4)
  v_mfma_f32_32x32x16_bf16 v[128:143], v[36:39], v[212:215], v[128:143]
  ds_read_b128 v[208:211], v236 offset:10240
  s_waitcnt lgkmcnt(4)
  v_mfma_f32_32x32x16_bf16 v[128:143], v[40:43], v[192:195], v[128:143]
  ds_read_b128 v[212:215], v236 offset:11264
  s_waitcnt lgkmcnt(4)
  v_mfma_f32_32x32x16_bf16 v[128:143], v[44:47], v[196:199], v[128:143]
  ds_read_b128 v[192:195], v236 offset:12288
  s_waitcnt lgkmcnt(4)
  v_mfma_f32_32x32x16_bf16 v[128:143], v[48:51], v[200:203], v[128:143]
  ds_read_b128 v[196:199], v236 offset:13312
  s_waitcnt lgkmcnt(4)
  v_mfma_f32_32x32x16_bf16 v[128:143], v[52:55], v[204:207], v[128:143]
  ds_read_b128 v[200:203], v236 offset:14336
  s_waitcnt lgkmcnt(4)
  v_mfma_f32_32x32x16_bf16 v[128:143], v[56:59], v[208:211], v[128:143]
  ds_read_b128 v[204:207], v236 offset:15360
  s_waitcnt lgkmcnt(4)
  v_mfma_f32_32x32x16_bf16 v[128:143], v[60:63], v[212:215], v[128:143]
  ds_read_b128 v[208:211], v236 offset:16384
  s_waitcnt lgkmcnt(4)
  v_mfma_f32_32x32x16_bf16 v[128:143], v[64:67], v[192:195], v[128:143]
  ds_read_b128 v[212:215], v236 offset:17408
  s_waitcnt lgkmcnt(4)
  v_mfma_f32_32x32x16_bf16 v[128:143], v[68:71], v[196:199], v[128:143]
  ds_read_b128 v[192:195], v236 offset:18432
  s_waitcnt lgkmcnt(4)
  v_mfma_f32_32x32x16_bf16 v[128:143], v[72:75], v[200:203], v[128:143]
  ds_read_b128 v[196:199], v236 offset:19456
  s_waitcnt lgkmcnt(4)
  v_mfma_f32_32x32x16_bf16 v[128:143], v[76:79], v[204:207], v[128:143]
  ds_read_b128 v[200:203], v236 offset:20480
  s_waitcnt lgkmcnt(4)
  v_mfma_f32_32x32x16_bf16 v[128:143], v[80:83], v[208:211], v[128:143]
  ds_read_b128 v[204:207], v236 offset:21504
  s_waitcnt lgkmcnt(4)
  v_mfma_f32_32x32x16_bf16 v[128:143], v[84:87], v[212:215], v[128:143]
  ds_read_b128 v[208:211], v236 offset:22528
  s_waitcnt lgkmcnt(4)
  v_mfma_f32_32x32x16_bf16 v[128:143], v[88:91], v[192:195], v[128:143]
  ds_read_b128 v[212:215], v236 offset:23552
  s_waitcnt lgkmcnt(4)
  v_mfma_f32_32x32x16_bf16 v[128:143], v[92:95], v[196:199], v[128:143]
  ds_read_b128 v[192:195], v236 offset:24576
  s_waitcnt lgkmcnt(4)
  v_mfma_f32_32x32x16_bf16 v[128:143], v[96:99], v[200:203], v[128:143]
  ds_read_b128 v[196:199], v236 offset:25600
  s_waitcnt lgkmcnt(4)
  v_mfma_f32_32x32x16_bf16 v[128:143], v[100:103], v[204:207], v[128:143]
  ds_read_b128 v[200:203], v236 offset:26624
  s_waitcnt lgkmcnt(4)
  v_mfma_f32_32x32x16_bf16 v[128:143], v[104:107], v[208:211], v[128:143]
  ds_read_b128 v[204:207], v236 offset:27648
  s_waitcnt lgkmcnt(4)
  v_mfma_f32_32x32x16_bf16 v[128:143], v[108:111], v[212:215], v[128:143]
  ds_read_b128 v[160:163], v233 offset:57856
  ds_read_b128 v[176:179], v233 offset:57984
  s_waitcnt lgkmcnt(5)
  v_mfma_f32_32x32x16_bf16 v[128:143], v[112:115], v[192:195], v[128:143]
  ds_read_b128 v[164:167], v233 offset:57888
  ds_read_b128 v[180:183], v233 offset:58016
  s_waitcnt lgkmcnt(6)
  v_mfma_f32_32x32x16_bf16 v[128:143], v[116:119], v[196:199], v[128:143]
  ds_read_b128 v[168:171], v233 offset:57920
  ds_read_b128 v[184:187], v233 offset:58048
  s_waitcnt lgkmcnt(7)
  v_mfma_f32_32x32x16_bf16 v[128:143], v[120:123], v[200:203], v[128:143]
  ds_read_b128 v[172:175], v233 offset:57952
  ds_read_b128 v[188:191], v233 offset:58080
  s_waitcnt lgkmcnt(8)
  v_mfma_f32_32x32x16_bf16 v[128:143], v[124:127], v[204:207], v[128:143]
  v_and_b32 v234, 15, v0
  s_lshl_b32 s9, s37, 5
  v_add_u32 v234, s9, v234
  v_mul_u32_u24 v234, 4224, v234
  v_add_u32 v234, v15, v234
  v_add_u32 v235, 67584, v234
  s_lshl_b32 s9, s55, 1
  s_add_u32 s9, s9, 8388608
  s_waitcnt lgkmcnt(7)
  s_nop 2
  v_fma_f32 v128, v160, v12, v128
  v_fma_f32 v129, v161, v12, v129
  v_fma_f32 v130, v162, v12, v130
  v_fma_f32 v131, v163, v12, v131
  s_waitcnt lgkmcnt(5)
  v_fma_f32 v132, v164, v12, v132
  v_fma_f32 v133, v165, v12, v133
  v_fma_f32 v134, v166, v12, v134
  v_fma_f32 v135, v167, v12, v135
  s_waitcnt lgkmcnt(3)
  v_fma_f32 v136, v168, v12, v136
  v_fma_f32 v137, v169, v12, v137
  v_fma_f32 v138, v170, v12, v138
  v_fma_f32 v139, v171, v12, v139
  s_waitcnt lgkmcnt(1)
  v_fma_f32 v140, v172, v12, v140
  v_fma_f32 v141, v173, v12, v141
  v_fma_f32 v142, v174, v12, v142
  v_fma_f32 v143, v175, v12, v143
  v_mul_f32 v128, v128, v176
  v_mul_f32 v129, v129, v177
  v_mul_f32 v130, v130, v178
  v_mul_f32 v131, v131, v179
  v_mul_f32 v132, v132, v180
  v_mul_f32 v133, v133, v181
  v_mul_f32 v134, v134, v182
  v_mul_f32 v135, v135, v183
  v_mul_f32 v136, v136, v184
  v_mul_f32 v137, v137, v185
  v_mul_f32 v138, v138, v186
  v_mul_f32 v139, v139, v187
  s_waitcnt lgkmcnt(0)
  v_mul_f32 v140, v140, v188
  v_mul_f32 v141, v141, v189
  v_mul_f32 v142, v142, v190
  v_mul_f32 v143, v143, v191
  v_cvt_pk_f16_f32 v236, v128, v129
  v_cvt_pk_f16_f32 v237, v130, v131
  v_cvt_pk_f16_f32 v238, v132, v133
  v_cvt_pk_f16_f32 v239, v134, v135
  v_cvt_pk_f16_f32 v240, v136, v137
  v_cvt_pk_f16_f32 v241, v138, v139
  v_cvt_pk_f16_f32 v242, v140, v141
  v_cvt_pk_f16_f32 v243, v142, v143
  v_permlane32_swap_b32 v236, v238
  v_permlane32_swap_b32 v237, v239
  v_permlane32_swap_b32 v240, v242
  v_permlane32_swap_b32 v241, v243
  s_nop 0
  v_permlane16_swap_b32 v236, v240
  v_permlane16_swap_b32 v237, v241
  v_permlane16_swap_b32 v238, v242
  v_permlane16_swap_b32 v239, v243
  buffer_store_dwordx4 v[236:239], v234, s[24:27], s9 offen offset:0 sc1
  buffer_store_dwordx4 v[240:243], v235, s[24:27], s9 offen offset:0 sc1
  v_lshlrev_b32 v128, 16, v216
  v_and_b32 v129, 0xffff0000, v216
  v_lshlrev_b32 v130, 16, v217
  v_and_b32 v131, 0xffff0000, v217
  v_lshlrev_b32 v132, 16, v218
  v_and_b32 v133, 0xffff0000, v218
  v_lshlrev_b32 v134, 16, v219
  v_and_b32 v135, 0xffff0000, v219
  v_lshlrev_b32 v136, 16, v220
  v_and_b32 v137, 0xffff0000, v220
  v_lshlrev_b32 v138, 16, v221
  v_and_b32 v139, 0xffff0000, v221
  v_lshlrev_b32 v140, 16, v222
  v_and_b32 v141, 0xffff0000, v222
  v_lshlrev_b32 v142, 16, v223
  v_and_b32 v143, 0xffff0000, v223
  v_lshlrev_b32 v144, 16, v224
  v_and_b32 v145, 0xffff0000, v224
  v_lshlrev_b32 v146, 16, v225
  v_and_b32 v147, 0xffff0000, v225
  v_lshlrev_b32 v148, 16, v226
  v_and_b32 v149, 0xffff0000, v226
  v_lshlrev_b32 v150, 16, v227
  v_and_b32 v151, 0xffff0000, v227
  v_lshlrev_b32 v152, 16, v228
  v_and_b32 v153, 0xffff0000, v228
  v_lshlrev_b32 v154, 16, v229
  v_and_b32 v155, 0xffff0000, v229
  v_lshlrev_b32 v156, 16, v230
  v_and_b32 v157, 0xffff0000, v230
  v_lshlrev_b32 v158, 16, v231
  v_and_b32 v159, 0xffff0000, v231
  v_and_b32 v232, 31, v0
  v_lshlrev_b32 v232, 3, v232
  s_lshl_b32 s9, s36, 8
  v_add_u32 v232, s9, v232
  s_mov_b32 s8, 4194304
  s_lshl_b32 s10, s37, 4
  s_add_u32 s10, s10, s38
  s_lshl_b32 s10, s10, 7
  s_lshl_b32 s11, s36, 2
  s_add_u32 s10, s10, s11
  s_add_u32 s10, s10, 19103744
  s_lshr_b32 s9, s36, 1
  s_lshl_b32 s9, s9, 2
  v_mov_b32 v233, s9
  v_mov_b32 v248, 0
  v_mov_b32 v249, 1
MK_cwln:
  ds_read_b32 v234, v233 offset:60932
  s_waitcnt lgkmcnt(0)
  v_cmp_ne_u32 vcc, 1, v234
  s_nop 4
  s_cbranch_vccz MK_cwln_ok
  s_sub_u32 s96, s96, 1
  s_cmp_eq_u32 s96, 0
  s_cbranch_scc1 MK_end
  s_sleep 0
  s_branch MK_cwln
MK_cwln_ok:
  ds_read_b32 v244, v232 offset:59904
  ds_read_b32 v245, v232 offset:59904
  ds_read_b32 v246, v232 offset:59908
  ds_read_b32 v247, v232 offset:59908
  s_waitcnt lgkmcnt(0)
  v_pk_fma_f32 v[128:129], v[128:129], v[246:247], v[244:245]
  v_pk_fma_f32 v[130:131], v[130:131], v[246:247], v[244:245]
  v_pk_fma_f32 v[132:133], v[132:133], v[246:247], v[244:245]
  v_pk_fma_f32 v[134:135], v[134:135], v[246:247], v[244:245]
  v_pk_fma_f32 v[136:137], v[136:137], v[246:247], v[244:245]
  v_pk_fma_f32 v[138:139], v[138:139], v[246:247], v[244:245]
  v_pk_fma_f32 v[140:141], v[140:141], v[246:247], v[244:245]
  v_pk_fma_f32 v[142:143], v[142:143], v[246:247], v[244:245]
  v_cvt_pk_bf16_f32 v216, v128, v129
  v_cvt_pk_bf16_f32 v217, v130, v131
  v_cvt_pk_bf16_f32 v218, v132, v133
  v_cvt_pk_bf16_f32 v219, v134, v135
  v_cvt_pk_bf16_f32 v220, v136, v137
  v_cvt_pk_bf16_f32 v221, v138, v139
  v_cvt_pk_bf16_f32 v222, v140, v141
  v_cvt_pk_bf16_f32 v223, v142, v143
  v_permlane32_swap_b32 v216, v218
  v_permlane32_swap_b32 v217, v219
  v_permlane32_swap_b32 v220, v222
  v_permlane32_swap_b32 v221, v223
  s_nop 0
  v_permlane16_swap_b32 v216, v220
  v_permlane16_swap_b32 v217, v221
  v_permlane16_swap_b32 v218, v222
  v_permlane16_swap_b32 v219, v223
  buffer_store_dwordx4 v[216:219], v10, s[24:27], s8 offen offset:0 sc1
  buffer_store_dwordx4 v[220:223], v14, s[24:27], s8 offen offset:0 sc1
  v_pk_fma_f32 v[144:145], v[144:145], v[246:247], v[244:245]
  v_pk_fma_f32 v[146:147], v[146:147], v[246:247], v[244:245]
  v_pk_fma_f32 v[148:149], v[148:149], v[246:247], v[244:245]
  v_pk_fma_f32 v[150:151], v[150:151], v[246:247], v[244:245]
  v_pk_fma_f32 v[152:153], v[152:153], v[246:247], v[244:245]
  v_pk_fma_f32 v[154:155], v[154:155], v[246:247], v[244:245]
  v_pk_fma_f32 v[156:157], v[156:157], v[246:247], v[244:245]
  v_pk_fma_f32 v[158:159], v[158:159], v[246:247], v[244:245]
  v_cvt_pk_bf16_f32 v224, v144, v145
  v_cvt_pk_bf16_f32 v225, v146, v147
  v_cvt_pk_bf16_f32 v226, v148, v149
  v_cvt_pk_bf16_f32 v227, v150, v151
  v_cvt_pk_bf16_f32 v228, v152, v153
  v_cvt_pk_bf16_f32 v229, v154, v155
  v_cvt_pk_bf16_f32 v230, v156, v157
  v_cvt_pk_bf16_f32 v231, v158, v159
  v_permlane32_swap_b32 v224, v226
  v_permlane32_swap_b32 v225, v227
  v_permlane32_swap_b32 v228, v230
  v_permlane32_swap_b32 v229, v231
  s_nop 0
  v_permlane16_swap_b32 v224, v228
  v_permlane16_swap_b32 v225, v229
  v_permlane16_swap_b32 v226, v230
  v_permlane16_swap_b32 v227, v231
  buffer_store_dwordx4 v[224:227], v10, s[24:27], s8 offen offset:64 sc1
  buffer_store_dwordx4 v[228:231], v14, s[24:27], s8 offen offset:64 sc1
  s_mov_b64 exec, 1
  ds_add_u32 v248, v249 offset:60952
  s_mov_b64 exec, -1
  s_add_u32 s9, s10, 114688
  s_waitcnt vmcnt(4)
  buffer_store_dword v249, v248, s[24:27], s9 offen sc1
MK_cw1:
  ds_read_b64 v[234:235], v248 offset:60944
  s_waitcnt lgkmcnt(0)
  v_and_b32 v234, v234, v235
  v_cmp_ne_u32 vcc, 1, v234
  s_nop 4
  s_cbranch_vccz MK_cw1_ok
  s_sub_u32 s96, s96, 1
  s_cmp_eq_u32 s96, 0
  s_cbranch_scc1 MK_end
  s_sleep 0
  s_branch MK_cw1
MK_cw1_ok:
  ds_read_b64_tr_b16 v[192:193], v1 offset:0
  ds_read_b64_tr_b16 v[194:195], v1 offset:512
  ds_read_b64_tr_b16 v[196:197], v2 offset:0
  ds_read_b64_tr_b16 v[198:199], v2 offset:512
  ds_read_b64_tr_b16 v[200:201], v1 offset:2048
  ds_read_b64_tr_b16 v[202:203], v1 offset:2560
  ds_read_b64_tr_b16 v[204:205], v2 offset:2048
  ds_read_b64_tr_b16 v[206:207], v2 offset:2560
  ds_read_b64_tr_b16 v[208:209], v1 offset:4096
  ds_read_b64_tr_b16 v[210:211], v1 offset:4608
  ds_read_b64_tr_b16 v[212:213], v2 offset:4096
  ds_read_b64_tr_b16 v[214:215], v2 offset:4608
  s_waitcnt lgkmcnt(10)
  v_mfma_f32_32x32x16_bf16 v[160:175], v[192:195], v[16:19], 0
  s_waitcnt lgkmcnt(8)
  v_mfma_f32_32x32x16_bf16 v[176:191], v[196:199], v[16:19], 0
  ds_read_b64_tr_b16 v[192:193], v1 offset:6144
  ds_read_b64_tr_b16 v[194:195], v1 offset:6656
  ds_read_b64_tr_b16 v[196:197], v2 offset:6144
  ds_read_b64_tr_b16 v[198:199], v2 offset:6656
  s_waitcnt lgkmcnt(10)
  v_mfma_f32_32x32x16_bf16 v[160:175], v[200:203], v[20:23], v[160:175]
  s_waitcnt lgkmcnt(8)
  v_mfma_f32_32x32x16_bf16 v[176:191], v[204:207], v[20:23], v[176:191]
  s_waitcnt lgkmcnt(6)
  v_mfma_f32_32x32x16_bf16 v[160:175], v[208:211], v[24:27], v[160:175]
  s_waitcnt lgkmcnt(4)
  v_mfma_f32_32x32x16_bf16 v[176:191], v[212:215], v[24:27], v[176:191]
  s_waitcnt lgkmcnt(2)
  v_mfma_f32_32x32x16_bf16 v[160:175], v[192:195], v[28:31], v[160:175]
  s_waitcnt lgkmcnt(0)
  v_mfma_f32_32x32x16_bf16 v[176:191], v[196:199], v[28:31], v[176:191]
  ds_read_b64_tr_b16 v[192:193], v1 offset:8192
  ds_read_b64_tr_b16 v[194:195], v1 offset:8704
  ds_read_b64_tr_b16 v[196:197], v2 offset:8192
  ds_read_b64_tr_b16 v[198:199], v2 offset:8704
  ds_read_b64_tr_b16 v[200:201], v1 offset:10240
  ds_read_b64_tr_b16 v[202:203], v1 offset:10752
  ds_read_b64_tr_b16 v[204:205], v2 offset:10240
  ds_read_b64_tr_b16 v[206:207], v2 offset:10752
  ds_read_b64_tr_b16 v[208:209], v1 offset:12288
  ds_read_b64_tr_b16 v[210:211], v1 offset:12800
  ds_read_b64_tr_b16 v[212:213], v2 offset:12288
  ds_read_b64_tr_b16 v[214:215], v2 offset:12800
  s_waitcnt lgkmcnt(10)
  v_mfma_f32_32x32x16_bf16 v[160:175], v[192:195], v[32:35], v[160:175]
  s_waitcnt lgkmcnt(8)
  v_mfma_f32_32x32x16_bf16 v[176:191], v[196:199], v[32:35], v[176:191]
  ds_read_b64_tr_b16 v[192:193], v1 offset:14336
  ds_read_b64_tr_b16 v[194:195], v1 offset:14848
  ds_read_b64_tr_b16 v[196:197], v2 offset:14336
  ds_read_b64_tr_b16 v[198:199], v2 offset:14848
  s_waitcnt lgkmcnt(10)
  v_mfma_f32_32x32x16_bf16 v[160:175], v[200:203], v[36:39], v[160:175]
  s_waitcnt lgkmcnt(8)
  v_mfma_f32_32x32x16_bf16 v[176:191], v[204:207], v[36:39], v[176:191]
  s_waitcnt lgkmcnt(6)
  v_mfma_f32_32x32x16_bf16 v[160:175], v[208:211], v[40:43], v[160:175]
  s_waitcnt lgkmcnt(4)
  v_mfma_f32_32x32x16_bf16 v[176:191], v[212:215], v[40:43], v[176:191]
  s_waitcnt lgkmcnt(2)
  v_mfma_f32_32x32x16_bf16 v[160:175], v[192:195], v[44:47], v[160:175]
  s_waitcnt lgkmcnt(0)
  v_mfma_f32_32x32x16_bf16 v[176:191], v[196:199], v[44:47], v[176:191]
  ds_read_b64_tr_b16 v[192:193], v1 offset:16384
  ds_read_b64_tr_b16 v[194:195], v1 offset:16896
  ds_read_b64_tr_b16 v[196:197], v2 offset:16384
  ds_read_b64_tr_b16 v[198:199], v2 offset:16896
  ds_read_b64_tr_b16 v[200:201], v1 offset:18432
  ds_read_b64_tr_b16 v[202:203], v1 offset:18944
  ds_read_b64_tr_b16 v[204:205], v2 offset:18432
  ds_read_b64_tr_b16 v[206:207], v2 offset:18944
  ds_read_b64_tr_b16 v[208:209], v1 offset:20480
  ds_read_b64_tr_b16 v[210:211], v1 offset:20992
  ds_read_b64_tr_b16 v[212:213], v2 offset:20480
  ds_read_b64_tr_b16 v[214:215], v2 offset:20992
  s_waitcnt lgkmcnt(10)
  v_mfma_f32_32x32x16_bf16 v[160:175], v[192:195], v[48:51], v[160:175]
  s_waitcnt lgkmcnt(8)
  v_mfma_f32_32x32x16_bf16 v[176:191], v[196:199], v[48:51], v[176:191]
  ds_read_b64_tr_b16 v[192:193], v1 offset:22528
  ds_read_b64_tr_b16 v[194:195], v1 offset:23040
  ds_read_b64_tr_b16 v[196:197], v2 offset:22528
  ds_read_b64_tr_b16 v[198:199], v2 offset:23040
  s_waitcnt lgkmcnt(10)
  v_mfma_f32_32x32x16_bf16 v[160:175], v[200:203], v[52:55], v[160:175]
  s_waitcnt lgkmcnt(8)
  v_mfma_f32_32x32x16_bf16 v[176:191], v[204:207], v[52:55], v[176:191]
  s_waitcnt lgkmcnt(6)
  v_mfma_f32_32x32x16_bf16 v[160:175], v[208:211], v[56:59], v[160:175]
  s_waitcnt lgkmcnt(4)
  v_mfma_f32_32x32x16_bf16 v[176:191], v[212:215], v[56:59], v[176:191]
  s_waitcnt lgkmcnt(2)
  v_mfma_f32_32x32x16_bf16 v[160:175], v[192:195], v[60:63], v[160:175]
  s_waitcnt lgkmcnt(0)
  v_mfma_f32_32x32x16_bf16 v[176:191], v[196:199], v[60:63], v[176:191]
  ds_read_b64_tr_b16 v[192:193], v1 offset:24576
  ds_read_b64_tr_b16 v[194:195], v1 offset:25088
  ds_read_b64_tr_b16 v[196:197], v2 offset:24576
  ds_read_b64_tr_b16 v[198:199], v2 offset:25088
  ds_read_b64_tr_b16 v[200:201], v1 offset:26624
  ds_read_b64_tr_b16 v[202:203], v1 offset:27136
  ds_read_b64_tr_b16 v[204:205], v2 offset:26624
  ds_read_b64_tr_b16 v[206:207], v2 offset:27136
  ds_read_b64_tr_b16 v[208:209], v1 offset:28672
  ds_read_b64_tr_b16 v[210:211], v1 offset:29184
  ds_read_b64_tr_b16 v[212:213], v2 offset:28672
  ds_read_b64_tr_b16 v[214:215], v2 offset:29184
  s_waitcnt lgkmcnt(10)
  v_mfma_f32_32x32x16_bf16 v[160:175], v[192:195], v[64:67], v[160:175]
  s_waitcnt lgkmcnt(8)
  v_mfma_f32_32x32x16_bf16 v[176:191], v[196:199], v[64:67], v[176:191]
  ds_read_b64_tr_b16 v[192:193], v1 offset:30720
  ds_read_b64_tr_b16 v[194:195], v1 offset:31232
  ds_read_b64_tr_b16 v[196:197], v2 offset:30720
  ds_read_b64_tr_b16 v[198:199], v2 offset:31232
  s_waitcnt lgkmcnt(10)
  v_mfma_f32_32x32x16_bf16 v[160:175], v[200:203], v[68:71], v[160:175]
  s_waitcnt lgkmcnt(8)
  v_mfma_f32_32x32x16_bf16 v[176:191], v[204:207], v[68:71], v[176:191]
  s_waitcnt lgkmcnt(6)
  v_mfma_f32_32x32x16_bf16 v[160:175], v[208:211], v[72:75], v[160:175]
  s_waitcnt lgkmcnt(4)
  v_mfma_f32_32x32x16_bf16 v[176:191], v[212:215], v[72:75], v[176:191]
  s_waitcnt lgkmcnt(2)
  v_mfma_f32_32x32x16_bf16 v[160:175], v[192:195], v[76:79], v[160:175]
  s_waitcnt lgkmcnt(0)
  v_mfma_f32_32x32x16_bf16 v[176:191], v[196:199], v[76:79], v[176:191]
  s_waitcnt vmcnt(1)
  buffer_store_dword v249, v248, s[24:27], s10 offen sc1
  ds_read_b64_tr_b16 v[192:193], v1 offset:32768
  ds_read_b64_tr_b16 v[194:195], v1 offset:33280
  ds_read_b64_tr_b16 v[196:197], v2 offset:32768
  ds_read_b64_tr_b16 v[198:199], v2 offset:33280
  ds_read_b64_tr_b16 v[200:201], v1 offset:34816
  ds_read_b64_tr_b16 v[202:203], v1 offset:35328
  ds_read_b64_tr_b16 v[204:205], v2 offset:34816
  ds_read_b64_tr_b16 v[206:207], v2 offset:35328
  ds_read_b64_tr_b16 v[208:209], v1 offset:36864
  ds_read_b64_tr_b16 v[210:211], v1 offset:37376
  ds_read_b64_tr_b16 v[212:213], v2 offset:36864
  ds_read_b64_tr_b16 v[214:215], v2 offset:37376
  s_waitcnt lgkmcnt(10)
  v_mfma_f32_32x32x16_bf16 v[160:175], v[192:195], v[80:83], v[160:175]
  s_waitcnt lgkmcnt(8)
  v_mfma_f32_32x32x16_bf16 v[176:191], v[196:199], v[80:83], v[176:191]
  ds_read_b64_tr_b16 v[192:193], v1 offset:38912
  ds_read_b64_tr_b16 v[194:195], v1 offset:39424
  ds_read_b64_tr_b16 v[196:197], v2 offset:38912
  ds_read_b64_tr_b16 v[198:199], v2 offset:39424
  s_waitcnt lgkmcnt(10)
  v_mfma_f32_32x32x16_bf16 v[160:175], v[200:203], v[84:87], v[160:175]
  s_waitcnt lgkmcnt(8)
  v_mfma_f32_32x32x16_bf16 v[176:191], v[204:207], v[84:87], v[176:191]
  s_waitcnt lgkmcnt(6)
  v_mfma_f32_32x32x16_bf16 v[160:175], v[208:211], v[88:91], v[160:175]
  s_waitcnt lgkmcnt(4)
  v_mfma_f32_32x32x16_bf16 v[176:191], v[212:215], v[88:91], v[176:191]
  s_waitcnt lgkmcnt(2)
  v_mfma_f32_32x32x16_bf16 v[160:175], v[192:195], v[92:95], v[160:175]
  s_waitcnt lgkmcnt(0)
  v_mfma_f32_32x32x16_bf16 v[176:191], v[196:199], v[92:95], v[176:191]
  ds_read_b64_tr_b16 v[192:193], v1 offset:40960
  ds_read_b64_tr_b16 v[194:195], v1 offset:41472
  ds_read_b64_tr_b16 v[196:197], v2 offset:40960
  ds_read_b64_tr_b16 v[198:199], v2 offset:41472
  ds_read_b64_tr_b16 v[200:201], v1 offset:43008
  ds_read_b64_tr_b16 v[202:203], v1 offset:43520
  ds_read_b64_tr_b16 v[204:205], v2 offset:43008
  ds_read_b64_tr_b16 v[206:207], v2 offset:43520
  ds_read_b64_tr_b16 v[208:209], v1 offset:45056
  ds_read_b64_tr_b16 v[210:211], v1 offset:45568
  ds_read_b64_tr_b16 v[212:213], v2 offset:45056
  ds_read_b64_tr_b16 v[214:215], v2 offset:45568
  s_waitcnt lgkmcnt(10)
  v_mfma_f32_32x32x16_bf16 v[160:175], v[192:195], v[96:99], v[160:175]
  s_waitcnt lgkmcnt(8)
  v_mfma_f32_32x32x16_bf16 v[176:191], v[196:199], v[96:99], v[176:191]
  ds_read_b64_tr_b16 v[192:193], v1 offset:47104
  ds_read_b64_tr_b16 v[194:195], v1 offset:47616
  ds_read_b64_tr_b16 v[196:197], v2 offset:47104
  ds_read_b64_tr_b16 v[198:199], v2 offset:47616
  s_waitcnt lgkmcnt(10)
  v_mfma_f32_32x32x16_bf16 v[160:175], v[200:203], v[100:103], v[160:175]
  s_waitcnt lgkmcnt(8)
  v_mfma_f32_32x32x16_bf16 v[176:191], v[204:207], v[100:103], v[176:191]
  s_waitcnt lgkmcnt(6)
  v_mfma_f32_32x32x16_bf16 v[160:175], v[208:211], v[104:107], v[160:175]
  s_waitcnt lgkmcnt(4)
  v_mfma_f32_32x32x16_bf16 v[176:191], v[212:215], v[104:107], v[176:191]
  s_waitcnt lgkmcnt(2)
  v_mfma_f32_32x32x16_bf16 v[160:175], v[192:195], v[108:111], v[160:175]
  s_waitcnt lgkmcnt(0)
  v_mfma_f32_32x32x16_bf16 v[176:191], v[196:199], v[108:111], v[176:191]
  ds_read_b64_tr_b16 v[192:193], v1 offset:49152
  ds_read_b64_tr_b16 v[194:195], v1 offset:49664
  ds_read_b64_tr_b16 v[196:197], v2 offset:49152
  ds_read_b64_tr_b16 v[198:199], v2 offset:49664
  ds_read_b64_tr_b16 v[200:201], v1 offset:51200
  ds_read_b64_tr_b16 v[202:203], v1 offset:51712
  ds_read_b64_tr_b16 v[204:205], v2 offset:51200
  ds_read_b64_tr_b16 v[206:207], v2 offset:51712
  ds_read_b64_tr_b16 v[208:209], v1 offset:53248
  ds_read_b64_tr_b16 v[210:211], v1 offset:53760
  ds_read_b64_tr_b16 v[212:213], v2 offset:53248
  ds_read_b64_tr_b16 v[214:215], v2 offset:53760
  s_waitcnt lgkmcnt(10)
  v_mfma_f32_32x32x16_bf16 v[160:175], v[192:195], v[112:115], v[160:175]
  s_waitcnt lgkmcnt(8)
  v_mfma_f32_32x32x16_bf16 v[176:191], v[196:199], v[112:115], v[176:191]
  ds_read_b64_tr_b16 v[192:193], v1 offset:55296
  ds_read_b64_tr_b16 v[194:195], v1 offset:55808
  ds_read_b64_tr_b16 v[196:197], v2 offset:55296
  ds_read_b64_tr_b16 v[198:199], v2 offset:55808
  s_waitcnt lgkmcnt(10)
  v_mfma_f32_32x32x16_bf16 v[160:175], v[200:203], v[116:119], v[160:175]
  s_waitcnt lgkmcnt(8)
  v_mfma_f32_32x32x16_bf16 v[176:191], v[204:207], v[116:119], v[176:191]
  s_waitcnt lgkmcnt(6)
  v_mfma_f32_32x32x16_bf16 v[160:175], v[208:211], v[120:123], v[160:175]
  s_waitcnt lgkmcnt(4)
  v_mfma_f32_32x32x16_bf16 v[176:191], v[212:215], v[120:123], v[176:191]
  s_waitcnt lgkmcnt(2)
  v_mfma_f32_32x32x16_bf16 v[160:175], v[192:195], v[124:127], v[160:175]
  s_waitcnt lgkmcnt(0)
  v_mfma_f32_32x32x16_bf16 v[176:191], v[196:199], v[124:127], v[176:191]
  v_and_b32 v232, 15, v0
  v_add_u32 v232, s55, v232
  v_lshlrev_b32 v232, 12, v232
  v_add_u32 v250, v15, v232
  v_add_u32 v251, 65536, v250
  v_mov_b32 v192, v252
  v_mov_b32 v193, v252
  v_mov_b32 v194, v253
  v_mov_b32 v195, v253
  v_mov_b32 v196, 0xc0135761
  v_mov_b32 v197, 0xc0135761
  v_mov_b32 v198, 0xbdd2d3e8
  v_mov_b32 v199, 0xbdd2d3e8
  v_mov_b32 v200, 0x3f800000
  v_mov_b32 v201, 0x3f800000
MK_ccs1:
  ds_read_b64 v[234:235], v248 offset:60960
  s_waitcnt lgkmcnt(0)
  v_and_b32 v234, v234, v235
  v_cmp_ne_u32 vcc, 1, v234
  s_nop 4
  s_cbranch_vccz MK_ccs1_ok
  s_sub_u32 s96, s96, 1
  s_cmp_eq_u32 s96, 0
  s_cbranch_scc1 MK_end
  s_sleep 0
  s_branch MK_ccs1
MK_ccs1_ok:
  ds_read_b128 v[232:235], v11 offset:57600
  ds_read_b128 v[236:239], v11 offset:57632
  s_waitcnt lgkmcnt(1)
  v_pk_mul_f32 v[240:241], v[192:193], v[232:233]
  v_pk_mul_f32 v[242:243], v[192:193], v[234:235]
  ds_read_b128 v[232:235], v11 offset:57664
  v_pk_fma_f32 v[240:241], v[160:161], v[194:195], v[240:241]
  v_pk_fma_f32 v[242:243], v[162:163], v[194:195], v[242:243]
  v_pk_mul_f32 v[244:245], v[240:241], v[240:241]
  v_pk_mul_f32 v[246:247], v[242:243], v[242:243]
  v_pk_fma_f32 v[244:245], v[244:245], v[198:199], v[196:197]
  v_pk_fma_f32 v[246:247], v[246:247], v[198:199], v[196:197]
  v_pk_mul_f32 v[244:245], v[244:245], v[240:241]
  v_pk_mul_f32 v[246:247], v[246:247], v[242:243]
  v_exp_f32 v248, v244
  v_exp_f32 v249, v245
  v_exp_f32 v250, v246
  v_exp_f32 v251, v247
  v_pk_add_f32 v[248:249], v[248:249], v[200:201]
  v_pk_add_f32 v[250:251], v[250:251], v[200:201]
  v_rcp_f32 v248, v248
  v_rcp_f32 v249, v249
  v_rcp_f32 v250, v250
  v_rcp_f32 v251, v251
  v_pk_mul_f32 v[240:241], v[240:241], v[248:249]
  v_pk_mul_f32 v[242:243], v[242:243], v[250:251]
  v_cvt_pk_bf16_f32 v216, v240, v241
  v_cvt_pk_bf16_f32 v217, v242, v243
  s_waitcnt lgkmcnt(1)
  v_pk_mul_f32 v[240:241], v[192:193], v[236:237]
  v_pk_mul_f32 v[242:243], v[192:193], v[238:239]
  ds_read_b128 v[236:239], v11 offset:57696
  v_pk_fma_f32 v[240:241], v[164:165], v[194:195], v[240:241]
  v_pk_fma_f32 v[242:243], v[166:167], v[194:195], v[242:243]
  v_pk_mul_f32 v[244:245], v[240:241], v[240:241]
  v_pk_mul_f32 v[246:247], v[242:243], v[242:243]
  v_pk_fma_f32 v[244:245], v[244:245], v[198:199], v[196:197]
  v_pk_fma_f32 v[246:247], v[246:247], v[198:199], v[196:197]
  v_pk_mul_f32 v[244:245], v[244:245], v[240:241]
  v_pk_mul_f32 v[246:247], v[246:247], v[242:243]
  v_exp_f32 v248, v244
  v_exp_f32 v249, v245
  v_exp_f32 v250, v246
  v_exp_f32 v251, v247
  v_pk_add_f32 v[248:249], v[248:249], v[200:201]
  v_pk_add_f32 v[250:251], v[250:251], v[200:201]
  v_rcp_f32 v248, v248
  v_rcp_f32 v249, v249
  v_rcp_f32 v250, v250
  v_rcp_f32 v251, v251
  v_pk_mul_f32 v[240:241], v[240:241], v[248:249]
  v_pk_mul_f32 v[242:243], v[242:243], v[250:251]
  v_cvt_pk_bf16_f32 v218, v240, v241
  v_cvt_pk_bf16_f32 v219, v242, v243
  s_waitcnt lgkmcnt(1)
  v_pk_mul_f32 v[240:241], v[192:193], v[232:233]
  v_pk_mul_f32 v[242:243], v[192:193], v[234:235]
  ds_read_b128 v[232:235], v11 offset:57728
  v_pk_fma_f32 v[240:241], v[168:169], v[194:195], v[240:241]
  v_pk_fma_f32 v[242:243], v[170:171], v[194:195], v[242:243]
  v_pk_mul_f32 v[244:245], v[240:241], v[240:241]
  v_pk_mul_f32 v[246:247], v[242:243], v[242:243]
  v_pk_fma_f32 v[244:245], v[244:245], v[198:199], v[196:197]
  v_pk_fma_f32 v[246:247], v[246:247], v[198:199], v[196:197]
  v_pk_mul_f32 v[244:245], v[244:245], v[240:241]
  v_pk_mul_f32 v[246:247], v[246:247], v[242:243]
  v_exp_f32 v248, v244
  v_exp_f32 v249, v245
  v_exp_f32 v250, v246
  v_exp_f32 v251, v247
  v_pk_add_f32 v[248:249], v[248:249], v[200:201]
  v_pk_add_f32 v[250:251], v[250:251], v[200:201]
  v_rcp_f32 v248, v248
  v_rcp_f32 v249, v249
  v_rcp_f32 v250, v250
  v_rcp_f32 v251, v251
  v_pk_mul_f32 v[240:241], v[240:241], v[248:249]
  v_pk_mul_f32 v[242:243], v[242:243], v[250:251]
  v_cvt_pk_bf16_f32 v220, v240, v241
  v_cvt_pk_bf16_f32 v221, v242, v243
  s_waitcnt lgkmcnt(1)
  v_pk_mul_f32 v[240:241], v[192:193], v[236:237]
  v_pk_mul_f32 v[242:243], v[192:193], v[238:239]
  ds_read_b128 v[236:239], v11 offset:57760
  v_pk_fma_f32 v[240:241], v[172:173], v[194:195], v[240:241]
  v_pk_fma_f32 v[242:243], v[174:175], v[194:195], v[242:243]
  v_pk_mul_f32 v[244:245], v[240:241], v[240:241]
  v_pk_mul_f32 v[246:247], v[242:243], v[242:243]
  v_pk_fma_f32 v[244:245], v[244:245], v[198:199], v[196:197]
  v_pk_fma_f32 v[246:247], v[246:247], v[198:199], v[196:197]
  v_pk_mul_f32 v[244:245], v[244:245], v[240:241]
  v_pk_mul_f32 v[246:247], v[246:247], v[242:243]
  v_exp_f32 v248, v244
  v_exp_f32 v249, v245
  v_exp_f32 v250, v246
  v_exp_f32 v251, v247
  v_pk_add_f32 v[248:249], v[248:249], v[200:201]
  v_pk_add_f32 v[250:251], v[250:251], v[200:201]
  v_rcp_f32 v248, v248
  v_rcp_f32 v249, v249
  v_rcp_f32 v250, v250
  v_rcp_f32 v251, v251
  v_pk_mul_f32 v[240:241], v[240:241], v[248:249]
  v_pk_mul_f32 v[242:243], v[242:243], v[250:251]
  v_cvt_pk_bf16_f32 v222, v240, v241
  v_cvt_pk_bf16_f32 v223, v242, v243
  s_waitcnt lgkmcnt(1)
  v_pk_mul_f32 v[240:241], v[192:193], v[232:233]
  v_pk_mul_f32 v[242:243], v[192:193], v[234:235]
  ds_read_b128 v[232:235], v11 offset:57792
  v_pk_fma_f32 v[240:241], v[176:177], v[194:195], v[240:241]
  v_pk_fma_f32 v[242:243], v[178:179], v[194:195], v[242:243]
  v_pk_mul_f32 v[244:245], v[240:241], v[240:241]
  v_pk_mul_f32 v[246:247], v[242:243], v[242:243]
  v_pk_fma_f32 v[244:245], v[244:245], v[198:199], v[196:197]
  v_pk_fma_f32 v[246:247], v[246:247], v[198:199], v[196:197]
  v_pk_mul_f32 v[244:245], v[244:245], v[240:241]
  v_pk_mul_f32 v[246:247], v[246:247], v[242:243]
  v_exp_f32 v248, v244
  v_exp_f32 v249, v245
  v_exp_f32 v250, v246
  v_exp_f32 v251, v247
  v_pk_add_f32 v[248:249], v[248:249], v[200:201]
  v_pk_add_f32 v[250:251], v[250:251], v[200:201]
  v_rcp_f32 v248, v248
  v_rcp_f32 v249, v249
  v_rcp_f32 v250, v250
  v_rcp_f32 v251, v251
  v_pk_mul_f32 v[240:241], v[240:241], v[248:249]
  v_pk_mul_f32 v[242:243], v[242:243], v[250:251]
  v_cvt_pk_bf16_f32 v224, v240, v241
  v_cvt_pk_bf16_f32 v225, v242, v243
  s_waitcnt lgkmcnt(1)
  v_pk_mul_f32 v[240:241], v[192:193], v[236:237]
  v_pk_mul_f32 v[242:243], v[192:193], v[238:239]
  ds_read_b128 v[236:239], v11 offset:57824
  v_pk_fma_f32 v[240:241], v[180:181], v[194:195], v[240:241]
  v_pk_fma_f32 v[242:243], v[182:183], v[194:195], v[242:243]
  v_pk_mul_f32 v[244:245], v[240:241], v[240:241]
  v_pk_mul_f32 v[246:247], v[242:243], v[242:243]
  v_pk_fma_f32 v[244:245], v[244:245], v[198:199], v[196:197]
  v_pk_fma_f32 v[246:247], v[246:247], v[198:199], v[196:197]
  v_pk_mul_f32 v[244:245], v[244:245], v[240:241]
  v_pk_mul_f32 v[246:247], v[246:247], v[242:243]
  v_exp_f32 v248, v244
  v_exp_f32 v249, v245
  v_exp_f32 v250, v246
  v_exp_f32 v251, v247
  v_pk_add_f32 v[248:249], v[248:249], v[200:201]
  v_pk_add_f32 v[250:251], v[250:251], v[200:201]
  v_rcp_f32 v248, v248
  v_rcp_f32 v249, v249
  v_rcp_f32 v250, v250
  v_rcp_f32 v251, v251
  v_pk_mul_f32 v[240:241], v[240:241], v[248:249]
  v_pk_mul_f32 v[242:243], v[242:243], v[250:251]
  v_cvt_pk_bf16_f32 v226, v240, v241
  v_cvt_pk_bf16_f32 v227, v242, v243
  s_waitcnt lgkmcnt(1)
  v_pk_mul_f32 v[240:241], v[192:193], v[232:233]
  v_pk_mul_f32 v[242:243], v[192:193], v[234:235]
  v_pk_fma_f32 v[240:241], v[184:185], v[194:195], v[240:241]
  v_pk_fma_f32 v[242:243], v[186:187], v[194:195], v[242:243]
  v_pk_mul_f32 v[244:245], v[240:241], v[240:241]
  v_pk_mul_f32 v[246:247], v[242:243], v[242:243]
  v_pk_fma_f32 v[244:245], v[244:245], v[198:199], v[196:197]
  v_pk_fma_f32 v[246:247], v[246:247], v[198:199], v[196:197]
  v_pk_mul_f32 v[244:245], v[244:245], v[240:241]
  v_pk_mul_f32 v[246:247], v[246:247], v[242:243]
  v_exp_f32 v248, v244
  v_exp_f32 v249, v245
  v_exp_f32 v250, v246
  v_exp_f32 v251, v247
  v_pk_add_f32 v[248:249], v[248:249], v[200:201]
  v_pk_add_f32 v[250:251], v[250:251], v[200:201]
  v_rcp_f32 v248, v248
  v_rcp_f32 v249, v249
  v_rcp_f32 v250, v250
  v_rcp_f32 v251, v251
  v_pk_mul_f32 v[240:241], v[240:241], v[248:249]
  v_pk_mul_f32 v[242:243], v[242:243], v[250:251]
  v_cvt_pk_bf16_f32 v228, v240, v241
  v_cvt_pk_bf16_f32 v229, v242, v243
  s_waitcnt lgkmcnt(0)
  v_pk_mul_f32 v[240:241], v[192:193], v[236:237]
  v_pk_mul_f32 v[242:243], v[192:193], v[238:239]
  v_pk_fma_f32 v[240:241], v[188:189], v[194:195], v[240:241]
  v_pk_fma_f32 v[242:243], v[190:191], v[194:195], v[242:243]
  v_pk_mul_f32 v[244:245], v[240:241], v[240:241]
  v_pk_mul_f32 v[246:247], v[242:243], v[242:243]
  v_pk_fma_f32 v[244:245], v[244:245], v[198:199], v[196:197]
  v_pk_fma_f32 v[246:247], v[246:247], v[198:199], v[196:197]
  v_pk_mul_f32 v[244:245], v[244:245], v[240:241]
  v_pk_mul_f32 v[246:247], v[246:247], v[242:243]
  v_exp_f32 v248, v244
  v_exp_f32 v249, v245
  v_exp_f32 v250, v246
  v_exp_f32 v251, v247
  v_pk_add_f32 v[248:249], v[248:249], v[200:201]
  v_pk_add_f32 v[250:251], v[250:251], v[200:201]
  v_rcp_f32 v248, v248
  v_rcp_f32 v249, v249
  v_rcp_f32 v250, v250
  v_rcp_f32 v251, v251
  v_pk_mul_f32 v[240:241], v[240:241], v[248:249]
  v_pk_mul_f32 v[242:243], v[242:243], v[250:251]
  v_cvt_pk_bf16_f32 v230, v240, v241
  v_cvt_pk_bf16_f32 v231, v242, v243
  v_add_u32 v7, 65536, v1
  v_add_u32 v8, 65536, v2
  v_subrev_u32 v9, 65536, v3
  v_subrev_u32 v12, 65536, v4
  v_subrev_u32 v244, 65536, v5
  v_subrev_u32 v245, 65536, v6
  s_waitcnt vmcnt(0)
  v_lshlrev_b32 v16, 16, v216
  v_and_b32 v17, 0xffff0000, v216
  v_lshlrev_b32 v18, 16, v217
  v_and_b32 v19, 0xffff0000, v217
  v_lshlrev_b32 v20, 16, v218
  v_and_b32 v21, 0xffff0000, v218
  v_lshlrev_b32 v22, 16, v219
  v_and_b32 v23, 0xffff0000, v219
  v_lshlrev_b32 v24, 16, v220
  v_and_b32 v25, 0xffff0000, v220
  v_lshlrev_b32 v26, 16, v221
  v_and_b32 v27, 0xffff0000, v221
  v_lshlrev_b32 v28, 16, v222
  v_and_b32 v29, 0xffff0000, v222
  v_lshlrev_b32 v30, 16, v223
  v_and_b32 v31, 0xffff0000, v223
  v_lshlrev_b32 v32, 16, v224
  v_and_b32 v33, 0xffff0000, v224
  v_lshlrev_b32 v34, 16, v225
  v_and_b32 v35, 0xffff0000, v225
  v_lshlrev_b32 v36, 16, v226
  v_and_b32 v37, 0xffff0000, v226
  v_lshlrev_b32 v38, 16, v227
  v_and_b32 v39, 0xffff0000, v227
  v_lshlrev_b32 v40, 16, v228
  v_and_b32 v41, 0xffff0000, v228
  v_lshlrev_b32 v42, 16, v229
  v_and_b32 v43, 0xffff0000, v229
  v_lshlrev_b32 v44, 16, v230
  v_and_b32 v45, 0xffff0000, v230
  v_lshlrev_b32 v46, 16, v231
  v_and_b32 v47, 0xffff0000, v231
  v_lshlrev_b32 v13, 16, v13
  v_mov_b32 v160, v13
  v_mov_b32 v161, v13
  v_mov_b32 v162, v13
  v_mov_b32 v163, v13
  v_mov_b32 v164, v13
  v_mov_b32 v165, v13
  v_mov_b32 v166, v13
  v_mov_b32 v167, v13
  v_mov_b32 v168, v13
  v_mov_b32 v169, v13
  v_mov_b32 v170, v13
  v_mov_b32 v171, v13
  v_mov_b32 v172, v13
  v_mov_b32 v173, v13
  v_mov_b32 v174, v13
  v_mov_b32 v175, v13
  v_mov_b32 v176, v13
  v_mov_b32 v177, v13
  v_mov_b32 v178, v13
  v_mov_b32 v179, v13
  v_mov_b32 v180, v13
  v_mov_b32 v181, v13
  v_mov_b32 v182, v13
  v_mov_b32 v183, v13
  v_mov_b32 v184, v13
  v_mov_b32 v185, v13
  v_mov_b32 v186, v13
  v_mov_b32 v187, v13
  v_mov_b32 v188, v13
  v_mov_b32 v189, v13
  v_mov_b32 v190, v13
  v_mov_b32 v191, v13
  s_mov_b32 s10, 12582912
  s_barrier
  s_barrier
  ds_read_b128 v[200:203], v3 offset:0
  ds_read_b64_tr_b16 v[192:193], v7 offset:0
  ds_read_b64_tr_b16 v[194:195], v7 offset:512
  ds_read_b64_tr_b16 v[196:197], v8 offset:0
  ds_read_b64_tr_b16 v[198:199], v8 offset:512
  ds_read_b128 v[212:215], v4 offset:0
  ds_read_b64_tr_b16 v[204:205], v7 offset:2048
  ds_read_b64_tr_b16 v[206:207], v7 offset:2560
  ds_read_b64_tr_b16 v[208:209], v8 offset:2048
  ds_read_b64_tr_b16 v[210:211], v8 offset:2560
  ds_read_b128 v[240:243], v5 offset:0
  ds_read_b64_tr_b16 v[232:233], v7 offset:4096
  ds_read_b64_tr_b16 v[234:235], v7 offset:4608
  ds_read_b64_tr_b16 v[236:237], v8 offset:4096
  ds_read_b64_tr_b16 v[238:239], v8 offset:4608
  ds_read_b128 v[152:155], v6 offset:0
  ds_read_b64_tr_b16 v[144:145], v7 offset:6144
  ds_read_b64_tr_b16 v[146:147], v7 offset:6656
  ds_read_b64_tr_b16 v[148:149], v8 offset:6144
  ds_read_b64_tr_b16 v[150:151], v8 offset:6656
  s_barrier
  s_waitcnt lgkmcnt(15)
  v_mfma_f32_32x32x16_bf16 v[160:175], v[192:195], v[200:203], v[160:175]
  ds_read_b64_tr_b16 v[192:193], v7 offset:8192
  ds_read_b64_tr_b16 v[194:195], v7 offset:8704
  v_mfma_f32_32x32x16_bf16 v[176:191], v[196:199], v[200:203], v[176:191]
  ds_read_b128 v[200:203], v3 offset:16384
  ds_read_b64_tr_b16 v[196:197], v8 offset:8192
  ds_read_b64_tr_b16 v[198:199], v8 offset:8704
  s_waitcnt lgkmcnt(15)
  v_mfma_f32_32x32x16_bf16 v[160:175], v[204:207], v[212:215], v[160:175]
  ds_read_b64_tr_b16 v[204:205], v7 offset:10240
  ds_read_b64_tr_b16 v[206:207], v7 offset:10752
  v_mfma_f32_32x32x16_bf16 v[176:191], v[208:211], v[212:215], v[176:191]
  ds_read_b128 v[212:215], v4 offset:16384
  ds_read_b64_tr_b16 v[208:209], v8 offset:10240
  ds_read_b64_tr_b16 v[210:211], v8 offset:10752
  s_waitcnt lgkmcnt(15)
  v_mfma_f32_32x32x16_bf16 v[160:175], v[232:235], v[240:243], v[160:175]
  ds_read_b64_tr_b16 v[232:233], v7 offset:12288
  ds_read_b64_tr_b16 v[234:235], v7 offset:12800
  v_mfma_f32_32x32x16_bf16 v[176:191], v[236:239], v[240:243], v[176:191]
  ds_read_b128 v[240:243], v5 offset:16384
  ds_read_b64_tr_b16 v[236:237], v8 offset:12288
  ds_read_b64_tr_b16 v[238:239], v8 offset:12800
  s_waitcnt lgkmcnt(15)
  v_mfma_f32_32x32x16_bf16 v[160:175], v[144:147], v[152:155], v[160:175]
  ds_read_b64_tr_b16 v[144:145], v7 offset:14336
  ds_read_b64_tr_b16 v[146:147], v7 offset:14848
  v_mfma_f32_32x32x16_bf16 v[176:191], v[148:151], v[152:155], v[176:191]
  ds_read_b128 v[152:155], v6 offset:16384
  ds_read_b64_tr_b16 v[148:149], v8 offset:14336
  ds_read_b64_tr_b16 v[150:151], v8 offset:14848
  s_barrier
  s_waitcnt lgkmcnt(15)
  v_mfma_f32_32x32x16_bf16 v[160:175], v[192:195], v[200:203], v[160:175]
  ds_read_b64_tr_b16 v[192:193], v7 offset:16384
  ds_read_b64_tr_b16 v[194:195], v7 offset:16896
  v_mfma_f32_32x32x16_bf16 v[176:191], v[196:199], v[200:203], v[176:191]
  ds_read_b128 v[200:203], v3 offset:32768
  ds_read_b64_tr_b16 v[196:197], v8 offset:16384
  ds_read_b64_tr_b16 v[198:199], v8 offset:16896
  s_waitcnt lgkmcnt(15)
  v_mfma_f32_32x32x16_bf16 v[160:175], v[204:207], v[212:215], v[160:175]
  ds_read_b64_tr_b16 v[204:205], v7 offset:18432
  ds_read_b64_tr_b16 v[206:207], v7 offset:18944
  v_mfma_f32_32x32x16_bf16 v[176:191], v[208:211], v[212:215], v[176:191]
  ds_read_b128 v[212:215], v4 offset:32768
  ds_read_b64_tr_b16 v[208:209], v8 offset:18432
  ds_read_b64_tr_b16 v[210:211], v8 offset:18944
  s_waitcnt lgkmcnt(15)
  v_mfma_f32_32x32x16_bf16 v[160:175], v[232:235], v[240:243], v[160:175]
  ds_read_b64_tr_b16 v[232:233], v7 offset:20480
  ds_read_b64_tr_b16 v[234:235], v7 offset:20992
  v_mfma_f32_32x32x16_bf16 v[176:191], v[236:239], v[240:243], v[176:191]
  ds_read_b128 v[240:243], v5 offset:32768
  ds_read_b64_tr_b16 v[236:237], v8 offset:20480
  ds_read_b64_tr_b16 v[238:239], v8 offset:20992
  s_waitcnt lgkmcnt(15)
  v_mfma_f32_32x32x16_bf16 v[160:175], v[144:147], v[152:155], v[160:175]
  ds_read_b64_tr_b16 v[144:145], v7 offset:22528
  ds_read_b64_tr_b16 v[146:147], v7 offset:23040
  v_mfma_f32_32x32x16_bf16 v[176:191], v[148:151], v[152:155], v[176:191]
  ds_read_b128 v[152:155], v6 offset:32768
  ds_read_b64_tr_b16 v[148:149], v8 offset:22528
  ds_read_b64_tr_b16 v[150:151], v8 offset:23040
  s_barrier
  s_waitcnt lgkmcnt(15)
  v_mfma_f32_32x32x16_bf16 v[160:175], v[192:195], v[200:203], v[160:175]
  ds_read_b64_tr_b16 v[192:193], v7 offset:24576
  ds_read_b64_tr_b16 v[194:195], v7 offset:25088
  v_mfma_f32_32x32x16_bf16 v[176:191], v[196:199], v[200:203], v[176:191]
  ds_read_b128 v[200:203], v3 offset:49152
  ds_read_b64_tr_b16 v[196:197], v8 offset:24576
  ds_read_b64_tr_b16 v[198:199], v8 offset:25088
  s_waitcnt lgkmcnt(15)
  v_mfma_f32_32x32x16_bf16 v[160:175], v[204:207], v[212:215], v[160:175]
  ds_read_b64_tr_b16 v[204:205], v7 offset:26624
  ds_read_b64_tr_b16 v[206:207], v7 offset:27136
  v_mfma_f32_32x32x16_bf16 v[176:191], v[208:211], v[212:215], v[176:191]
  ds_read_b128 v[212:215], v4 offset:49152
  ds_read_b64_tr_b16 v[208:209], v8 offset:26624
  ds_read_b64_tr_b16 v[210:211], v8 offset:27136
  s_waitcnt lgkmcnt(15)
  v_mfma_f32_32x32x16_bf16 v[160:175], v[232:235], v[240:243], v[160:175]
  ds_read_b64_tr_b16 v[232:233], v7 offset:28672
  ds_read_b64_tr_b16 v[234:235], v7 offset:29184
  v_mfma_f32_32x32x16_bf16 v[176:191], v[236:239], v[240:243], v[176:191]
  ds_read_b128 v[240:243], v5 offset:49152
  ds_read_b64_tr_b16 v[236:237], v8 offset:28672
  ds_read_b64_tr_b16 v[238:239], v8 offset:29184
  s_waitcnt lgkmcnt(15)
  v_mfma_f32_32x32x16_bf16 v[160:175], v[144:147], v[152:155], v[160:175]
  ds_read_b64_tr_b16 v[144:145], v7 offset:30720
  ds_read_b64_tr_b16 v[146:147], v7 offset:31232
  v_mfma_f32_32x32x16_bf16 v[176:191], v[148:151], v[152:155], v[176:191]
  ds_read_b128 v[152:155], v6 offset:49152
  ds_read_b64_tr_b16 v[148:149], v8 offset:30720
  ds_read_b64_tr_b16 v[150:151], v8 offset:31232
  s_barrier
  s_waitcnt lgkmcnt(15)
  v_mfma_f32_32x32x16_bf16 v[160:175], v[192:195], v[200:203], v[160:175]
  ds_read_b64_tr_b16 v[192:193], v1 offset:0
  ds_read_b64_tr_b16 v[194:195], v1 offset:512
  v_mfma_f32_32x32x16_bf16 v[176:191], v[196:199], v[200:203], v[176:191]
  ds_read_b128 v[200:203], v9
  ds_read_b64_tr_b16 v[196:197], v2 offset:0
  ds_read_b64_tr_b16 v[198:199], v2 offset:512
  s_waitcnt lgkmcnt(15)
  v_mfma_f32_32x32x16_bf16 v[160:175], v[204:207], v[212:215], v[160:175]
  ds_read_b64_tr_b16 v[204:205], v1 offset:2048
  ds_read_b64_tr_b16 v[206:207], v1 offset:2560
  v_mfma_f32_32x32x16_bf16 v[176:191], v[208:211], v[212:215], v[176:191]
  ds_read_b128 v[212:215], v12
  ds_read_b64_tr_b16 v[208:209], v2 offset:2048
  ds_read_b64_tr_b16 v[210:211], v2 offset:2560
  s_waitcnt lgkmcnt(15)
  v_mfma_f32_32x32x16_bf16 v[160:175], v[232:235], v[240:243], v[160:175]
  ds_read_b64_tr_b16 v[232:233], v1 offset:4096
  ds_read_b64_tr_b16 v[234:235], v1 offset:4608
  v_mfma_f32_32x32x16_bf16 v[176:191], v[236:239], v[240:243], v[176:191]
  ds_read_b128 v[240:243], v244
  ds_read_b64_tr_b16 v[236:237], v2 offset:4096
  ds_read_b64_tr_b16 v[238:239], v2 offset:4608
  s_waitcnt lgkmcnt(15)
  v_mfma_f32_32x32x16_bf16 v[160:175], v[144:147], v[152:155], v[160:175]
  ds_read_b64_tr_b16 v[144:145], v1 offset:6144
  ds_read_b64_tr_b16 v[146:147], v1 offset:6656
  v_mfma_f32_32x32x16_bf16 v[176:191], v[148:151], v[152:155], v[176:191]
  ds_read_b128 v[152:155], v245
  ds_read_b64_tr_b16 v[148:149], v2 offset:6144
  ds_read_b64_tr_b16 v[150:151], v2 offset:6656
  s_barrier
  s_waitcnt lgkmcnt(15)
  v_mfma_f32_32x32x16_bf16 v[160:175], v[192:195], v[200:203], v[160:175]
  ds_read_b64_tr_b16 v[192:193], v1 offset:8192
  ds_read_b64_tr_b16 v[194:195], v1 offset:8704
  v_mfma_f32_32x32x16_bf16 v[176:191], v[196:199], v[200:203], v[176:191]
  ds_read_b128 v[200:203], v3 offset:0
  ds_read_b64_tr_b16 v[196:197], v2 offset:8192
  ds_read_b64_tr_b16 v[198:199], v2 offset:8704
  s_waitcnt lgkmcnt(15)
  v_mfma_f32_32x32x16_bf16 v[160:175], v[204:207], v[212:215], v[160:175]
  ds_read_b64_tr_b16 v[204:205], v1 offset:10240
  ds_read_b64_tr_b16 v[206:207], v1 offset:10752
  v_mfma_f32_32x32x16_bf16 v[176:191], v[208:211], v[212:215], v[176:191]
  ds_read_b128 v[212:215], v4 offset:0
  ds_read_b64_tr_b16 v[208:209], v2 offset:10240
  ds_read_b64_tr_b16 v[210:211], v2 offset:10752
  s_waitcnt lgkmcnt(15)
  v_mfma_f32_32x32x16_bf16 v[160:175], v[232:235], v[240:243], v[160:175]
  ds_read_b64_tr_b16 v[232:233], v1 offset:12288
  ds_read_b64_tr_b16 v[234:235], v1 offset:12800
  v_mfma_f32_32x32x16_bf16 v[176:191], v[236:239], v[240:243], v[176:191]
  ds_read_b128 v[240:243], v5 offset:0
  ds_read_b64_tr_b16 v[236:237], v2 offset:12288
  ds_read_b64_tr_b16 v[238:239], v2 offset:12800
  s_waitcnt lgkmcnt(15)
  v_mfma_f32_32x32x16_bf16 v[160:175], v[144:147], v[152:155], v[160:175]
  ds_read_b64_tr_b16 v[144:145], v1 offset:14336
  ds_read_b64_tr_b16 v[146:147], v1 offset:14848
  v_mfma_f32_32x32x16_bf16 v[176:191], v[148:151], v[152:155], v[176:191]
  ds_read_b128 v[152:155], v6 offset:0
  ds_read_b64_tr_b16 v[148:149], v2 offset:14336
  ds_read_b64_tr_b16 v[150:151], v2 offset:14848
  s_barrier
  s_waitcnt lgkmcnt(15)
  v_mfma_f32_32x32x16_bf16 v[160:175], v[192:195], v[200:203], v[160:175]
  ds_read_b64_tr_b16 v[192:193], v1 offset:16384
  ds_read_b64_tr_b16 v[194:195], v1 offset:16896
  v_mfma_f32_32x32x16_bf16 v[176:191], v[196:199], v[200:203], v[176:191]
  ds_read_b128 v[200:203], v3 offset:16384
  ds_read_b64_tr_b16 v[196:197], v2 offset:16384
  ds_read_b64_tr_b16 v[198:199], v2 offset:16896
  s_waitcnt lgkmcnt(15)
  v_mfma_f32_32x32x16_bf16 v[160:175], v[204:207], v[212:215], v[160:175]
  ds_read_b64_tr_b16 v[204:205], v1 offset:18432
  ds_read_b64_tr_b16 v[206:207], v1 offset:18944
  v_mfma_f32_32x32x16_bf16 v[176:191], v[208:211], v[212:215], v[176:191]
  ds_read_b128 v[212:215], v4 offset:16384
  ds_read_b64_tr_b16 v[208:209], v2 offset:18432
  ds_read_b64_tr_b16 v[210:211], v2 offset:18944
  s_waitcnt lgkmcnt(15)
  v_mfma_f32_32x32x16_bf16 v[160:175], v[232:235], v[240:243], v[160:175]
  ds_read_b64_tr_b16 v[232:233], v1 offset:20480
  ds_read_b64_tr_b16 v[234:235], v1 offset:20992
  v_mfma_f32_32x32x16_bf16 v[176:191], v[236:239], v[240:243], v[176:191]
  ds_read_b128 v[240:243], v5 offset:16384
  ds_read_b64_tr_b16 v[236:237], v2 offset:20480
  ds_read_b64_tr_b16 v[238:239], v2 offset:20992
  s_waitcnt lgkmcnt(15)
  v_mfma_f32_32x32x16_bf16 v[160:175], v[144:147], v[152:155], v[160:175]
  ds_read_b64_tr_b16 v[144:145], v1 offset:22528
  ds_read_b64_tr_b16 v[146:147], v1 offset:23040
  v_mfma_f32_32x32x16_bf16 v[176:191], v[148:151], v[152:155], v[176:191]
  ds_read_b128 v[152:155], v6 offset:16384
  ds_read_b64_tr_b16 v[148:149], v2 offset:22528
  ds_read_b64_tr_b16 v[150:151], v2 offset:23040
  s_barrier
  s_waitcnt lgkmcnt(15)
  v_mfma_f32_32x32x16_bf16 v[160:175], v[192:195], v[200:203], v[160:175]
  ds_read_b64_tr_b16 v[192:193], v1 offset:24576
  ds_read_b64_tr_b16 v[194:195], v1 offset:25088
  v_mfma_f32_32x32x16_bf16 v[176:191], v[196:199], v[200:203], v[176:191]
  ds_read_b128 v[200:203], v3 offset:32768
  ds_read_b64_tr_b16 v[196:197], v2 offset:24576
  ds_read_b64_tr_b16 v[198:199], v2 offset:25088
  s_waitcnt lgkmcnt(15)
  v_mfma_f32_32x32x16_bf16 v[160:175], v[204:207], v[212:215], v[160:175]
  ds_read_b64_tr_b16 v[204:205], v1 offset:26624
  ds_read_b64_tr_b16 v[206:207], v1 offset:27136
  v_mfma_f32_32x32x16_bf16 v[176:191], v[208:211], v[212:215], v[176:191]
  ds_read_b128 v[212:215], v4 offset:32768
  ds_read_b64_tr_b16 v[208:209], v2 offset:26624
  ds_read_b64_tr_b16 v[210:211], v2 offset:27136
  s_waitcnt lgkmcnt(15)
  v_mfma_f32_32x32x16_bf16 v[160:175], v[232:235], v[240:243], v[160:175]
  ds_read_b64_tr_b16 v[232:233], v1 offset:28672
  ds_read_b64_tr_b16 v[234:235], v1 offset:29184
  v_mfma_f32_32x32x16_bf16 v[176:191], v[236:239], v[240:243], v[176:191]
  ds_read_b128 v[240:243], v5 offset:32768
  ds_read_b64_tr_b16 v[236:237], v2 offset:28672
  ds_read_b64_tr_b16 v[238:239], v2 offset:29184
  s_waitcnt lgkmcnt(15)
  v_mfma_f32_32x32x16_bf16 v[160:175], v[144:147], v[152:155], v[160:175]
  ds_read_b64_tr_b16 v[144:145], v1 offset:30720
  ds_read_b64_tr_b16 v[146:147], v1 offset:31232
  v_mfma_f32_32x32x16_bf16 v[176:191], v[148:151], v[152:155], v[176:191]
  ds_read_b128 v[152:155], v6 offset:32768
  ds_read_b64_tr_b16 v[148:149], v2 offset:30720
  ds_read_b64_tr_b16 v[150:151], v2 offset:31232
  s_barrier
  s_waitcnt lgkmcnt(15)
  v_mfma_f32_32x32x16_bf16 v[160:175], v[192:195], v[200:203], v[160:175]
  ds_read_b64_tr_b16 v[192:193], v7 offset:0
  ds_read_b64_tr_b16 v[194:195], v7 offset:512
  v_mfma_f32_32x32x16_bf16 v[176:191], v[196:199], v[200:203], v[176:191]
  ds_read_b128 v[200:203], v3 offset:49152
  ds_read_b64_tr_b16 v[196:197], v8 offset:0
  ds_read_b64_tr_b16 v[198:199], v8 offset:512
  s_waitcnt lgkmcnt(15)
  v_mfma_f32_32x32x16_bf16 v[160:175], v[204:207], v[212:215], v[160:175]
  ds_read_b64_tr_b16 v[204:205], v7 offset:2048
  ds_read_b64_tr_b16 v[206:207], v7 offset:2560
  v_mfma_f32_32x32x16_bf16 v[176:191], v[208:211], v[212:215], v[176:191]
  ds_read_b128 v[212:215], v4 offset:49152
  ds_read_b64_tr_b16 v[208:209], v8 offset:2048
  ds_read_b64_tr_b16 v[210:211], v8 offset:2560
  s_waitcnt lgkmcnt(15)
  v_mfma_f32_32x32x16_bf16 v[160:175], v[232:235], v[240:243], v[160:175]
  ds_read_b64_tr_b16 v[232:233], v7 offset:4096
  ds_read_b64_tr_b16 v[234:235], v7 offset:4608
  v_mfma_f32_32x32x16_bf16 v[176:191], v[236:239], v[240:243], v[176:191]
  ds_read_b128 v[240:243], v5 offset:49152
  ds_read_b64_tr_b16 v[236:237], v8 offset:4096
  ds_read_b64_tr_b16 v[238:239], v8 offset:4608
  s_waitcnt lgkmcnt(15)
  v_mfma_f32_32x32x16_bf16 v[160:175], v[144:147], v[152:155], v[160:175]
  ds_read_b64_tr_b16 v[144:145], v7 offset:6144
  ds_read_b64_tr_b16 v[146:147], v7 offset:6656
  v_mfma_f32_32x32x16_bf16 v[176:191], v[148:151], v[152:155], v[176:191]
  ds_read_b128 v[152:155], v6 offset:49152
  ds_read_b64_tr_b16 v[148:149], v8 offset:6144
  ds_read_b64_tr_b16 v[150:151], v8 offset:6656
  s_barrier
  s_waitcnt lgkmcnt(15)
  v_mfma_f32_32x32x16_bf16 v[160:175], v[192:195], v[200:203], v[160:175]
  ds_read_b64_tr_b16 v[192:193], v7 offset:8192
  ds_read_b64_tr_b16 v[194:195], v7 offset:8704
  v_mfma_f32_32x32x16_bf16 v[176:191], v[196:199], v[200:203], v[176:191]
  ds_read_b128 v[200:203], v9
  ds_read_b64_tr_b16 v[196:197], v8 offset:8192
  ds_read_b64_tr_b16 v[198:199], v8 offset:8704
  s_waitcnt lgkmcnt(15)
  v_mfma_f32_32x32x16_bf16 v[160:175], v[204:207], v[212:215], v[160:175]
  ds_read_b64_tr_b16 v[204:205], v7 offset:10240
  ds_read_b64_tr_b16 v[206:207], v7 offset:10752
  v_mfma_f32_32x32x16_bf16 v[176:191], v[208:211], v[212:215], v[176:191]
  ds_read_b128 v[212:215], v12
  ds_read_b64_tr_b16 v[208:209], v8 offset:10240
  ds_read_b64_tr_b16 v[210:211], v8 offset:10752
  s_waitcnt lgkmcnt(15)
  v_mfma_f32_32x32x16_bf16 v[160:175], v[232:235], v[240:243], v[160:175]
  ds_read_b64_tr_b16 v[232:233], v7 offset:12288
  ds_read_b64_tr_b16 v[234:235], v7 offset:12800
  v_mfma_f32_32x32x16_bf16 v[176:191], v[236:239], v[240:243], v[176:191]
  ds_read_b128 v[240:243], v244
  ds_read_b64_tr_b16 v[236:237], v8 offset:12288
  ds_read_b64_tr_b16 v[238:239], v8 offset:12800
  s_waitcnt lgkmcnt(15)
  v_mfma_f32_32x32x16_bf16 v[160:175], v[144:147], v[152:155], v[160:175]
  ds_read_b64_tr_b16 v[144:145], v7 offset:14336
  ds_read_b64_tr_b16 v[146:147], v7 offset:14848
  v_mfma_f32_32x32x16_bf16 v[176:191], v[148:151], v[152:155], v[176:191]
  ds_read_b128 v[152:155], v245
  ds_read_b64_tr_b16 v[148:149], v8 offset:14336
  ds_read_b64_tr_b16 v[150:151], v8 offset:14848
  s_barrier
  s_waitcnt lgkmcnt(15)
  v_mfma_f32_32x32x16_bf16 v[160:175], v[192:195], v[200:203], v[160:175]
  ds_read_b64_tr_b16 v[192:193], v7 offset:16384
  ds_read_b64_tr_b16 v[194:195], v7 offset:16896
  v_mfma_f32_32x32x16_bf16 v[176:191], v[196:199], v[200:203], v[176:191]
  ds_read_b128 v[200:203], v3 offset:0
  ds_read_b64_tr_b16 v[196:197], v8 offset:16384
  ds_read_b64_tr_b16 v[198:199], v8 offset:16896
  s_waitcnt lgkmcnt(15)
  v_mfma_f32_32x32x16_bf16 v[160:175], v[204:207], v[212:215], v[160:175]
  ds_read_b64_tr_b16 v[204:205], v7 offset:18432
  ds_read_b64_tr_b16 v[206:207], v7 offset:18944
  v_mfma_f32_32x32x16_bf16 v[176:191], v[208:211], v[212:215], v[176:191]
  ds_read_b128 v[212:215], v4 offset:0
  ds_read_b64_tr_b16 v[208:209], v8 offset:18432
  ds_read_b64_tr_b16 v[210:211], v8 offset:18944
  s_waitcnt lgkmcnt(15)
  v_mfma_f32_32x32x16_bf16 v[160:175], v[232:235], v[240:243], v[160:175]
  ds_read_b64_tr_b16 v[232:233], v7 offset:20480
  ds_read_b64_tr_b16 v[234:235], v7 offset:20992
  v_mfma_f32_32x32x16_bf16 v[176:191], v[236:239], v[240:243], v[176:191]
  ds_read_b128 v[240:243], v5 offset:0
  ds_read_b64_tr_b16 v[236:237], v8 offset:20480
  ds_read_b64_tr_b16 v[238:239], v8 offset:20992
  s_waitcnt lgkmcnt(15)
  v_mfma_f32_32x32x16_bf16 v[160:175], v[144:147], v[152:155], v[160:175]
  ds_read_b64_tr_b16 v[144:145], v7 offset:22528
  ds_read_b64_tr_b16 v[146:147], v7 offset:23040
  v_mfma_f32_32x32x16_bf16 v[176:191], v[148:151], v[152:155], v[176:191]
  ds_read_b128 v[152:155], v6 offset:0
  ds_read_b64_tr_b16 v[148:149], v8 offset:22528
  ds_read_b64_tr_b16 v[150:151], v8 offset:23040
  s_barrier
  s_waitcnt lgkmcnt(15)
  v_mfma_f32_32x32x16_bf16 v[160:175], v[192:195], v[200:203], v[160:175]
  ds_read_b64_tr_b16 v[192:193], v7 offset:24576
  ds_read_b64_tr_b16 v[194:195], v7 offset:25088
  v_mfma_f32_32x32x16_bf16 v[176:191], v[196:199], v[200:203], v[176:191]
  ds_read_b128 v[200:203], v3 offset:16384
  ds_read_b64_tr_b16 v[196:197], v8 offset:24576
  ds_read_b64_tr_b16 v[198:199], v8 offset:25088
  s_waitcnt lgkmcnt(15)
  v_mfma_f32_32x32x16_bf16 v[160:175], v[204:207], v[212:215], v[160:175]
  ds_read_b64_tr_b16 v[204:205], v7 offset:26624
  ds_read_b64_tr_b16 v[206:207], v7 offset:27136
  v_mfma_f32_32x32x16_bf16 v[176:191], v[208:211], v[212:215], v[176:191]
  ds_read_b128 v[212:215], v4 offset:16384
  ds_read_b64_tr_b16 v[208:209], v8 offset:26624
  ds_read_b64_tr_b16 v[210:211], v8 offset:27136
  s_waitcnt lgkmcnt(15)
  v_mfma_f32_32x32x16_bf16 v[160:175], v[232:235], v[240:243], v[160:175]
  ds_read_b64_tr_b16 v[232:233], v7 offset:28672
  ds_read_b64_tr_b16 v[234:235], v7 offset:29184
  v_mfma_f32_32x32x16_bf16 v[176:191], v[236:239], v[240:243], v[176:191]
  ds_read_b128 v[240:243], v5 offset:16384
  ds_read_b64_tr_b16 v[236:237], v8 offset:28672
  ds_read_b64_tr_b16 v[238:239], v8 offset:29184
  s_waitcnt lgkmcnt(15)
  v_mfma_f32_32x32x16_bf16 v[160:175], v[144:147], v[152:155], v[160:175]
  ds_read_b64_tr_b16 v[144:145], v7 offset:30720
  ds_read_b64_tr_b16 v[146:147], v7 offset:31232
  v_mfma_f32_32x32x16_bf16 v[176:191], v[148:151], v[152:155], v[176:191]
  ds_read_b128 v[152:155], v6 offset:16384
  ds_read_b64_tr_b16 v[148:149], v8 offset:30720
  ds_read_b64_tr_b16 v[150:151], v8 offset:31232
  s_barrier
  s_waitcnt lgkmcnt(15)
  v_mfma_f32_32x32x16_bf16 v[160:175], v[192:195], v[200:203], v[160:175]
  ds_read_b64_tr_b16 v[192:193], v1 offset:0
  ds_read_b64_tr_b16 v[194:195], v1 offset:512
  v_mfma_f32_32x32x16_bf16 v[176:191], v[196:199], v[200:203], v[176:191]
  ds_read_b128 v[200:203], v3 offset:32768
  ds_read_b64_tr_b16 v[196:197], v2 offset:0
  ds_read_b64_tr_b16 v[198:199], v2 offset:512
  s_waitcnt lgkmcnt(15)
  v_mfma_f32_32x32x16_bf16 v[160:175], v[204:207], v[212:215], v[160:175]
  ds_read_b64_tr_b16 v[204:205], v1 offset:2048
  ds_read_b64_tr_b16 v[206:207], v1 offset:2560
  v_mfma_f32_32x32x16_bf16 v[176:191], v[208:211], v[212:215], v[176:191]
  ds_read_b128 v[212:215], v4 offset:32768
  ds_read_b64_tr_b16 v[208:209], v2 offset:2048
  ds_read_b64_tr_b16 v[210:211], v2 offset:2560
  s_waitcnt lgkmcnt(15)
  v_mfma_f32_32x32x16_bf16 v[160:175], v[232:235], v[240:243], v[160:175]
  ds_read_b64_tr_b16 v[232:233], v1 offset:4096
  ds_read_b64_tr_b16 v[234:235], v1 offset:4608
  v_mfma_f32_32x32x16_bf16 v[176:191], v[236:239], v[240:243], v[176:191]
  ds_read_b128 v[240:243], v5 offset:32768
  ds_read_b64_tr_b16 v[236:237], v2 offset:4096
  ds_read_b64_tr_b16 v[238:239], v2 offset:4608
  s_waitcnt lgkmcnt(15)
  v_mfma_f32_32x32x16_bf16 v[160:175], v[144:147], v[152:155], v[160:175]
  ds_read_b64_tr_b16 v[144:145], v1 offset:6144
  ds_read_b64_tr_b16 v[146:147], v1 offset:6656
  v_mfma_f32_32x32x16_bf16 v[176:191], v[148:151], v[152:155], v[176:191]
  ds_read_b128 v[152:155], v6 offset:32768
  ds_read_b64_tr_b16 v[148:149], v2 offset:6144
  ds_read_b64_tr_b16 v[150:151], v2 offset:6656
  s_barrier
  s_waitcnt lgkmcnt(15)
  v_mfma_f32_32x32x16_bf16 v[160:175], v[192:195], v[200:203], v[160:175]
  ds_read_b64_tr_b16 v[192:193], v1 offset:8192
  ds_read_b64_tr_b16 v[194:195], v1 offset:8704
  v_mfma_f32_32x32x16_bf16 v[176:191], v[196:199], v[200:203], v[176:191]
  ds_read_b128 v[200:203], v3 offset:49152
  ds_read_b64_tr_b16 v[196:197], v2 offset:8192
  ds_read_b64_tr_b16 v[198:199], v2 offset:8704
  s_waitcnt lgkmcnt(15)
  v_mfma_f32_32x32x16_bf16 v[160:175], v[204:207], v[212:215], v[160:175]
  ds_read_b64_tr_b16 v[204:205], v1 offset:10240
  ds_read_b64_tr_b16 v[206:207], v1 offset:10752
  v_mfma_f32_32x32x16_bf16 v[176:191], v[208:211], v[212:215], v[176:191]
  ds_read_b128 v[212:215], v4 offset:49152
  ds_read_b64_tr_b16 v[208:209], v2 offset:10240
  ds_read_b64_tr_b16 v[210:211], v2 offset:10752
  s_waitcnt lgkmcnt(15)
  v_mfma_f32_32x32x16_bf16 v[160:175], v[232:235], v[240:243], v[160:175]
  ds_read_b64_tr_b16 v[232:233], v1 offset:12288
  ds_read_b64_tr_b16 v[234:235], v1 offset:12800
  v_mfma_f32_32x32x16_bf16 v[176:191], v[236:239], v[240:243], v[176:191]
  ds_read_b128 v[240:243], v5 offset:49152
  ds_read_b64_tr_b16 v[236:237], v2 offset:12288
  ds_read_b64_tr_b16 v[238:239], v2 offset:12800
  s_waitcnt lgkmcnt(15)
  v_mfma_f32_32x32x16_bf16 v[160:175], v[144:147], v[152:155], v[160:175]
  ds_read_b64_tr_b16 v[144:145], v1 offset:14336
  ds_read_b64_tr_b16 v[146:147], v1 offset:14848
  v_mfma_f32_32x32x16_bf16 v[176:191], v[148:151], v[152:155], v[176:191]
  ds_read_b128 v[152:155], v6 offset:49152
  ds_read_b64_tr_b16 v[148:149], v2 offset:14336
  ds_read_b64_tr_b16 v[150:151], v2 offset:14848
  s_barrier
  s_waitcnt lgkmcnt(15)
  v_mfma_f32_32x32x16_bf16 v[160:175], v[192:195], v[200:203], v[160:175]
  ds_read_b64_tr_b16 v[192:193], v1 offset:16384
  ds_read_b64_tr_b16 v[194:195], v1 offset:16896
  v_mfma_f32_32x32x16_bf16 v[176:191], v[196:199], v[200:203], v[176:191]
  ds_read_b128 v[200:203], v9
  ds_read_b64_tr_b16 v[196:197], v2 offset:16384
  ds_read_b64_tr_b16 v[198:199], v2 offset:16896
  s_waitcnt lgkmcnt(15)
  v_mfma_f32_32x32x16_bf16 v[160:175], v[204:207], v[212:215], v[160:175]
  ds_read_b64_tr_b16 v[204:205], v1 offset:18432
  ds_read_b64_tr_b16 v[206:207], v1 offset:18944
  v_mfma_f32_32x32x16_bf16 v[176:191], v[208:211], v[212:215], v[176:191]
  ds_read_b128 v[212:215], v12
  ds_read_b64_tr_b16 v[208:209], v2 offset:18432
  ds_read_b64_tr_b16 v[210:211], v2 offset:18944
  s_waitcnt lgkmcnt(15)
  v_mfma_f32_32x32x16_bf16 v[160:175], v[232:235], v[240:243], v[160:175]
  ds_read_b64_tr_b16 v[232:233], v1 offset:20480
  ds_read_b64_tr_b16 v[234:235], v1 offset:20992
  v_mfma_f32_32x32x16_bf16 v[176:191], v[236:239], v[240:243], v[176:191]
  ds_read_b128 v[240:243], v244
  ds_read_b64_tr_b16 v[236:237], v2 offset:20480
  ds_read_b64_tr_b16 v[238:239], v2 offset:20992
  s_waitcnt lgkmcnt(15)
  v_mfma_f32_32x32x16_bf16 v[160:175], v[144:147], v[152:155], v[160:175]
  ds_read_b64_tr_b16 v[144:145], v1 offset:22528
  ds_read_b64_tr_b16 v[146:147], v1 offset:23040
  v_mfma_f32_32x32x16_bf16 v[176:191], v[148:151], v[152:155], v[176:191]
  ds_read_b128 v[152:155], v245
  ds_read_b64_tr_b16 v[148:149], v2 offset:22528
  ds_read_b64_tr_b16 v[150:151], v2 offset:23040
  s_barrier
  s_waitcnt lgkmcnt(15)
  v_mfma_f32_32x32x16_bf16 v[160:175], v[192:195], v[200:203], v[160:175]
  ds_read_b64_tr_b16 v[192:193], v1 offset:24576
  ds_read_b64_tr_b16 v[194:195], v1 offset:25088
  v_mfma_f32_32x32x16_bf16 v[176:191], v[196:199], v[200:203], v[176:191]
  ds_read_b128 v[200:203], v3 offset:0
  ds_read_b64_tr_b16 v[196:197], v2 offset:24576
  ds_read_b64_tr_b16 v[198:199], v2 offset:25088
  s_waitcnt lgkmcnt(15)
  v_mfma_f32_32x32x16_bf16 v[160:175], v[204:207], v[212:215], v[160:175]
  ds_read_b64_tr_b16 v[204:205], v1 offset:26624
  ds_read_b64_tr_b16 v[206:207], v1 offset:27136
  v_mfma_f32_32x32x16_bf16 v[176:191], v[208:211], v[212:215], v[176:191]
  ds_read_b128 v[212:215], v4 offset:0
  ds_read_b64_tr_b16 v[208:209], v2 offset:26624
  ds_read_b64_tr_b16 v[210:211], v2 offset:27136
  s_waitcnt lgkmcnt(15)
  v_mfma_f32_32x32x16_bf16 v[160:175], v[232:235], v[240:243], v[160:175]
  ds_read_b64_tr_b16 v[232:233], v1 offset:28672
  ds_read_b64_tr_b16 v[234:235], v1 offset:29184
  v_mfma_f32_32x32x16_bf16 v[176:191], v[236:239], v[240:243], v[176:191]
  ds_read_b128 v[240:243], v5 offset:0
  ds_read_b64_tr_b16 v[236:237], v2 offset:28672
  ds_read_b64_tr_b16 v[238:239], v2 offset:29184
  s_waitcnt lgkmcnt(15)
  v_mfma_f32_32x32x16_bf16 v[160:175], v[144:147], v[152:155], v[160:175]
  ds_read_b64_tr_b16 v[144:145], v1 offset:30720
  ds_read_b64_tr_b16 v[146:147], v1 offset:31232
  v_mfma_f32_32x32x16_bf16 v[176:191], v[148:151], v[152:155], v[176:191]
  ds_read_b128 v[152:155], v6 offset:0
  ds_read_b64_tr_b16 v[148:149], v2 offset:30720
  ds_read_b64_tr_b16 v[150:151], v2 offset:31232
  s_barrier
  s_waitcnt lgkmcnt(15)
  v_mfma_f32_32x32x16_bf16 v[160:175], v[192:195], v[200:203], v[160:175]
  ds_read_b64_tr_b16 v[192:193], v7 offset:0
  ds_read_b64_tr_b16 v[194:195], v7 offset:512
  v_mfma_f32_32x32x16_bf16 v[176:191], v[196:199], v[200:203], v[176:191]
  ds_read_b128 v[200:203], v3 offset:16384
  ds_read_b64_tr_b16 v[196:197], v8 offset:0
  ds_read_b64_tr_b16 v[198:199], v8 offset:512
  s_waitcnt lgkmcnt(15)
  v_mfma_f32_32x32x16_bf16 v[160:175], v[204:207], v[212:215], v[160:175]
  ds_read_b64_tr_b16 v[204:205], v7 offset:2048
  ds_read_b64_tr_b16 v[206:207], v7 offset:2560
  v_mfma_f32_32x32x16_bf16 v[176:191], v[208:211], v[212:215], v[176:191]
  ds_read_b128 v[212:215], v4 offset:16384
  ds_read_b64_tr_b16 v[208:209], v8 offset:2048
  ds_read_b64_tr_b16 v[210:211], v8 offset:2560
  s_waitcnt lgkmcnt(15)
  v_mfma_f32_32x32x16_bf16 v[160:175], v[232:235], v[240:243], v[160:175]
  ds_read_b64_tr_b16 v[232:233], v7 offset:4096
  ds_read_b64_tr_b16 v[234:235], v7 offset:4608
  v_mfma_f32_32x32x16_bf16 v[176:191], v[236:239], v[240:243], v[176:191]
  ds_read_b128 v[240:243], v5 offset:16384
  ds_read_b64_tr_b16 v[236:237], v8 offset:4096
  ds_read_b64_tr_b16 v[238:239], v8 offset:4608
  s_waitcnt lgkmcnt(15)
  v_mfma_f32_32x32x16_bf16 v[160:175], v[144:147], v[152:155], v[160:175]
  ds_read_b64_tr_b16 v[144:145], v7 offset:6144
  ds_read_b64_tr_b16 v[146:147], v7 offset:6656
  v_mfma_f32_32x32x16_bf16 v[176:191], v[148:151], v[152:155], v[176:191]
  ds_read_b128 v[152:155], v6 offset:16384
  ds_read_b64_tr_b16 v[148:149], v8 offset:6144
  ds_read_b64_tr_b16 v[150:151], v8 offset:6656
  s_barrier
  s_waitcnt lgkmcnt(15)
  v_mfma_f32_32x32x16_bf16 v[160:175], v[192:195], v[200:203], v[160:175]
  ds_read_b64_tr_b16 v[192:193], v7 offset:8192
  ds_read_b64_tr_b16 v[194:195], v7 offset:8704
  v_mfma_f32_32x32x16_bf16 v[176:191], v[196:199], v[200:203], v[176:191]
  ds_read_b128 v[200:203], v3 offset:32768
  ds_read_b64_tr_b16 v[196:197], v8 offset:8192
  ds_read_b64_tr_b16 v[198:199], v8 offset:8704
  s_waitcnt lgkmcnt(15)
  v_mfma_f32_32x32x16_bf16 v[160:175], v[204:207], v[212:215], v[160:175]
  ds_read_b64_tr_b16 v[204:205], v7 offset:10240
  ds_read_b64_tr_b16 v[206:207], v7 offset:10752
  v_mfma_f32_32x32x16_bf16 v[176:191], v[208:211], v[212:215], v[176:191]
  ds_read_b128 v[212:215], v4 offset:32768
  ds_read_b64_tr_b16 v[208:209], v8 offset:10240
  ds_read_b64_tr_b16 v[210:211], v8 offset:10752
  s_waitcnt lgkmcnt(15)
  v_mfma_f32_32x32x16_bf16 v[160:175], v[232:235], v[240:243], v[160:175]
  ds_read_b64_tr_b16 v[232:233], v7 offset:12288
  ds_read_b64_tr_b16 v[234:235], v7 offset:12800
  v_mfma_f32_32x32x16_bf16 v[176:191], v[236:239], v[240:243], v[176:191]
  ds_read_b128 v[240:243], v5 offset:32768
  ds_read_b64_tr_b16 v[236:237], v8 offset:12288
  ds_read_b64_tr_b16 v[238:239], v8 offset:12800
  s_waitcnt lgkmcnt(15)
  v_mfma_f32_32x32x16_bf16 v[160:175], v[144:147], v[152:155], v[160:175]
  ds_read_b64_tr_b16 v[144:145], v7 offset:14336
  ds_read_b64_tr_b16 v[146:147], v7 offset:14848
  v_mfma_f32_32x32x16_bf16 v[176:191], v[148:151], v[152:155], v[176:191]
  ds_read_b128 v[152:155], v6 offset:32768
  ds_read_b64_tr_b16 v[148:149], v8 offset:14336
  ds_read_b64_tr_b16 v[150:151], v8 offset:14848
  s_barrier
  s_waitcnt lgkmcnt(15)
  v_mfma_f32_32x32x16_bf16 v[160:175], v[192:195], v[200:203], v[160:175]
  ds_read_b64_tr_b16 v[192:193], v7 offset:16384
  ds_read_b64_tr_b16 v[194:195], v7 offset:16896
  v_mfma_f32_32x32x16_bf16 v[176:191], v[196:199], v[200:203], v[176:191]
  ds_read_b128 v[200:203], v3 offset:49152
  ds_read_b64_tr_b16 v[196:197], v8 offset:16384
  ds_read_b64_tr_b16 v[198:199], v8 offset:16896
  s_waitcnt lgkmcnt(15)
  v_mfma_f32_32x32x16_bf16 v[160:175], v[204:207], v[212:215], v[160:175]
  ds_read_b64_tr_b16 v[204:205], v7 offset:18432
  ds_read_b64_tr_b16 v[206:207], v7 offset:18944
  v_mfma_f32_32x32x16_bf16 v[176:191], v[208:211], v[212:215], v[176:191]
  ds_read_b128 v[212:215], v4 offset:49152
  ds_read_b64_tr_b16 v[208:209], v8 offset:18432
  ds_read_b64_tr_b16 v[210:211], v8 offset:18944
  s_waitcnt lgkmcnt(15)
  v_mfma_f32_32x32x16_bf16 v[160:175], v[232:235], v[240:243], v[160:175]
  ds_read_b64_tr_b16 v[232:233], v7 offset:20480
  ds_read_b64_tr_b16 v[234:235], v7 offset:20992
  v_mfma_f32_32x32x16_bf16 v[176:191], v[236:239], v[240:243], v[176:191]
  ds_read_b128 v[240:243], v5 offset:49152
  ds_read_b64_tr_b16 v[236:237], v8 offset:20480
  ds_read_b64_tr_b16 v[238:239], v8 offset:20992
  s_waitcnt lgkmcnt(15)
  v_mfma_f32_32x32x16_bf16 v[160:175], v[144:147], v[152:155], v[160:175]
  ds_read_b64_tr_b16 v[144:145], v7 offset:22528
  ds_read_b64_tr_b16 v[146:147], v7 offset:23040
  v_mfma_f32_32x32x16_bf16 v[176:191], v[148:151], v[152:155], v[176:191]
  ds_read_b128 v[152:155], v6 offset:49152
  ds_read_b64_tr_b16 v[148:149], v8 offset:22528
  ds_read_b64_tr_b16 v[150:151], v8 offset:23040
  s_barrier
  s_waitcnt lgkmcnt(15)
  v_mfma_f32_32x32x16_bf16 v[160:175], v[192:195], v[200:203], v[160:175]
  ds_read_b64_tr_b16 v[192:193], v7 offset:24576
  ds_read_b64_tr_b16 v[194:195], v7 offset:25088
  v_mfma_f32_32x32x16_bf16 v[176:191], v[196:199], v[200:203], v[176:191]
  ds_read_b128 v[200:203], v9
  ds_read_b64_tr_b16 v[196:197], v8 offset:24576
  ds_read_b64_tr_b16 v[198:199], v8 offset:25088
  s_waitcnt lgkmcnt(15)
  v_mfma_f32_32x32x16_bf16 v[160:175], v[204:207], v[212:215], v[160:175]
  ds_read_b64_tr_b16 v[204:205], v7 offset:26624
  ds_read_b64_tr_b16 v[206:207], v7 offset:27136
  v_mfma_f32_32x32x16_bf16 v[176:191], v[208:211], v[212:215], v[176:191]
  ds_read_b128 v[212:215], v12
  ds_read_b64_tr_b16 v[208:209], v8 offset:26624
  ds_read_b64_tr_b16 v[210:211], v8 offset:27136
  s_waitcnt lgkmcnt(15)
  v_mfma_f32_32x32x16_bf16 v[160:175], v[232:235], v[240:243], v[160:175]
  ds_read_b64_tr_b16 v[232:233], v7 offset:28672
  ds_read_b64_tr_b16 v[234:235], v7 offset:29184
  v_mfma_f32_32x32x16_bf16 v[176:191], v[236:239], v[240:243], v[176:191]
  ds_read_b128 v[240:243], v244
  ds_read_b64_tr_b16 v[236:237], v8 offset:28672
  ds_read_b64_tr_b16 v[238:239], v8 offset:29184
  s_waitcnt lgkmcnt(15)
  v_mfma_f32_32x32x16_bf16 v[160:175], v[144:147], v[152:155], v[160:175]
  ds_read_b64_tr_b16 v[144:145], v7 offset:30720
  ds_read_b64_tr_b16 v[146:147], v7 offset:31232
  v_mfma_f32_32x32x16_bf16 v[176:191], v[148:151], v[152:155], v[176:191]
  ds_read_b128 v[152:155], v245
  ds_read_b64_tr_b16 v[148:149], v8 offset:30720
  ds_read_b64_tr_b16 v[150:151], v8 offset:31232
  s_barrier
  s_waitcnt lgkmcnt(15)
  v_mfma_f32_32x32x16_bf16 v[160:175], v[192:195], v[200:203], v[160:175]
  ds_read_b64_tr_b16 v[192:193], v1 offset:0
  ds_read_b64_tr_b16 v[194:195], v1 offset:512
  v_mfma_f32_32x32x16_bf16 v[176:191], v[196:199], v[200:203], v[176:191]
  ds_read_b128 v[200:203], v3 offset:0
  ds_read_b64_tr_b16 v[196:197], v2 offset:0
  ds_read_b64_tr_b16 v[198:199], v2 offset:512
  s_waitcnt lgkmcnt(15)
  v_mfma_f32_32x32x16_bf16 v[160:175], v[204:207], v[212:215], v[160:175]
  ds_read_b64_tr_b16 v[204:205], v1 offset:2048
  ds_read_b64_tr_b16 v[206:207], v1 offset:2560
  v_mfma_f32_32x32x16_bf16 v[176:191], v[208:211], v[212:215], v[176:191]
  ds_read_b128 v[212:215], v4 offset:0
  ds_read_b64_tr_b16 v[208:209], v2 offset:2048
  ds_read_b64_tr_b16 v[210:211], v2 offset:2560
  s_waitcnt lgkmcnt(15)
  v_mfma_f32_32x32x16_bf16 v[160:175], v[232:235], v[240:243], v[160:175]
  ds_read_b64_tr_b16 v[232:233], v1 offset:4096
  ds_read_b64_tr_b16 v[234:235], v1 offset:4608
  v_mfma_f32_32x32x16_bf16 v[176:191], v[236:239], v[240:243], v[176:191]
  ds_read_b128 v[240:243], v5 offset:0
  ds_read_b64_tr_b16 v[236:237], v2 offset:4096
  ds_read_b64_tr_b16 v[238:239], v2 offset:4608
  s_waitcnt lgkmcnt(15)
  v_mfma_f32_32x32x16_bf16 v[160:175], v[144:147], v[152:155], v[160:175]
  ds_read_b64_tr_b16 v[144:145], v1 offset:6144
  ds_read_b64_tr_b16 v[146:147], v1 offset:6656
  v_mfma_f32_32x32x16_bf16 v[176:191], v[148:151], v[152:155], v[176:191]
  ds_read_b128 v[152:155], v6 offset:0
  ds_read_b64_tr_b16 v[148:149], v2 offset:6144
  ds_read_b64_tr_b16 v[150:151], v2 offset:6656
  s_barrier
  s_waitcnt lgkmcnt(15)
  v_mfma_f32_32x32x16_bf16 v[160:175], v[192:195], v[200:203], v[160:175]
  ds_read_b64_tr_b16 v[192:193], v1 offset:8192
  ds_read_b64_tr_b16 v[194:195], v1 offset:8704
  v_mfma_f32_32x32x16_bf16 v[176:191], v[196:199], v[200:203], v[176:191]
  ds_read_b128 v[200:203], v3 offset:16384
  ds_read_b64_tr_b16 v[196:197], v2 offset:8192
  ds_read_b64_tr_b16 v[198:199], v2 offset:8704
  s_waitcnt lgkmcnt(15)
  v_mfma_f32_32x32x16_bf16 v[160:175], v[204:207], v[212:215], v[160:175]
  ds_read_b64_tr_b16 v[204:205], v1 offset:10240
  ds_read_b64_tr_b16 v[206:207], v1 offset:10752
  v_mfma_f32_32x32x16_bf16 v[176:191], v[208:211], v[212:215], v[176:191]
  ds_read_b128 v[212:215], v4 offset:16384
  ds_read_b64_tr_b16 v[208:209], v2 offset:10240
  ds_read_b64_tr_b16 v[210:211], v2 offset:10752
  s_waitcnt lgkmcnt(15)
  v_mfma_f32_32x32x16_bf16 v[160:175], v[232:235], v[240:243], v[160:175]
  ds_read_b64_tr_b16 v[232:233], v1 offset:12288
  ds_read_b64_tr_b16 v[234:235], v1 offset:12800
  v_mfma_f32_32x32x16_bf16 v[176:191], v[236:239], v[240:243], v[176:191]
  ds_read_b128 v[240:243], v5 offset:16384
  ds_read_b64_tr_b16 v[236:237], v2 offset:12288
  ds_read_b64_tr_b16 v[238:239], v2 offset:12800
  s_waitcnt lgkmcnt(15)
  v_mfma_f32_32x32x16_bf16 v[160:175], v[144:147], v[152:155], v[160:175]
  ds_read_b64_tr_b16 v[144:145], v1 offset:14336
  ds_read_b64_tr_b16 v[146:147], v1 offset:14848
  v_mfma_f32_32x32x16_bf16 v[176:191], v[148:151], v[152:155], v[176:191]
  ds_read_b128 v[152:155], v6 offset:16384
  ds_read_b64_tr_b16 v[148:149], v2 offset:14336
  ds_read_b64_tr_b16 v[150:151], v2 offset:14848
  s_barrier
  s_waitcnt lgkmcnt(15)
  v_mfma_f32_32x32x16_bf16 v[160:175], v[192:195], v[200:203], v[160:175]
  ds_read_b64_tr_b16 v[192:193], v1 offset:16384
  ds_read_b64_tr_b16 v[194:195], v1 offset:16896
  v_mfma_f32_32x32x16_bf16 v[176:191], v[196:199], v[200:203], v[176:191]
  ds_read_b128 v[200:203], v3 offset:32768
  ds_read_b64_tr_b16 v[196:197], v2 offset:16384
  ds_read_b64_tr_b16 v[198:199], v2 offset:16896
  s_waitcnt lgkmcnt(15)
  v_mfma_f32_32x32x16_bf16 v[160:175], v[204:207], v[212:215], v[160:175]
  ds_read_b64_tr_b16 v[204:205], v1 offset:18432
  ds_read_b64_tr_b16 v[206:207], v1 offset:18944
  v_mfma_f32_32x32x16_bf16 v[176:191], v[208:211], v[212:215], v[176:191]
  ds_read_b128 v[212:215], v4 offset:32768
  ds_read_b64_tr_b16 v[208:209], v2 offset:18432
  ds_read_b64_tr_b16 v[210:211], v2 offset:18944
  s_waitcnt lgkmcnt(15)
  v_mfma_f32_32x32x16_bf16 v[160:175], v[232:235], v[240:243], v[160:175]
  ds_read_b64_tr_b16 v[232:233], v1 offset:20480
  ds_read_b64_tr_b16 v[234:235], v1 offset:20992
  v_mfma_f32_32x32x16_bf16 v[176:191], v[236:239], v[240:243], v[176:191]
  ds_read_b128 v[240:243], v5 offset:32768
  ds_read_b64_tr_b16 v[236:237], v2 offset:20480
  ds_read_b64_tr_b16 v[238:239], v2 offset:20992
  s_waitcnt lgkmcnt(15)
  v_mfma_f32_32x32x16_bf16 v[160:175], v[144:147], v[152:155], v[160:175]
  ds_read_b64_tr_b16 v[144:145], v1 offset:22528
  ds_read_b64_tr_b16 v[146:147], v1 offset:23040
  v_mfma_f32_32x32x16_bf16 v[176:191], v[148:151], v[152:155], v[176:191]
  ds_read_b128 v[152:155], v6 offset:32768
  ds_read_b64_tr_b16 v[148:149], v2 offset:22528
  ds_read_b64_tr_b16 v[150:151], v2 offset:23040
  s_barrier
  s_waitcnt lgkmcnt(15)
  v_mfma_f32_32x32x16_bf16 v[160:175], v[192:195], v[200:203], v[160:175]
  ds_read_b64_tr_b16 v[192:193], v1 offset:24576
  ds_read_b64_tr_b16 v[194:195], v1 offset:25088
  v_mfma_f32_32x32x16_bf16 v[176:191], v[196:199], v[200:203], v[176:191]
  ds_read_b128 v[200:203], v3 offset:49152
  ds_read_b64_tr_b16 v[196:197], v2 offset:24576
  ds_read_b64_tr_b16 v[198:199], v2 offset:25088
  s_waitcnt lgkmcnt(15)
  v_mfma_f32_32x32x16_bf16 v[160:175], v[204:207], v[212:215], v[160:175]
  ds_read_b64_tr_b16 v[204:205], v1 offset:26624
  ds_read_b64_tr_b16 v[206:207], v1 offset:27136
  v_mfma_f32_32x32x16_bf16 v[176:191], v[208:211], v[212:215], v[176:191]
  ds_read_b128 v[212:215], v4 offset:49152
  ds_read_b64_tr_b16 v[208:209], v2 offset:26624
  ds_read_b64_tr_b16 v[210:211], v2 offset:27136
  s_waitcnt lgkmcnt(15)
  v_mfma_f32_32x32x16_bf16 v[160:175], v[232:235], v[240:243], v[160:175]
  ds_read_b64_tr_b16 v[232:233], v1 offset:28672
  ds_read_b64_tr_b16 v[234:235], v1 offset:29184
  v_mfma_f32_32x32x16_bf16 v[176:191], v[236:239], v[240:243], v[176:191]
  ds_read_b128 v[240:243], v5 offset:49152
  ds_read_b64_tr_b16 v[236:237], v2 offset:28672
  ds_read_b64_tr_b16 v[238:239], v2 offset:29184
  s_waitcnt lgkmcnt(15)
  v_mfma_f32_32x32x16_bf16 v[160:175], v[144:147], v[152:155], v[160:175]
  ds_read_b64_tr_b16 v[144:145], v1 offset:30720
  ds_read_b64_tr_b16 v[146:147], v1 offset:31232
  v_mfma_f32_32x32x16_bf16 v[176:191], v[148:151], v[152:155], v[176:191]
  ds_read_b128 v[152:155], v6 offset:49152
  ds_read_b64_tr_b16 v[148:149], v2 offset:30720
  ds_read_b64_tr_b16 v[150:151], v2 offset:31232
  s_barrier
  s_waitcnt lgkmcnt(15)
  v_mfma_f32_32x32x16_bf16 v[160:175], v[192:195], v[200:203], v[160:175]
  ds_read_b64_tr_b16 v[192:193], v7 offset:0
  ds_read_b64_tr_b16 v[194:195], v7 offset:512
  v_mfma_f32_32x32x16_bf16 v[176:191], v[196:199], v[200:203], v[176:191]
  ds_read_b128 v[200:203], v9
  ds_read_b64_tr_b16 v[196:197], v8 offset:0
  ds_read_b64_tr_b16 v[198:199], v8 offset:512
  s_waitcnt lgkmcnt(15)
  v_mfma_f32_32x32x16_bf16 v[160:175], v[204:207], v[212:215], v[160:175]
  ds_read_b64_tr_b16 v[204:205], v7 offset:2048
  ds_read_b64_tr_b16 v[206:207], v7 offset:2560
  v_mfma_f32_32x32x16_bf16 v[176:191], v[208:211], v[212:215], v[176:191]
  ds_read_b128 v[212:215], v12
  ds_read_b64_tr_b16 v[208:209], v8 offset:2048
  ds_read_b64_tr_b16 v[210:211], v8 offset:2560
  s_waitcnt lgkmcnt(15)
  v_mfma_f32_32x32x16_bf16 v[160:175], v[232:235], v[240:243], v[160:175]
  ds_read_b64_tr_b16 v[232:233], v7 offset:4096
  ds_read_b64_tr_b16 v[234:235], v7 offset:4608
  v_mfma_f32_32x32x16_bf16 v[176:191], v[236:239], v[240:243], v[176:191]
  ds_read_b128 v[240:243], v244
  ds_read_b64_tr_b16 v[236:237], v8 offset:4096
  ds_read_b64_tr_b16 v[238:239], v8 offset:4608
  s_waitcnt lgkmcnt(15)
  v_mfma_f32_32x32x16_bf16 v[160:175], v[144:147], v[152:155], v[160:175]
  ds_read_b64_tr_b16 v[144:145], v7 offset:6144
  ds_read_b64_tr_b16 v[146:147], v7 offset:6656
  v_mfma_f32_32x32x16_bf16 v[176:191], v[148:151], v[152:155], v[176:191]
  ds_read_b128 v[152:155], v245
  ds_read_b64_tr_b16 v[148:149], v8 offset:6144
  ds_read_b64_tr_b16 v[150:151], v8 offset:6656
  s_barrier
  s_waitcnt lgkmcnt(15)
  v_mfma_f32_32x32x16_bf16 v[160:175], v[192:195], v[200:203], v[160:175]
  ds_read_b64_tr_b16 v[192:193], v7 offset:8192
  ds_read_b64_tr_b16 v[194:195], v7 offset:8704
  v_mfma_f32_32x32x16_bf16 v[176:191], v[196:199], v[200:203], v[176:191]
  ds_read_b128 v[200:203], v3 offset:0
  ds_read_b64_tr_b16 v[196:197], v8 offset:8192
  ds_read_b64_tr_b16 v[198:199], v8 offset:8704
  s_waitcnt lgkmcnt(15)
  v_mfma_f32_32x32x16_bf16 v[160:175], v[204:207], v[212:215], v[160:175]
  ds_read_b64_tr_b16 v[204:205], v7 offset:10240
  ds_read_b64_tr_b16 v[206:207], v7 offset:10752
  v_mfma_f32_32x32x16_bf16 v[176:191], v[208:211], v[212:215], v[176:191]
  ds_read_b128 v[212:215], v4 offset:0
  ds_read_b64_tr_b16 v[208:209], v8 offset:10240
  ds_read_b64_tr_b16 v[210:211], v8 offset:10752
  s_waitcnt lgkmcnt(15)
  v_mfma_f32_32x32x16_bf16 v[160:175], v[232:235], v[240:243], v[160:175]
  ds_read_b64_tr_b16 v[232:233], v7 offset:12288
  ds_read_b64_tr_b16 v[234:235], v7 offset:12800
  v_mfma_f32_32x32x16_bf16 v[176:191], v[236:239], v[240:243], v[176:191]
  ds_read_b128 v[240:243], v5 offset:0
  ds_read_b64_tr_b16 v[236:237], v8 offset:12288
  ds_read_b64_tr_b16 v[238:239], v8 offset:12800
  s_waitcnt lgkmcnt(15)
  v_mfma_f32_32x32x16_bf16 v[160:175], v[144:147], v[152:155], v[160:175]
  ds_read_b64_tr_b16 v[144:145], v7 offset:14336
  ds_read_b64_tr_b16 v[146:147], v7 offset:14848
  v_mfma_f32_32x32x16_bf16 v[176:191], v[148:151], v[152:155], v[176:191]
  ds_read_b128 v[152:155], v6 offset:0
  ds_read_b64_tr_b16 v[148:149], v8 offset:14336
  ds_read_b64_tr_b16 v[150:151], v8 offset:14848
  s_barrier
  s_waitcnt lgkmcnt(15)
  v_mfma_f32_32x32x16_bf16 v[160:175], v[192:195], v[200:203], v[160:175]
  ds_read_b64_tr_b16 v[192:193], v7 offset:16384
  ds_read_b64_tr_b16 v[194:195], v7 offset:16896
  v_mfma_f32_32x32x16_bf16 v[176:191], v[196:199], v[200:203], v[176:191]
  ds_read_b128 v[200:203], v3 offset:16384
  ds_read_b64_tr_b16 v[196:197], v8 offset:16384
  ds_read_b64_tr_b16 v[198:199], v8 offset:16896
  s_waitcnt lgkmcnt(15)
  v_mfma_f32_32x32x16_bf16 v[160:175], v[204:207], v[212:215], v[160:175]
  ds_read_b64_tr_b16 v[204:205], v7 offset:18432
  ds_read_b64_tr_b16 v[206:207], v7 offset:18944
  v_mfma_f32_32x32x16_bf16 v[176:191], v[208:211], v[212:215], v[176:191]
  ds_read_b128 v[212:215], v4 offset:16384
  ds_read_b64_tr_b16 v[208:209], v8 offset:18432
  ds_read_b64_tr_b16 v[210:211], v8 offset:18944
  s_waitcnt lgkmcnt(15)
  v_mfma_f32_32x32x16_bf16 v[160:175], v[232:235], v[240:243], v[160:175]
  ds_read_b64_tr_b16 v[232:233], v7 offset:20480
  ds_read_b64_tr_b16 v[234:235], v7 offset:20992
  v_mfma_f32_32x32x16_bf16 v[176:191], v[236:239], v[240:243], v[176:191]
  ds_read_b128 v[240:243], v5 offset:16384
  ds_read_b64_tr_b16 v[236:237], v8 offset:20480
  ds_read_b64_tr_b16 v[238:239], v8 offset:20992
  s_waitcnt lgkmcnt(15)
  v_mfma_f32_32x32x16_bf16 v[160:175], v[144:147], v[152:155], v[160:175]
  ds_read_b64_tr_b16 v[144:145], v7 offset:22528
  ds_read_b64_tr_b16 v[146:147], v7 offset:23040
  v_mfma_f32_32x32x16_bf16 v[176:191], v[148:151], v[152:155], v[176:191]
  ds_read_b128 v[152:155], v6 offset:16384
  ds_read_b64_tr_b16 v[148:149], v8 offset:22528
  ds_read_b64_tr_b16 v[150:151], v8 offset:23040
  s_barrier
  s_waitcnt lgkmcnt(15)
  v_mfma_f32_32x32x16_bf16 v[160:175], v[192:195], v[200:203], v[160:175]
  ds_read_b64_tr_b16 v[192:193], v7 offset:24576
  ds_read_b64_tr_b16 v[194:195], v7 offset:25088
  v_mfma_f32_32x32x16_bf16 v[176:191], v[196:199], v[200:203], v[176:191]
  ds_read_b128 v[200:203], v3 offset:32768
  ds_read_b64_tr_b16 v[196:197], v8 offset:24576
  ds_read_b64_tr_b16 v[198:199], v8 offset:25088
  s_waitcnt lgkmcnt(15)
  v_mfma_f32_32x32x16_bf16 v[160:175], v[204:207], v[212:215], v[160:175]
  ds_read_b64_tr_b16 v[204:205], v7 offset:26624
  ds_read_b64_tr_b16 v[206:207], v7 offset:27136
  v_mfma_f32_32x32x16_bf16 v[176:191], v[208:211], v[212:215], v[176:191]
  ds_read_b128 v[212:215], v4 offset:32768
  ds_read_b64_tr_b16 v[208:209], v8 offset:26624
  ds_read_b64_tr_b16 v[210:211], v8 offset:27136
  s_waitcnt lgkmcnt(15)
  v_mfma_f32_32x32x16_bf16 v[160:175], v[232:235], v[240:243], v[160:175]
  ds_read_b64_tr_b16 v[232:233], v7 offset:28672
  ds_read_b64_tr_b16 v[234:235], v7 offset:29184
  v_mfma_f32_32x32x16_bf16 v[176:191], v[236:239], v[240:243], v[176:191]
  ds_read_b128 v[240:243], v5 offset:32768
  ds_read_b64_tr_b16 v[236:237], v8 offset:28672
  ds_read_b64_tr_b16 v[238:239], v8 offset:29184
  s_waitcnt lgkmcnt(15)
  v_mfma_f32_32x32x16_bf16 v[160:175], v[144:147], v[152:155], v[160:175]
  ds_read_b64_tr_b16 v[144:145], v7 offset:30720
  ds_read_b64_tr_b16 v[146:147], v7 offset:31232
  v_mfma_f32_32x32x16_bf16 v[176:191], v[148:151], v[152:155], v[176:191]
  ds_read_b128 v[152:155], v6 offset:32768
  ds_read_b64_tr_b16 v[148:149], v8 offset:30720
  ds_read_b64_tr_b16 v[150:151], v8 offset:31232
  s_barrier
  s_waitcnt lgkmcnt(15)
  v_mfma_f32_32x32x16_bf16 v[160:175], v[192:195], v[200:203], v[160:175]
  ds_read_b64_tr_b16 v[192:193], v1 offset:0
  ds_read_b64_tr_b16 v[194:195], v1 offset:512
  v_mfma_f32_32x32x16_bf16 v[176:191], v[196:199], v[200:203], v[176:191]
  ds_read_b128 v[200:203], v3 offset:49152
  ds_read_b64_tr_b16 v[196:197], v2 offset:0
  ds_read_b64_tr_b16 v[198:199], v2 offset:512
  s_waitcnt lgkmcnt(15)
  v_mfma_f32_32x32x16_bf16 v[160:175], v[204:207], v[212:215], v[160:175]
  ds_read_b64_tr_b16 v[204:205], v1 offset:2048
  ds_read_b64_tr_b16 v[206:207], v1 offset:2560
  v_mfma_f32_32x32x16_bf16 v[176:191], v[208:211], v[212:215], v[176:191]
  ds_read_b128 v[212:215], v4 offset:49152
  ds_read_b64_tr_b16 v[208:209], v2 offset:2048
  ds_read_b64_tr_b16 v[210:211], v2 offset:2560
  s_waitcnt lgkmcnt(15)
  v_mfma_f32_32x32x16_bf16 v[160:175], v[232:235], v[240:243], v[160:175]
  ds_read_b64_tr_b16 v[232:233], v1 offset:4096
  ds_read_b64_tr_b16 v[234:235], v1 offset:4608
  v_mfma_f32_32x32x16_bf16 v[176:191], v[236:239], v[240:243], v[176:191]
  ds_read_b128 v[240:243], v5 offset:49152
  ds_read_b64_tr_b16 v[236:237], v2 offset:4096
  ds_read_b64_tr_b16 v[238:239], v2 offset:4608
  s_waitcnt lgkmcnt(15)
  v_mfma_f32_32x32x16_bf16 v[160:175], v[144:147], v[152:155], v[160:175]
  ds_read_b64_tr_b16 v[144:145], v1 offset:6144
  ds_read_b64_tr_b16 v[146:147], v1 offset:6656
  v_mfma_f32_32x32x16_bf16 v[176:191], v[148:151], v[152:155], v[176:191]
  ds_read_b128 v[152:155], v6 offset:49152
  ds_read_b64_tr_b16 v[148:149], v2 offset:6144
  ds_read_b64_tr_b16 v[150:151], v2 offset:6656
  s_barrier
  s_waitcnt lgkmcnt(15)
  v_mfma_f32_32x32x16_bf16 v[160:175], v[192:195], v[200:203], v[160:175]
  ds_read_b64_tr_b16 v[192:193], v1 offset:8192
  ds_read_b64_tr_b16 v[194:195], v1 offset:8704
  v_mfma_f32_32x32x16_bf16 v[176:191], v[196:199], v[200:203], v[176:191]
  ds_read_b128 v[200:203], v9
  ds_read_b64_tr_b16 v[196:197], v2 offset:8192
  ds_read_b64_tr_b16 v[198:199], v2 offset:8704
  s_waitcnt lgkmcnt(15)
  v_mfma_f32_32x32x16_bf16 v[160:175], v[204:207], v[212:215], v[160:175]
  ds_read_b64_tr_b16 v[204:205], v1 offset:10240
  ds_read_b64_tr_b16 v[206:207], v1 offset:10752
  v_mfma_f32_32x32x16_bf16 v[176:191], v[208:211], v[212:215], v[176:191]
  ds_read_b128 v[212:215], v12
  ds_read_b64_tr_b16 v[208:209], v2 offset:10240
  ds_read_b64_tr_b16 v[210:211], v2 offset:10752
  s_waitcnt lgkmcnt(15)
  v_mfma_f32_32x32x16_bf16 v[160:175], v[232:235], v[240:243], v[160:175]
  ds_read_b64_tr_b16 v[232:233], v1 offset:12288
  ds_read_b64_tr_b16 v[234:235], v1 offset:12800
  v_mfma_f32_32x32x16_bf16 v[176:191], v[236:239], v[240:243], v[176:191]
  ds_read_b128 v[240:243], v244
  ds_read_b64_tr_b16 v[236:237], v2 offset:12288
  ds_read_b64_tr_b16 v[238:239], v2 offset:12800
  s_waitcnt lgkmcnt(15)
  v_mfma_f32_32x32x16_bf16 v[160:175], v[144:147], v[152:155], v[160:175]
  ds_read_b64_tr_b16 v[144:145], v1 offset:14336
  ds_read_b64_tr_b16 v[146:147], v1 offset:14848
  v_mfma_f32_32x32x16_bf16 v[176:191], v[148:151], v[152:155], v[176:191]
  ds_read_b128 v[152:155], v245
  ds_read_b64_tr_b16 v[148:149], v2 offset:14336
  ds_read_b64_tr_b16 v[150:151], v2 offset:14848
  s_barrier
  s_waitcnt lgkmcnt(15)
  v_mfma_f32_32x32x16_bf16 v[160:175], v[192:195], v[200:203], v[160:175]
  ds_read_b64_tr_b16 v[192:193], v1 offset:16384
  ds_read_b64_tr_b16 v[194:195], v1 offset:16896
  v_mfma_f32_32x32x16_bf16 v[176:191], v[196:199], v[200:203], v[176:191]
  ds_read_b128 v[200:203], v3 offset:0
  ds_read_b64_tr_b16 v[196:197], v2 offset:16384
  ds_read_b64_tr_b16 v[198:199], v2 offset:16896
  s_waitcnt lgkmcnt(15)
  v_mfma_f32_32x32x16_bf16 v[160:175], v[204:207], v[212:215], v[160:175]
  ds_read_b64_tr_b16 v[204:205], v1 offset:18432
  ds_read_b64_tr_b16 v[206:207], v1 offset:18944
  v_mfma_f32_32x32x16_bf16 v[176:191], v[208:211], v[212:215], v[176:191]
  ds_read_b128 v[212:215], v4 offset:0
  ds_read_b64_tr_b16 v[208:209], v2 offset:18432
  ds_read_b64_tr_b16 v[210:211], v2 offset:18944
  s_waitcnt lgkmcnt(15)
  v_mfma_f32_32x32x16_bf16 v[160:175], v[232:235], v[240:243], v[160:175]
  ds_read_b64_tr_b16 v[232:233], v1 offset:20480
  ds_read_b64_tr_b16 v[234:235], v1 offset:20992
  v_mfma_f32_32x32x16_bf16 v[176:191], v[236:239], v[240:243], v[176:191]
  ds_read_b128 v[240:243], v5 offset:0
  ds_read_b64_tr_b16 v[236:237], v2 offset:20480
  ds_read_b64_tr_b16 v[238:239], v2 offset:20992
  s_waitcnt lgkmcnt(15)
  v_mfma_f32_32x32x16_bf16 v[160:175], v[144:147], v[152:155], v[160:175]
  ds_read_b64_tr_b16 v[144:145], v1 offset:22528
  ds_read_b64_tr_b16 v[146:147], v1 offset:23040
  v_mfma_f32_32x32x16_bf16 v[176:191], v[148:151], v[152:155], v[176:191]
  ds_read_b128 v[152:155], v6 offset:0
  ds_read_b64_tr_b16 v[148:149], v2 offset:22528
  ds_read_b64_tr_b16 v[150:151], v2 offset:23040
  s_barrier
  s_waitcnt lgkmcnt(15)
  v_mfma_f32_32x32x16_bf16 v[160:175], v[192:195], v[200:203], v[160:175]
  ds_read_b64_tr_b16 v[192:193], v1 offset:24576
  ds_read_b64_tr_b16 v[194:195], v1 offset:25088
  v_mfma_f32_32x32x16_bf16 v[176:191], v[196:199], v[200:203], v[176:191]
  ds_read_b128 v[200:203], v3 offset:16384
  ds_read_b64_tr_b16 v[196:197], v2 offset:24576
  ds_read_b64_tr_b16 v[198:199], v2 offset:25088
  s_waitcnt lgkmcnt(15)
  v_mfma_f32_32x32x16_bf16 v[160:175], v[204:207], v[212:215], v[160:175]
  ds_read_b64_tr_b16 v[204:205], v1 offset:26624
  ds_read_b64_tr_b16 v[206:207], v1 offset:27136
  v_mfma_f32_32x32x16_bf16 v[176:191], v[208:211], v[212:215], v[176:191]
  ds_read_b128 v[212:215], v4 offset:16384
  ds_read_b64_tr_b16 v[208:209], v2 offset:26624
  ds_read_b64_tr_b16 v[210:211], v2 offset:27136
  s_waitcnt lgkmcnt(15)
  v_mfma_f32_32x32x16_bf16 v[160:175], v[232:235], v[240:243], v[160:175]
  ds_read_b64_tr_b16 v[232:233], v1 offset:28672
  ds_read_b64_tr_b16 v[234:235], v1 offset:29184
  v_mfma_f32_32x32x16_bf16 v[176:191], v[236:239], v[240:243], v[176:191]
  ds_read_b128 v[240:243], v5 offset:16384
  ds_read_b64_tr_b16 v[236:237], v2 offset:28672
  ds_read_b64_tr_b16 v[238:239], v2 offset:29184
  s_waitcnt lgkmcnt(15)
  v_mfma_f32_32x32x16_bf16 v[160:175], v[144:147], v[152:155], v[160:175]
  ds_read_b64_tr_b16 v[144:145], v1 offset:30720
  ds_read_b64_tr_b16 v[146:147], v1 offset:31232
  v_mfma_f32_32x32x16_bf16 v[176:191], v[148:151], v[152:155], v[176:191]
  ds_read_b128 v[152:155], v6 offset:16384
  ds_read_b64_tr_b16 v[148:149], v2 offset:30720
  ds_read_b64_tr_b16 v[150:151], v2 offset:31232
  s_waitcnt lgkmcnt(15)
  v_mfma_f32_32x32x16_bf16 v[160:175], v[192:195], v[200:203], v[160:175]
  v_mfma_f32_32x32x16_bf16 v[176:191], v[196:199], v[200:203], v[176:191]
  s_waitcnt lgkmcnt(12)
  v_mfma_f32_32x32x16_bf16 v[160:175], v[204:207], v[212:215], v[160:175]
  s_waitcnt lgkmcnt(10)
  v_mfma_f32_32x32x16_bf16 v[176:191], v[208:211], v[212:215], v[176:191]
  s_waitcnt lgkmcnt(7)
  v_mfma_f32_32x32x16_bf16 v[160:175], v[232:235], v[240:243], v[160:175]
  s_waitcnt lgkmcnt(5)
  v_mfma_f32_32x32x16_bf16 v[176:191], v[236:239], v[240:243], v[176:191]
  s_waitcnt lgkmcnt(2)
  v_mfma_f32_32x32x16_bf16 v[160:175], v[144:147], v[152:155], v[160:175]
  s_waitcnt lgkmcnt(0)
  v_mfma_f32_32x32x16_bf16 v[176:191], v[148:151], v[152:155], v[176:191]
  s_nop 9
  v_pk_mul_f32 v[160:161], v[160:161], v[16:17]
  v_pk_mul_f32 v[162:163], v[162:163], v[18:19]
  v_pk_mul_f32 v[164:165], v[164:165], v[20:21]
  v_pk_mul_f32 v[166:167], v[166:167], v[22:23]
  v_pk_mul_f32 v[168:169], v[168:169], v[24:25]
  v_pk_mul_f32 v[170:171], v[170:171], v[26:27]
  v_pk_mul_f32 v[172:173], v[172:173], v[28:29]
  v_pk_mul_f32 v[174:175], v[174:175], v[30:31]
  v_cvt_pk_bf16_f32 v112, v160, v161
  v_cvt_pk_bf16_f32 v113, v162, v163
  v_cvt_pk_bf16_f32 v114, v164, v165
  v_cvt_pk_bf16_f32 v115, v166, v167
  v_cvt_pk_bf16_f32 v116, v168, v169
  v_cvt_pk_bf16_f32 v117, v170, v171
  v_cvt_pk_bf16_f32 v118, v172, v173
  v_cvt_pk_bf16_f32 v119, v174, v175
  v_permlane32_swap_b32 v112, v114
  v_permlane32_swap_b32 v113, v115
  v_permlane32_swap_b32 v116, v118
  v_permlane32_swap_b32 v117, v119
  s_nop 0
  v_permlane16_swap_b32 v112, v116
  v_permlane16_swap_b32 v113, v117
  v_permlane16_swap_b32 v114, v118
  v_permlane16_swap_b32 v115, v119
  buffer_store_dwordx4 v[112:115], v10, s[24:27], s10 offen offset:0 sc1
  buffer_store_dwordx4 v[116:119], v14, s[24:27], s10 offen offset:0 sc1
  v_pk_mul_f32 v[176:177], v[176:177], v[32:33]
  v_pk_mul_f32 v[178:179], v[178:179], v[34:35]
  v_pk_mul_f32 v[180:181], v[180:181], v[36:37]
  v_pk_mul_f32 v[182:183], v[182:183], v[38:39]
  v_pk_mul_f32 v[184:185], v[184:185], v[40:41]
  v_pk_mul_f32 v[186:187], v[186:187], v[42:43]
  v_pk_mul_f32 v[188:189], v[188:189], v[44:45]
  v_pk_mul_f32 v[190:191], v[190:191], v[46:47]
  v_cvt_pk_bf16_f32 v120, v176, v177
  v_cvt_pk_bf16_f32 v121, v178, v179
  v_cvt_pk_bf16_f32 v122, v180, v181
  v_cvt_pk_bf16_f32 v123, v182, v183
  v_cvt_pk_bf16_f32 v124, v184, v185
  v_cvt_pk_bf16_f32 v125, v186, v187
  v_cvt_pk_bf16_f32 v126, v188, v189
  v_cvt_pk_bf16_f32 v127, v190, v191
  v_permlane32_swap_b32 v120, v122
  v_permlane32_swap_b32 v121, v123
  v_permlane32_swap_b32 v124, v126
  v_permlane32_swap_b32 v125, v127
  s_nop 0
  v_permlane16_swap_b32 v120, v124
  v_permlane16_swap_b32 v121, v125
  v_permlane16_swap_b32 v122, v126
  v_permlane16_swap_b32 v123, v127
  buffer_store_dwordx4 v[120:123], v10, s[24:27], s10 offen offset:64 sc1
  buffer_store_dwordx4 v[124:127], v14, s[24:27], s10 offen offset:64 sc1
  s_lshl_b32 s8, s38, 4
  s_add_u32 s8, s8, s37
  s_lshl_b32 s8, s8, 7
  s_lshl_b32 s9, s36, 2
  s_add_u32 s8, s8, s9
  s_add_u32 s8, s8, 19333120
  s_and_b32 s48, s36, 1
  s_lshr_b32 s49, s36, 1
  v_lshrrev_b32 v140, 5, v0
  v_bfe_u32 v141, v0, 2, 2
  v_lshl_add_u32 v1, v140, 3, v141
  v_lshlrev_b32 v1, 7, v1
  v_lshrrev_b32 v141, 1, v141
  v_lshl_add_u32 v1, v141, 6, v1
  v_bfe_u32 v141, v0, 4, 1
  v_lshl_add_u32 v1, v141, 5, v1
  v_and_b32 v141, 3, v0
  v_lshl_add_u32 v1, v141, 3, v1
  s_lshl_b32 s50, s49, 6
  v_xor_b32 v7, s50, v1
  s_lshl_b32 s50, s48, 6
  v_xor_b32 v1, s50, v1
  v_and_b32 v140, 31, v0
  v_bfe_u32 v141, v0, 1, 3
  v_lshrrev_b32 v2, 5, v0
  v_xor_b32 v141, v141, v2
  v_xor_b32 v2, 0, v141
  v_lshlrev_b32 v2, 4, v2
  v_lshl_add_u32 v2, v140, 7, v2
  v_xor_b32 v3, 2, v141
  v_lshlrev_b32 v3, 4, v3
  v_lshl_add_u32 v3, v140, 7, v3
  v_xor_b32 v4, 4, v141
  v_lshlrev_b32 v4, 4, v4
  v_lshl_add_u32 v4, v140, 7, v4
  v_xor_b32 v5, 6, v141
  v_lshlrev_b32 v5, 4, v5
  v_lshl_add_u32 v5, v140, 7, v5
  s_lshl_b32 s50, s49, 12
  v_add_u32 v2, s50, v2
  v_add_u32 v3, s50, v3
  v_add_u32 v4, s50, v4
  v_add_u32 v5, s50, v5
  v_lshlrev_b32 v6, 4, v0
  s_lshl_b32 s50, s48, 10
  v_add_u32 v6, s50, v6
  v_add_u32 v151, 65536, v1
  v_add_u32 v161, 131072, v1
  v_add_u32 v152, 65536, v2
  v_add_u32 v162, 131072, v2
  v_add_u32 v153, 65536, v3
  v_add_u32 v163, 131072, v3
  v_add_u32 v154, 65536, v4
  v_add_u32 v164, 131072, v4
  v_add_u32 v155, 65536, v5
  v_add_u32 v165, 131072, v5
  v_add_u32 v156, 65536, v6
  v_add_u32 v166, 131072, v6
  v_add_u32 v157, 65536, v7
  v_add_u32 v167, 131072, v7
  s_lshl_b32 s50, s93, 6
  s_lshl_b32 s51, s49, 5
  s_add_u32 s50, s50, s51
  v_and_b32 v140, 31, v0
  v_add_u32 v140, s50, v140
  v_mul_u32_u24 v140, 896, v140
  v_lshrrev_b32 v141, 5, v0
  v_lshl_add_u32 v8, v141, 4, v140
  s_lshl_b32 s50, s92, 7
  s_lshl_b32 s51, s48, 6
  s_add_u32 s50, s50, s51
  v_add_u32 v8, s50, v8
  v_mov_b32 v140, 0
  v_mov_b32 v141, 1
  s_waitcnt vmcnt(0)
  buffer_store_dword v141, v140, s[24:27], s8 offen sc1
  buffer_load_dwordx4 v[128:131], v8, s[16:19], 0 offen offset:0
  buffer_load_dwordx4 v[132:135], v8, s[16:19], 0 offen offset:32
  s_barrier
  s_mov_b32 s50, 19988480
  buffer_load_dword v9, v140, s[24:27], s50 offen sc1
  ds_read_b128 v[48:51], v6 offset:49152
  ds_read_b64_tr_b16 v[52:53], v167 offset:8192
  ds_read_b64_tr_b16 v[54:55], v167 offset:8704
  ds_read_b128 v[56:59], v6 offset:51200
  ds_read_b64_tr_b16 v[60:61], v167 offset:10240
  ds_read_b64_tr_b16 v[62:63], v167 offset:10752
  ds_read_b128 v[64:67], v6 offset:53248
  ds_read_b64_tr_b16 v[68:69], v167 offset:12288
  ds_read_b64_tr_b16 v[70:71], v167 offset:12800
  ds_read_b128 v[72:75], v6 offset:55296
  ds_read_b64_tr_b16 v[76:77], v167 offset:14336
  ds_read_b64_tr_b16 v[78:79], v167 offset:14848
  s_barrier
  s_waitcnt lgkmcnt(9)
  v_mfma_f32_32x32x16_f16 v[32:47], v[48:51], v[52:55], 0
  ds_read_b128 v[80:83], v156 offset:0
  ds_read_b64_tr_b16 v[84:85], v7 offset:0
  ds_read_b64_tr_b16 v[86:87], v7 offset:512
  s_waitcnt lgkmcnt(9)
  v_mfma_f32_32x32x16_f16 v[32:47], v[56:59], v[60:63], v[32:47]
  ds_read_b128 v[88:91], v156 offset:2048
  ds_read_b64_tr_b16 v[92:93], v7 offset:2048
  ds_read_b64_tr_b16 v[94:95], v7 offset:2560
  s_waitcnt lgkmcnt(9)
  v_mfma_f32_32x32x16_f16 v[32:47], v[64:67], v[68:71], v[32:47]
  ds_read_b128 v[96:99], v156 offset:4096
  ds_read_b64_tr_b16 v[100:101], v7 offset:4096
  ds_read_b64_tr_b16 v[102:103], v7 offset:4608
  s_waitcnt lgkmcnt(9)
  v_mfma_f32_32x32x16_f16 v[32:47], v[72:75], v[76:79], v[32:47]
  ds_read_b128 v[104:107], v156 offset:6144
  ds_read_b64_tr_b16 v[108:109], v7 offset:6144
  ds_read_b64_tr_b16 v[110:111], v7 offset:6656
  s_barrier
  s_waitcnt lgkmcnt(9)
  v_mfma_f32_32x32x16_f16 v[32:47], v[80:83], v[84:87], v[32:47]
  ds_read_b128 v[48:51], v156 offset:8192
  ds_read_b64_tr_b16 v[52:53], v167 offset:16384
  ds_read_b64_tr_b16 v[54:55], v167 offset:16896
  s_waitcnt lgkmcnt(9)
  v_mfma_f32_32x32x16_f16 v[32:47], v[88:91], v[92:95], v[32:47]
  ds_read_b128 v[56:59], v156 offset:10240
  ds_read_b64_tr_b16 v[60:61], v167 offset:18432
  ds_read_b64_tr_b16 v[62:63], v167 offset:18944
  s_waitcnt lgkmcnt(9)
  v_mfma_f32_32x32x16_f16 v[32:47], v[96:99], v[100:103], v[32:47]
  ds_read_b128 v[64:67], v156 offset:12288
  ds_read_b64_tr_b16 v[68:69], v167 offset:20480
  ds_read_b64_tr_b16 v[70:71], v167 offset:20992
  s_waitcnt lgkmcnt(9)
  v_mfma_f32_32x32x16_f16 v[32:47], v[104:107], v[108:111], v[32:47]
  ds_read_b128 v[72:75], v156 offset:14336
  ds_read_b64_tr_b16 v[76:77], v167 offset:22528
  ds_read_b64_tr_b16 v[78:79], v167 offset:23040
  s_barrier
  s_waitcnt lgkmcnt(9)
  v_mfma_f32_32x32x16_f16 v[32:47], v[48:51], v[52:55], v[32:47]
  ds_read_b128 v[80:83], v156 offset:16384
  ds_read_b64_tr_b16 v[84:85], v167 offset:24576
  ds_read_b64_tr_b16 v[86:87], v167 offset:25088
  s_waitcnt lgkmcnt(9)
  v_mfma_f32_32x32x16_f16 v[32:47], v[56:59], v[60:63], v[32:47]
  ds_read_b128 v[88:91], v156 offset:18432
  ds_read_b64_tr_b16 v[92:93], v167 offset:26624
  ds_read_b64_tr_b16 v[94:95], v167 offset:27136
  s_waitcnt lgkmcnt(9)
  v_mfma_f32_32x32x16_f16 v[32:47], v[64:67], v[68:71], v[32:47]
  ds_read_b128 v[96:99], v156 offset:20480
  ds_read_b64_tr_b16 v[100:101], v167 offset:28672
  ds_read_b64_tr_b16 v[102:103], v167 offset:29184
  s_waitcnt lgkmcnt(9)
  v_mfma_f32_32x32x16_f16 v[32:47], v[72:75], v[76:79], v[32:47]
  ds_read_b128 v[104:107], v156 offset:22528
  ds_read_b64_tr_b16 v[108:109], v167 offset:30720
  ds_read_b64_tr_b16 v[110:111], v167 offset:31232
  s_barrier
  s_waitcnt lgkmcnt(9)
  v_mfma_f32_32x32x16_f16 v[32:47], v[80:83], v[84:87], v[32:47]
  ds_read_b128 v[48:51], v156 offset:24576
  ds_read_b64_tr_b16 v[52:53], v7 offset:16384
  ds_read_b64_tr_b16 v[54:55], v7 offset:16896
  s_waitcnt lgkmcnt(9)
  v_mfma_f32_32x32x16_f16 v[32:47], v[88:91], v[92:95], v[32:47]
  ds_read_b128 v[56:59], v156 offset:26624
  ds_read_b64_tr_b16 v[60:61], v7 offset:18432
  ds_read_b64_tr_b16 v[62:63], v7 offset:18944
  s_waitcnt lgkmcnt(9)
  v_mfma_f32_32x32x16_f16 v[32:47], v[96:99], v[100:103], v[32:47]
  ds_read_b128 v[64:67], v156 offset:28672
  ds_read_b64_tr_b16 v[68:69], v7 offset:20480
  ds_read_b64_tr_b16 v[70:71], v7 offset:20992
  s_waitcnt lgkmcnt(9)
  v_mfma_f32_32x32x16_f16 v[32:47], v[104:107], v[108:111], v[32:47]
  ds_read_b128 v[72:75], v156 offset:30720
  ds_read_b64_tr_b16 v[76:77], v7 offset:22528
  ds_read_b64_tr_b16 v[78:79], v7 offset:23040
  s_barrier
  s_waitcnt lgkmcnt(9)
  v_mfma_f32_32x32x16_f16 v[32:47], v[48:51], v[52:55], v[32:47]
  ds_read_b128 v[80:83], v166 offset:0
  ds_read_b64_tr_b16 v[84:85], v157 offset:40960
  ds_read_b64_tr_b16 v[86:87], v157 offset:41472
  s_waitcnt lgkmcnt(9)
  v_mfma_f32_32x32x16_f16 v[32:47], v[56:59], v[60:63], v[32:47]
  ds_read_b128 v[88:91], v166 offset:2048
  ds_read_b64_tr_b16 v[92:93], v157 offset:43008
  ds_read_b64_tr_b16 v[94:95], v157 offset:43520
  s_waitcnt lgkmcnt(9)
  v_mfma_f32_32x32x16_f16 v[32:47], v[64:67], v[68:71], v[32:47]
  ds_read_b128 v[96:99], v166 offset:4096
  ds_read_b64_tr_b16 v[100:101], v157 offset:45056
  ds_read_b64_tr_b16 v[102:103], v157 offset:45568
  s_waitcnt lgkmcnt(9)
  v_mfma_f32_32x32x16_f16 v[32:47], v[72:75], v[76:79], v[32:47]
  ds_read_b128 v[104:107], v166 offset:6144
  ds_read_b64_tr_b16 v[108:109], v157 offset:47104
  ds_read_b64_tr_b16 v[110:111], v157 offset:47616
  s_barrier
  s_waitcnt lgkmcnt(9)
  v_mfma_f32_32x32x16_f16 v[32:47], v[80:83], v[84:87], v[32:47]
  ds_read_b128 v[48:51], v6 offset:8192
  ds_read_b64_tr_b16 v[52:53], v7 offset:49152
  ds_read_b64_tr_b16 v[54:55], v7 offset:49664
  s_waitcnt lgkmcnt(9)
  v_mfma_f32_32x32x16_f16 v[32:47], v[88:91], v[92:95], v[32:47]
  ds_read_b128 v[56:59], v6 offset:10240
  ds_read_b64_tr_b16 v[60:61], v7 offset:51200
  ds_read_b64_tr_b16 v[62:63], v7 offset:51712
  s_waitcnt lgkmcnt(9)
  v_mfma_f32_32x32x16_f16 v[32:47], v[96:99], v[100:103], v[32:47]
  ds_read_b128 v[64:67], v6 offset:12288
  ds_read_b64_tr_b16 v[68:69], v7 offset:53248
  ds_read_b64_tr_b16 v[70:71], v7 offset:53760
  s_waitcnt lgkmcnt(9)
  v_mfma_f32_32x32x16_f16 v[32:47], v[104:107], v[108:111], v[32:47]
  ds_read_b128 v[72:75], v6 offset:14336
  ds_read_b64_tr_b16 v[76:77], v7 offset:55296
  ds_read_b64_tr_b16 v[78:79], v7 offset:55808
  s_waitcnt lgkmcnt(9)
  v_mfma_f32_32x32x16_f16 v[32:47], v[48:51], v[52:55], v[32:47]
  s_waitcnt lgkmcnt(6)
  v_mfma_f32_32x32x16_f16 v[32:47], v[56:59], v[60:63], v[32:47]
  s_waitcnt lgkmcnt(3)
  v_mfma_f32_32x32x16_f16 v[32:47], v[64:67], v[68:71], v[32:47]
  s_waitcnt lgkmcnt(0)
  v_mfma_f32_32x32x16_f16 v[32:47], v[72:75], v[76:79], v[32:47]
  s_waitcnt vmcnt(0)
  v_rcp_f32 v9, v9
  s_nop 0
  v_mul_f32 v9, 0x3c124925, v9
  v_permlane32_swap_b32 v128, v130
  v_permlane32_swap_b32 v129, v131
  v_permlane32_swap_b32 v132, v134
  v_permlane32_swap_b32 v133, v135
  v_lshlrev_b32 v192, 16, v128
  v_and_b32 v193, 0xffff0000, v128
  v_lshlrev_b32 v194, 16, v129
  v_and_b32 v195, 0xffff0000, v129
  v_lshlrev_b32 v196, 16, v130
  v_and_b32 v197, 0xffff0000, v130
  v_lshlrev_b32 v198, 16, v131
  v_and_b32 v199, 0xffff0000, v131
  v_lshlrev_b32 v200, 16, v132
  v_and_b32 v201, 0xffff0000, v132
  v_lshlrev_b32 v202, 16, v133
  v_and_b32 v203, 0xffff0000, v133
  v_lshlrev_b32 v204, 16, v134
  v_and_b32 v205, 0xffff0000, v134
  v_lshlrev_b32 v206, 16, v135
  v_and_b32 v207, 0xffff0000, v135
  v_mov_b32 v208, 0xbfb8aa3b
  v_mov_b32 v209, 0xbfb8aa3b
  v_mov_b32 v210, 1.0
  v_mov_b32 v211, 1.0
  v_mul_f32 v176, v32, v9
  v_mul_f32 v177, v33, v9
  v_mul_f32 v178, v34, v9
  v_mul_f32 v179, v35, v9
  v_mul_f32 v180, v36, v9
  v_mul_f32 v181, v37, v9
  v_mul_f32 v182, v38, v9
  v_mul_f32 v183, v39, v9
  v_mul_f32 v184, v40, v9
  v_mul_f32 v185, v41, v9
  v_mul_f32 v186, v42, v9
  v_mul_f32 v187, v43, v9
  v_mul_f32 v188, v44, v9
  v_mul_f32 v189, v45, v9
  v_mul_f32 v190, v46, v9
  v_mul_f32 v191, v47, v9
  v_cvt_pk_bf16_f32 v128, v176, v177
  v_cvt_pk_bf16_f32 v129, v178, v179
  v_cvt_pk_bf16_f32 v130, v180, v181
  v_cvt_pk_bf16_f32 v131, v182, v183
  v_cvt_pk_bf16_f32 v132, v184, v185
  v_cvt_pk_bf16_f32 v133, v186, v187
  v_cvt_pk_bf16_f32 v134, v188, v189
  v_cvt_pk_bf16_f32 v135, v190, v191
  v_lshlrev_b32 v176, 16, v128
  v_and_b32 v177, 0xffff0000, v128
  v_lshlrev_b32 v178, 16, v129
  v_and_b32 v179, 0xffff0000, v129
  v_lshlrev_b32 v180, 16, v130
  v_and_b32 v181, 0xffff0000, v130
  v_lshlrev_b32 v182, 16, v131
  v_and_b32 v183, 0xffff0000, v131
  v_lshlrev_b32 v184, 16, v132
  v_and_b32 v185, 0xffff0000, v132
  v_lshlrev_b32 v186, 16, v133
  v_and_b32 v187, 0xffff0000, v133
  v_lshlrev_b32 v188, 16, v134
  v_and_b32 v189, 0xffff0000, v134
  v_lshlrev_b32 v190, 16, v135
  v_and_b32 v191, 0xffff0000, v135
  s_barrier
  ds_read_b64_tr_b16 v[80:81], v1 offset:32768
  ds_read_b64_tr_b16 v[82:83], v1 offset:33280
  ds_read_b128 v[84:87], v152 offset:16384
  ds_read_b64_tr_b16 v[88:89], v1 offset:34816
  ds_read_b64_tr_b16 v[90:91], v1 offset:35328
  ds_read_b128 v[92:95], v153 offset:16384
  ds_read_b64_tr_b16 v[96:97], v1 offset:36864
  ds_read_b64_tr_b16 v[98:99], v1 offset:37376
  ds_read_b128 v[100:103], v154 offset:16384
  ds_read_b64_tr_b16 v[104:105], v1 offset:38912
  ds_read_b64_tr_b16 v[106:107], v1 offset:39424
  ds_read_b128 v[108:111], v155 offset:16384
  s_waitcnt lgkmcnt(9)
  v_mfma_f32_32x32x16_bf16 v[16:31], v[80:83], v[84:87], 0
  ds_read_b64_tr_b16 v[48:49], v1 offset:40960
  ds_read_b64_tr_b16 v[50:51], v1 offset:41472
  ds_read_b128 v[52:55], v162 offset:24576
  s_waitcnt lgkmcnt(9)
  v_mfma_f32_32x32x16_bf16 v[16:31], v[88:91], v[92:95], v[16:31]
  ds_read_b64_tr_b16 v[56:57], v1 offset:43008
  ds_read_b64_tr_b16 v[58:59], v1 offset:43520
  ds_read_b128 v[60:63], v163 offset:24576
  s_waitcnt lgkmcnt(9)
  v_mfma_f32_32x32x16_bf16 v[16:31], v[96:99], v[100:103], v[16:31]
  ds_read_b64_tr_b16 v[64:65], v1 offset:45056
  ds_read_b64_tr_b16 v[66:67], v1 offset:45568
  ds_read_b128 v[68:71], v164 offset:24576
  s_waitcnt lgkmcnt(9)
  v_mfma_f32_32x32x16_bf16 v[16:31], v[104:107], v[108:111], v[16:31]
  ds_read_b64_tr_b16 v[72:73], v1 offset:47104
  ds_read_b64_tr_b16 v[74:75], v1 offset:47616
  ds_read_b128 v[76:79], v165 offset:24576
  s_barrier
  s_waitcnt lgkmcnt(9)
  v_mfma_f32_32x32x16_bf16 v[16:31], v[48:51], v[52:55], v[16:31]
  ds_read_b64_tr_b16 v[80:81], v1 offset:24576
  ds_read_b64_tr_b16 v[82:83], v1 offset:25088
  ds_read_b128 v[84:87], v152 offset:24576
  s_waitcnt lgkmcnt(9)
  v_mfma_f32_32x32x16_bf16 v[16:31], v[56:59], v[60:63], v[16:31]
  ds_read_b64_tr_b16 v[88:89], v1 offset:26624
  ds_read_b64_tr_b16 v[90:91], v1 offset:27136
  ds_read_b128 v[92:95], v153 offset:24576
  s_waitcnt lgkmcnt(9)
  v_mfma_f32_32x32x16_bf16 v[16:31], v[64:67], v[68:71], v[16:31]
  ds_read_b64_tr_b16 v[96:97], v1 offset:28672
  ds_read_b64_tr_b16 v[98:99], v1 offset:29184
  ds_read_b128 v[100:103], v154 offset:24576
  s_waitcnt lgkmcnt(9)
  v_mfma_f32_32x32x16_bf16 v[16:31], v[72:75], v[76:79], v[16:31]
  ds_read_b64_tr_b16 v[104:105], v1 offset:30720
  ds_read_b64_tr_b16 v[106:107], v1 offset:31232
  ds_read_b128 v[108:111], v155 offset:24576
  s_waitcnt lgkmcnt(9)
  v_mfma_f32_32x32x16_bf16 v[16:31], v[80:83], v[84:87], v[16:31]
  ds_read_b64_tr_b16 v[48:49], v151 offset:32768
  ds_read_b64_tr_b16 v[50:51], v151 offset:33280
  ds_read_b128 v[52:55], v2 offset:16384
  s_waitcnt lgkmcnt(9)
  v_mfma_f32_32x32x16_bf16 v[16:31], v[88:91], v[92:95], v[16:31]
  ds_read_b64_tr_b16 v[56:57], v151 offset:34816
  ds_read_b64_tr_b16 v[58:59], v151 offset:35328
  ds_read_b128 v[60:63], v3 offset:16384
  s_waitcnt lgkmcnt(9)
  v_mfma_f32_32x32x16_bf16 v[16:31], v[96:99], v[100:103], v[16:31]
  ds_read_b64_tr_b16 v[64:65], v151 offset:36864
  ds_read_b64_tr_b16 v[66:67], v151 offset:37376
  ds_read_b128 v[68:71], v4 offset:16384
  s_waitcnt lgkmcnt(9)
  v_mfma_f32_32x32x16_bf16 v[16:31], v[104:107], v[108:111], v[16:31]
  ds_read_b64_tr_b16 v[72:73], v151 offset:38912
  ds_read_b64_tr_b16 v[74:75], v151 offset:39424
  ds_read_b128 v[76:79], v5 offset:16384
  s_barrier
  s_waitcnt lgkmcnt(9)
  v_mfma_f32_32x32x16_bf16 v[16:31], v[48:51], v[52:55], v[16:31]
  ds_read_b64_tr_b16 v[80:81], v151 offset:49152
  ds_read_b64_tr_b16 v[82:83], v151 offset:49664
  ds_read_b128 v[84:87], v152 offset:40960
  s_waitcnt lgkmcnt(9)
  v_mfma_f32_32x32x16_bf16 v[16:31], v[56:59], v[60:63], v[16:31]
  ds_read_b64_tr_b16 v[88:89], v151 offset:51200
  ds_read_b64_tr_b16 v[90:91], v151 offset:51712
  ds_read_b128 v[92:95], v153 offset:40960
  s_waitcnt lgkmcnt(9)
  v_mfma_f32_32x32x16_bf16 v[16:31], v[64:67], v[68:71], v[16:31]
  ds_read_b64_tr_b16 v[96:97], v151 offset:53248
  ds_read_b64_tr_b16 v[98:99], v151 offset:53760
  ds_read_b128 v[100:103], v154 offset:40960
  s_waitcnt lgkmcnt(9)
  v_mfma_f32_32x32x16_bf16 v[16:31], v[72:75], v[76:79], v[16:31]
  ds_read_b64_tr_b16 v[104:105], v151 offset:55296
  ds_read_b64_tr_b16 v[106:107], v151 offset:55808
  ds_read_b128 v[108:111], v155 offset:40960
  s_waitcnt lgkmcnt(9)
  v_mfma_f32_32x32x16_bf16 v[16:31], v[80:83], v[84:87], v[16:31]
  ds_read_b64_tr_b16 v[48:49], v151 offset:57344
  ds_read_b64_tr_b16 v[50:51], v151 offset:57856
  ds_read_b128 v[52:55], v162 offset:0
  s_waitcnt lgkmcnt(9)
  v_mfma_f32_32x32x16_bf16 v[16:31], v[88:91], v[92:95], v[16:31]
  ds_read_b64_tr_b16 v[56:57], v151 offset:59392
  ds_read_b64_tr_b16 v[58:59], v151 offset:59904
  ds_read_b128 v[60:63], v163 offset:0
  s_waitcnt lgkmcnt(9)
  v_mfma_f32_32x32x16_bf16 v[16:31], v[96:99], v[100:103], v[16:31]
  ds_read_b64_tr_b16 v[64:65], v151 offset:61440
  ds_read_b64_tr_b16 v[66:67], v151 offset:61952
  ds_read_b128 v[68:71], v164 offset:0
  s_waitcnt lgkmcnt(9)
  v_mfma_f32_32x32x16_bf16 v[16:31], v[104:107], v[108:111], v[16:31]
  ds_read_b64_tr_b16 v[72:73], v151 offset:63488
  ds_read_b64_tr_b16 v[74:75], v151 offset:64000
  ds_read_b128 v[76:79], v165 offset:0
  s_barrier
  s_waitcnt lgkmcnt(9)
  v_mfma_f32_32x32x16_bf16 v[16:31], v[48:51], v[52:55], v[16:31]
  ds_read_b64_tr_b16 v[80:81], v161 offset:8192
  ds_read_b64_tr_b16 v[82:83], v161 offset:8704
  ds_read_b128 v[84:87], v2 offset:49152
  s_waitcnt lgkmcnt(9)
  v_mfma_f32_32x32x16_bf16 v[16:31], v[56:59], v[60:63], v[16:31]
  ds_read_b64_tr_b16 v[88:89], v161 offset:10240
  ds_read_b64_tr_b16 v[90:91], v161 offset:10752
  ds_read_b128 v[92:95], v3 offset:49152
  s_waitcnt lgkmcnt(9)
  v_mfma_f32_32x32x16_bf16 v[16:31], v[64:67], v[68:71], v[16:31]
  ds_read_b64_tr_b16 v[96:97], v161 offset:12288
  ds_read_b64_tr_b16 v[98:99], v161 offset:12800
  ds_read_b128 v[100:103], v4 offset:49152
  s_waitcnt lgkmcnt(9)
  v_mfma_f32_32x32x16_bf16 v[16:31], v[72:75], v[76:79], v[16:31]
  ds_read_b64_tr_b16 v[104:105], v161 offset:14336
  ds_read_b64_tr_b16 v[106:107], v161 offset:14848
  ds_read_b128 v[108:111], v5 offset:49152
  s_waitcnt lgkmcnt(9)
  v_mfma_f32_32x32x16_bf16 v[16:31], v[80:83], v[84:87], v[16:31]
  ds_read_b64_tr_b16 v[48:49], v151 offset:0
  ds_read_b64_tr_b16 v[50:51], v151 offset:512
  ds_read_b128 v[52:55], v152 offset:16384
  s_waitcnt lgkmcnt(9)
  v_mfma_f32_32x32x16_bf16 v[16:31], v[88:91], v[92:95], v[16:31]
  ds_read_b64_tr_b16 v[56:57], v151 offset:2048
  ds_read_b64_tr_b16 v[58:59], v151 offset:2560
  ds_read_b128 v[60:63], v153 offset:16384
  s_waitcnt lgkmcnt(9)
  v_mfma_f32_32x32x16_bf16 v[16:31], v[96:99], v[100:103], v[16:31]
  ds_read_b64_tr_b16 v[64:65], v151 offset:4096
  ds_read_b64_tr_b16 v[66:67], v151 offset:4608
  ds_read_b128 v[68:71], v154 offset:16384
  s_waitcnt lgkmcnt(9)
  v_mfma_f32_32x32x16_bf16 v[16:31], v[104:107], v[108:111], v[16:31]
  ds_read_b64_tr_b16 v[72:73], v151 offset:6144
  ds_read_b64_tr_b16 v[74:75], v151 offset:6656
  ds_read_b128 v[76:79], v155 offset:16384
  s_barrier
  s_waitcnt lgkmcnt(9)
  v_mfma_f32_32x32x16_bf16 v[16:31], v[48:51], v[52:55], v[16:31]
  ds_read_b64_tr_b16 v[80:81], v1 offset:0
  ds_read_b64_tr_b16 v[82:83], v1 offset:512
  ds_read_b128 v[84:87], v152 offset:24576
  s_waitcnt lgkmcnt(9)
  v_mfma_f32_32x32x16_bf16 v[16:31], v[56:59], v[60:63], v[16:31]
  ds_read_b64_tr_b16 v[88:89], v1 offset:2048
  ds_read_b64_tr_b16 v[90:91], v1 offset:2560
  ds_read_b128 v[92:95], v153 offset:24576
  s_waitcnt lgkmcnt(9)
  v_mfma_f32_32x32x16_bf16 v[16:31], v[64:67], v[68:71], v[16:31]
  ds_read_b64_tr_b16 v[96:97], v1 offset:4096
  ds_read_b64_tr_b16 v[98:99], v1 offset:4608
  ds_read_b128 v[100:103], v154 offset:24576
  s_waitcnt lgkmcnt(9)
  v_mfma_f32_32x32x16_bf16 v[16:31], v[72:75], v[76:79], v[16:31]
  ds_read_b64_tr_b16 v[104:105], v1 offset:6144
  ds_read_b64_tr_b16 v[106:107], v1 offset:6656
  ds_read_b128 v[108:111], v155 offset:24576
  s_waitcnt lgkmcnt(9)
  v_mfma_f32_32x32x16_bf16 v[16:31], v[80:83], v[84:87], v[16:31]
  ds_read_b64_tr_b16 v[48:49], v151 offset:8192
  ds_read_b64_tr_b16 v[50:51], v151 offset:8704
  ds_read_b128 v[52:55], v2 offset:24576
  s_waitcnt lgkmcnt(9)
  v_mfma_f32_32x32x16_bf16 v[16:31], v[88:91], v[92:95], v[16:31]
  ds_read_b64_tr_b16 v[56:57], v151 offset:10240
  ds_read_b64_tr_b16 v[58:59], v151 offset:10752
  ds_read_b128 v[60:63], v3 offset:24576
  s_waitcnt lgkmcnt(9)
  v_mfma_f32_32x32x16_bf16 v[16:31], v[96:99], v[100:103], v[16:31]
  ds_read_b64_tr_b16 v[64:65], v151 offset:12288
  ds_read_b64_tr_b16 v[66:67], v151 offset:12800
  ds_read_b128 v[68:71], v4 offset:24576
  s_waitcnt lgkmcnt(9)
  v_mfma_f32_32x32x16_bf16 v[16:31], v[104:107], v[108:111], v[16:31]
  ds_read_b64_tr_b16 v[72:73], v151 offset:14336
  ds_read_b64_tr_b16 v[74:75], v151 offset:14848
  ds_read_b128 v[76:79], v5 offset:24576
  s_barrier
  s_waitcnt lgkmcnt(9)
  v_mfma_f32_32x32x16_bf16 v[16:31], v[48:51], v[52:55], v[16:31]
  ds_read_b64_tr_b16 v[80:81], v161 offset:16384
  ds_read_b64_tr_b16 v[82:83], v161 offset:16896
  ds_read_b128 v[84:87], v2 offset:40960
  s_waitcnt lgkmcnt(9)
  v_mfma_f32_32x32x16_bf16 v[16:31], v[56:59], v[60:63], v[16:31]
  ds_read_b64_tr_b16 v[88:89], v161 offset:18432
  ds_read_b64_tr_b16 v[90:91], v161 offset:18944
  ds_read_b128 v[92:95], v3 offset:40960
  s_waitcnt lgkmcnt(9)
  v_mfma_f32_32x32x16_bf16 v[16:31], v[64:67], v[68:71], v[16:31]
  ds_read_b64_tr_b16 v[96:97], v161 offset:20480
  ds_read_b64_tr_b16 v[98:99], v161 offset:20992
  ds_read_b128 v[100:103], v4 offset:40960
  s_waitcnt lgkmcnt(9)
  v_mfma_f32_32x32x16_bf16 v[16:31], v[72:75], v[76:79], v[16:31]
  ds_read_b64_tr_b16 v[104:105], v161 offset:22528
  ds_read_b64_tr_b16 v[106:107], v161 offset:23040
  ds_read_b128 v[108:111], v5 offset:40960
  s_waitcnt lgkmcnt(9)
  v_mfma_f32_32x32x16_bf16 v[16:31], v[80:83], v[84:87], v[16:31]
  ds_read_b64_tr_b16 v[48:49], v1 offset:8192
  ds_read_b64_tr_b16 v[50:51], v1 offset:8704
  ds_read_b128 v[52:55], v2 offset:16384
  s_waitcnt lgkmcnt(9)
  v_mfma_f32_32x32x16_bf16 v[16:31], v[88:91], v[92:95], v[16:31]
  ds_read_b64_tr_b16 v[56:57], v1 offset:10240
  ds_read_b64_tr_b16 v[58:59], v1 offset:10752
  ds_read_b128 v[60:63], v3 offset:16384
  s_waitcnt lgkmcnt(9)
  v_mfma_f32_32x32x16_bf16 v[16:31], v[96:99], v[100:103], v[16:31]
  ds_read_b64_tr_b16 v[64:65], v1 offset:12288
  ds_read_b64_tr_b16 v[66:67], v1 offset:12800
  ds_read_b128 v[68:71], v4 offset:16384
  s_waitcnt lgkmcnt(9)
  v_mfma_f32_32x32x16_bf16 v[16:31], v[104:107], v[108:111], v[16:31]
  ds_read_b64_tr_b16 v[72:73], v1 offset:14336
  ds_read_b64_tr_b16 v[74:75], v1 offset:14848
  ds_read_b128 v[76:79], v5 offset:16384
  s_barrier
  s_waitcnt lgkmcnt(9)
  v_mfma_f32_32x32x16_bf16 v[16:31], v[48:51], v[52:55], v[16:31]
  ds_read_b64_tr_b16 v[80:81], v1 offset:32768
  ds_read_b64_tr_b16 v[82:83], v1 offset:33280
  ds_read_b128 v[84:87], v152 offset:32768
  s_waitcnt lgkmcnt(9)
  v_mfma_f32_32x32x16_bf16 v[16:31], v[56:59], v[60:63], v[16:31]
  ds_read_b64_tr_b16 v[88:89], v1 offset:34816
  ds_read_b64_tr_b16 v[90:91], v1 offset:35328
  ds_read_b128 v[92:95], v153 offset:32768
  s_waitcnt lgkmcnt(9)
  v_mfma_f32_32x32x16_bf16 v[16:31], v[64:67], v[68:71], v[16:31]
  ds_read_b64_tr_b16 v[96:97], v1 offset:36864
  ds_read_b64_tr_b16 v[98:99], v1 offset:37376
  ds_read_b128 v[100:103], v154 offset:32768
  s_waitcnt lgkmcnt(9)
  v_mfma_f32_32x32x16_bf16 v[16:31], v[72:75], v[76:79], v[16:31]
  ds_read_b64_tr_b16 v[104:105], v1 offset:38912
  ds_read_b64_tr_b16 v[106:107], v1 offset:39424
  ds_read_b128 v[108:111], v155 offset:32768
  s_waitcnt lgkmcnt(9)
  v_mfma_f32_32x32x16_bf16 v[16:31], v[80:83], v[84:87], v[16:31]
  ds_read_b64_tr_b16 v[48:49], v161 offset:24576
  ds_read_b64_tr_b16 v[50:51], v161 offset:25088
  ds_read_b128 v[52:55], v152 offset:40960
  s_waitcnt lgkmcnt(9)
  v_mfma_f32_32x32x16_bf16 v[16:31], v[88:91], v[92:95], v[16:31]
  ds_read_b64_tr_b16 v[56:57], v161 offset:26624
  ds_read_b64_tr_b16 v[58:59], v161 offset:27136
  ds_read_b128 v[60:63], v153 offset:40960
  s_waitcnt lgkmcnt(9)
  v_mfma_f32_32x32x16_bf16 v[16:31], v[96:99], v[100:103], v[16:31]
  ds_read_b64_tr_b16 v[64:65], v161 offset:28672
  ds_read_b64_tr_b16 v[66:67], v161 offset:29184
  ds_read_b128 v[68:71], v154 offset:40960
  s_waitcnt lgkmcnt(9)
  v_mfma_f32_32x32x16_bf16 v[16:31], v[104:107], v[108:111], v[16:31]
  ds_read_b64_tr_b16 v[72:73], v161 offset:30720
  ds_read_b64_tr_b16 v[74:75], v161 offset:31232
  ds_read_b128 v[76:79], v155 offset:40960
  s_waitcnt lgkmcnt(9)
  v_mfma_f32_32x32x16_bf16 v[16:31], v[48:51], v[52:55], v[16:31]
  s_waitcnt lgkmcnt(6)
  v_mfma_f32_32x32x16_bf16 v[16:31], v[56:59], v[60:63], v[16:31]
  s_waitcnt lgkmcnt(3)
  v_mfma_f32_32x32x16_bf16 v[16:31], v[64:67], v[68:71], v[16:31]
  s_waitcnt lgkmcnt(0)
  v_mfma_f32_32x32x16_bf16 v[16:31], v[72:75], v[76:79], v[16:31]
  s_nop 11
  v_cvt_pk_bf16_f32 v80, v16, v17
  v_cvt_pk_bf16_f32 v81, v18, v19
  v_cvt_pk_bf16_f32 v82, v20, v21
  v_cvt_pk_bf16_f32 v83, v22, v23
  v_cvt_pk_bf16_f32 v84, v24, v25
  v_cvt_pk_bf16_f32 v85, v26, v27
  v_cvt_pk_bf16_f32 v86, v28, v29
  v_cvt_pk_bf16_f32 v87, v30, v31
  v_lshlrev_b32 v48, 16, v80
  v_and_b32 v49, 0xffff0000, v80
  v_lshlrev_b32 v50, 16, v81
  v_and_b32 v51, 0xffff0000, v81
  v_lshlrev_b32 v52, 16, v82
  v_and_b32 v53, 0xffff0000, v82
  v_lshlrev_b32 v54, 16, v83
  v_and_b32 v55, 0xffff0000, v83
  v_lshlrev_b32 v56, 16, v84
  v_and_b32 v57, 0xffff0000, v84
  v_lshlrev_b32 v58, 16, v85
  v_and_b32 v59, 0xffff0000, v85
  v_lshlrev_b32 v60, 16, v86
  v_and_b32 v61, 0xffff0000, v86
  v_lshlrev_b32 v62, 16, v87
  v_and_b32 v63, 0xffff0000, v87
  v_pk_mul_f32 v[80:81], v[48:49], v[208:209]
  v_pk_mul_f32 v[82:83], v[50:51], v[208:209]
  v_pk_mul_f32 v[84:85], v[52:53], v[208:209]
  v_pk_mul_f32 v[86:87], v[54:55], v[208:209]
  v_pk_mul_f32 v[88:89], v[56:57], v[208:209]
  v_pk_mul_f32 v[90:91], v[58:59], v[208:209]
  v_pk_mul_f32 v[92:93], v[60:61], v[208:209]
  v_pk_mul_f32 v[94:95], v[62:63], v[208:209]
  v_exp_f32 v80, v80
  v_exp_f32 v81, v81
  v_exp_f32 v82, v82
  v_exp_f32 v83, v83
  v_exp_f32 v84, v84
  v_exp_f32 v85, v85
  v_exp_f32 v86, v86
  v_exp_f32 v87, v87
  v_exp_f32 v88, v88
  v_exp_f32 v89, v89
  v_exp_f32 v90, v90
  v_exp_f32 v91, v91
  v_exp_f32 v92, v92
  v_exp_f32 v93, v93
  v_exp_f32 v94, v94
  v_exp_f32 v95, v95
  v_pk_add_f32 v[80:81], v[80:81], v[210:211]
  v_pk_add_f32 v[82:83], v[82:83], v[210:211]
  v_pk_add_f32 v[84:85], v[84:85], v[210:211]
  v_pk_add_f32 v[86:87], v[86:87], v[210:211]
  v_pk_add_f32 v[88:89], v[88:89], v[210:211]
  v_pk_add_f32 v[90:91], v[90:91], v[210:211]
  v_pk_add_f32 v[92:93], v[92:93], v[210:211]
  v_pk_add_f32 v[94:95], v[94:95], v[210:211]
  v_rcp_f32 v80, v80
  v_rcp_f32 v81, v81
  v_rcp_f32 v82, v82
  v_rcp_f32 v83, v83
  v_rcp_f32 v84, v84
  v_rcp_f32 v85, v85
  v_rcp_f32 v86, v86
  v_rcp_f32 v87, v87
  v_rcp_f32 v88, v88
  v_rcp_f32 v89, v89
  v_rcp_f32 v90, v90
  v_rcp_f32 v91, v91
  v_rcp_f32 v92, v92
  v_rcp_f32 v93, v93
  v_rcp_f32 v94, v94
  v_rcp_f32 v95, v95
  v_pk_mul_f32 v[48:49], v[48:49], v[80:81]
  v_pk_mul_f32 v[50:51], v[50:51], v[82:83]
  v_pk_mul_f32 v[52:53], v[52:53], v[84:85]
  v_pk_mul_f32 v[54:55], v[54:55], v[86:87]
  v_pk_mul_f32 v[56:57], v[56:57], v[88:89]
  v_pk_mul_f32 v[58:59], v[58:59], v[90:91]
  v_pk_mul_f32 v[60:61], v[60:61], v[92:93]
  v_pk_mul_f32 v[62:63], v[62:63], v[94:95]
  v_pk_fma_f32 v[48:49], v[48:49], v[176:177], v[192:193]
  v_pk_fma_f32 v[50:51], v[50:51], v[178:179], v[194:195]
  v_pk_fma_f32 v[52:53], v[52:53], v[180:181], v[196:197]
  v_pk_fma_f32 v[54:55], v[54:55], v[182:183], v[198:199]
  v_pk_fma_f32 v[56:57], v[56:57], v[184:185], v[200:201]
  v_pk_fma_f32 v[58:59], v[58:59], v[186:187], v[202:203]
  v_pk_fma_f32 v[60:61], v[60:61], v[188:189], v[204:205]
  v_pk_fma_f32 v[62:63], v[62:63], v[190:191], v[206:207]
  v_cvt_pk_bf16_f32 v80, v48, v49
  v_cvt_pk_bf16_f32 v81, v50, v51
  v_cvt_pk_bf16_f32 v82, v52, v53
  v_cvt_pk_bf16_f32 v83, v54, v55
  v_cvt_pk_bf16_f32 v84, v56, v57
  v_cvt_pk_bf16_f32 v85, v58, v59
  v_cvt_pk_bf16_f32 v86, v60, v61
  v_cvt_pk_bf16_f32 v87, v62, v63
  v_permlane32_swap_b32 v80, v82
  v_permlane32_swap_b32 v81, v83
  buffer_store_dwordx4 v[80:83], v8, s[80:83], 0 offen offset:0
  v_permlane32_swap_b32 v84, v86
  v_permlane32_swap_b32 v85, v87
  buffer_store_dwordx4 v[84:87], v8, s[80:83], 0 offen offset:32
  s_endpgm
MK_side:
  s_sub_u32 s40, s2, 224
  s_lshl_b32 s40, s40, 3
  s_add_u32 s40, s40, s36
  s_mul_i32 s60, s40, 3072
  s_add_u32 s60, s60, 18874368
  v_lshlrev_b32 v4, 4, v0
  v_mov_b32 v8, -1
  v_mov_b32 v9, -1
  v_mov_b32 v10, -1
  v_mov_b32 v11, -1
  buffer_store_dwordx4 v[8:11], v4, s[24:27], s60 offen offset:0 sc1
  buffer_store_dwordx4 v[8:11], v4, s[24:27], s60 offen offset:1024 sc1
  buffer_store_dwordx4 v[8:11], v4, s[24:27], s60 offen offset:2048 sc1
  v_mov_b32 v4, 0
  v_mov_b32 v6, 140000
  ds_write_b32 v6, v4
  s_sub_u32 s60, s2, 224
  s_lshl_b32 s61, s60, 7
  s_lshl_b32 s14, s60, 3
  s_add_u32 s60, s61, 19468288
  s_add_u32 s61, s61, 19464192
  s_and_b32 s15, s2, 7
  s_lshl_b32 s15, s15, 8
  s_bfe_u32 s3, s2, 0x20003
  s_lshl_b32 s3, s3, 6
  s_add_u32 s15, s15, s3
  s_lshl_b32 s3, s36, 3
  s_add_u32 s15, s15, s3
  s_lshl_b32 s15, s15, 12
  v_lshlrev_b32 v3, 4, v0
  s_waitcnt vmcnt(0) lgkmcnt(0)
  s_barrier
  s_cmp_lg_u32 s36, 0
  s_cbranch_scc1 MK_snf_1
  v_mov_b32 v5, 1
  buffer_store_dword v5, v4, s[32:35], s14 offen sc1
MK_snf_1:
  s_mov_b32 s43, s61
  s_mov_b32 s60, s40
  s_lshr_b32 s61, s60, 4
  s_bfe_u32 s62, s60, 0x20002
  s_lshl_b32 s62, s62, 3
  s_and_b32 s63, s60, 3
  s_lshl_b32 s63, s63, 6
  v_add_u32 v128, s63, v0
  v_lshlrev_b32 v128, 1, v128
  s_lshl_b32 s8, s61, 7
  s_add_u32 s8, s8, s62
  s_mul_i32 s8, s8, 450
  s_add_u32 s88, s8, 0
  s_add_u32 s89, s8, 14400
  s_add_u32 s90, s8, 28800
  s_add_u32 s91, s8, 43200
  s_lshl_b32 s8, s61, 7
  s_and_b32 s9, s36, 3
  s_lshl_b32 s9, s9, 5
  s_add_u32 s8, s8, s9
  s_and_b32 s9, s2, 1
  s_lshl_b32 s9, s9, 4
  s_add_u32 s8, s8, s9
  s_mul_i32 s8, s8, 450
  s_add_u32 s9, s8, 4096
  s_lshl_b32 s10, s36, 13
  s_add_u32 s10, s10, 63488
  s_cmp_ge_u32 s36, 4
  s_cselect_b32 s4, s84, s4
  s_cselect_b32 s5, s85, s5
  s_add_u32 m0, s10, 0
  s_nop 0
  buffer_load_dwordx4 v3, s[4:7], s8 offen offset:0 lds
  buffer_load_dwordx4 v3, s[4:7], s8 offen offset:1024 lds
  buffer_load_dwordx4 v3, s[4:7], s8 offen offset:2048 lds
  buffer_load_dwordx4 v3, s[4:7], s8 offen offset:3072 lds
  s_add_u32 m0, s10, 4096
  s_nop 0
  buffer_load_dwordx4 v3, s[4:7], s9 offen offset:0 lds
  buffer_load_dwordx4 v3, s[4:7], s9 offen offset:1024 lds
  buffer_load_dwordx4 v3, s[4:7], s9 offen offset:2048 lds
  buffer_load_dwordx4 v3, s[4:7], s9 offen offset:3072 lds
  s_mov_b32 m0, 150000
  s_add_u32 s3, s15, 0
  buffer_load_dwordx4 v3, s[68:71], s3 offen lds
  s_add_u32 s3, s15, 4096
  buffer_load_dwordx4 v3, s[68:71], s3 offen lds
  s_add_u32 s3, s15, 8192
  buffer_load_dwordx4 v3, s[68:71], s3 offen lds
  s_add_u32 s3, s15, 12288
  buffer_load_dwordx4 v3, s[68:71], s3 offen lds
  s_add_u32 s3, s15, 16384
  buffer_load_dwordx4 v3, s[68:71], s3 offen lds
  s_add_u32 s3, s15, 20480
  buffer_load_dwordx4 v3, s[68:71], s3 offen lds
  s_add_u32 s3, s15, 24576
  buffer_load_dwordx4 v3, s[68:71], s3 offen lds
  s_add_u32 s3, s15, 28672
  buffer_load_dwordx4 v3, s[68:71], s3 offen lds
  s_waitcnt vmcnt(8)
  s_barrier
  s_lshr_b32 s8, s36, 2
  s_mul_i32 s8, s8, 3600
  s_add_u32 s8, s8, 63488
  v_add_u32 v128, s8, v128
  ds_read_u16 v64, v128 offset:0
  ds_read_u16 v96, v128 offset:32768
  ds_read_u16 v65, v128 offset:8192
  ds_read_u16 v97, v128 offset:40960
  ds_read_u16 v66, v128 offset:16384
  ds_read_u16 v98, v128 offset:49152
  ds_read_u16 v67, v128 offset:24576
  ds_read_u16 v99, v128 offset:57344
  ds_read_u16 v68, v128 offset:450
  ds_read_u16 v100, v128 offset:33218
  ds_read_u16 v69, v128 offset:8642
  ds_read_u16 v101, v128 offset:41410
  ds_read_u16 v70, v128 offset:16834
  ds_read_u16 v102, v128 offset:49602
  ds_read_u16 v71, v128 offset:25026
  ds_read_u16 v103, v128 offset:57794
  ds_read_u16 v72, v128 offset:900
  ds_read_u16 v104, v128 offset:33668
  ds_read_u16 v73, v128 offset:9092
  ds_read_u16 v105, v128 offset:41860
  ds_read_u16 v74, v128 offset:17284
  ds_read_u16 v106, v128 offset:50052
  ds_read_u16 v75, v128 offset:25476
  ds_read_u16 v107, v128 offset:58244
  ds_read_u16 v76, v128 offset:1350
  ds_read_u16 v108, v128 offset:34118
  ds_read_u16 v77, v128 offset:9542
  ds_read_u16 v109, v128 offset:42310
  ds_read_u16 v78, v128 offset:17734
  ds_read_u16 v110, v128 offset:50502
  ds_read_u16 v79, v128 offset:25926
  ds_read_u16 v111, v128 offset:58694
  ds_read_u16 v80, v128 offset:1800
  ds_read_u16 v112, v128 offset:34568
  ds_read_u16 v81, v128 offset:9992
  ds_read_u16 v113, v128 offset:42760
  ds_read_u16 v82, v128 offset:18184
  ds_read_u16 v114, v128 offset:50952
  ds_read_u16 v83, v128 offset:26376
  ds_read_u16 v115, v128 offset:59144
  ds_read_u16 v84, v128 offset:2250
  ds_read_u16 v116, v128 offset:35018
  ds_read_u16 v85, v128 offset:10442
  ds_read_u16 v117, v128 offset:43210
  ds_read_u16 v86, v128 offset:18634
  ds_read_u16 v118, v128 offset:51402
  ds_read_u16 v87, v128 offset:26826
  ds_read_u16 v119, v128 offset:59594
  ds_read_u16 v88, v128 offset:2700
  ds_read_u16 v120, v128 offset:35468
  ds_read_u16 v89, v128 offset:10892
  ds_read_u16 v121, v128 offset:43660
  ds_read_u16 v90, v128 offset:19084
  ds_read_u16 v122, v128 offset:51852
  ds_read_u16 v91, v128 offset:27276
  ds_read_u16 v123, v128 offset:60044
  ds_read_u16 v92, v128 offset:3150
  ds_read_u16 v124, v128 offset:35918
  ds_read_u16 v93, v128 offset:11342
  ds_read_u16 v125, v128 offset:44110
  ds_read_u16 v94, v128 offset:19534
  ds_read_u16 v126, v128 offset:52302
  ds_read_u16 v95, v128 offset:27726
  ds_read_u16 v127, v128 offset:60494
  s_mov_b32 m0, 150000
  s_add_u32 s3, s15, 1024
  buffer_load_dwordx4 v3, s[68:71], s3 offen lds
  s_add_u32 s3, s15, 5120
  buffer_load_dwordx4 v3, s[68:71], s3 offen lds
  s_add_u32 s3, s15, 9216
  buffer_load_dwordx4 v3, s[68:71], s3 offen lds
  s_add_u32 s3, s15, 13312
  buffer_load_dwordx4 v3, s[68:71], s3 offen lds
  s_add_u32 s3, s15, 17408
  buffer_load_dwordx4 v3, s[68:71], s3 offen lds
  s_add_u32 s3, s15, 21504
  buffer_load_dwordx4 v3, s[68:71], s3 offen lds
  s_add_u32 s3, s15, 25600
  buffer_load_dwordx4 v3, s[68:71], s3 offen lds
  s_add_u32 s3, s15, 29696
  buffer_load_dwordx4 v3, s[68:71], s3 offen lds
  s_waitcnt lgkmcnt(0)
  s_barrier
  s_lshl_b32 s48, s36, 10
  s_bfe_u32 s12, s2, 0x20003
  s_lshl_b32 s12, s12, 1
  s_add_u32 s13, s12, 0
  s_and_b32 s13, s13, 7
  s_lshl_b32 s13, s13, 13
  s_add_u32 s13, s13, s48
  s_mov_b32 m0, s13
  s_add_u32 s13, s13, 804864
  buffer_load_dwordx4 v3, s[28:31], s13 offen lds
  s_add_u32 s13, s12, 1
  s_and_b32 s13, s13, 7
  s_lshl_b32 s13, s13, 13
  s_add_u32 s13, s13, s48
  s_mov_b32 m0, s13
  s_add_u32 s13, s13, 804864
  buffer_load_dwordx4 v3, s[28:31], s13 offen lds
  s_add_u32 s13, s12, 2
  s_and_b32 s13, s13, 7
  s_lshl_b32 s13, s13, 13
  s_add_u32 s13, s13, s48
  s_mov_b32 m0, s13
  s_add_u32 s13, s13, 804864
  buffer_load_dwordx4 v3, s[28:31], s13 offen lds
  s_add_u32 s13, s12, 3
  s_and_b32 s13, s13, 7
  s_lshl_b32 s13, s13, 13
  s_add_u32 s13, s13, s48
  s_mov_b32 m0, s13
  s_add_u32 s13, s13, 804864
  buffer_load_dwordx4 v3, s[28:31], s13 offen lds
  s_add_u32 s13, s12, 4
  s_and_b32 s13, s13, 7
  s_lshl_b32 s13, s13, 13
  s_add_u32 s13, s13, s48
  s_mov_b32 m0, s13
  s_add_u32 s13, s13, 804864
  buffer_load_dwordx4 v3, s[28:31], s13 offen lds
  s_add_u32 s13, s12, 5
  s_and_b32 s13, s13, 7
  s_lshl_b32 s13, s13, 13
  s_add_u32 s13, s13, s48
  s_mov_b32 m0, s13
  s_add_u32 s13, s13, 804864
  buffer_load_dwordx4 v3, s[28:31], s13 offen lds
  s_add_u32 s13, s12, 6
  s_and_b32 s13, s13, 7
  s_lshl_b32 s13, s13, 13
  s_add_u32 s13, s13, s48
  s_mov_b32 m0, s13
  s_add_u32 s13, s13, 804864
  buffer_load_dwordx4 v3, s[28:31], s13 offen lds
  s_add_u32 s13, s12, 7
  s_and_b32 s13, s13, 7
  s_lshl_b32 s13, s13, 13
  s_add_u32 s13, s13, s48
  s_mov_b32 m0, s13
  s_add_u32 s13, s13, 804864
  buffer_load_dwordx4 v3, s[28:31], s13 offen lds
  v_lshlrev_b32 v1, 4, v0
  s_lshl_b32 s10, s61, 5
  s_add_u32 s10, s10, s62
  s_lshl_b32 s10, s10, 4
  s_add_u32 s10, s10, 10485760
  v_and_b32 v129, 15, v0
  v_add_u32 v129, s63, v129
  v_lshrrev_b32 v130, 4, v0
  v_lshlrev_b32 v130, 4, v130
  v_mov_b32 v132, 0x7f000000
  v_add_u32 v133, 0, v129
  v_lshl_add_u32 v136, v133, 13, v130
  v_cmp_gt_u32 vcc, 225, v133
  s_nop 1
  v_cndmask_b32 v136, v132, v136, vcc
  v_add_u32 v133, 16, v129
  v_lshl_add_u32 v137, v133, 13, v130
  v_cmp_gt_u32 vcc, 225, v133
  s_nop 1
  v_cndmask_b32 v137, v132, v137, vcc
  v_add_u32 v133, 32, v129
  v_lshl_add_u32 v138, v133, 13, v130
  v_cmp_gt_u32 vcc, 225, v133
  s_nop 1
  v_cndmask_b32 v138, v132, v138, vcc
  v_add_u32 v133, 48, v129
  v_lshl_add_u32 v139, v133, 13, v130
  v_cmp_gt_u32 vcc, 225, v133
  s_nop 1
  v_cndmask_b32 v139, v132, v139, vcc
  v_mov_b32 v131, 0
  s_mov_b32 s11, 0x7fff7fff
  s_waitcnt vmcnt(63)
  v_lshl_or_b32 v64, v96, 16, v64
  v_and_b32 v129, s11, v64
  v_pk_max_u16 v131, v131, v129
  v_lshl_or_b32 v65, v97, 16, v65
  v_and_b32 v129, s11, v65
  v_pk_max_u16 v131, v131, v129
  v_lshl_or_b32 v66, v98, 16, v66
  v_and_b32 v129, s11, v66
  v_pk_max_u16 v131, v131, v129
  v_lshl_or_b32 v67, v99, 16, v67
  v_and_b32 v129, s11, v67
  v_pk_max_u16 v131, v131, v129
  v_lshl_or_b32 v68, v100, 16, v68
  v_and_b32 v129, s11, v68
  v_pk_max_u16 v131, v131, v129
  v_lshl_or_b32 v69, v101, 16, v69
  v_and_b32 v129, s11, v69
  v_pk_max_u16 v131, v131, v129
  v_lshl_or_b32 v70, v102, 16, v70
  v_and_b32 v129, s11, v70
  v_pk_max_u16 v131, v131, v129
  v_lshl_or_b32 v71, v103, 16, v71
  v_and_b32 v129, s11, v71
  v_pk_max_u16 v131, v131, v129
  v_lshl_or_b32 v72, v104, 16, v72
  v_and_b32 v129, s11, v72
  v_pk_max_u16 v131, v131, v129
  v_lshl_or_b32 v73, v105, 16, v73
  v_and_b32 v129, s11, v73
  v_pk_max_u16 v131, v131, v129
  v_lshl_or_b32 v74, v106, 16, v74
  v_and_b32 v129, s11, v74
  v_pk_max_u16 v131, v131, v129
  v_lshl_or_b32 v75, v107, 16, v75
  v_and_b32 v129, s11, v75
  v_pk_max_u16 v131, v131, v129
  v_lshl_or_b32 v76, v108, 16, v76
  v_and_b32 v129, s11, v76
  v_pk_max_u16 v131, v131, v129
  v_lshl_or_b32 v77, v109, 16, v77
  v_and_b32 v129, s11, v77
  v_pk_max_u16 v131, v131, v129
  v_lshl_or_b32 v78, v110, 16, v78
  v_and_b32 v129, s11, v78
  v_pk_max_u16 v131, v131, v129
  v_lshl_or_b32 v79, v111, 16, v79
  v_and_b32 v129, s11, v79
  v_pk_max_u16 v131, v131, v129
  v_permlane32_swap_b32 v64, v72
  v_permlane32_swap_b32 v68, v76
  v_permlane32_swap_b32 v65, v73
  v_permlane32_swap_b32 v69, v77
  v_permlane32_swap_b32 v66, v74
  v_permlane32_swap_b32 v70, v78
  v_permlane32_swap_b32 v67, v75
  v_permlane32_swap_b32 v71, v79
  v_permlane16_swap_b32 v64, v68
  v_permlane16_swap_b32 v72, v76
  v_permlane16_swap_b32 v65, v69
  v_permlane16_swap_b32 v73, v77
  v_permlane16_swap_b32 v66, v70
  v_permlane16_swap_b32 v74, v78
  v_permlane16_swap_b32 v67, v71
  v_permlane16_swap_b32 v75, v79
  buffer_store_dwordx4 v[64:67], v136, s[24:27], s10 offen offset:0 sc1
  buffer_store_dwordx4 v[68:71], v137, s[24:27], s10 offen offset:0 sc1
  buffer_store_dwordx4 v[72:75], v138, s[24:27], s10 offen offset:0 sc1
  buffer_store_dwordx4 v[76:79], v139, s[24:27], s10 offen offset:0 sc1
  v_lshl_or_b32 v80, v112, 16, v80
  v_and_b32 v129, s11, v80
  v_pk_max_u16 v131, v131, v129
  v_lshl_or_b32 v81, v113, 16, v81
  v_and_b32 v129, s11, v81
  v_pk_max_u16 v131, v131, v129
  v_lshl_or_b32 v82, v114, 16, v82
  v_and_b32 v129, s11, v82
  v_pk_max_u16 v131, v131, v129
  v_lshl_or_b32 v83, v115, 16, v83
  v_and_b32 v129, s11, v83
  v_pk_max_u16 v131, v131, v129
  v_lshl_or_b32 v84, v116, 16, v84
  v_and_b32 v129, s11, v84
  v_pk_max_u16 v131, v131, v129
  v_lshl_or_b32 v85, v117, 16, v85
  v_and_b32 v129, s11, v85
  v_pk_max_u16 v131, v131, v129
  v_lshl_or_b32 v86, v118, 16, v86
  v_and_b32 v129, s11, v86
  v_pk_max_u16 v131, v131, v129
  v_lshl_or_b32 v87, v119, 16, v87
  v_and_b32 v129, s11, v87
  v_pk_max_u16 v131, v131, v129
  v_lshl_or_b32 v88, v120, 16, v88
  v_and_b32 v129, s11, v88
  v_pk_max_u16 v131, v131, v129
  v_lshl_or_b32 v89, v121, 16, v89
  v_and_b32 v129, s11, v89
  v_pk_max_u16 v131, v131, v129
  v_lshl_or_b32 v90, v122, 16, v90
  v_and_b32 v129, s11, v90
  v_pk_max_u16 v131, v131, v129
  v_lshl_or_b32 v91, v123, 16, v91
  v_and_b32 v129, s11, v91
  v_pk_max_u16 v131, v131, v129
  v_lshl_or_b32 v92, v124, 16, v92
  v_and_b32 v129, s11, v92
  v_pk_max_u16 v131, v131, v129
  v_lshl_or_b32 v93, v125, 16, v93
  v_and_b32 v129, s11, v93
  v_pk_max_u16 v131, v131, v129
  v_lshl_or_b32 v94, v126, 16, v94
  v_and_b32 v129, s11, v94
  v_pk_max_u16 v131, v131, v129
  v_lshl_or_b32 v95, v127, 16, v95
  v_and_b32 v129, s11, v95
  v_pk_max_u16 v131, v131, v129
  v_permlane32_swap_b32 v80, v88
  v_permlane32_swap_b32 v84, v92
  v_permlane32_swap_b32 v81, v89
  v_permlane32_swap_b32 v85, v93
  v_permlane32_swap_b32 v82, v90
  v_permlane32_swap_b32 v86, v94
  v_permlane32_swap_b32 v83, v91
  v_permlane32_swap_b32 v87, v95
  v_permlane16_swap_b32 v80, v84
  v_permlane16_swap_b32 v88, v92
  v_permlane16_swap_b32 v81, v85
  v_permlane16_swap_b32 v89, v93
  v_permlane16_swap_b32 v82, v86
  v_permlane16_swap_b32 v90, v94
  v_permlane16_swap_b32 v83, v87
  v_permlane16_swap_b32 v91, v95
  buffer_store_dwordx4 v[80:83], v136, s[24:27], s10 offen offset:64 sc1
  buffer_store_dwordx4 v[84:87], v137, s[24:27], s10 offen offset:64 sc1
  buffer_store_dwordx4 v[88:91], v138, s[24:27], s10 offen offset:64 sc1
  buffer_store_dwordx4 v[92:95], v139, s[24:27], s10 offen offset:64 sc1
  v_lshrrev_b32 v129, 16, v131
  v_and_b32 v131, 0xffff, v131
  v_max_u32 v131, v131, v129
  ds_swizzle_b32 v129, v131 offset:0x41f
  s_waitcnt lgkmcnt(0)
  v_max_u32 v131, v131, v129
  ds_swizzle_b32 v129, v131 offset:0x81f
  s_waitcnt lgkmcnt(0)
  v_max_u32 v131, v131, v129
  ds_swizzle_b32 v129, v131 offset:0x101f
  s_waitcnt lgkmcnt(0)
  v_max_u32 v131, v131, v129
  ds_swizzle_b32 v129, v131 offset:0x201f
  s_waitcnt lgkmcnt(0)
  v_max_u32 v131, v131, v129
  ds_swizzle_b32 v129, v131 offset:0x401f
  s_waitcnt lgkmcnt(0)
  v_max_u32 v131, v131, v129
  v_mov_b32 v129, v131
  s_nop 1
  v_permlane32_swap_b32 v131, v129
  v_max_u32 v131, v131, v129
  v_and_b32 v129, 31, v0
  v_lshlrev_b32 v129, 3, v129
MK_whs:
  buffer_load_dword v130, v129, s[32:35], 0 offen sc1
  s_waitcnt vmcnt(0)
  v_cmp_ne_u32 vcc, 1, v130
  s_nop 4
  s_cbranch_vccz MK_whs_ok
  s_sub_u32 s96, s96, 1
  s_cmp_eq_u32 s96, 0
  s_cbranch_scc1 MK_end
  s_sleep 2
  s_branch MK_whs
MK_whs_ok:
  s_lshr_b32 s10, s60, 2
  s_lshl_b32 s10, s10, 7
  s_and_b32 s11, s60, 3
  s_lshl_b32 s11, s11, 2
  s_add_u32 s10, s10, s11
  s_add_u32 s10, s10, 19468288
  v_mov_b32 v129, 0
  buffer_store_dword v131, v129, s[24:27], s10 offen sc1
  s_mov_b32 s61, s43
  s_barrier
  s_cmp_le_u32 s40, 224
  s_cbranch_scc1 MK_fgo
  s_mov_b32 m0, 150000
  s_add_u32 s3, s15, 2048
  buffer_load_dwordx4 v3, s[68:71], s3 offen lds
  s_add_u32 s3, s15, 6144
  buffer_load_dwordx4 v3, s[68:71], s3 offen lds
  s_add_u32 s3, s15, 10240
  buffer_load_dwordx4 v3, s[68:71], s3 offen lds
  s_add_u32 s3, s15, 14336
  buffer_load_dwordx4 v3, s[68:71], s3 offen lds
  s_add_u32 s3, s15, 18432
  buffer_load_dwordx4 v3, s[68:71], s3 offen lds
  s_add_u32 s3, s15, 22528
  buffer_load_dwordx4 v3, s[68:71], s3 offen lds
  s_add_u32 s3, s15, 26624
  buffer_load_dwordx4 v3, s[68:71], s3 offen lds
  s_add_u32 s3, s15, 30720
  buffer_load_dwordx4 v3, s[68:71], s3 offen lds
  s_mov_b32 m0, 150000
  s_add_u32 s3, s15, 3072
  buffer_load_dwordx4 v3, s[68:71], s3 offen lds
  s_add_u32 s3, s15, 7168
  buffer_load_dwordx4 v3, s[68:71], s3 offen lds
  s_add_u32 s3, s15, 11264
  buffer_load_dwordx4 v3, s[68:71], s3 offen lds
  s_add_u32 s3, s15, 15360
  buffer_load_dwordx4 v3, s[68:71], s3 offen lds
  s_add_u32 s3, s15, 19456
  buffer_load_dwordx4 v3, s[68:71], s3 offen lds
  s_add_u32 s3, s15, 23552
  buffer_load_dwordx4 v3, s[68:71], s3 offen lds
  s_add_u32 s3, s15, 27648
  buffer_load_dwordx4 v3, s[68:71], s3 offen lds
  s_add_u32 s3, s15, 31744
  buffer_load_dwordx4 v3, s[68:71], s3 offen lds
  s_branch MK_fdone
MK_fgo:
  s_lshl_b32 s41, s40, 1
  s_add_u32 s42, s41, 1
  s_cmp_eq_u32 s40, 224
  s_cselect_b32 s41, 1, s41
  s_cselect_b32 s42, 4000, s42
  s_cmp_eq_u32 s40, 0
  s_cselect_b32 s42, 4000, s42
  s_lshr_b32 s56, s41, 5
  s_lshl_b32 s56, s56, 11
  s_add_u32 s56, s56, 19218432
  s_mul_i32 s41, s41, 4224
  s_mul_i32 s42, s42, 4224
  s_lshl_b32 s50, s36, 13
  s_add_u32 s50, s50, 63488
  s_add_u32 s51, s41, 8388608
  s_add_u32 s52, s42, 8388608
  v_lshrrev_b32 v8, 5, v0
  v_bfe_u32 v9, v0, 2, 2
  v_lshl_add_u32 v2, v8, 2, v9
  v_lshlrev_b32 v2, 7, v2
  v_bfe_u32 v9, v0, 4, 1
  v_lshl_add_u32 v2, v9, 5, v2
  v_and_b32 v9, 3, v0
  v_lshl_add_u32 v2, v9, 3, v2
  v_add_u32 v2, s50, v2
  v_lshrrev_b32 v8, 2, v0
  v_lshlrev_b32 v8, 7, v8
  v_and_b32 v9, 3, v0
  v_lshl_add_u32 v8, v9, 2, v8
MK_spollA:
  buffer_load_dword v9, v8, s[24:27], s56 offen sc1
  s_waitcnt vmcnt(0)
  v_cmp_ne_u32 vcc, 1, v9
  s_nop 4
  s_cbranch_vccz MK_spollA_ok
  s_sub_u32 s96, s96, 1
  s_cmp_eq_u32 s96, 0
  s_cbranch_scc1 MK_end
  s_sleep 8
  s_branch MK_spollA
MK_spollA_ok:
  s_mov_b32 m0, s50
  s_nop 0
  buffer_load_dwordx4 v1, s[24:27], s51 offen offset:0 sc1 lds
  buffer_load_dwordx4 v1, s[24:27], s51 offen offset:1024 sc1 lds
  buffer_load_dwordx4 v1, s[24:27], s51 offen offset:2048 sc1 lds
  buffer_load_dwordx4 v1, s[24:27], s51 offen offset:3072 sc1 lds
  s_add_u32 m0, s50, 4096
  s_nop 0
  buffer_load_dwordx4 v1, s[24:27], s52 offen offset:0 sc1 lds
  buffer_load_dwordx4 v1, s[24:27], s52 offen offset:1024 sc1 lds
  buffer_load_dwordx4 v1, s[24:27], s52 offen offset:2048 sc1 lds
  buffer_load_dwordx4 v1, s[24:27], s52 offen offset:3072 sc1 lds
  s_waitcnt vmcnt(0)
  ds_read_b64_tr_b16 v[16:17], v2 offset:0
  ds_read_b64_tr_b16 v[18:19], v2 offset:1024
  ds_read_b64_tr_b16 v[20:21], v2 offset:2048
  ds_read_b64_tr_b16 v[22:23], v2 offset:3072
  ds_read_b64_tr_b16 v[24:25], v2 offset:64
  ds_read_b64_tr_b16 v[26:27], v2 offset:1088
  ds_read_b64_tr_b16 v[28:29], v2 offset:2112
  ds_read_b64_tr_b16 v[30:31], v2 offset:3136
  ds_read_b64_tr_b16 v[32:33], v2 offset:4096
  ds_read_b64_tr_b16 v[34:35], v2 offset:5120
  ds_read_b64_tr_b16 v[36:37], v2 offset:6144
  ds_read_b64_tr_b16 v[38:39], v2 offset:7168
  ds_read_b64_tr_b16 v[40:41], v2 offset:4160
  ds_read_b64_tr_b16 v[42:43], v2 offset:5184
  ds_read_b64_tr_b16 v[44:45], v2 offset:6208
  ds_read_b64_tr_b16 v[46:47], v2 offset:7232
  ds_read_b128 v[112:115], v1 offset:0
  ds_read_b128 v[116:119], v1 offset:1024
  ds_read_b128 v[120:123], v1 offset:2048
  ds_read_b128 v[124:127], v1 offset:3072
  ds_read_b128 v[128:131], v1 offset:4096
  ds_read_b128 v[132:135], v1 offset:5120
  s_waitcnt lgkmcnt(5)
  v_mfma_f32_32x32x16_f16 v[48:63], v[16:19], v[112:115], 0
  v_mfma_f32_32x32x16_f16 v[80:95], v[32:35], v[112:115], 0
  s_waitcnt lgkmcnt(3)
  v_mfma_f32_32x32x16_f16 v[48:63], v[32:35], v[120:123], v[48:63]
  s_waitcnt lgkmcnt(1)
  v_mfma_f32_32x32x16_f16 v[80:95], v[16:19], v[128:131], v[80:95]
  v_mfma_f32_32x32x16_f16 v[48:63], v[20:23], v[116:119], v[48:63]
  v_mfma_f32_32x32x16_f16 v[80:95], v[36:39], v[116:119], v[80:95]
  v_mfma_f32_32x32x16_f16 v[48:63], v[36:39], v[124:127], v[48:63]
  s_waitcnt lgkmcnt(0)
  v_mfma_f32_32x32x16_f16 v[80:95], v[20:23], v[132:135], v[80:95]
  v_mfma_f32_32x32x16_f16 v[64:79], v[24:27], v[112:115], 0
  v_mfma_f32_32x32x16_f16 v[96:111], v[40:43], v[112:115], 0
  v_mfma_f32_32x32x16_f16 v[64:79], v[40:43], v[120:123], v[64:79]
  v_mfma_f32_32x32x16_f16 v[96:111], v[24:27], v[128:131], v[96:111]
  v_mfma_f32_32x32x16_f16 v[64:79], v[28:31], v[116:119], v[64:79]
  v_mfma_f32_32x32x16_f16 v[96:111], v[44:47], v[116:119], v[96:111]
  v_mfma_f32_32x32x16_f16 v[64:79], v[44:47], v[124:127], v[64:79]
  v_mfma_f32_32x32x16_f16 v[96:111], v[28:31], v[132:135], v[96:111]
  ds_read_b128 v[160:163], v1 offset:30720
  ds_read_b128 v[164:167], v1 offset:31744
  ds_read_b128 v[168:171], v1 offset:32768
  ds_read_b128 v[172:175], v1 offset:33792
  ds_read_b128 v[176:179], v1 offset:34816
  ds_read_b128 v[180:183], v1 offset:35840
  ds_read_b128 v[184:187], v1 offset:36864
  ds_read_b128 v[188:191], v1 offset:37888
  s_waitcnt lgkmcnt(7)
  v_mul_f32 v192, v48, v160
  v_mul_f32 v193, v49, v161
  v_mul_f32 v194, v50, v162
  v_mul_f32 v195, v51, v163
  v_mul_f32 v196, v80, v160
  v_mul_f32 v197, v81, v161
  v_mul_f32 v198, v82, v162
  v_mul_f32 v199, v83, v163
  s_waitcnt lgkmcnt(6)
  v_fma_f32 v192, v80, v164, v192
  v_fma_f32 v193, v81, v165, v193
  v_fma_f32 v194, v82, v166, v194
  v_fma_f32 v195, v83, v167, v195
  v_fma_f32 v196, -v48, v164, v196
  v_fma_f32 v197, -v49, v165, v197
  v_fma_f32 v198, -v50, v166, v198
  v_fma_f32 v199, -v51, v167, v199
  v_cvt_pk_f16_f32 v16, v192, v193
  v_cvt_pk_f16_f32 v17, v194, v195
  v_cvt_pk_f16_f32 v32, v196, v197
  v_cvt_pk_f16_f32 v33, v198, v199
  ds_read_b128 v[160:163], v1 offset:38912
  ds_read_b128 v[164:167], v1 offset:39936
  s_waitcnt lgkmcnt(7)
  v_mul_f32 v192, v52, v168
  v_mul_f32 v193, v53, v169
  v_mul_f32 v194, v54, v170
  v_mul_f32 v195, v55, v171
  v_mul_f32 v196, v84, v168
  v_mul_f32 v197, v85, v169
  v_mul_f32 v198, v86, v170
  v_mul_f32 v199, v87, v171
  s_waitcnt lgkmcnt(6)
  v_fma_f32 v192, v84, v172, v192
  v_fma_f32 v193, v85, v173, v193
  v_fma_f32 v194, v86, v174, v194
  v_fma_f32 v195, v87, v175, v195
  v_fma_f32 v196, -v52, v172, v196
  v_fma_f32 v197, -v53, v173, v197
  v_fma_f32 v198, -v54, v174, v198
  v_fma_f32 v199, -v55, v175, v199
  v_cvt_pk_f16_f32 v18, v192, v193
  v_cvt_pk_f16_f32 v19, v194, v195
  v_cvt_pk_f16_f32 v34, v196, v197
  v_cvt_pk_f16_f32 v35, v198, v199
  ds_read_b128 v[168:171], v1 offset:40960
  ds_read_b128 v[172:175], v1 offset:41984
  s_waitcnt lgkmcnt(7)
  v_mul_f32 v192, v56, v176
  v_mul_f32 v193, v57, v177
  v_mul_f32 v194, v58, v178
  v_mul_f32 v195, v59, v179
  v_mul_f32 v196, v88, v176
  v_mul_f32 v197, v89, v177
  v_mul_f32 v198, v90, v178
  v_mul_f32 v199, v91, v179
  s_waitcnt lgkmcnt(6)
  v_fma_f32 v192, v88, v180, v192
  v_fma_f32 v193, v89, v181, v193
  v_fma_f32 v194, v90, v182, v194
  v_fma_f32 v195, v91, v183, v195
  v_fma_f32 v196, -v56, v180, v196
  v_fma_f32 v197, -v57, v181, v197
  v_fma_f32 v198, -v58, v182, v198
  v_fma_f32 v199, -v59, v183, v199
  v_cvt_pk_f16_f32 v20, v192, v193
  v_cvt_pk_f16_f32 v21, v194, v195
  v_cvt_pk_f16_f32 v36, v196, v197
  v_cvt_pk_f16_f32 v37, v198, v199
  ds_read_b128 v[176:179], v1 offset:43008
  ds_read_b128 v[180:183], v1 offset:44032
  s_waitcnt lgkmcnt(7)
  v_mul_f32 v192, v60, v184
  v_mul_f32 v193, v61, v185
  v_mul_f32 v194, v62, v186
  v_mul_f32 v195, v63, v187
  v_mul_f32 v196, v92, v184
  v_mul_f32 v197, v93, v185
  v_mul_f32 v198, v94, v186
  v_mul_f32 v199, v95, v187
  s_waitcnt lgkmcnt(6)
  v_fma_f32 v192, v92, v188, v192
  v_fma_f32 v193, v93, v189, v193
  v_fma_f32 v194, v94, v190, v194
  v_fma_f32 v195, v95, v191, v195
  v_fma_f32 v196, -v60, v188, v196
  v_fma_f32 v197, -v61, v189, v197
  v_fma_f32 v198, -v62, v190, v198
  v_fma_f32 v199, -v63, v191, v199
  v_cvt_pk_f16_f32 v22, v192, v193
  v_cvt_pk_f16_f32 v23, v194, v195
  v_cvt_pk_f16_f32 v38, v196, v197
  v_cvt_pk_f16_f32 v39, v198, v199
  ds_read_b128 v[184:187], v1 offset:45056
  ds_read_b128 v[188:191], v1 offset:46080
  s_waitcnt lgkmcnt(7)
  v_mul_f32 v192, v64, v160
  v_mul_f32 v193, v65, v161
  v_mul_f32 v194, v66, v162
  v_mul_f32 v195, v67, v163
  v_mul_f32 v196, v96, v160
  v_mul_f32 v197, v97, v161
  v_mul_f32 v198, v98, v162
  v_mul_f32 v199, v99, v163
  s_waitcnt lgkmcnt(6)
  v_fma_f32 v192, v96, v164, v192
  v_fma_f32 v193, v97, v165, v193
  v_fma_f32 v194, v98, v166, v194
  v_fma_f32 v195, v99, v167, v195
  v_fma_f32 v196, -v64, v164, v196
  v_fma_f32 v197, -v65, v165, v197
  v_fma_f32 v198, -v66, v166, v198
  v_fma_f32 v199, -v67, v167, v199
  v_cvt_pk_f16_f32 v24, v192, v193
  v_cvt_pk_f16_f32 v25, v194, v195
  v_cvt_pk_f16_f32 v40, v196, v197
  v_cvt_pk_f16_f32 v41, v198, v199
  s_waitcnt lgkmcnt(5)
  v_mul_f32 v192, v68, v168
  v_mul_f32 v193, v69, v169
  v_mul_f32 v194, v70, v170
  v_mul_f32 v195, v71, v171
  v_mul_f32 v196, v100, v168
  v_mul_f32 v197, v101, v169
  v_mul_f32 v198, v102, v170
  v_mul_f32 v199, v103, v171
  s_waitcnt lgkmcnt(4)
  v_fma_f32 v192, v100, v172, v192
  v_fma_f32 v193, v101, v173, v193
  v_fma_f32 v194, v102, v174, v194
  v_fma_f32 v195, v103, v175, v195
  v_fma_f32 v196, -v68, v172, v196
  v_fma_f32 v197, -v69, v173, v197
  v_fma_f32 v198, -v70, v174, v198
  v_fma_f32 v199, -v71, v175, v199
  v_cvt_pk_f16_f32 v26, v192, v193
  v_cvt_pk_f16_f32 v27, v194, v195
  v_cvt_pk_f16_f32 v42, v196, v197
  v_cvt_pk_f16_f32 v43, v198, v199
  s_waitcnt lgkmcnt(3)
  v_mul_f32 v192, v72, v176
  v_mul_f32 v193, v73, v177
  v_mul_f32 v194, v74, v178
  v_mul_f32 v195, v75, v179
  v_mul_f32 v196, v104, v176
  v_mul_f32 v197, v105, v177
  v_mul_f32 v198, v106, v178
  v_mul_f32 v199, v107, v179
  s_waitcnt lgkmcnt(2)
  v_fma_f32 v192, v104, v180, v192
  v_fma_f32 v193, v105, v181, v193
  v_fma_f32 v194, v106, v182, v194
  v_fma_f32 v195, v107, v183, v195
  v_fma_f32 v196, -v72, v180, v196
  v_fma_f32 v197, -v73, v181, v197
  v_fma_f32 v198, -v74, v182, v198
  v_fma_f32 v199, -v75, v183, v199
  v_cvt_pk_f16_f32 v28, v192, v193
  v_cvt_pk_f16_f32 v29, v194, v195
  v_cvt_pk_f16_f32 v44, v196, v197
  v_cvt_pk_f16_f32 v45, v198, v199
  s_waitcnt lgkmcnt(1)
  v_mul_f32 v192, v76, v184
  v_mul_f32 v193, v77, v185
  v_mul_f32 v194, v78, v186
  v_mul_f32 v195, v79, v187
  v_mul_f32 v196, v108, v184
  v_mul_f32 v197, v109, v185
  v_mul_f32 v198, v110, v186
  v_mul_f32 v199, v111, v187
  s_waitcnt lgkmcnt(0)
  v_fma_f32 v192, v108, v188, v192
  v_fma_f32 v193, v109, v189, v193
  v_fma_f32 v194, v110, v190, v194
  v_fma_f32 v195, v111, v191, v195
  v_fma_f32 v196, -v76, v188, v196
  v_fma_f32 v197, -v77, v189, v197
  v_fma_f32 v198, -v78, v190, v198
  v_fma_f32 v199, -v79, v191, v199
  v_cvt_pk_f16_f32 v30, v192, v193
  v_cvt_pk_f16_f32 v31, v194, v195
  v_cvt_pk_f16_f32 v46, v196, v197
  v_cvt_pk_f16_f32 v47, v198, v199
  s_mov_b32 s55, 19468288
  v_lshlrev_b32 v8, 7, v0
MK_spollw:
  buffer_load_dwordx4 v[4:7], v8, s[24:27], s55 offen sc1
  s_waitcnt vmcnt(0)
  v_max_u32 v4, v4, v5
  v_max3_u32 v4, v4, v6, v7
  v_cmp_lt_u32 vcc, 0xffff, v4
  s_nop 4
  s_cbranch_vccz MK_spollw_ok
  s_sub_u32 s96, s96, 1
  s_cmp_eq_u32 s96, 0
  s_cbranch_scc1 MK_end
  s_sleep 4
  s_branch MK_spollw
MK_spollw_ok:
  s_lshl_b32 s53, s40, 13
  s_add_u32 s53, s53, 10485760
  s_add_u32 s54, s53, 4096
  buffer_load_dwordx4 v[200:203], v1, s[24:27], s53 offen offset:0 sc1
  buffer_load_dwordx4 v[204:207], v1, s[24:27], s53 offen offset:1024 sc1
  buffer_load_dwordx4 v[208:211], v1, s[24:27], s53 offen offset:2048 sc1
  buffer_load_dwordx4 v[212:215], v1, s[24:27], s53 offen offset:3072 sc1
  buffer_load_dwordx4 v[216:219], v1, s[24:27], s54 offen offset:0 sc1
  buffer_load_dwordx4 v[220:223], v1, s[24:27], s54 offen offset:1024 sc1
  buffer_load_dwordx4 v[224:227], v1, s[24:27], s54 offen offset:2048 sc1
  buffer_load_dwordx4 v[228:231], v1, s[24:27], s54 offen offset:3072 sc1
  ds_swizzle_b32 v5, v4 offset:0x41f
  s_waitcnt lgkmcnt(0)
  v_max_u32 v4, v4, v5
  ds_swizzle_b32 v5, v4 offset:0x81f
  s_waitcnt lgkmcnt(0)
  v_max_u32 v4, v4, v5
  ds_swizzle_b32 v5, v4 offset:0x101f
  s_waitcnt lgkmcnt(0)
  v_max_u32 v4, v4, v5
  ds_swizzle_b32 v5, v4 offset:0x201f
  s_waitcnt lgkmcnt(0)
  v_max_u32 v4, v4, v5
  ds_swizzle_b32 v5, v4 offset:0x401f
  s_waitcnt lgkmcnt(0)
  v_max_u32 v4, v4, v5
  v_mov_b32 v5, v4
  s_nop 1
  v_permlane32_swap_b32 v4, v5
  v_max_u32 v4, v4, v5
  v_lshrrev_b32 v4, 7, v4
  v_max_u32 v4, 1, v4
  v_min_u32 v4, 252, v4
  v_sub_u32 v5, 250, v4
  v_max_i32 v5, 1, v5
  v_lshlrev_b32 v3, 23, v5
  s_mov_b32 s55, 19988480
  s_cmp_eq_u32 s40, 0
  s_cselect_b32 s55, s55, 0x7f000000
  v_mov_b32 v5, 0
  buffer_store_dword v3, v5, s[24:27], s55 offen sc1
  s_mov_b32 m0, 150000
  ds_read_b128 v[136:139], v1 offset:6144
  ds_read_b128 v[140:143], v1 offset:14336
  ds_read_b128 v[144:147], v1 offset:22528
  ds_read_b128 v[148:151], v1 offset:7168
  ds_read_b128 v[152:155], v1 offset:15360
  ds_read_b128 v[156:159], v1 offset:23552
  ds_read_b128 v[112:115], v1 offset:8192
  ds_read_b128 v[116:119], v1 offset:16384
  ds_read_b128 v[120:123], v1 offset:24576
  s_waitcnt lgkmcnt(8)
  v_mfma_f32_32x32x16_f16 v[48:63], v[136:139], v[16:19], 0
  v_mfma_f32_32x32x16_f16 v[80:95], v[136:139], v[32:35], 0
  s_waitcnt lgkmcnt(7)
  v_mfma_f32_32x32x16_f16 v[48:63], v[140:143], v[32:35], v[48:63]
  s_waitcnt lgkmcnt(6)
  v_mfma_f32_32x32x16_f16 v[80:95], v[144:147], v[16:19], v[80:95]
  ds_read_b128 v[124:127], v1 offset:9216
  ds_read_b128 v[128:131], v1 offset:17408
  ds_read_b128 v[132:135], v1 offset:25600
  s_waitcnt lgkmcnt(8)
  v_mfma_f32_32x32x16_f16 v[48:63], v[148:151], v[20:23], v[48:63]
  v_mfma_f32_32x32x16_f16 v[80:95], v[148:151], v[36:39], v[80:95]
  s_waitcnt lgkmcnt(7)
  v_mfma_f32_32x32x16_f16 v[48:63], v[152:155], v[36:39], v[48:63]
  s_waitcnt lgkmcnt(6)
  v_mfma_f32_32x32x16_f16 v[80:95], v[156:159], v[20:23], v[80:95]
  s_waitcnt lgkmcnt(5)
  v_mfma_f32_32x32x16_f16 v[48:63], v[112:115], v[24:27], v[48:63]
  v_mfma_f32_32x32x16_f16 v[80:95], v[112:115], v[40:43], v[80:95]
  s_waitcnt lgkmcnt(4)
  v_mfma_f32_32x32x16_f16 v[48:63], v[116:119], v[40:43], v[48:63]
  s_waitcnt lgkmcnt(3)
  v_mfma_f32_32x32x16_f16 v[80:95], v[120:123], v[24:27], v[80:95]
  s_add_u32 s3, s15, 2048
  buffer_load_dwordx4 v1, s[68:71], s3 offen lds
  s_waitcnt lgkmcnt(2)
  v_mfma_f32_32x32x16_f16 v[48:63], v[124:127], v[28:31], v[48:63]
  v_mfma_f32_32x32x16_f16 v[80:95], v[124:127], v[44:47], v[80:95]
  s_waitcnt lgkmcnt(1)
  v_mfma_f32_32x32x16_f16 v[48:63], v[128:131], v[44:47], v[48:63]
  s_waitcnt lgkmcnt(0)
  v_mfma_f32_32x32x16_f16 v[80:95], v[132:135], v[28:31], v[80:95]
  ds_read_b128 v[136:139], v1 offset:10240
  ds_read_b128 v[140:143], v1 offset:18432
  ds_read_b128 v[144:147], v1 offset:26624
  ds_read_b128 v[148:151], v1 offset:11264
  ds_read_b128 v[152:155], v1 offset:19456
  ds_read_b128 v[156:159], v1 offset:27648
  ds_read_b128 v[112:115], v1 offset:12288
  ds_read_b128 v[116:119], v1 offset:20480
  ds_read_b128 v[120:123], v1 offset:28672
  s_waitcnt lgkmcnt(8)
  v_mfma_f32_32x32x16_f16 v[64:79], v[136:139], v[16:19], 0
  v_mfma_f32_32x32x16_f16 v[96:111], v[136:139], v[32:35], 0
  s_waitcnt lgkmcnt(7)
  v_mfma_f32_32x32x16_f16 v[64:79], v[140:143], v[32:35], v[64:79]
  s_waitcnt lgkmcnt(6)
  v_mfma_f32_32x32x16_f16 v[96:111], v[144:147], v[16:19], v[96:111]
  ds_read_b128 v[124:127], v1 offset:13312
  ds_read_b128 v[128:131], v1 offset:21504
  ds_read_b128 v[132:135], v1 offset:29696
  s_waitcnt lgkmcnt(8)
  v_mfma_f32_32x32x16_f16 v[64:79], v[148:151], v[20:23], v[64:79]
  v_mfma_f32_32x32x16_f16 v[96:111], v[148:151], v[36:39], v[96:111]
  s_waitcnt lgkmcnt(7)
  v_mfma_f32_32x32x16_f16 v[64:79], v[152:155], v[36:39], v[64:79]
  s_waitcnt lgkmcnt(6)
  v_mfma_f32_32x32x16_f16 v[96:111], v[156:159], v[20:23], v[96:111]
  s_add_u32 s3, s15, 6144
  buffer_load_dwordx4 v1, s[68:71], s3 offen lds
  s_waitcnt lgkmcnt(5)
  v_mfma_f32_32x32x16_f16 v[64:79], v[112:115], v[24:27], v[64:79]
  v_mfma_f32_32x32x16_f16 v[96:111], v[112:115], v[40:43], v[96:111]
  s_waitcnt lgkmcnt(4)
  v_mfma_f32_32x32x16_f16 v[64:79], v[116:119], v[40:43], v[64:79]
  s_waitcnt lgkmcnt(3)
  v_mfma_f32_32x32x16_f16 v[96:111], v[120:123], v[24:27], v[96:111]
  s_waitcnt lgkmcnt(2)
  v_mfma_f32_32x32x16_f16 v[64:79], v[124:127], v[28:31], v[64:79]
  v_mfma_f32_32x32x16_f16 v[96:111], v[124:127], v[44:47], v[96:111]
  s_waitcnt lgkmcnt(1)
  v_mfma_f32_32x32x16_f16 v[64:79], v[128:131], v[44:47], v[64:79]
  s_waitcnt lgkmcnt(0)
  v_mfma_f32_32x32x16_f16 v[96:111], v[132:135], v[28:31], v[96:111]
  s_waitcnt vmcnt(10)
  v_lshlrev_b32 v160, 16, v200
  v_lshlrev_b32 v161, 16, v201
  v_lshlrev_b32 v162, 16, v202
  v_lshlrev_b32 v163, 16, v203
  v_and_b32 v164, 0xffff0000, v200
  v_and_b32 v165, 0xffff0000, v201
  v_and_b32 v166, 0xffff0000, v202
  v_and_b32 v167, 0xffff0000, v203
  v_mul_f32 v160, v160, v3
  v_mul_f32 v161, v161, v3
  v_mul_f32 v162, v162, v3
  v_mul_f32 v163, v163, v3
  v_mul_f32 v164, v164, v3
  v_mul_f32 v165, v165, v3
  v_mul_f32 v166, v166, v3
  v_mul_f32 v167, v167, v3
  s_add_u32 s3, s15, 10240
  buffer_load_dwordx4 v1, s[68:71], s3 offen lds
  v_mul_f32 v192, v48, v160
  v_mul_f32 v193, v49, v161
  v_mul_f32 v194, v50, v162
  v_mul_f32 v195, v51, v163
  v_mul_f32 v196, v80, v160
  v_mul_f32 v197, v81, v161
  v_mul_f32 v198, v82, v162
  v_mul_f32 v199, v83, v163
  v_fma_f32 v192, -v80, v164, v192
  v_fma_f32 v193, -v81, v165, v193
  v_fma_f32 v194, -v82, v166, v194
  v_fma_f32 v195, -v83, v167, v195
  v_fma_f32 v196, v48, v164, v196
  v_fma_f32 v197, v49, v165, v197
  v_fma_f32 v198, v50, v166, v198
  v_fma_f32 v199, v51, v167, v199
  v_cvt_pk_f16_f32 v16, v192, v193
  v_cvt_pk_f16_f32 v17, v194, v195
  v_cvt_pk_f16_f32 v32, v196, v197
  v_cvt_pk_f16_f32 v33, v198, v199
  s_waitcnt vmcnt(10)
  v_lshlrev_b32 v160, 16, v204
  v_lshlrev_b32 v161, 16, v205
  v_lshlrev_b32 v162, 16, v206
  v_lshlrev_b32 v163, 16, v207
  s_add_u32 s3, s15, 14336
  buffer_load_dwordx4 v1, s[68:71], s3 offen lds
  v_and_b32 v164, 0xffff0000, v204
  v_and_b32 v165, 0xffff0000, v205
  v_and_b32 v166, 0xffff0000, v206
  v_and_b32 v167, 0xffff0000, v207
  v_mul_f32 v160, v160, v3
  v_mul_f32 v161, v161, v3
  v_mul_f32 v162, v162, v3
  v_mul_f32 v163, v163, v3
  v_mul_f32 v164, v164, v3
  v_mul_f32 v165, v165, v3
  v_mul_f32 v166, v166, v3
  v_mul_f32 v167, v167, v3
  v_mul_f32 v192, v52, v160
  v_mul_f32 v193, v53, v161
  v_mul_f32 v194, v54, v162
  v_mul_f32 v195, v55, v163
  v_mul_f32 v196, v84, v160
  v_mul_f32 v197, v85, v161
  v_mul_f32 v198, v86, v162
  v_mul_f32 v199, v87, v163
  v_fma_f32 v192, -v84, v164, v192
  v_fma_f32 v193, -v85, v165, v193
  v_fma_f32 v194, -v86, v166, v194
  v_fma_f32 v195, -v87, v167, v195
  s_add_u32 s3, s15, 18432
  buffer_load_dwordx4 v1, s[68:71], s3 offen lds
  v_fma_f32 v196, v52, v164, v196
  v_fma_f32 v197, v53, v165, v197
  v_fma_f32 v198, v54, v166, v198
  v_fma_f32 v199, v55, v167, v199
  v_cvt_pk_f16_f32 v18, v192, v193
  v_cvt_pk_f16_f32 v19, v194, v195
  v_cvt_pk_f16_f32 v34, v196, v197
  v_cvt_pk_f16_f32 v35, v198, v199
  s_waitcnt vmcnt(11)
  v_lshlrev_b32 v160, 16, v208
  v_lshlrev_b32 v161, 16, v209
  v_lshlrev_b32 v162, 16, v210
  v_lshlrev_b32 v163, 16, v211
  v_and_b32 v164, 0xffff0000, v208
  v_and_b32 v165, 0xffff0000, v209
  v_and_b32 v166, 0xffff0000, v210
  v_and_b32 v167, 0xffff0000, v211
  v_mul_f32 v160, v160, v3
  v_mul_f32 v161, v161, v3
  v_mul_f32 v162, v162, v3
  v_mul_f32 v163, v163, v3
  v_mul_f32 v164, v164, v3
  v_mul_f32 v165, v165, v3
  v_mul_f32 v166, v166, v3
  v_mul_f32 v167, v167, v3
  s_add_u32 s3, s15, 22528
  buffer_load_dwordx4 v1, s[68:71], s3 offen lds
  v_mul_f32 v192, v56, v160
  v_mul_f32 v193, v57, v161
  v_mul_f32 v194, v58, v162
  v_mul_f32 v195, v59, v163
  v_mul_f32 v196, v88, v160
  v_mul_f32 v197, v89, v161
  v_mul_f32 v198, v90, v162
  v_mul_f32 v199, v91, v163
  v_fma_f32 v192, -v88, v164, v192
  v_fma_f32 v193, -v89, v165, v193
  v_fma_f32 v194, -v90, v166, v194
  v_fma_f32 v195, -v91, v167, v195
  v_fma_f32 v196, v56, v164, v196
  v_fma_f32 v197, v57, v165, v197
  v_fma_f32 v198, v58, v166, v198
  v_fma_f32 v199, v59, v167, v199
  v_cvt_pk_f16_f32 v20, v192, v193
  v_cvt_pk_f16_f32 v21, v194, v195
  v_cvt_pk_f16_f32 v36, v196, v197
  v_cvt_pk_f16_f32 v37, v198, v199
  s_waitcnt vmcnt(11)
  v_lshlrev_b32 v160, 16, v212
  v_lshlrev_b32 v161, 16, v213
  v_lshlrev_b32 v162, 16, v214
  v_lshlrev_b32 v163, 16, v215
  s_add_u32 s3, s15, 26624
  buffer_load_dwordx4 v1, s[68:71], s3 offen lds
  v_and_b32 v164, 0xffff0000, v212
  v_and_b32 v165, 0xffff0000, v213
  v_and_b32 v166, 0xffff0000, v214
  v_and_b32 v167, 0xffff0000, v215
  v_mul_f32 v160, v160, v3
  v_mul_f32 v161, v161, v3
  v_mul_f32 v162, v162, v3
  v_mul_f32 v163, v163, v3
  v_mul_f32 v164, v164, v3
  v_mul_f32 v165, v165, v3
  v_mul_f32 v166, v166, v3
  v_mul_f32 v167, v167, v3
  v_mul_f32 v192, v60, v160
  v_mul_f32 v193, v61, v161
  v_mul_f32 v194, v62, v162
  v_mul_f32 v195, v63, v163
  v_mul_f32 v196, v92, v160
  v_mul_f32 v197, v93, v161
  v_mul_f32 v198, v94, v162
  v_mul_f32 v199, v95, v163
  v_fma_f32 v192, -v92, v164, v192
  v_fma_f32 v193, -v93, v165, v193
  v_fma_f32 v194, -v94, v166, v194
  v_fma_f32 v195, -v95, v167, v195
  s_add_u32 s3, s15, 30720
  buffer_load_dwordx4 v1, s[68:71], s3 offen lds
  v_fma_f32 v196, v60, v164, v196
  v_fma_f32 v197, v61, v165, v197
  v_fma_f32 v198, v62, v166, v198
  v_fma_f32 v199, v63, v167, v199
  v_cvt_pk_f16_f32 v22, v192, v193
  v_cvt_pk_f16_f32 v23, v194, v195
  v_cvt_pk_f16_f32 v38, v196, v197
  v_cvt_pk_f16_f32 v39, v198, v199
  s_waitcnt vmcnt(12)
  v_lshlrev_b32 v160, 16, v216
  v_lshlrev_b32 v161, 16, v217
  v_lshlrev_b32 v162, 16, v218
  v_lshlrev_b32 v163, 16, v219
  v_and_b32 v164, 0xffff0000, v216
  v_and_b32 v165, 0xffff0000, v217
  v_and_b32 v166, 0xffff0000, v218
  v_and_b32 v167, 0xffff0000, v219
  v_mul_f32 v160, v160, v3
  v_mul_f32 v161, v161, v3
  v_mul_f32 v162, v162, v3
  v_mul_f32 v163, v163, v3
  v_mul_f32 v164, v164, v3
  v_mul_f32 v165, v165, v3
  v_mul_f32 v166, v166, v3
  v_mul_f32 v167, v167, v3
  s_add_u32 s3, s15, 3072
  buffer_load_dwordx4 v1, s[68:71], s3 offen lds
  v_mul_f32 v192, v64, v160
  v_mul_f32 v193, v65, v161
  v_mul_f32 v194, v66, v162
  v_mul_f32 v195, v67, v163
  v_mul_f32 v196, v96, v160
  v_mul_f32 v197, v97, v161
  v_mul_f32 v198, v98, v162
  v_mul_f32 v199, v99, v163
  v_fma_f32 v192, -v96, v164, v192
  v_fma_f32 v193, -v97, v165, v193
  v_fma_f32 v194, -v98, v166, v194
  v_fma_f32 v195, -v99, v167, v195
  v_fma_f32 v196, v64, v164, v196
  v_fma_f32 v197, v65, v165, v197
  v_fma_f32 v198, v66, v166, v198
  v_fma_f32 v199, v67, v167, v199
  v_cvt_pk_f16_f32 v24, v192, v193
  v_cvt_pk_f16_f32 v25, v194, v195
  v_cvt_pk_f16_f32 v40, v196, v197
  v_cvt_pk_f16_f32 v41, v198, v199
  s_waitcnt vmcnt(12)
  v_lshlrev_b32 v160, 16, v220
  v_lshlrev_b32 v161, 16, v221
  v_lshlrev_b32 v162, 16, v222
  v_lshlrev_b32 v163, 16, v223
  s_add_u32 s3, s15, 7168
  buffer_load_dwordx4 v1, s[68:71], s3 offen lds
  v_and_b32 v164, 0xffff0000, v220
  v_and_b32 v165, 0xffff0000, v221
  v_and_b32 v166, 0xffff0000, v222
  v_and_b32 v167, 0xffff0000, v223
  v_mul_f32 v160, v160, v3
  v_mul_f32 v161, v161, v3
  v_mul_f32 v162, v162, v3
  v_mul_f32 v163, v163, v3
  v_mul_f32 v164, v164, v3
  v_mul_f32 v165, v165, v3
  v_mul_f32 v166, v166, v3
  v_mul_f32 v167, v167, v3
  v_mul_f32 v192, v68, v160
  v_mul_f32 v193, v69, v161
  v_mul_f32 v194, v70, v162
  v_mul_f32 v195, v71, v163
  v_mul_f32 v196, v100, v160
  v_mul_f32 v197, v101, v161
  v_mul_f32 v198, v102, v162
  v_mul_f32 v199, v103, v163
  v_fma_f32 v192, -v100, v164, v192
  v_fma_f32 v193, -v101, v165, v193
  v_fma_f32 v194, -v102, v166, v194
  v_fma_f32 v195, -v103, v167, v195
  s_add_u32 s3, s15, 11264
  buffer_load_dwordx4 v1, s[68:71], s3 offen lds
  v_fma_f32 v196, v68, v164, v196
  v_fma_f32 v197, v69, v165, v197
  v_fma_f32 v198, v70, v166, v198
  v_fma_f32 v199, v71, v167, v199
  v_cvt_pk_f16_f32 v26, v192, v193
  v_cvt_pk_f16_f32 v27, v194, v195
  v_cvt_pk_f16_f32 v42, v196, v197
  v_cvt_pk_f16_f32 v43, v198, v199
  s_waitcnt vmcnt(13)
  v_lshlrev_b32 v160, 16, v224
  v_lshlrev_b32 v161, 16, v225
  v_lshlrev_b32 v162, 16, v226
  v_lshlrev_b32 v163, 16, v227
  v_and_b32 v164, 0xffff0000, v224
  v_and_b32 v165, 0xffff0000, v225
  v_and_b32 v166, 0xffff0000, v226
  v_and_b32 v167, 0xffff0000, v227
  v_mul_f32 v160, v160, v3
  v_mul_f32 v161, v161, v3
  v_mul_f32 v162, v162, v3
  v_mul_f32 v163, v163, v3
  v_mul_f32 v164, v164, v3
  v_mul_f32 v165, v165, v3
  v_mul_f32 v166, v166, v3
  v_mul_f32 v167, v167, v3
  s_add_u32 s3, s15, 15360
  buffer_load_dwordx4 v1, s[68:71], s3 offen lds
  v_mul_f32 v192, v72, v160
  v_mul_f32 v193, v73, v161
  v_mul_f32 v194, v74, v162
  v_mul_f32 v195, v75, v163
  v_mul_f32 v196, v104, v160
  v_mul_f32 v197, v105, v161
  v_mul_f32 v198, v106, v162
  v_mul_f32 v199, v107, v163
  v_fma_f32 v192, -v104, v164, v192
  v_fma_f32 v193, -v105, v165, v193
  v_fma_f32 v194, -v106, v166, v194
  v_fma_f32 v195, -v107, v167, v195
  v_fma_f32 v196, v72, v164, v196
  v_fma_f32 v197, v73, v165, v197
  v_fma_f32 v198, v74, v166, v198
  v_fma_f32 v199, v75, v167, v199
  v_cvt_pk_f16_f32 v28, v192, v193
  v_cvt_pk_f16_f32 v29, v194, v195
  v_cvt_pk_f16_f32 v44, v196, v197
  v_cvt_pk_f16_f32 v45, v198, v199
  s_waitcnt vmcnt(13)
  v_lshlrev_b32 v160, 16, v228
  v_lshlrev_b32 v161, 16, v229
  v_lshlrev_b32 v162, 16, v230
  v_lshlrev_b32 v163, 16, v231
  s_add_u32 s3, s15, 19456
  buffer_load_dwordx4 v1, s[68:71], s3 offen lds
  v_and_b32 v164, 0xffff0000, v228
  v_and_b32 v165, 0xffff0000, v229
  v_and_b32 v166, 0xffff0000, v230
  v_and_b32 v167, 0xffff0000, v231
  v_mul_f32 v160, v160, v3
  v_mul_f32 v161, v161, v3
  v_mul_f32 v162, v162, v3
  v_mul_f32 v163, v163, v3
  v_mul_f32 v164, v164, v3
  v_mul_f32 v165, v165, v3
  v_mul_f32 v166, v166, v3
  v_mul_f32 v167, v167, v3
  v_mul_f32 v192, v76, v160
  v_mul_f32 v193, v77, v161
  v_mul_f32 v194, v78, v162
  v_mul_f32 v195, v79, v163
  v_mul_f32 v196, v108, v160
  v_mul_f32 v197, v109, v161
  v_mul_f32 v198, v110, v162
  v_mul_f32 v199, v111, v163
  v_fma_f32 v192, -v108, v164, v192
  v_fma_f32 v193, -v109, v165, v193
  v_fma_f32 v194, -v110, v166, v194
  v_fma_f32 v195, -v111, v167, v195
  s_add_u32 s3, s15, 23552
  buffer_load_dwordx4 v1, s[68:71], s3 offen lds
  v_fma_f32 v196, v76, v164, v196
  v_fma_f32 v197, v77, v165, v197
  v_fma_f32 v198, v78, v166, v198
  v_fma_f32 v199, v79, v167, v199
  v_cvt_pk_f16_f32 v30, v192, v193
  v_cvt_pk_f16_f32 v31, v194, v195
  v_cvt_pk_f16_f32 v46, v196, v197
  v_cvt_pk_f16_f32 v47, v198, v199
  ds_read_b128 v[136:139], v1 offset:6144
  ds_read_b128 v[140:143], v1 offset:14336
  ds_read_b128 v[144:147], v1 offset:22528
  ds_read_b128 v[148:151], v1 offset:7168
  ds_read_b128 v[152:155], v1 offset:15360
  ds_read_b128 v[156:159], v1 offset:23552
  ds_read_b128 v[112:115], v1 offset:8192
  ds_read_b128 v[116:119], v1 offset:16384
  ds_read_b128 v[120:123], v1 offset:24576
  s_waitcnt lgkmcnt(8)
  v_mfma_f32_32x32x16_f16 v[48:63], v[16:19], v[136:139], 0
  v_mfma_f32_32x32x16_f16 v[80:95], v[32:35], v[136:139], 0
  s_waitcnt lgkmcnt(6)
  v_mfma_f32_32x32x16_f16 v[48:63], v[32:35], v[144:147], v[48:63]
  v_mfma_f32_32x32x16_f16 v[80:95], v[16:19], v[140:143], v[80:95]
  ds_read_b128 v[124:127], v1 offset:9216
  ds_read_b128 v[128:131], v1 offset:17408
  ds_read_b128 v[132:135], v1 offset:25600
  s_add_u32 s3, s15, 27648
  buffer_load_dwordx4 v1, s[68:71], s3 offen lds
  s_waitcnt lgkmcnt(8)
  v_mfma_f32_32x32x16_f16 v[48:63], v[20:23], v[148:151], v[48:63]
  v_mfma_f32_32x32x16_f16 v[80:95], v[36:39], v[148:151], v[80:95]
  s_waitcnt lgkmcnt(6)
  v_mfma_f32_32x32x16_f16 v[48:63], v[36:39], v[156:159], v[48:63]
  v_mfma_f32_32x32x16_f16 v[80:95], v[20:23], v[152:155], v[80:95]
  s_waitcnt lgkmcnt(5)
  v_mfma_f32_32x32x16_f16 v[48:63], v[24:27], v[112:115], v[48:63]
  v_mfma_f32_32x32x16_f16 v[80:95], v[40:43], v[112:115], v[80:95]
  s_waitcnt lgkmcnt(3)
  v_mfma_f32_32x32x16_f16 v[48:63], v[40:43], v[120:123], v[48:63]
  v_mfma_f32_32x32x16_f16 v[80:95], v[24:27], v[116:119], v[80:95]
  s_waitcnt lgkmcnt(2)
  v_mfma_f32_32x32x16_f16 v[48:63], v[28:31], v[124:127], v[48:63]
  v_mfma_f32_32x32x16_f16 v[80:95], v[44:47], v[124:127], v[80:95]
  s_waitcnt lgkmcnt(0)
  v_mfma_f32_32x32x16_f16 v[48:63], v[44:47], v[132:135], v[48:63]
  v_mfma_f32_32x32x16_f16 v[80:95], v[28:31], v[128:131], v[80:95]
  ds_read_b128 v[136:139], v1 offset:10240
  ds_read_b128 v[140:143], v1 offset:18432
  ds_read_b128 v[144:147], v1 offset:26624
  ds_read_b128 v[148:151], v1 offset:11264
  ds_read_b128 v[152:155], v1 offset:19456
  ds_read_b128 v[156:159], v1 offset:27648
  ds_read_b128 v[112:115], v1 offset:12288
  ds_read_b128 v[116:119], v1 offset:20480
  ds_read_b128 v[120:123], v1 offset:28672
  s_waitcnt lgkmcnt(8)
  v_mfma_f32_32x32x16_f16 v[64:79], v[16:19], v[136:139], 0
  v_mfma_f32_32x32x16_f16 v[96:111], v[32:35], v[136:139], 0
  s_waitcnt lgkmcnt(6)
  v_mfma_f32_32x32x16_f16 v[64:79], v[32:35], v[144:147], v[64:79]
  s_add_u32 s3, s15, 31744
  buffer_load_dwordx4 v1, s[68:71], s3 offen lds
  v_mfma_f32_32x32x16_f16 v[96:111], v[16:19], v[140:143], v[96:111]
  ds_read_b128 v[124:127], v1 offset:13312
  ds_read_b128 v[128:131], v1 offset:21504
  ds_read_b128 v[132:135], v1 offset:29696
  s_waitcnt lgkmcnt(8)
  v_mfma_f32_32x32x16_f16 v[64:79], v[20:23], v[148:151], v[64:79]
  v_mfma_f32_32x32x16_f16 v[96:111], v[36:39], v[148:151], v[96:111]
  s_waitcnt lgkmcnt(6)
  v_mfma_f32_32x32x16_f16 v[64:79], v[36:39], v[156:159], v[64:79]
  v_mfma_f32_32x32x16_f16 v[96:111], v[20:23], v[152:155], v[96:111]
  s_waitcnt lgkmcnt(5)
  v_mfma_f32_32x32x16_f16 v[64:79], v[24:27], v[112:115], v[64:79]
  v_mfma_f32_32x32x16_f16 v[96:111], v[40:43], v[112:115], v[96:111]
  s_waitcnt lgkmcnt(3)
  v_mfma_f32_32x32x16_f16 v[64:79], v[40:43], v[120:123], v[64:79]
  v_mfma_f32_32x32x16_f16 v[96:111], v[24:27], v[116:119], v[96:111]
  s_waitcnt lgkmcnt(2)
  v_mfma_f32_32x32x16_f16 v[64:79], v[28:31], v[124:127], v[64:79]
  v_mfma_f32_32x32x16_f16 v[96:111], v[44:47], v[124:127], v[96:111]
  s_waitcnt lgkmcnt(0)
  v_mfma_f32_32x32x16_f16 v[64:79], v[44:47], v[132:135], v[64:79]
  v_mfma_f32_32x32x16_f16 v[96:111], v[28:31], v[128:131], v[96:111]
  ds_read_b128 v[160:163], v1 offset:47104
  ds_read_b128 v[164:167], v1 offset:48128
  ds_read_b128 v[168:171], v1 offset:49152
  ds_read_b128 v[172:175], v1 offset:50176
  ds_read_b128 v[176:179], v1 offset:51200
  ds_read_b128 v[180:183], v1 offset:52224
  ds_read_b128 v[184:187], v1 offset:53248
  ds_read_b128 v[188:191], v1 offset:54272
  s_waitcnt lgkmcnt(7)
  v_mul_f32 v192, v48, v160
  v_mul_f32 v193, v49, v161
  v_mul_f32 v194, v50, v162
  v_mul_f32 v195, v51, v163
  v_mul_f32 v196, v80, v160
  v_mul_f32 v197, v81, v161
  v_mul_f32 v198, v82, v162
  v_mul_f32 v199, v83, v163
  s_waitcnt lgkmcnt(6)
  v_fma_f32 v192, -v80, v164, v192
  v_fma_f32 v193, -v81, v165, v193
  v_fma_f32 v194, -v82, v166, v194
  v_fma_f32 v195, -v83, v167, v195
  v_fma_f32 v196, v48, v164, v196
  v_fma_f32 v197, v49, v165, v197
  v_fma_f32 v198, v50, v166, v198
  v_fma_f32 v199, v51, v167, v199
  v_cvt_pk_f16_f32 v16, v192, v193
  v_cvt_pk_f16_f32 v17, v194, v195
  v_cvt_pk_f16_f32 v32, v196, v197
  v_cvt_pk_f16_f32 v33, v198, v199
  ds_read_b128 v[160:163], v1 offset:55296
  ds_read_b128 v[164:167], v1 offset:56320
  s_waitcnt lgkmcnt(7)
  v_mul_f32 v192, v52, v168
  v_mul_f32 v193, v53, v169
  v_mul_f32 v194, v54, v170
  v_mul_f32 v195, v55, v171
  v_mul_f32 v196, v84, v168
  v_mul_f32 v197, v85, v169
  v_mul_f32 v198, v86, v170
  v_mul_f32 v199, v87, v171
  s_waitcnt lgkmcnt(6)
  v_fma_f32 v192, -v84, v172, v192
  v_fma_f32 v193, -v85, v173, v193
  v_fma_f32 v194, -v86, v174, v194
  v_fma_f32 v195, -v87, v175, v195
  v_fma_f32 v196, v52, v172, v196
  v_fma_f32 v197, v53, v173, v197
  v_fma_f32 v198, v54, v174, v198
  v_fma_f32 v199, v55, v175, v199
  v_cvt_pk_f16_f32 v18, v192, v193
  v_cvt_pk_f16_f32 v19, v194, v195
  v_cvt_pk_f16_f32 v34, v196, v197
  v_cvt_pk_f16_f32 v35, v198, v199
  ds_read_b128 v[168:171], v1 offset:57344
  ds_read_b128 v[172:175], v1 offset:58368
  s_waitcnt lgkmcnt(7)
  v_mul_f32 v192, v56, v176
  v_mul_f32 v193, v57, v177
  v_mul_f32 v194, v58, v178
  v_mul_f32 v195, v59, v179
  v_mul_f32 v196, v88, v176
  v_mul_f32 v197, v89, v177
  v_mul_f32 v198, v90, v178
  v_mul_f32 v199, v91, v179
  s_waitcnt lgkmcnt(6)
  v_fma_f32 v192, -v88, v180, v192
  v_fma_f32 v193, -v89, v181, v193
  v_fma_f32 v194, -v90, v182, v194
  v_fma_f32 v195, -v91, v183, v195
  v_fma_f32 v196, v56, v180, v196
  v_fma_f32 v197, v57, v181, v197
  v_fma_f32 v198, v58, v182, v198
  v_fma_f32 v199, v59, v183, v199
  v_cvt_pk_f16_f32 v20, v192, v193
  v_cvt_pk_f16_f32 v21, v194, v195
  v_cvt_pk_f16_f32 v36, v196, v197
  v_cvt_pk_f16_f32 v37, v198, v199
  ds_read_b128 v[176:179], v1 offset:59392
  ds_read_b128 v[180:183], v1 offset:60416
  s_waitcnt lgkmcnt(7)
  v_mul_f32 v192, v60, v184
  v_mul_f32 v193, v61, v185
  v_mul_f32 v194, v62, v186
  v_mul_f32 v195, v63, v187
  v_mul_f32 v196, v92, v184
  v_mul_f32 v197, v93, v185
  v_mul_f32 v198, v94, v186
  v_mul_f32 v199, v95, v187
  s_waitcnt lgkmcnt(6)
  v_fma_f32 v192, -v92, v188, v192
  v_fma_f32 v193, -v93, v189, v193
  v_fma_f32 v194, -v94, v190, v194
  v_fma_f32 v195, -v95, v191, v195
  v_fma_f32 v196, v60, v188, v196
  v_fma_f32 v197, v61, v189, v197
  v_fma_f32 v198, v62, v190, v198
  v_fma_f32 v199, v63, v191, v199
  v_cvt_pk_f16_f32 v22, v192, v193
  v_cvt_pk_f16_f32 v23, v194, v195
  v_cvt_pk_f16_f32 v38, v196, v197
  v_cvt_pk_f16_f32 v39, v198, v199
  ds_read_b128 v[184:187], v1 offset:61440
  ds_read_b128 v[188:191], v1 offset:62464
  s_waitcnt lgkmcnt(7)
  v_mul_f32 v192, v64, v160
  v_mul_f32 v193, v65, v161
  v_mul_f32 v194, v66, v162
  v_mul_f32 v195, v67, v163
  v_mul_f32 v196, v96, v160
  v_mul_f32 v197, v97, v161
  v_mul_f32 v198, v98, v162
  v_mul_f32 v199, v99, v163
  s_waitcnt lgkmcnt(6)
  v_fma_f32 v192, -v96, v164, v192
  v_fma_f32 v193, -v97, v165, v193
  v_fma_f32 v194, -v98, v166, v194
  v_fma_f32 v195, -v99, v167, v195
  v_fma_f32 v196, v64, v164, v196
  v_fma_f32 v197, v65, v165, v197
  v_fma_f32 v198, v66, v166, v198
  v_fma_f32 v199, v67, v167, v199
  v_cvt_pk_f16_f32 v24, v192, v193
  v_cvt_pk_f16_f32 v25, v194, v195
  v_cvt_pk_f16_f32 v40, v196, v197
  v_cvt_pk_f16_f32 v41, v198, v199
  s_waitcnt lgkmcnt(5)
  v_mul_f32 v192, v68, v168
  v_mul_f32 v193, v69, v169
  v_mul_f32 v194, v70, v170
  v_mul_f32 v195, v71, v171
  v_mul_f32 v196, v100, v168
  v_mul_f32 v197, v101, v169
  v_mul_f32 v198, v102, v170
  v_mul_f32 v199, v103, v171
  s_waitcnt lgkmcnt(4)
  v_fma_f32 v192, -v100, v172, v192
  v_fma_f32 v193, -v101, v173, v193
  v_fma_f32 v194, -v102, v174, v194
  v_fma_f32 v195, -v103, v175, v195
  v_fma_f32 v196, v68, v172, v196
  v_fma_f32 v197, v69, v173, v197
  v_fma_f32 v198, v70, v174, v198
  v_fma_f32 v199, v71, v175, v199
  v_cvt_pk_f16_f32 v26, v192, v193
  v_cvt_pk_f16_f32 v27, v194, v195
  v_cvt_pk_f16_f32 v42, v196, v197
  v_cvt_pk_f16_f32 v43, v198, v199
  s_waitcnt lgkmcnt(3)
  v_mul_f32 v192, v72, v176
  v_mul_f32 v193, v73, v177
  v_mul_f32 v194, v74, v178
  v_mul_f32 v195, v75, v179
  v_mul_f32 v196, v104, v176
  v_mul_f32 v197, v105, v177
  v_mul_f32 v198, v106, v178
  v_mul_f32 v199, v107, v179
  s_waitcnt lgkmcnt(2)
  v_fma_f32 v192, -v104, v180, v192
  v_fma_f32 v193, -v105, v181, v193
  v_fma_f32 v194, -v106, v182, v194
  v_fma_f32 v195, -v107, v183, v195
  v_fma_f32 v196, v72, v180, v196
  v_fma_f32 v197, v73, v181, v197
  v_fma_f32 v198, v74, v182, v198
  v_fma_f32 v199, v75, v183, v199
  v_cvt_pk_f16_f32 v28, v192, v193
  v_cvt_pk_f16_f32 v29, v194, v195
  v_cvt_pk_f16_f32 v44, v196, v197
  v_cvt_pk_f16_f32 v45, v198, v199
  s_waitcnt lgkmcnt(1)
  v_mul_f32 v192, v76, v184
  v_mul_f32 v193, v77, v185
  v_mul_f32 v194, v78, v186
  v_mul_f32 v195, v79, v187
  v_mul_f32 v196, v108, v184
  v_mul_f32 v197, v109, v185
  v_mul_f32 v198, v110, v186
  v_mul_f32 v199, v111, v187
  s_waitcnt lgkmcnt(0)
  v_fma_f32 v192, -v108, v188, v192
  v_fma_f32 v193, -v109, v189, v193
  v_fma_f32 v194, -v110, v190, v194
  v_fma_f32 v195, -v111, v191, v195
  v_fma_f32 v196, v76, v188, v196
  v_fma_f32 v197, v77, v189, v197
  v_fma_f32 v198, v78, v190, v198
  v_fma_f32 v199, v79, v191, v199
  v_cvt_pk_f16_f32 v30, v192, v193
  v_cvt_pk_f16_f32 v31, v194, v195
  v_cvt_pk_f16_f32 v46, v196, v197
  v_cvt_pk_f16_f32 v47, v198, v199
  ds_read_b128 v[136:139], v1 offset:0
  ds_read_b128 v[140:143], v1 offset:1024
  ds_read_b128 v[144:147], v1 offset:2048
  ds_read_b128 v[148:151], v1 offset:3072
  ds_read_b128 v[152:155], v1 offset:4096
  ds_read_b128 v[156:159], v1 offset:5120
  s_waitcnt lgkmcnt(5)
  v_mfma_f32_32x32x16_f16 v[48:63], v[16:19], v[136:139], 0
  v_mfma_f32_32x32x16_f16 v[80:95], v[32:35], v[136:139], 0
  s_waitcnt lgkmcnt(1)
  v_mfma_f32_32x32x16_f16 v[48:63], v[32:35], v[152:155], v[48:63]
  v_mfma_f32_32x32x16_f16 v[80:95], v[16:19], v[144:147], v[80:95]
  v_mfma_f32_32x32x16_f16 v[48:63], v[20:23], v[140:143], v[48:63]
  v_mfma_f32_32x32x16_f16 v[80:95], v[36:39], v[140:143], v[80:95]
  s_waitcnt lgkmcnt(0)
  v_mfma_f32_32x32x16_f16 v[48:63], v[36:39], v[156:159], v[48:63]
  v_mfma_f32_32x32x16_f16 v[80:95], v[20:23], v[148:151], v[80:95]
  v_mfma_f32_32x32x16_f16 v[64:79], v[24:27], v[136:139], 0
  v_mfma_f32_32x32x16_f16 v[96:111], v[40:43], v[136:139], 0
  v_mfma_f32_32x32x16_f16 v[64:79], v[40:43], v[152:155], v[64:79]
  v_mfma_f32_32x32x16_f16 v[96:111], v[24:27], v[144:147], v[96:111]
  v_mfma_f32_32x32x16_f16 v[64:79], v[28:31], v[140:143], v[64:79]
  v_mfma_f32_32x32x16_f16 v[96:111], v[44:47], v[140:143], v[96:111]
  v_mfma_f32_32x32x16_f16 v[64:79], v[44:47], v[156:159], v[64:79]
  v_mfma_f32_32x32x16_f16 v[96:111], v[28:31], v[148:151], v[96:111]
  s_mov_b32 s56, 0x3e800000
  s_cmp_ge_u32 s42, 16896000
  s_cselect_b32 s56, 0x3e000000, s56
  v_and_b32 v8, 15, v0
  v_lshlrev_b32 v8, 7, v8
  v_bfe_u32 v9, v0, 4, 1
  v_lshlrev_b32 v9, 5, v9
  v_lshrrev_b32 v10, 5, v0
  v_lshl_add_u32 v9, v10, 4, v9
  v_add_u32 v8, v8, v9
  v_add_u32 v9, 2048, v8
  s_add_u32 s51, s41, 16777216
  s_add_u32 s52, s42, 16777216
  v_mul_f32 v48, s56, v48
  v_mul_f32 v49, s56, v49
  v_mul_f32 v50, s56, v50
  v_mul_f32 v51, s56, v51
  v_mul_f32 v52, s56, v52
  v_mul_f32 v53, s56, v53
  v_mul_f32 v54, s56, v54
  v_mul_f32 v55, s56, v55
  v_mul_f32 v56, s56, v56
  v_mul_f32 v57, s56, v57
  v_mul_f32 v58, s56, v58
  v_mul_f32 v59, s56, v59
  v_mul_f32 v60, s56, v60
  v_mul_f32 v61, s56, v61
  v_mul_f32 v62, s56, v62
  v_mul_f32 v63, s56, v63
  v_cvt_pk_f16_f32 v16, v48, v49
  v_cvt_pk_f16_f32 v17, v50, v51
  v_cvt_pk_f16_f32 v18, v52, v53
  v_cvt_pk_f16_f32 v19, v54, v55
  v_cvt_pk_f16_f32 v20, v56, v57
  v_cvt_pk_f16_f32 v21, v58, v59
  v_cvt_pk_f16_f32 v22, v60, v61
  v_cvt_pk_f16_f32 v23, v62, v63
  v_permlane32_swap_b32 v16, v18
  v_permlane32_swap_b32 v17, v19
  v_permlane32_swap_b32 v20, v22
  v_permlane32_swap_b32 v21, v23
  s_nop 0
  v_permlane16_swap_b32 v16, v20
  v_permlane16_swap_b32 v17, v21
  v_permlane16_swap_b32 v18, v22
  v_permlane16_swap_b32 v19, v23
  buffer_store_dwordx4 v[16:19], v8, s[24:27], s51 offen offset:0 sc1
  buffer_store_dwordx4 v[20:23], v9, s[24:27], s51 offen offset:0 sc1
  v_mul_f32 v64, s56, v64
  v_mul_f32 v65, s56, v65
  v_mul_f32 v66, s56, v66
  v_mul_f32 v67, s56, v67
  v_mul_f32 v68, s56, v68
  v_mul_f32 v69, s56, v69
  v_mul_f32 v70, s56, v70
  v_mul_f32 v71, s56, v71
  v_mul_f32 v72, s56, v72
  v_mul_f32 v73, s56, v73
  v_mul_f32 v74, s56, v74
  v_mul_f32 v75, s56, v75
  v_mul_f32 v76, s56, v76
  v_mul_f32 v77, s56, v77
  v_mul_f32 v78, s56, v78
  v_mul_f32 v79, s56, v79
  v_cvt_pk_f16_f32 v24, v64, v65
  v_cvt_pk_f16_f32 v25, v66, v67
  v_cvt_pk_f16_f32 v26, v68, v69
  v_cvt_pk_f16_f32 v27, v70, v71
  v_cvt_pk_f16_f32 v28, v72, v73
  v_cvt_pk_f16_f32 v29, v74, v75
  v_cvt_pk_f16_f32 v30, v76, v77
  v_cvt_pk_f16_f32 v31, v78, v79
  v_permlane32_swap_b32 v24, v26
  v_permlane32_swap_b32 v25, v27
  v_permlane32_swap_b32 v28, v30
  v_permlane32_swap_b32 v29, v31
  s_nop 0
  v_permlane16_swap_b32 v24, v28
  v_permlane16_swap_b32 v25, v29
  v_permlane16_swap_b32 v26, v30
  v_permlane16_swap_b32 v27, v31
  buffer_store_dwordx4 v[24:27], v8, s[24:27], s51 offen offset:64 sc1
  buffer_store_dwordx4 v[28:31], v9, s[24:27], s51 offen offset:64 sc1
  v_mul_f32 v80, s56, v80
  v_mul_f32 v81, s56, v81
  v_mul_f32 v82, s56, v82
  v_mul_f32 v83, s56, v83
  v_mul_f32 v84, s56, v84
  v_mul_f32 v85, s56, v85
  v_mul_f32 v86, s56, v86
  v_mul_f32 v87, s56, v87
  v_mul_f32 v88, s56, v88
  v_mul_f32 v89, s56, v89
  v_mul_f32 v90, s56, v90
  v_mul_f32 v91, s56, v91
  v_mul_f32 v92, s56, v92
  v_mul_f32 v93, s56, v93
  v_mul_f32 v94, s56, v94
  v_mul_f32 v95, s56, v95
  v_cvt_pk_f16_f32 v32, v80, v81
  v_cvt_pk_f16_f32 v33, v82, v83
  v_cvt_pk_f16_f32 v34, v84, v85
  v_cvt_pk_f16_f32 v35, v86, v87
  v_cvt_pk_f16_f32 v36, v88, v89
  v_cvt_pk_f16_f32 v37, v90, v91
  v_cvt_pk_f16_f32 v38, v92, v93
  v_cvt_pk_f16_f32 v39, v94, v95
  v_permlane32_swap_b32 v32, v34
  v_permlane32_swap_b32 v33, v35
  v_permlane32_swap_b32 v36, v38
  v_permlane32_swap_b32 v37, v39
  s_nop 0
  v_permlane16_swap_b32 v32, v36
  v_permlane16_swap_b32 v33, v37
  v_permlane16_swap_b32 v34, v38
  v_permlane16_swap_b32 v35, v39
  buffer_store_dwordx4 v[32:35], v8, s[24:27], s52 offen offset:0 sc1
  buffer_store_dwordx4 v[36:39], v9, s[24:27], s52 offen offset:0 sc1
  v_mul_f32 v96, s56, v96
  v_mul_f32 v97, s56, v97
  v_mul_f32 v98, s56, v98
  v_mul_f32 v99, s56, v99
  v_mul_f32 v100, s56, v100
  v_mul_f32 v101, s56, v101
  v_mul_f32 v102, s56, v102
  v_mul_f32 v103, s56, v103
  v_mul_f32 v104, s56, v104
  v_mul_f32 v105, s56, v105
  v_mul_f32 v106, s56, v106
  v_mul_f32 v107, s56, v107
  v_mul_f32 v108, s56, v108
  v_mul_f32 v109, s56, v109
  v_mul_f32 v110, s56, v110
  v_mul_f32 v111, s56, v111
  v_cvt_pk_f16_f32 v40, v96, v97
  v_cvt_pk_f16_f32 v41, v98, v99
  v_cvt_pk_f16_f32 v42, v100, v101
  v_cvt_pk_f16_f32 v43, v102, v103
  v_cvt_pk_f16_f32 v44, v104, v105
  v_cvt_pk_f16_f32 v45, v106, v107
  v_cvt_pk_f16_f32 v46, v108, v109
  v_cvt_pk_f16_f32 v47, v110, v111
  v_permlane32_swap_b32 v40, v42
  v_permlane32_swap_b32 v41, v43
  v_permlane32_swap_b32 v44, v46
  v_permlane32_swap_b32 v45, v47
  s_nop 0
  v_permlane16_swap_b32 v40, v44
  v_permlane16_swap_b32 v41, v45
  v_permlane16_swap_b32 v42, v46
  v_permlane16_swap_b32 v43, v47
  buffer_store_dwordx4 v[40:43], v8, s[24:27], s52 offen offset:64 sc1
  buffer_store_dwordx4 v[44:47], v9, s[24:27], s52 offen offset:64 sc1
  s_waitcnt vmcnt(0)
MK_fdone:
  s_barrier
  s_cmp_lg_u32 s36, 0
  s_cselect_b32 s61, 0x7f000000, s61
  v_mov_b32 v4, 0
  v_mov_b32 v5, 1
  buffer_store_dword v5, v4, s[24:27], s61 offen sc1
MK_end:
  s_endpgm
MK_codeend:
.section .rodata,"a"
.p2align 6
.amdhsa_kernel recurrent_scan__spectral_gfnet__mixer_gmlp__prompt_kernel
  .amdhsa_next_free_vgpr 256
  .amdhsa_next_free_sgpr 102
  .amdhsa_accum_offset 256
  .amdhsa_group_segment_fixed_size 0
  .amdhsa_kernarg_size 88
  .amdhsa_user_sgpr_count 2
  .amdhsa_user_sgpr_kernarg_segment_ptr 1
  .amdhsa_system_sgpr_workgroup_id_x 1
  .amdhsa_float_denorm_mode_32 3
  .amdhsa_float_denorm_mode_16_64 3
.end_amdhsa_kernel
.set XB_0, 16256
.set XH_0, 15360
.set XB_1, 16256
.set XH_1, 15360
.set XB_2, 16256
.set XH_2, 15359
.set XB_3, 16256
.set XH_3, 15358
.set XB_4, 16256
.set XH_4, 15357
.set XB_5, 16255
.set XH_5, 15355
.set XB_6, 16255
.set XH_6, 15353
.set XB_7, 16255
.set XH_7, 15350
.set XB_8, 16254
.set XH_8, 15347
.set XB_9, 16254
.set XH_9, 15344
.set XB_10, 16253
.set XH_10, 15340
.set XB_11, 16253
.set XH_11, 15336
.set XB_12, 16252
.set XH_12, 15331
.set XB_13, 16252
.set XH_13, 15326
.set XB_14, 16251
.set XH_14, 15321
.set XB_15, 16250
.set XH_15, 15315
.set XB_16, 16250
.set XH_16, 15309
.set XB_17, 16249
.set XH_17, 15302
.set XB_18, 16248
.set XH_18, 15295
.set XB_19, 16247
.set XH_19, 15288
.set XB_20, 16246
.set XH_20, 15280
.set XB_21, 16245
.set XH_21, 15272
.set XB_22, 16244
.set XH_22, 15263
.set XB_23, 16243
.set XH_23, 15254
.set XB_24, 16242
.set XH_24, 15245
.set XB_25, 16240
.set XH_25, 15235
.set XB_26, 16239
.set XH_26, 15225
.set XB_27, 16238
.set XH_27, 15215
.set XB_28, 16237
.set XH_28, 15204
.set XB_29, 16235
.set XH_29, 15193
.set XB_30, 16234
.set XH_30, 15181
.set XB_31, 16232
.set XH_31, 15169
.set XB_32, 16231
.set XH_32, 15157
.set XB_33, 16229
.set XH_33, 15145
.set XB_34, 16227
.set XH_34, 15132
.set XB_35, 16226
.set XH_35, 15118
.set XB_36, 16224
.set XH_36, 15104
.set XB_37, 16222
.set XH_37, 15090
.set XB_38, 16220
.set XH_38, 15076
.set XB_39, 16219
.set XH_39, 15061
.set XB_40, 16217
.set XH_40, 15046
.set XB_41, 16215
.set XH_41, 15031
.set XB_42, 16213
.set XH_42, 15015
.set XB_43, 16211
.set XH_43, 14999
.set XB_44, 16209
.set XH_44, 14982
.set XB_45, 16207
.set XH_45, 14965
.set XB_46, 16205
.set XH_46, 14948
.set XB_47, 16202
.set XH_47, 14931
.set XB_48, 16200
.set XH_48, 14913
.set XB_49, 16198
.set XH_49, 14895
.set XB_50, 16196
.set XH_50, 14877
.set XB_51, 16193
.set XH_51, 14858
.set XB_52, 16191
.set XH_52, 14839
.set XB_53, 16188
.set XH_53, 14820
.set XB_54, 16186
.set XH_54, 14800
.set XB_55, 16184
.set XH_55, 14780
.set XB_56, 16181
.set XH_56, 14760
.set XB_57, 16178
.set XH_57, 14740
.set XB_58, 16176
.set XH_58, 14719
.set XB_59, 16173
.set XH_59, 14698
.set XB_60, 16171
.set XH_60, 14677
.set XB_61, 16168
.set XH_61, 14655
.set XB_62, 16165
.set XH_62, 14633
.set XB_63, 16162
.set XH_63, 14611
.set XB_64, 16160
.set XH_64, 14589
.set XB_65, 16157
.set XH_65, 14566
.set XB_66, 16154
.set XH_66, 14543
.set XB_67, 16151
.set XH_67, 14520
.set XB_68, 16148
.set XH_68, 14497
.set XB_69, 16145
.set XH_69, 14474
.set XB_70, 16142
.set XH_70, 14450
.set XB_71, 16139
.set XH_71, 14426
.set XB_72, 16136
.set XH_72, 14402
.set XB_73, 16133
.set XH_73, 14377
.set XB_74, 16130
.set XH_74, 14353
.set XB_75, 16126
.set XH_75, 14319
.set XB_76, 16120
.set XH_76, 14269
.set XB_77, 16113
.set XH_77, 14219
.set XB_78, 16107
.set XH_78, 14168
.set XB_79, 16101
.set XH_79, 14117
.set XB_80, 16094
.set XH_80, 14065
.set XB_81, 16088
.set XH_81, 14013
.set XB_82, 16081
.set XH_82, 13961
.set XB_83, 16075
.set XH_83, 13908
.set XB_84, 16068
.set XH_84, 13855
.set XB_85, 16061
.set XH_85, 13802
.set XB_86, 16055
.set XH_86, 13749
.set XB_87, 16048
.set XH_87, 13695
.set XB_88, 16041
.set XH_88, 13641
.set XB_89, 16034
.set XH_89, 13586
.set XB_90, 16027
.set XH_90, 13532
.set XB_91, 16021
.set XH_91, 13477
.set XB_92, 16014
.set XH_92, 13422
.set XB_93, 16007
.set XH_93, 13367
.set XB_94, 16000
.set XH_94, 13310
.set XB_95, 15986
.set XH_95, 13199
.set XB_96, 15972
.set XH_96, 13087
.set XB_97, 15958
.set XH_97, 12975
.set XB_98, 15944
.set XH_98, 12862
.set XB_99, 15930
.set XH_99, 12749
.set XB_100, 15916
.set XH_100, 12636
.set XB_101, 15901
.set XH_101, 12523
.set XB_102, 15887
.set XH_102, 12409
.set XB_103, 15873
.set XH_103, 12295
.set XB_104, 15845
.set XH_104, 12074
.set XB_105, 15817
.set XH_105, 11846
.set XB_106, 15788
.set XH_106, 11617
.set XB_107, 15759
.set XH_107, 11388
.set XB_108, 15718
.set XH_108, 11053
.set XB_109, 15660
.set XH_109, 10594
.set XB_110, 15590
.set XH_110, 10030
.set XB_111, 15462
.set XH_111, 9006
.set XB_112, 9357
.set XH_112, 0
.set XB_113, 48230
.set XH_113, 41774
.set XB_114, 48358
.set XH_114, 42798
.set XB_115, 48428
.set XH_115, 43362
.set XB_116, 48486
.set XH_116, 43821
.set XB_117, 48527
.set XH_117, 44156
.set XB_118, 48556
.set XH_118, 44385
.set XB_119, 48585
.set XH_119, 44614
.set XB_120, 48613
.set XH_120, 44842
.set XB_121, 48641
.set XH_121, 45063
.set XB_122, 48655
.set XH_122, 45177
.set XB_123, 48669
.set XH_123, 45291
.set XB_124, 48684
.set XH_124, 45404
.set XB_125, 48698
.set XH_125, 45517
.set XB_126, 48712
.set XH_126, 45630
.set XB_127, 48726
.set XH_127, 45743
.set XB_128, 48740
.set XH_128, 45855
.set XB_129, 48754
.set XH_129, 45967
.set XB_130, 48768
.set XH_130, 46078
.set XB_131, 48775
.set XH_131, 46135
.set XB_132, 48782
.set XH_132, 46190
.set XB_133, 48789
.set XH_133, 46245
.set XB_134, 48795
.set XH_134, 46300
.set XB_135, 48802
.set XH_135, 46354
.set XB_136, 48809
.set XH_136, 46409
.set XB_137, 48816
.set XH_137, 46463
.set XB_138, 48823
.set XH_138, 46517
.set XB_139, 48829
.set XH_139, 46570
.set XB_140, 48836
.set XH_140, 46623
.set XB_141, 48843
.set XH_141, 46676
.set XB_142, 48849
.set XH_142, 46729
.set XB_143, 48856
.set XH_143, 46781
.set XB_144, 48862
.set XH_144, 46833
.set XB_145, 48869
.set XH_145, 46885
.set XB_146, 48875
.set XH_146, 46936
.set XB_147, 48881
.set XH_147, 46987
.set XB_148, 48888
.set XH_148, 47037
.set XB_149, 48894
.set XH_149, 47087
.set XB_150, 48898
.set XH_150, 47121
.set XB_151, 48901
.set XH_151, 47145
.set XB_152, 48904
.set XH_152, 47170
.set XB_153, 48907
.set XH_153, 47194
.set XB_154, 48910
.set XH_154, 47218
.set XB_155, 48913
.set XH_155, 47242
.set XB_156, 48916
.set XH_156, 47265
.set XB_157, 48919
.set XH_157, 47288
.set XB_158, 48922
.set XH_158, 47311
.set XB_159, 48925
.set XH_159, 47334
.set XB_160, 48928
.set XH_160, 47357
.set XB_161, 48930
.set XH_161, 47379
.set XB_162, 48933
.set XH_162, 47401
.set XB_163, 48936
.set XH_163, 47423
.set XB_164, 48939
.set XH_164, 47445
.set XB_165, 48941
.set XH_165, 47466
.set XB_166, 48944
.set XH_166, 47487
.set XB_167, 48946
.set XH_167, 47508
.set XB_168, 48949
.set XH_168, 47528
.set XB_169, 48952
.set XH_169, 47548
.set XB_170, 48954
.set XH_170, 47568
.set XB_171, 48956
.set XH_171, 47588
.set XB_172, 48959
.set XH_172, 47607
.set XB_173, 48961
.set XH_173, 47626
.set XB_174, 48964
.set XH_174, 47645
.set XB_175, 48966
.set XH_175, 47663
.set XB_176, 48968
.set XH_176, 47681
.set XB_177, 48970
.set XH_177, 47699
.set XB_178, 48973
.set XH_178, 47716
.set XB_179, 48975
.set XH_179, 47733
.set XB_180, 48977
.set XH_180, 47750
.set XB_181, 48979
.set XH_181, 47767
.set XB_182, 48981
.set XH_182, 47783
.set XB_183, 48983
.set XH_183, 47799
.set XB_184, 48985
.set XH_184, 47814
.set XB_185, 48987
.set XH_185, 47829
.set XB_186, 48988
.set XH_186, 47844
.set XB_187, 48990
.set XH_187, 47858
.set XB_188, 48992
.set XH_188, 47872
.set XB_189, 48994
.set XH_189, 47886
.set XB_190, 48995
.set XH_190, 47900
.set XB_191, 48997
.set XH_191, 47913
.set XB_192, 48999
.set XH_192, 47925
.set XB_193, 49000
.set XH_193, 47937
.set XB_194, 49002
.set XH_194, 47949
.set XB_195, 49003
.set XH_195, 47961
.set XB_196, 49005
.set XH_196, 47972
.set XB_197, 49006
.set XH_197, 47983
.set XB_198, 49007
.set XH_198, 47993
.set XB_199, 49008
.set XH_199, 48003
.set XB_200, 49010
.set XH_200, 48013
.set XB_201, 49011
.set XH_201, 48022
.set XB_202, 49012
.set XH_202, 48031
.set XB_203, 49013
.set XH_203, 48040
.set XB_204, 49014
.set XH_204, 48048
.set XB_205, 49015
.set XH_205, 48056
.set XB_206, 49016
.set XH_206, 48063
.set XB_207, 49017
.set XH_207, 48070
.set XB_208, 49018
.set XH_208, 48077
.set XB_209, 49018
.set XH_209, 48083
.set XB_210, 49019
.set XH_210, 48089
.set XB_211, 49020
.set XH_211, 48094
.set XB_212, 49020
.set XH_212, 48099
.set XB_213, 49021
.set XH_213, 48104
.set XB_214, 49021
.set XH_214, 48108
.set XB_215, 49022
.set XH_215, 48112
.set XB_216, 49022
.set XH_216, 48115
.set XB_217, 49023
.set XH_217, 48118
.set XB_218, 49023
.set XH_218, 48121
.set XB_219, 49023
.set XH_219, 48123
.set XB_220, 49024
.set XH_220, 48125
.set XB_221, 49024
.set XH_221, 48126
.set XB_222, 49024
.set XH_222, 48127
.set XB_223, 49024
.set XH_223, 48128
.set XB_224, 49024
.set XH_224, 48128
.set XB_225, 49024
.set XH_225, 48128
.set XB_226, 49024
.set XH_226, 48127
.set XB_227, 49024
.set XH_227, 48126
.set XB_228, 49024
.set XH_228, 48125
.set XB_229, 49023
.set XH_229, 48123
.set XB_230, 49023
.set XH_230, 48121
.set XB_231, 49023
.set XH_231, 48118
.set XB_232, 49022
.set XH_232, 48115
.set XB_233, 49022
.set XH_233, 48112
.set XB_234, 49021
.set XH_234, 48108
.set XB_235, 49021
.set XH_235, 48104
.set XB_236, 49020
.set XH_236, 48099
.set XB_237, 49020
.set XH_237, 48094
.set XB_238, 49019
.set XH_238, 48089
.set XB_239, 49018
.set XH_239, 48083
.set XB_240, 49018
.set XH_240, 48077
.set XB_241, 49017
.set XH_241, 48070
.set XB_242, 49016
.set XH_242, 48063
.set XB_243, 49015
.set XH_243, 48056
.set XB_244, 49014
.set XH_244, 48048
.set XB_245, 49013
.set XH_245, 48040
.set XB_246, 49012
.set XH_246, 48031
.set XB_247, 49011
.set XH_247, 48022
.set XB_248, 49010
.set XH_248, 48013
.set XB_249, 49008
.set XH_249, 48003
.set XB_250, 49007
.set XH_250, 47993
.set XB_251, 49006
.set XH_251, 47983
.set XB_252, 49005
.set XH_252, 47972
.set XB_253, 49003
.set XH_253, 47961
.set XB_254, 49002
.set XH_254, 47949
.set XB_255, 49000
.set XH_255, 47937
.set XB_256, 48999
.set XH_256, 47925
.set XB_257, 48997
.set XH_257, 47913
.set XB_258, 48995
.set XH_258, 47900
.set XB_259, 48994
.set XH_259, 47886
.set XB_260, 48992
.set XH_260, 47872
.set XB_261, 48990
.set XH_261, 47858
.set XB_262, 48988
.set XH_262, 47844
.set XB_263, 48987
.set XH_263, 47829
.set XB_264, 48985
.set XH_264, 47814
.set XB_265, 48983
.set XH_265, 47799
.set XB_266, 48981
.set XH_266, 47783
.set XB_267, 48979
.set XH_267, 47767
.set XB_268, 48977
.set XH_268, 47750
.set XB_269, 48975
.set XH_269, 47733
.set XB_270, 48973
.set XH_270, 47716
.set XB_271, 48970
.set XH_271, 47699
.set XB_272, 48968
.set XH_272, 47681
.set XB_273, 48966
.set XH_273, 47663
.set XB_274, 48964
.set XH_274, 47645
.set XB_275, 48961
.set XH_275, 47626
.set XB_276, 48959
.set XH_276, 47607
.set XB_277, 48956
.set XH_277, 47588
.set XB_278, 48954
.set XH_278, 47568
.set XB_279, 48952
.set XH_279, 47548
.set XB_280, 48949
.set XH_280, 47528
.set XB_281, 48946
.set XH_281, 47508
.set XB_282, 48944
.set XH_282, 47487
.set XB_283, 48941
.set XH_283, 47466
.set XB_284, 48939
.set XH_284, 47445
.set XB_285, 48936
.set XH_285, 47423
.set XB_286, 48933
.set XH_286, 47401
.set XB_287, 48930
.set XH_287, 47379
.set XB_288, 48928
.set XH_288, 47357
.set XB_289, 48925
.set XH_289, 47334
.set XB_290, 48922
.set XH_290, 47311
.set XB_291, 48919
.set XH_291, 47288
.set XB_292, 48916
.set XH_292, 47265
.set XB_293, 48913
.set XH_293, 47242
.set XB_294, 48910
.set XH_294, 47218
.set XB_295, 48907
.set XH_295, 47194
.set XB_296, 48904
.set XH_296, 47170
.set XB_297, 48901
.set XH_297, 47145
.set XB_298, 48898
.set XH_298, 47121
.set XB_299, 48894
.set XH_299, 47087
.set XB_300, 48888
.set XH_300, 47037
.set XB_301, 48881
.set XH_301, 46987
.set XB_302, 48875
.set XH_302, 46936
.set XB_303, 48869
.set XH_303, 46885
.set XB_304, 48862
.set XH_304, 46833
.set XB_305, 48856
.set XH_305, 46781
.set XB_306, 48849
.set XH_306, 46729
.set XB_307, 48843
.set XH_307, 46676
.set XB_308, 48836
.set XH_308, 46623
.set XB_309, 48829
.set XH_309, 46570
.set XB_310, 48823
.set XH_310, 46517
.set XB_311, 48816
.set XH_311, 46463
.set XB_312, 48809
.set XH_312, 46409
.set XB_313, 48802
.set XH_313, 46354
.set XB_314, 48795
.set XH_314, 46300
.set XB_315, 48789
.set XH_315, 46245
.set XB_316, 48782
.set XH_316, 46190
.set XB_317, 48775
.set XH_317, 46135
.set XB_318, 48768
.set XH_318, 46078
.set XB_319, 48754
.set XH_319, 45967
.set XB_320, 48740
.set XH_320, 45855
.set XB_321, 48726
.set XH_321, 45743
.set XB_322, 48712
.set XH_322, 45630
.set XB_323, 48698
.set XH_323, 45517
.set XB_324, 48684
.set XH_324, 45404
.set XB_325, 48669
.set XH_325, 45291
.set XB_326, 48655
.set XH_326, 45177
.set XB_327, 48641
.set XH_327, 45063
.set XB_328, 48613
.set XH_328, 44842
.set XB_329, 48585
.set XH_329, 44614
.set XB_330, 48556
.set XH_330, 44385
.set XB_331, 48527
.set XH_331, 44156
.set XB_332, 48486
.set XH_332, 43821
.set XB_333, 48428
.set XH_333, 43362
.set XB_334, 48358
.set XH_334, 42798
.set XB_335, 48230
.set XH_335, 41774
.set XB_336, 42324
.set XH_336, 32768
.set XB_337, 15462
.set XH_337, 9006
.set XB_338, 15590
.set XH_338, 10030
.set XB_339, 15660
.set XH_339, 10594
.set XB_340, 15718
.set XH_340, 11053
.set XB_341, 15759
.set XH_341, 11388
.set XB_342, 15788
.set XH_342, 11617
.set XB_343, 15817
.set XH_343, 11846
.set XB_344, 15845
.set XH_344, 12074
.set XB_345, 15873
.set XH_345, 12295
.set XB_346, 15887
.set XH_346, 12409
.set XB_347, 15901
.set XH_347, 12523
.set XB_348, 15916
.set XH_348, 12636
.set XB_349, 15930
.set XH_349, 12749
.set XB_350, 15944
.set XH_350, 12862
.set XB_351, 15958
.set XH_351, 12975
.set XB_352, 15972
.set XH_352, 13087
.set XB_353, 15986
.set XH_353, 13199
.set XB_354, 16000
.set XH_354, 13310
.set XB_355, 16007
.set XH_355, 13367
.set XB_356, 16014
.set XH_356, 13422
.set XB_357, 16021
.set XH_357, 13477
.set XB_358, 16027
.set XH_358, 13532
.set XB_359, 16034
.set XH_359, 13586
.set XB_360, 16041
.set XH_360, 13641
.set XB_361, 16048
.set XH_361, 13695
.set XB_362, 16055
.set XH_362, 13749
.set XB_363, 16061
.set XH_363, 13802
.set XB_364, 16068
.set XH_364, 13855
.set XB_365, 16075
.set XH_365, 13908
.set XB_366, 16081
.set XH_366, 13961
.set XB_367, 16088
.set XH_367, 14013
.set XB_368, 16094
.set XH_368, 14065
.set XB_369, 16101
.set XH_369, 14117
.set XB_370, 16107
.set XH_370, 14168
.set XB_371, 16113
.set XH_371, 14219
.set XB_372, 16120
.set XH_372, 14269
.set XB_373, 16126
.set XH_373, 14319
.set XB_374, 16130
.set XH_374, 14353
.set XB_375, 16133
.set XH_375, 14377
.set XB_376, 16136
.set XH_376, 14402
.set XB_377, 16139
.set XH_377, 14426
.set XB_378, 16142
.set XH_378, 14450
.set XB_379, 16145
.set XH_379, 14474
.set XB_380, 16148
.set XH_380, 14497
.set XB_381, 16151
.set XH_381, 14520
.set XB_382, 16154
.set XH_382, 14543
.set XB_383, 16157
.set XH_383, 14566
.set XB_384, 16160
.set XH_384, 14589
.set XB_385, 16162
.set XH_385, 14611
.set XB_386, 16165
.set XH_386, 14633
.set XB_387, 16168
.set XH_387, 14655
.set XB_388, 16171
.set XH_388, 14677
.set XB_389, 16173
.set XH_389, 14698
.set XB_390, 16176
.set XH_390, 14719
.set XB_391, 16178
.set XH_391, 14740
.set XB_392, 16181
.set XH_392, 14760
.set XB_393, 16184
.set XH_393, 14780
.set XB_394, 16186
.set XH_394, 14800
.set XB_395, 16188
.set XH_395, 14820
.set XB_396, 16191
.set XH_396, 14839
.set XB_397, 16193
.set XH_397, 14858
.set XB_398, 16196
.set XH_398, 14877
.set XB_399, 16198
.set XH_399, 14895
.set XB_400, 16200
.set XH_400, 14913
.set XB_401, 16202
.set XH_401, 14931
.set XB_402, 16205
.set XH_402, 14948
.set XB_403, 16207
.set XH_403, 14965
.set XB_404, 16209
.set XH_404, 14982
.set XB_405, 16211
.set XH_405, 14999
.set XB_406, 16213
.set XH_406, 15015
.set XB_407, 16215
.set XH_407, 15031
.set XB_408, 16217
.set XH_408, 15046
.set XB_409, 16219
.set XH_409, 15061
.set XB_410, 16220
.set XH_410, 15076
.set XB_411, 16222
.set XH_411, 15090
.set XB_412, 16224
.set XH_412, 15104
.set XB_413, 16226
.set XH_413, 15118
.set XB_414, 16227
.set XH_414, 15132
.set XB_415, 16229
.set XH_415, 15145
.set XB_416, 16231
.set XH_416, 15157
.set XB_417, 16232
.set XH_417, 15169
.set XB_418, 16234
.set XH_418, 15181
.set XB_419, 16235
.set XH_419, 15193
.set XB_420, 16237
.set XH_420, 15204
.set XB_421, 16238
.set XH_421, 15215
.set XB_422, 16239
.set XH_422, 15225
.set XB_423, 16240
.set XH_423, 15235
.set XB_424, 16242
.set XH_424, 15245
.set XB_425, 16243
.set XH_425, 15254
.set XB_426, 16244
.set XH_426, 15263
.set XB_427, 16245
.set XH_427, 15272
.set XB_428, 16246
.set XH_428, 15280
.set XB_429, 16247
.set XH_429, 15288
.set XB_430, 16248
.set XH_430, 15295
.set XB_431, 16249
.set XH_431, 15302
.set XB_432, 16250
.set XH_432, 15309
.set XB_433, 16250
.set XH_433, 15315
.set XB_434, 16251
.set XH_434, 15321
.set XB_435, 16252
.set XH_435, 15326
.set XB_436, 16252
.set XH_436, 15331
.set XB_437, 16253
.set XH_437, 15336
.set XB_438, 16253
.set XH_438, 15340
.set XB_439, 16254
.set XH_439, 15344
.set XB_440, 16254
.set XH_440, 15347
.set XB_441, 16255
.set XH_441, 15350
.set XB_442, 16255
.set XH_442, 15353
.set XB_443, 16255
.set XH_443, 15355
.set XB_444, 16256
.set XH_444, 15357
.set XB_445, 16256
.set XH_445, 15358
.set XB_446, 16256
.set XH_446, 15359
.set XB_447, 16256
.set XH_447, 15360

.altmacro
.macro eb8 p0,p1,p2,p3,p4,p5,p6,p7
.short XB_\p0, XB_\p1, XB_\p2, XB_\p3, XB_\p4, XB_\p5, XB_\p6, XB_\p7
.endm
.macro eh8 p0,p1,p2,p3,p4,p5,p6,p7
.short XH_\p0, XH_\p1, XH_\p2, XH_\p3, XH_\p4, XH_\p5, XH_\p6, XH_\p7
.endm
.p2align 8
tab0:
.set tq, 0
.rept 14*7*4*64
.set tl, tq % 64
.set te, (tq / 64) % 4
.set tkc, (tq / 256) % 7
.set tcg, tq / 1792
.set tcp, 32*tcg + tl % 32
.set tk, tcp / 2
.set tim, tcp % 2
.if tcp == 1
.set tk, 224
.set tim, 0
.endif
.set td, 64*tkc + 16*te + 8*(tl/32)
.set tb, tk*td + 112*tim
eb8 %(tb % 448), %((tb+tk) % 448), %((tb+2*tk) % 448), %((tb+3*tk) % 448), %((tb+4*tk) % 448), %((tb+5*tk) % 448), %((tb+6*tk) % 448), %((tb+7*tk) % 448)
.set tq, tq+1
.endr
.set tq, 0
.rept 7*7*4*2*64
.set tl, tq % 64
.set tst, (tq / 64) % 2
.set te, (tq / 128) % 4
.set tsg, (tq / 512) % 7
.set tdt, tq / 3584
.set td, 64*tdt + 32*tst + tl % 32
.set tk, (64*tsg + 16*te + 8*(tl/32)) / 2
.set tb, tk*td
.set tb1, tb + 112
.if tk == 0
.set tb1, 224*td
.endif
eh8 %(tb % 448), %(tb1 % 448), %((tb+td) % 448), %((tb+td+112) % 448), %((tb+2*td) % 448), %((tb+2*td+112) % 448), %((tb+3*td) % 448), %((tb+3*td+112) % 448)
.set tq, tq+1
.endr
.noaltmacro

.long 0x43e00000,0x0,0x0,0x0,0x0,0x0,0x0,0x0
.long 0x0,0x0,0x0,0x0,0x0,0x0,0x0,0x0
.long 0xa7000000,0x0,0x0,0x0,0x0,0x0,0x0,0x0
.long 0xa6000000,0xa6800000,0x0,0x0,0xa7400000,0x0,0x0,0x0
.long 0xa6ea0000,0xa7400000,0x0,0x0,0x0,0x0,0x0,0x0
.long 0xa6800000,0x0,0xa6000000,0x0,0x0,0x0,0x0,0x0
.long 0xa6e00000,0xa7000000,0x0,0x0,0x0,0x0,0x0,0x0
.long 0xa777a000,0xa777a000,0xa5800000,0x0,0x0,0x0,0x0,0x0
.long 0x0,0xa7d28000,0xa5800000,0x0,0x0,0x0,0xa6800000,0xa6800000
.long 0xa6800000,0x0,0xa5800000,0x0,0x0,0x0,0x0,0x0
.long 0xa7000000,0xa6800000,0xa5800000,0x0,0x0,0xa7400000,0x0,0x0
.long 0xa6000000,0xa6800000,0x0,0x0,0x0,0x0,0x0,0x0
.long 0xa6dcc000,0xa7800000,0x0,0x0,0x0,0x0,0x0,0x0
.long 0x0,0x0,0x0,0x0,0x0,0x0,0x0,0x0
.long 0xa8000000,0x0,0x0,0x0,0x0,0x0,0x0,0x0
.long 0x0,0x0,0x0,0x0,0x0,0x0,0x0,0x0
.long 0x0,0x26468000,0x0,0x0,0x0,0x0,0xa5800000,0xa5800000
.long 0xa6000000,0xa6800000,0x0,0x0,0xa7400000,0xa6800000,0xa5800000,0xa5800000
.long 0xa7000000,0xa6800000,0xa5800000,0xa5800000,0xa6000000,0xa6000000,0xa5800000,0xa5800000
.long 0xa6800000,0x0,0xa6800000,0xa6800000,0xa6000000,0xa6000000,0xa5800000,0xa5800000
.long 0xa7750000,0xa7300000,0xa5800000,0xa5800000,0xa6000000,0xa6000000,0xa5800000,0xa5800000
.long 0xa777a000,0xa777a000,0xa5800000,0xa5800000,0xa6000000,0xa6000000,0xa5800000,0xa5800000
.long 0xa6e00000,0xa7000000,0xa5800000,0xa5800000,0xa6000000,0xa6000000,0xa6800000,0xa6800000
.long 0xa6800000,0x0,0xa5800000,0xa5800000,0xa6000000,0xa6000000,0xa5800000,0xa5800000
.long 0x0,0xa7ca8000,0xa5800000,0xa5800000,0xa6800000,0xa7400000,0xa5800000,0xa5800000
.long 0xa6000000,0xa6800000,0xa5800000,0xa5800000,0x0,0xa6000000,0xa5800000,0xa5800000
.long 0xa7000000,0x0,0xa6000000,0xa6000000,0x0,0x0,0x0,0x0
.long 0x0,0x0,0x0,0x0,0x0,0x0,0x0,0x0
.long 0xa8800000,0xa8800000,0x0,0x0,0x0,0x0,0x0,0x0
.long 0x0,0x0,0x0,0x0,0x0,0x0,0x0,0x0
.long 0xa6c00000,0x0,0xa5800000,0xa5800000,0xa6000000,0x0,0xa5800000,0xa5800000
.long 0xa6000000,0xa6800000,0xa5800000,0xa5800000,0xa7300000,0xa6800000,0xa5800000,0xa5800000
.long 0x0,0x27a8d000,0xa5800000,0xa5000000,0xa6000000,0xa6000000,0xa5000000,0xa5000000
.long 0xa6800000,0x0,0xa6800000,0xa6800000,0xa6000000,0xa6000000,0xa5000000,0xa5000000
.long 0xa6e00000,0xa7000000,0xa5800000,0xa5800000,0xa6000000,0xa6000000,0xa5800000,0xa5800000
.long 0xa777a000,0xa777a000,0xa5800000,0xa5800000,0xa5800000,0xa6000000,0xa5800000,0xa5800000
.long 0xa7750000,0xa7300000,0xa5800000,0xa5000000,0xa6000000,0xa5800000,0xa6800000,0xa6800000
.long 0xa6800000,0x0,0xa5800000,0xa5000000,0xa6000000,0xa5800000,0xa5000000,0xa5000000
.long 0xa6c00000,0xa6800000,0xa5800000,0xa5800000,0xa6800000,0xa7300000,0xa5800000,0xa5800000
.long 0xa6000000,0xa6800000,0xa5800000,0xa5800000,0xa6000000,0xa6000000,0xa5800000,0xa5800000
.long 0x0,0xa78a8000,0xa6000000,0xa6000000,0x0,0x0,0x0,0x0
.long 0x0,0x0,0x0,0x0,0x0,0x0,0x0,0x0
.long 0xa8000000,0xa8000000,0x0,0x0,0x0,0x0,0x0,0x0
.long 0x0,0x0,0x0,0x0,0x0,0x0,0xa6000000,0xa6000000
.long 0xa6dcc000,0xa7800000,0xa5800000,0xa5800000,0xa6000000,0xa6000000,0xa5800000,0xa5800000
.long 0xa6000000,0xa6800000,0xa5800000,0xa5800000,0xa7300000,0xa6800000,0xa5800000,0xa5800000
.long 0xa6c00000,0xa6800000,0xa5800000,0xa5000000,0xa6000000,0xa6000000,0xa5000000,0xa5000000
.long 0xa6800000,0x0,0xa6800000,0xa6800000,0xa6000000,0xa5800000,0xa5000000,0xa5000000
.long 0x0,0x26c34000,0xa5800000,0xa5800000,0xa6000000,0xa6000000,0xa5800000,0xa5800000
.long 0xa777a000,0xa777a000,0xa5800000,0xa5800000,0xa5800000,0xa6000000,0xa5800000,0xa5800000
.long 0xa6e00000,0xa7000000,0xa5800000,0xa5000000,0xa6000000,0xa5800000,0xa6800000,0xa6800000
.long 0xa6800000,0x0,0xa5800000,0xa5000000,0xa5800000,0xa5800000,0xa5000000,0xa5000000
.long 0xa6ea0000,0xa7400000,0xa5800000,0xa5800000,0xa6800000,0xa7300000,0xa5800000,0xa5800000
.long 0xa6000000,0xa6800000,0xa5800000,0xa5800000,0xa6000000,0xa6000000,0xa5800000,0xa5800000
.long 0xa6c00000,0x0,0xa6000000,0xa6000000,0x0,0x0,0x0,0x0
.long 0x0,0x0,0x0,0x0,0x0,0x0,0x0,0x0
.long 0x0,0x0,0x0,0x0,0x0,0x0,0x0,0x0
.long 0x0,0x0,0x0,0x0,0x0,0x0,0x0,0x0
.long 0x0,0x0,0x0,0x0,0x0,0x0,0x0,0x0
.long 0x0,0x0,0x0,0x0,0x0,0x0,0x0,0x0
.long 0x0,0x0,0x0,0x0,0x0,0x0,0x0,0x0
.long 0x0,0x0,0x0,0x0,0x0,0x0,0x0,0x0
.long 0x0,0x0,0x0,0x0,0x0,0x0,0x0,0x0
.long 0x0,0x0,0x0,0x0,0x0,0x0,0x0,0x0
.long 0x3c003c00,0x3c003c00,0x3c003c00,0x3c003c00,0x3bd93c00,0x3aa73b64,0xb23e0000,0xb872b61f
.long 0x3b643c00,0x361f39a8,0xbb64bc00,0xb61fb9a8,0x3aa73c00,0xb23e361f,0x38728000,0x3bd93b64
.long 0x39a83c00,0xb9a80000,0x39a83c00,0xb9a80000,0x38723c00,0xbbd9b61f,0xbaa70000,0xb23ebb64
.long 0x361f3c00,0xbb64b9a8,0xb61fbc00,0x3b6439a8,0x323e3c00,0xb872bb64,0x3bd98000,0xbaa7361f
.long 0x3c00,0x8000bc00,0x3c00,0x8000bc00,0xb23e3c00,0x3872bb64,0xbbd90000,0x3aa7361f
.long 0xb61f3c00,0x3b64b9a8,0x361fbc00,0xbb6439a8,0xb8723c00,0x3bd9b61f,0x3aa78000,0x323ebb64
.long 0xb9a83c00,0x39a88000,0xb9a83c00,0x39a88000,0xbaa73c00,0x323e361f,0xb8720000,0xbbd93b64
.long 0xbb643c00,0xb61f39a8,0x3b64bc00,0x361fb9a8,0xbbd93c00,0xbaa73b64,0x323e8000,0x3872b61f
.long 0xbc003c00,0xbc003c00,0xbc003c00,0xbc003c00,0xbbd93c00,0xbaa73b64,0x323e0000,0x3872b61f
.long 0xbb643c00,0xb61f39a8,0x3b64bc00,0x361fb9a8,0xbaa73c00,0x323e361f,0xb8728000,0xbbd93b64
.long 0xb9a83c00,0x39a80000,0xb9a83c00,0x39a80000,0xb8723c00,0x3bd9b61f,0x3aa70000,0x323ebb64
.long 0xb61f3c00,0x3b64b9a8,0x361fbc00,0xbb6439a8,0xb23e3c00,0x3872bb64,0xbbd98000,0x3aa7361f
.long 0x80003c00,0xbc00,0x80003c00,0xbc00,0x323e3c00,0xb872bb64,0x3bd90000,0xbaa7361f
.long 0x361f3c00,0xbb64b9a8,0xb61fbc00,0x3b6439a8,0x38723c00,0xbbd9b61f,0xbaa78000,0xb23ebb64
.long 0x39a83c00,0xb9a88000,0x39a83c00,0xb9a88000,0x3aa73c00,0xb23e361f,0x38720000,0x3bd93b64
.long 0x3b643c00,0x361f39a8,0xbb64bc00,0xb61fb9a8,0x3bd93c00,0x3aa73b64,0xb23e8000,0xb872b61f
.long 0x3c003c00,0x3c003c00,0x3c003c00,0x3c003c00,0x387239a8,0x323e361f,0xbaa7b9a8,0xbbd9bb64
.long 0xb61f0000,0xbb64b9a8,0x361f8000,0x3b6439a8,0xbbd9b9a8,0xb872bb64,0x323e39a8,0xbaa7b61f
.long 0xb9a8bc00,0x39a88000,0xb9a8bc00,0x39a88000,0x323eb9a8,0x3aa73b64,0x3bd939a8,0xb872361f
.long 0x3b648000,0xb61f39a8,0xbb640000,0x361fb9a8,0x3aa739a8,0xbbd9b61f,0x3872b9a8,0xb23e3b64
.long 0x3c00,0x8000bc00,0x3c00,0x8000bc00,0xbaa739a8,0x3bd9b61f,0xb872b9a8,0x323e3b64
.long 0xbb640000,0x361f39a8,0x3b648000,0xb61fb9a8,0xb23eb9a8,0xbaa73b64,0xbbd939a8,0x3872361f
.long 0x39a8bc00,0xb9a80000,0x39a8bc00,0xb9a80000,0x3bd9b9a8,0x3872bb64,0xb23e39a8,0x3aa7b61f
.long 0x361f8000,0x3b64b9a8,0xb61f0000,0xbb6439a8,0xb87239a8,0xb23e361f,0x3aa7b9a8,0x3bd9bb64
.long 0xbc003c00,0xbc003c00,0xbc003c00,0xbc003c00,0xb87239a8,0xb23e361f,0x3aa7b9a8,0x3bd9bb64
.long 0x361f0000,0x3b64b9a8,0xb61f8000,0xbb6439a8,0x3bd9b9a8,0x3872bb64,0xb23e39a8,0x3aa7b61f
.long 0x39a8bc00,0xb9a88000,0x39a8bc00,0xb9a88000,0xb23eb9a8,0xbaa73b64,0xbbd939a8,0x3872361f
.long 0xbb648000,0x361f39a8,0x3b640000,0xb61fb9a8,0xbaa739a8,0x3bd9b61f,0xb872b9a8,0x323e3b64
.long 0x80003c00,0xbc00,0x80003c00,0xbc00,0x3aa739a8,0xbbd9b61f,0x3872b9a8,0xb23e3b64
.long 0x3b640000,0xb61f39a8,0xbb648000,0x361fb9a8,0x323eb9a8,0x3aa73b64,0x3bd939a8,0xb872361f
.long 0xb9a8bc00,0x39a80000,0xb9a8bc00,0x39a80000,0xbbd9b9a8,0xb872bb64,0x323e39a8,0xbaa7b61f
.long 0xb61f8000,0xbb64b9a8,0x361f0000,0x3b6439a8,0x387239a8,0x323e361f,0xbaa7b9a8,0xbbd9bb64
.long 0x3c003c00,0x3c003c00,0x3c003c00,0x3c003c00,0xbbd9bc00,0xbaa7bb64,0x323e8000,0x3872361f
.long 0x3b643c00,0x361f39a8,0xbb64bc00,0xb61fb9a8,0xbaa7bc00,0x323eb61f,0xb8720000,0xbbd9bb64
.long 0x39a83c00,0xb9a80000,0x39a83c00,0xb9a80000,0xb872bc00,0x3bd9361f,0x3aa78000,0x323e3b64
.long 0x361f3c00,0xbb64b9a8,0xb61fbc00,0x3b6439a8,0xb23ebc00,0x38723b64,0xbbd90000,0x3aa7b61f
.long 0x3c00,0x8000bc00,0x3c00,0x8000bc00,0x323ebc00,0xb8723b64,0x3bd98000,0xbaa7b61f
.long 0xb61f3c00,0x3b64b9a8,0x361fbc00,0xbb6439a8,0x3872bc00,0xbbd9361f,0xbaa70000,0xb23e3b64
.long 0xb9a83c00,0x39a88000,0xb9a83c00,0x39a88000,0x3aa7bc00,0xb23eb61f,0x38728000,0x3bd9bb64
.long 0xbb643c00,0xb61f39a8,0x3b64bc00,0x361fb9a8,0x3bd9bc00,0x3aa7bb64,0xb23e0000,0xb872361f
.long 0xbc003c00,0xbc003c00,0xbc003c00,0xbc003c00,0x3bd9bc00,0x3aa7bb64,0xb23e8000,0xb872361f
.long 0xbb643c00,0xb61f39a8,0x3b64bc00,0x361fb9a8,0x3aa7bc00,0xb23eb61f,0x38720000,0x3bd9bb64
.long 0xb9a83c00,0x39a80000,0xb9a83c00,0x39a80000,0x3872bc00,0xbbd9361f,0xbaa78000,0xb23e3b64
.long 0xb61f3c00,0x3b64b9a8,0x361fbc00,0xbb6439a8,0x323ebc00,0xb8723b64,0x3bd90000,0xbaa7b61f
.long 0x80003c00,0xbc00,0x80003c00,0xbc00,0xb23ebc00,0x38723b64,0xbbd98000,0x3aa7b61f
.long 0x361f3c00,0xbb64b9a8,0xb61fbc00,0x3b6439a8,0xb872bc00,0x3bd9361f,0x3aa70000,0x323e3b64
.long 0x39a83c00,0xb9a88000,0x39a83c00,0xb9a88000,0xbaa7bc00,0x323eb61f,0xb8728000,0xbbd9bb64
.long 0x3b643c00,0x361f39a8,0xbb64bc00,0xb61fb9a8,0xbbd9bc00,0xbaa7bb64,0x323e0000,0x3872361f
.long 0x3c003c00,0x3c003c00,0x3c003c00,0x3c003c00,0xb872b9a8,0xb23eb61f,0x3aa739a8,0x3bd93b64
.long 0xb61f0000,0xbb64b9a8,0x361f8000,0x3b6439a8,0x3bd939a8,0x38723b64,0xb23eb9a8,0x3aa7361f
.long 0xb9a8bc00,0x39a88000,0xb9a8bc00,0x39a88000,0xb23e39a8,0xbaa7bb64,0xbbd9b9a8,0x3872b61f
.long 0x3b648000,0xb61f39a8,0xbb640000,0x361fb9a8,0xbaa7b9a8,0x3bd9361f,0xb87239a8,0x323ebb64
.long 0x3c00,0x8000bc00,0x3c00,0x8000bc00,0x3aa7b9a8,0xbbd9361f,0x387239a8,0xb23ebb64
.long 0xbb640000,0x361f39a8,0x3b648000,0xb61fb9a8,0x323e39a8,0x3aa7bb64,0x3bd9b9a8,0xb872b61f
.long 0x39a8bc00,0xb9a80000,0x39a8bc00,0xb9a80000,0xbbd939a8,0xb8723b64,0x323eb9a8,0xbaa7361f
.long 0x361f8000,0x3b64b9a8,0xb61f0000,0xbb6439a8,0x3872b9a8,0x323eb61f,0xbaa739a8,0xbbd93b64
.long 0xbc003c00,0xbc003c00,0xbc003c00,0xbc003c00,0x3872b9a8,0x323eb61f,0xbaa739a8,0xbbd93b64
.long 0x361f0000,0x3b64b9a8,0xb61f8000,0xbb6439a8,0xbbd939a8,0xb8723b64,0x323eb9a8,0xbaa7361f
.long 0x39a8bc00,0xb9a88000,0x39a8bc00,0xb9a88000,0x323e39a8,0x3aa7bb64,0x3bd9b9a8,0xb872b61f
.long 0xbb648000,0x361f39a8,0x3b640000,0xb61fb9a8,0x3aa7b9a8,0xbbd9361f,0x387239a8,0xb23ebb64
.long 0x80003c00,0xbc00,0x80003c00,0xbc00,0xbaa7b9a8,0x3bd9361f,0xb87239a8,0x323ebb64
.long 0x3b640000,0xb61f39a8,0xbb648000,0x361fb9a8,0xb23e39a8,0xbaa7bb64,0xbbd9b9a8,0x3872b61f
.long 0xb9a8bc00,0x39a80000,0xb9a8bc00,0x39a80000,0x3bd939a8,0x38723b64,0xb23eb9a8,0x3aa7361f
.long 0xb61f8000,0xbb64b9a8,0x361f0000,0x3b6439a8,0xb872b9a8,0xb23eb61f,0x3aa739a8,0x3bd93b64
.long 0x0,0x0,0x0,0x0,0x323e0000,0x3872361f,0x3bd93c00,0x3aa73b64
.long 0x361f0000,0x3b6439a8,0xb61f0000,0xbb64b9a8,0x38720000,0x3bd93b64,0xbaa7bc00,0x323eb61f
.long 0x39a80000,0x39a83c00,0x39a80000,0x39a83c00,0x3aa70000,0x323e3b64,0x38723c00,0xbbd9b61f
.long 0x3b640000,0xb61f39a8,0xbb640000,0x361fb9a8,0x3bd90000,0xbaa7361f,0xb23ebc00,0x38723b64
.long 0x3c000000,0xbc000000,0x3c000000,0xbc000000,0x3bd90000,0xbaa7b61f,0xb23e3c00,0x3872bb64
.long 0x3b640000,0xb61fb9a8,0xbb640000,0x361f39a8,0x3aa70000,0x323ebb64,0x3872bc00,0xbbd9361f
.long 0x39a80000,0x39a8bc00,0x39a80000,0x39a8bc00,0x38720000,0x3bd9bb64,0xbaa73c00,0x323e361f
.long 0x361f0000,0x3b64b9a8,0xb61f0000,0xbb6439a8,0x323e0000,0x3872b61f,0x3bd9bc00,0x3aa7bb64
.long 0x0,0x0,0x0,0x0,0xb23e0000,0xb872361f,0xbbd93c00,0xbaa73b64
.long 0xb61f0000,0xbb6439a8,0x361f0000,0x3b64b9a8,0xb8720000,0xbbd93b64,0x3aa7bc00,0xb23eb61f
.long 0xb9a80000,0xb9a83c00,0xb9a80000,0xb9a83c00,0xbaa70000,0xb23e3b64,0xb8723c00,0x3bd9b61f
.long 0xbb640000,0x361f39a8,0x3b640000,0xb61fb9a8,0xbbd90000,0x3aa7361f,0x323ebc00,0xb8723b64
.long 0xbc000000,0x3c000000,0xbc000000,0x3c000000,0xbbd90000,0x3aa7b61f,0x323e3c00,0xb872bb64
.long 0xbb640000,0x361fb9a8,0x3b640000,0xb61f39a8,0xbaa70000,0xb23ebb64,0xb872bc00,0x3bd9361f
.long 0xb9a80000,0xb9a8bc00,0xb9a80000,0xb9a8bc00,0xb8720000,0xbbd9bb64,0x3aa73c00,0xb23e361f
.long 0xb61f0000,0xbb64b9a8,0x361f0000,0x3b6439a8,0xb23e0000,0xb872b61f,0xbbd9bc00,0xbaa7bb64
.long 0x0,0x0,0x0,0x0,0x3aa739a8,0x3bd93b64,0x387239a8,0x323e361f
.long 0x3b643c00,0x361f39a8,0xbb64bc00,0xb61fb9a8,0x323e39a8,0xbaa7b61f,0x3bd939a8,0x38723b64
.long 0xb9a80000,0xb9a8bc00,0xb9a80000,0xb9a8bc00,0xbbd9b9a8,0x3872b61f,0x323eb9a8,0x3aa73b64
.long 0xb61fbc00,0x3b6439a8,0x361f3c00,0xbb64b9a8,0x3872b9a8,0xb23e3b64,0xbaa7b9a8,0x3bd9361f
.long 0x3c000000,0xbc000000,0x3c000000,0xbc000000,0x387239a8,0xb23ebb64,0xbaa739a8,0x3bd9b61f
.long 0xb61f3c00,0x3b64b9a8,0x361fbc00,0xbb6439a8,0xbbd939a8,0x3872361f,0x323e39a8,0x3aa7bb64
.long 0xb9a80000,0xb9a83c00,0xb9a80000,0xb9a83c00,0x323eb9a8,0xbaa7361f,0x3bd9b9a8,0x3872bb64
.long 0x3b64bc00,0x361fb9a8,0xbb643c00,0xb61f39a8,0x3aa7b9a8,0x3bd9bb64,0x3872b9a8,0x323eb61f
.long 0x0,0x0,0x0,0x0,0xbaa739a8,0xbbd93b64,0xb87239a8,0xb23e361f
.long 0xbb643c00,0xb61f39a8,0x3b64bc00,0x361fb9a8,0xb23e39a8,0x3aa7b61f,0xbbd939a8,0xb8723b64
.long 0x39a80000,0x39a8bc00,0x39a80000,0x39a8bc00,0x3bd9b9a8,0xb872b61f,0xb23eb9a8,0xbaa73b64
.long 0x361fbc00,0xbb6439a8,0xb61f3c00,0x3b64b9a8,0xb872b9a8,0x323e3b64,0x3aa7b9a8,0xbbd9361f
.long 0xbc000000,0x3c000000,0xbc000000,0x3c000000,0xb87239a8,0x323ebb64,0x3aa739a8,0xbbd9b61f
.long 0x361f3c00,0xbb64b9a8,0xb61fbc00,0x3b6439a8,0x3bd939a8,0xb872361f,0xb23e39a8,0xbaa7bb64
.long 0x39a80000,0x39a83c00,0x39a80000,0x39a83c00,0xb23eb9a8,0x3aa7361f,0xbbd9b9a8,0xb872bb64
.long 0xbb64bc00,0xb61fb9a8,0x3b643c00,0x361f39a8,0xbaa7b9a8,0xbbd9bb64,0xb872b9a8,0xb23eb61f
.long 0x0,0x0,0x0,0x0,0xb23e0000,0xb872b61f,0xbbd9bc00,0xbaa7bb64
.long 0x361f0000,0x3b6439a8,0xb61f0000,0xbb64b9a8,0xb8720000,0xbbd9bb64,0x3aa73c00,0xb23e361f
.long 0x39a80000,0x39a83c00,0x39a80000,0x39a83c00,0xbaa70000,0xb23ebb64,0xb872bc00,0x3bd9361f
.long 0x3b640000,0xb61f39a8,0xbb640000,0x361fb9a8,0xbbd90000,0x3aa7b61f,0x323e3c00,0xb872bb64
.long 0x3c000000,0xbc000000,0x3c000000,0xbc000000,0xbbd90000,0x3aa7361f,0x323ebc00,0xb8723b64
.long 0x3b640000,0xb61fb9a8,0xbb640000,0x361f39a8,0xbaa70000,0xb23e3b64,0xb8723c00,0x3bd9b61f
.long 0x39a80000,0x39a8bc00,0x39a80000,0x39a8bc00,0xb8720000,0xbbd93b64,0x3aa7bc00,0xb23eb61f
.long 0x361f0000,0x3b64b9a8,0xb61f0000,0xbb6439a8,0xb23e0000,0xb872361f,0xbbd93c00,0xbaa73b64
.long 0x0,0x0,0x0,0x0,0x323e0000,0x3872b61f,0x3bd9bc00,0x3aa7bb64
.long 0xb61f0000,0xbb6439a8,0x361f0000,0x3b64b9a8,0x38720000,0x3bd9bb64,0xbaa73c00,0x323e361f
.long 0xb9a80000,0xb9a83c00,0xb9a80000,0xb9a83c00,0x3aa70000,0x323ebb64,0x3872bc00,0xbbd9361f
.long 0xbb640000,0x361f39a8,0x3b640000,0xb61fb9a8,0x3bd90000,0xbaa7b61f,0xb23e3c00,0x3872bb64
.long 0xbc000000,0x3c000000,0xbc000000,0x3c000000,0x3bd90000,0xbaa7361f,0xb23ebc00,0x38723b64
.long 0xbb640000,0x361fb9a8,0x3b640000,0xb61f39a8,0x3aa70000,0x323e3b64,0x38723c00,0xbbd9b61f
.long 0xb9a80000,0xb9a8bc00,0xb9a80000,0xb9a8bc00,0x38720000,0x3bd93b64,0xbaa7bc00,0x323eb61f
.long 0xb61f0000,0xbb64b9a8,0x361f0000,0x3b6439a8,0x323e0000,0x3872361f,0x3bd93c00,0x3aa73b64
.long 0x0,0x0,0x0,0x0,0xbaa7b9a8,0xbbd9bb64,0xb872b9a8,0xb23eb61f
.long 0x3b643c00,0x361f39a8,0xbb64bc00,0xb61fb9a8,0xb23eb9a8,0x3aa7361f,0xbbd9b9a8,0xb872bb64
.long 0xb9a80000,0xb9a8bc00,0xb9a80000,0xb9a8bc00,0x3bd939a8,0xb872361f,0xb23e39a8,0xbaa7bb64
.long 0xb61fbc00,0x3b6439a8,0x361f3c00,0xbb64b9a8,0xb87239a8,0x323ebb64,0x3aa739a8,0xbbd9b61f
.long 0x3c000000,0xbc000000,0x3c000000,0xbc000000,0xb872b9a8,0x323e3b64,0x3aa7b9a8,0xbbd9361f
.long 0xb61f3c00,0x3b64b9a8,0x361fbc00,0xbb6439a8,0x3bd9b9a8,0xb872b61f,0xb23eb9a8,0xbaa73b64
.long 0xb9a80000,0xb9a83c00,0xb9a80000,0xb9a83c00,0xb23e39a8,0x3aa7b61f,0xbbd939a8,0xb8723b64
.long 0x3b64bc00,0x361fb9a8,0xbb643c00,0xb61f39a8,0xbaa739a8,0xbbd93b64,0xb87239a8,0xb23e361f
.long 0x0,0x0,0x0,0x0,0x3aa7b9a8,0x3bd9bb64,0x3872b9a8,0x323eb61f
.long 0xbb643c00,0xb61f39a8,0x3b64bc00,0x361fb9a8,0x323eb9a8,0xbaa7361f,0x3bd9b9a8,0x3872bb64
.long 0x39a80000,0x39a8bc00,0x39a80000,0x39a8bc00,0xbbd939a8,0x3872361f,0x323e39a8,0x3aa7bb64
.long 0x361fbc00,0xbb6439a8,0xb61f3c00,0x3b64b9a8,0x387239a8,0xb23ebb64,0xbaa739a8,0x3bd9b61f
.long 0xbc000000,0x3c000000,0xbc000000,0x3c000000,0x3872b9a8,0xb23e3b64,0xbaa7b9a8,0x3bd9361f
.long 0x361f3c00,0xbb64b9a8,0xb61fbc00,0x3b6439a8,0xbbd9b9a8,0x3872b61f,0x323eb9a8,0x3aa73b64
.long 0x39a80000,0x39a83c00,0x39a80000,0x39a83c00,0x323e39a8,0xbaa7b61f,0x3bd939a8,0x38723b64
.long 0xbb64bc00,0xb61fb9a8,0x3b643c00,0x361f39a8,0x3aa739a8,0x3bd93b64,0x387239a8,0x323e361f
.long 0x80008000,0x80008000,0x80008000,0x80008000,0xb23e8000,0xb872b61f,0xbbd9bc00,0xbaa7bb64
.long 0xb61f8000,0xbb64b9a8,0x361f8000,0x3b6439a8,0xb8728000,0xbbd9bb64,0x3aa73c00,0xb23e361f
.long 0xb9a88000,0xb9a8bc00,0xb9a88000,0xb9a8bc00,0xbaa78000,0xb23ebb64,0xb872bc00,0x3bd9361f
.long 0xbb648000,0x361fb9a8,0x3b648000,0xb61f39a8,0xbbd98000,0x3aa7b61f,0x323e3c00,0xb872bb64
.long 0xbc008000,0x3c008000,0xbc008000,0x3c008000,0xbbd98000,0x3aa7361f,0x323ebc00,0xb8723b64
.long 0xbb648000,0x361f39a8,0x3b648000,0xb61fb9a8,0xbaa78000,0xb23e3b64,0xb8723c00,0x3bd9b61f
.long 0xb9a88000,0xb9a83c00,0xb9a88000,0xb9a83c00,0xb8728000,0xbbd93b64,0x3aa7bc00,0xb23eb61f
.long 0xb61f8000,0xbb6439a8,0x361f8000,0x3b64b9a8,0xb23e8000,0xb872361f,0xbbd93c00,0xbaa73b64
.long 0x80008000,0x80008000,0x80008000,0x80008000,0x323e8000,0x3872b61f,0x3bd9bc00,0x3aa7bb64
.long 0x361f8000,0x3b64b9a8,0xb61f8000,0xbb6439a8,0x38728000,0x3bd9bb64,0xbaa73c00,0x323e361f
.long 0x39a88000,0x39a8bc00,0x39a88000,0x39a8bc00,0x3aa78000,0x323ebb64,0x3872bc00,0xbbd9361f
.long 0x3b648000,0xb61fb9a8,0xbb648000,0x361f39a8,0x3bd98000,0xbaa7b61f,0xb23e3c00,0x3872bb64
.long 0x3c008000,0xbc008000,0x3c008000,0xbc008000,0x3bd98000,0xbaa7361f,0xb23ebc00,0x38723b64
.long 0x3b648000,0xb61f39a8,0xbb648000,0x361fb9a8,0x3aa78000,0x323e3b64,0x38723c00,0xbbd9b61f
.long 0x39a88000,0x39a83c00,0x39a88000,0x39a83c00,0x38728000,0x3bd93b64,0xbaa7bc00,0x323eb61f
.long 0x361f8000,0x3b6439a8,0xb61f8000,0xbb64b9a8,0x323e8000,0x3872361f,0x3bd93c00,0x3aa73b64
.long 0x80008000,0x80008000,0x80008000,0x80008000,0xbaa7b9a8,0xbbd9bb64,0xb872b9a8,0xb23eb61f
.long 0xbb64bc00,0xb61fb9a8,0x3b643c00,0x361f39a8,0xb23eb9a8,0x3aa7361f,0xbbd9b9a8,0xb872bb64
.long 0x39a88000,0x39a83c00,0x39a88000,0x39a83c00,0x3bd939a8,0xb872361f,0xb23e39a8,0xbaa7bb64
.long 0x361f3c00,0xbb64b9a8,0xb61fbc00,0x3b6439a8,0xb87239a8,0x323ebb64,0x3aa739a8,0xbbd9b61f
.long 0xbc008000,0x3c008000,0xbc008000,0x3c008000,0xb872b9a8,0x323e3b64,0x3aa7b9a8,0xbbd9361f
.long 0x361fbc00,0xbb6439a8,0xb61f3c00,0x3b64b9a8,0x3bd9b9a8,0xb872b61f,0xb23eb9a8,0xbaa73b64
.long 0x39a88000,0x39a8bc00,0x39a88000,0x39a8bc00,0xb23e39a8,0x3aa7b61f,0xbbd939a8,0xb8723b64
.long 0xbb643c00,0xb61f39a8,0x3b64bc00,0x361fb9a8,0xbaa739a8,0xbbd93b64,0xb87239a8,0xb23e361f
.long 0x80008000,0x80008000,0x80008000,0x80008000,0x3aa7b9a8,0x3bd9bb64,0x3872b9a8,0x323eb61f
.long 0x3b64bc00,0x361fb9a8,0xbb643c00,0xb61f39a8,0x323eb9a8,0xbaa7361f,0x3bd9b9a8,0x3872bb64
.long 0xb9a88000,0xb9a83c00,0xb9a88000,0xb9a83c00,0xbbd939a8,0x3872361f,0x323e39a8,0x3aa7bb64
.long 0xb61f3c00,0x3b64b9a8,0x361fbc00,0xbb6439a8,0x387239a8,0xb23ebb64,0xbaa739a8,0x3bd9b61f
.long 0x3c008000,0xbc008000,0x3c008000,0xbc008000,0x3872b9a8,0xb23e3b64,0xbaa7b9a8,0x3bd9361f
.long 0xb61fbc00,0x3b6439a8,0x361f3c00,0xbb64b9a8,0xbbd9b9a8,0x3872b61f,0x323eb9a8,0x3aa73b64
.long 0xb9a88000,0xb9a8bc00,0xb9a88000,0xb9a8bc00,0x323e39a8,0xbaa7b61f,0x3bd939a8,0x38723b64
.long 0x3b643c00,0x361f39a8,0xbb64bc00,0xb61fb9a8,0x3aa739a8,0x3bd93b64,0x387239a8,0x323e361f
.long 0x80008000,0x80008000,0x80008000,0x80008000,0x323e8000,0x3872361f,0x3bd93c00,0x3aa73b64
.long 0xb61f8000,0xbb64b9a8,0x361f8000,0x3b6439a8,0x38728000,0x3bd93b64,0xbaa7bc00,0x323eb61f
.long 0xb9a88000,0xb9a8bc00,0xb9a88000,0xb9a8bc00,0x3aa78000,0x323e3b64,0x38723c00,0xbbd9b61f
.long 0xbb648000,0x361fb9a8,0x3b648000,0xb61f39a8,0x3bd98000,0xbaa7361f,0xb23ebc00,0x38723b64
.long 0xbc008000,0x3c008000,0xbc008000,0x3c008000,0x3bd98000,0xbaa7b61f,0xb23e3c00,0x3872bb64
.long 0xbb648000,0x361f39a8,0x3b648000,0xb61fb9a8,0x3aa78000,0x323ebb64,0x3872bc00,0xbbd9361f
.long 0xb9a88000,0xb9a83c00,0xb9a88000,0xb9a83c00,0x38728000,0x3bd9bb64,0xbaa73c00,0x323e361f
.long 0xb61f8000,0xbb6439a8,0x361f8000,0x3b64b9a8,0x323e8000,0x3872b61f,0x3bd9bc00,0x3aa7bb64
.long 0x80008000,0x80008000,0x80008000,0x80008000,0xb23e8000,0xb872361f,0xbbd93c00,0xbaa73b64
.long 0x361f8000,0x3b64b9a8,0xb61f8000,0xbb6439a8,0xb8728000,0xbbd93b64,0x3aa7bc00,0xb23eb61f
.long 0x39a88000,0x39a8bc00,0x39a88000,0x39a8bc00,0xbaa78000,0xb23e3b64,0xb8723c00,0x3bd9b61f
.long 0x3b648000,0xb61fb9a8,0xbb648000,0x361f39a8,0xbbd98000,0x3aa7361f,0x323ebc00,0xb8723b64
.long 0x3c008000,0xbc008000,0x3c008000,0xbc008000,0xbbd98000,0x3aa7b61f,0x323e3c00,0xb872bb64
.long 0x3b648000,0xb61f39a8,0xbb648000,0x361fb9a8,0xbaa78000,0xb23ebb64,0xb872bc00,0x3bd9361f
.long 0x39a88000,0x39a83c00,0x39a88000,0x39a83c00,0xb8728000,0xbbd9bb64,0x3aa73c00,0xb23e361f
.long 0x361f8000,0x3b6439a8,0xb61f8000,0xbb64b9a8,0xb23e8000,0xb872b61f,0xbbd9bc00,0xbaa7bb64
.long 0x80008000,0x80008000,0x80008000,0x80008000,0x3aa739a8,0x3bd93b64,0x387239a8,0x323e361f
.long 0xbb64bc00,0xb61fb9a8,0x3b643c00,0x361f39a8,0x323e39a8,0xbaa7b61f,0x3bd939a8,0x38723b64
.long 0x39a88000,0x39a83c00,0x39a88000,0x39a83c00,0xbbd9b9a8,0x3872b61f,0x323eb9a8,0x3aa73b64
.long 0x361f3c00,0xbb64b9a8,0xb61fbc00,0x3b6439a8,0x3872b9a8,0xb23e3b64,0xbaa7b9a8,0x3bd9361f
.long 0xbc008000,0x3c008000,0xbc008000,0x3c008000,0x387239a8,0xb23ebb64,0xbaa739a8,0x3bd9b61f
.long 0x361fbc00,0xbb6439a8,0xb61f3c00,0x3b64b9a8,0xbbd939a8,0x3872361f,0x323e39a8,0x3aa7bb64
.long 0x39a88000,0x39a8bc00,0x39a88000,0x39a8bc00,0x323eb9a8,0xbaa7361f,0x3bd9b9a8,0x3872bb64
.long 0xbb643c00,0xb61f39a8,0x3b64bc00,0x361fb9a8,0x3aa7b9a8,0x3bd9bb64,0x3872b9a8,0x323eb61f
.long 0x80008000,0x80008000,0x80008000,0x80008000,0xbaa739a8,0xbbd93b64,0xb87239a8,0xb23e361f
.long 0x3b64bc00,0x361fb9a8,0xbb643c00,0xb61f39a8,0xb23e39a8,0x3aa7b61f,0xbbd939a8,0xb8723b64
.long 0xb9a88000,0xb9a83c00,0xb9a88000,0xb9a83c00,0x3bd9b9a8,0xb872b61f,0xb23eb9a8,0xbaa73b64
.long 0xb61f3c00,0x3b64b9a8,0x361fbc00,0xbb6439a8,0xb872b9a8,0x323e3b64,0x3aa7b9a8,0xbbd9361f
.long 0x3c008000,0xbc008000,0x3c008000,0xbc008000,0xb87239a8,0x323ebb64,0x3aa739a8,0xbbd9b61f
.long 0xb61fbc00,0x3b6439a8,0x361f3c00,0xbb64b9a8,0x3bd939a8,0xb872361f,0xb23e39a8,0xbaa7bb64
.long 0xb9a88000,0xb9a8bc00,0xb9a88000,0xb9a8bc00,0xb23eb9a8,0x3aa7361f,0xbbd9b9a8,0xb872bb64
.long 0x3b643c00,0x361f39a8,0xbb64bc00,0xb61fb9a8,0xbaa7b9a8,0xbbd9bb64,0xb872b9a8,0xb23eb61f
.long 0x3c003c00,0x3c003c00,0x3c003c00,0x3c003c00,0x3bf63c00,0x3ba83bd9,0x391339a8,0x378b3872
.long 0x3bd93c00,0x3aa73b64,0xb23e0000,0xb872b61f,0x3ba83c00,0x39133aa7,0xbb0eb9a8,0xbbf6bbd9
.long 0x3b643c00,0x361f39a8,0xbb64bc00,0xb61fb9a8,0x3b0e3c00,0x2e463872,0xb4a5b9a8,0x3913323e
.long 0x3aa73c00,0xb23e361f,0x38728000,0x3bd93b64,0x3a2f3c00,0xb78b323e,0x3bf639a8,0x34a53aa7
.long 0x39a83c00,0xb9a80000,0x39a83c00,0xb9a80000,0x39133c00,0xbb0eb23e,0xae4639a8,0xbba8baa7
.long 0x38723c00,0xbbd9b61f,0xbaa70000,0xb23ebb64,0x378b3c00,0xbbf6b872,0xbba8b9a8,0x3a2fb23e
.long 0x361f3c00,0xbb64b9a8,0xb61fbc00,0x3b6439a8,0x34a53c00,0xba2fbaa7,0x378bb9a8,0x2e463bd9
.long 0x323e3c00,0xb872bb64,0x3bd98000,0xbaa7361f,0x2e463c00,0xb4a5bbd9,0x3a2f39a8,0xbb0eb872
.long 0x3c00,0x8000bc00,0x3c00,0x8000bc00,0xae463c00,0x34a5bbd9,0xba2f39a8,0x3b0eb872
.long 0xb23e3c00,0x3872bb64,0xbbd90000,0x3aa7361f,0xb4a53c00,0x3a2fbaa7,0xb78bb9a8,0xae463bd9
.long 0xb61f3c00,0x3b64b9a8,0x361fbc00,0xbb6439a8,0xb78b3c00,0x3bf6b872,0x3ba8b9a8,0xba2fb23e
.long 0xb8723c00,0x3bd9b61f,0x3aa78000,0x323ebb64,0xb9133c00,0x3b0eb23e,0x2e4639a8,0x3ba8baa7
.long 0xb9a83c00,0x39a88000,0xb9a83c00,0x39a88000,0xba2f3c00,0x378b323e,0xbbf639a8,0xb4a53aa7
.long 0xbaa73c00,0x323e361f,0xb8720000,0xbbd93b64,0xbb0e3c00,0xae463872,0x34a5b9a8,0xb913323e
.long 0xbb643c00,0xb61f39a8,0x3b64bc00,0x361fb9a8,0xbba83c00,0xb9133aa7,0x3b0eb9a8,0x3bf6bbd9
.long 0xbbd93c00,0xbaa73b64,0x323e8000,0x3872b61f,0xbbf63c00,0xbba83bd9,0xb91339a8,0xb78b3872
.long 0x3c003c00,0x3c003c00,0x3c003c00,0x3c003c00,0x3b0e3b64,0x3a2f3aa7,0x34a5361f,0x2e46323e
.long 0x387239a8,0x323e361f,0xbaa7b9a8,0xbbd9bb64,0x2e46361f,0xb78bb23e,0xba2fbb64,0xb4a5b872
.long 0xb61f0000,0xbb64b9a8,0x361f8000,0x3b6439a8,0xba2fb61f,0xbba8bbd9,0x3bf63b64,0x378b3aa7
.long 0xbbd9b9a8,0xb872bb64,0x323e39a8,0xbaa7b61f,0xbba8bb64,0x2e46b872,0xbb0eb61f,0xb913bbd9
.long 0xb9a8bc00,0x39a88000,0xb9a8bc00,0x39a88000,0xb4a5bb64,0x3bf63872,0x378bb61f,0x3a2f3bd9
.long 0x323eb9a8,0x3aa73b64,0x3bd939a8,0xb872361f,0x3913b61f,0x34a53bd9,0x2e463b64,0xbb0ebaa7
.long 0x3b648000,0xb61f39a8,0xbb640000,0x361fb9a8,0x3bf6361f,0xbb0e323e,0xb913bb64,0x3ba83872
.long 0x3aa739a8,0xbbd9b61f,0x3872b9a8,0xb23e3b64,0x378b3b64,0xb913baa7,0x3ba8361f,0xbbf6b23e
.long 0x3c00,0x8000bc00,0x3c00,0x8000bc00,0xb78b3b64,0x3913baa7,0xbba8361f,0x3bf6b23e
.long 0xbaa739a8,0x3bd9b61f,0xb872b9a8,0x323e3b64,0xbbf6361f,0x3b0e323e,0x3913bb64,0xbba83872
.long 0xbb640000,0x361f39a8,0x3b648000,0xb61fb9a8,0xb913b61f,0xb4a53bd9,0xae463b64,0x3b0ebaa7
.long 0xb23eb9a8,0xbaa73b64,0xbbd939a8,0x3872361f,0x34a5bb64,0xbbf63872,0xb78bb61f,0xba2f3bd9
.long 0x39a8bc00,0xb9a80000,0x39a8bc00,0xb9a80000,0x3ba8bb64,0xae46b872,0x3b0eb61f,0x3913bbd9
.long 0x3bd9b9a8,0x3872bb64,0xb23e39a8,0x3aa7b61f,0x3a2fb61f,0x3ba8bbd9,0xbbf63b64,0xb78b3aa7
.long 0x361f8000,0x3b64b9a8,0xb61f0000,0xbb6439a8,0xae46361f,0x378bb23e,0x3a2fbb64,0x34a5b872
.long 0xb87239a8,0xb23e361f,0x3aa7b9a8,0x3bd9bb64,0xbb0e3b64,0xba2f3aa7,0xb4a5361f,0xae46323e
.long 0x3c003c00,0x3c003c00,0x3c003c00,0x3c003c00,0xae460000,0xb4a5b23e,0xba2fb9a8,0xbb0ebaa7
.long 0xbbd9bc00,0xbaa7bb64,0x323e8000,0x3872361f,0x34a58000,0x3a2f3872,0x378b39a8,0xae46323e
.long 0x3b643c00,0x361f39a8,0xbb64bc00,0xb61fb9a8,0xb78b0000,0xbbf6baa7,0x3ba839a8,0x3a2f3bd9
.long 0xbaa7bc00,0x323eb61f,0xb8720000,0xbbd9bb64,0x39138000,0x3b0e3bd9,0xae46b9a8,0x3ba83872
.long 0x39a83c00,0xb9a80000,0x39a83c00,0xb9a80000,0xba2f0000,0xb78bbbd9,0xbbf6b9a8,0x34a5b872
.long 0xb872bc00,0x3bd9361f,0x3aa78000,0x323e3b64,0x3b0e8000,0xae463aa7,0xb4a539a8,0xb913bbd9
.long 0x361f3c00,0xbb64b9a8,0xb61fbc00,0x3b6439a8,0xbba80000,0x3913b872,0x3b0e39a8,0xbbf6b23e
.long 0xb23ebc00,0x38723b64,0xbbd90000,0x3aa7b61f,0x3bf68000,0xbba8323e,0x3913b9a8,0xb78b3aa7
.long 0x3c00,0x8000bc00,0x3c00,0x8000bc00,0xbbf60000,0x3ba8323e,0xb913b9a8,0x378b3aa7
.long 0x323ebc00,0xb8723b64,0x3bd98000,0xbaa7b61f,0x3ba88000,0xb913b872,0xbb0e39a8,0x3bf6b23e
.long 0xb61f3c00,0x3b64b9a8,0x361fbc00,0xbb6439a8,0xbb0e0000,0x2e463aa7,0x34a539a8,0x3913bbd9
.long 0x3872bc00,0xbbd9361f,0xbaa70000,0xb23e3b64,0x3a2f8000,0x378bbbd9,0x3bf6b9a8,0xb4a5b872
.long 0xb9a83c00,0x39a88000,0xb9a83c00,0x39a88000,0xb9130000,0xbb0e3bd9,0x2e46b9a8,0xbba83872
.long 0x3aa7bc00,0xb23eb61f,0x38728000,0x3bd9bb64,0x378b8000,0x3bf6baa7,0xbba839a8,0xba2f3bd9
.long 0xbb643c00,0xb61f39a8,0x3b64bc00,0x361fb9a8,0xb4a50000,0xba2f3872,0xb78b39a8,0x2e46323e
.long 0x3bd9bc00,0x3aa7bb64,0xb23e0000,0xb872361f,0x2e468000,0x34a5b23e,0x3a2fb9a8,0x3b0ebaa7
.long 0x3c003c00,0x3c003c00,0x3c003c00,0x3c003c00,0xb78bb61f,0xb913b872,0xbba8bb64,0xbbf6bbd9
.long 0xb872b9a8,0xb23eb61f,0x3aa739a8,0x3bd93b64,0x3bf63b64,0x3b0e3bd9,0xb913b61f,0xbba8baa7
.long 0xb61f0000,0xbb64b9a8,0x361f8000,0x3b6439a8,0xb913bb64,0x34a5b23e,0xae46361f,0xbb0eb872
.long 0x3bd939a8,0x38723b64,0xb23eb9a8,0x3aa7361f,0xb4a5361f,0xbbf6baa7,0x378b3b64,0xba2fb23e
.long 0xb9a8bc00,0x39a88000,0xb9a8bc00,0x39a88000,0x3ba8361f,0x2e463aa7,0x3b0e3b64,0xb913323e
.long 0xb23e39a8,0xbaa7bb64,0xbbd9b9a8,0x3872b61f,0xba2fbb64,0x3ba8323e,0x3bf6361f,0xb78b3872
.long 0x3b648000,0xb61f39a8,0xbb640000,0x361fb9a8,0xae463b64,0xb78bbbd9,0x3a2fb61f,0xb4a53aa7
.long 0xbaa7b9a8,0x3bd9361f,0xb87239a8,0x323ebb64,0x3b0eb61f,0xba2f3872,0x34a5bb64,0xae463bd9
.long 0x3c00,0x8000bc00,0x3c00,0x8000bc00,0xbb0eb61f,0x3a2f3872,0xb4a5bb64,0x2e463bd9
.long 0x3aa7b9a8,0xbbd9361f,0x387239a8,0xb23ebb64,0x2e463b64,0x378bbbd9,0xba2fb61f,0x34a53aa7
.long 0xbb640000,0x361f39a8,0x3b648000,0xb61fb9a8,0x3a2fbb64,0xbba8323e,0xbbf6361f,0x378b3872
.long 0x323e39a8,0x3aa7bb64,0x3bd9b9a8,0xb872b61f,0xbba8361f,0xae463aa7,0xbb0e3b64,0x3913323e
.long 0x39a8bc00,0xb9a80000,0x39a8bc00,0xb9a80000,0x34a5361f,0x3bf6baa7,0xb78b3b64,0x3a2fb23e
.long 0xbbd939a8,0xb8723b64,0x323eb9a8,0xbaa7361f,0x3913bb64,0xb4a5b23e,0x2e46361f,0x3b0eb872
.long 0x361f8000,0x3b64b9a8,0xb61f0000,0xbb6439a8,0xbbf63b64,0xbb0e3bd9,0x3913b61f,0x3ba8baa7
.long 0x3872b9a8,0x323eb61f,0xbaa739a8,0xbbd93b64,0x378bb61f,0x3913b872,0x3ba8bb64,0x3bf6bbd9
.long 0x3c003c00,0x3c003c00,0x3c003c00,0x3c003c00,0xbbf6bc00,0xbba8bbd9,0xb913b9a8,0xb78bb872
.long 0x3bd93c00,0x3aa73b64,0xb23e0000,0xb872b61f,0xbba8bc00,0xb913baa7,0x3b0e39a8,0x3bf63bd9
.long 0x3b643c00,0x361f39a8,0xbb64bc00,0xb61fb9a8,0xbb0ebc00,0xae46b872,0x34a539a8,0xb913b23e
.long 0x3aa73c00,0xb23e361f,0x38728000,0x3bd93b64,0xba2fbc00,0x378bb23e,0xbbf6b9a8,0xb4a5baa7
.long 0x39a83c00,0xb9a80000,0x39a83c00,0xb9a80000,0xb913bc00,0x3b0e323e,0x2e46b9a8,0x3ba83aa7
.long 0x38723c00,0xbbd9b61f,0xbaa70000,0xb23ebb64,0xb78bbc00,0x3bf63872,0x3ba839a8,0xba2f323e
.long 0x361f3c00,0xbb64b9a8,0xb61fbc00,0x3b6439a8,0xb4a5bc00,0x3a2f3aa7,0xb78b39a8,0xae46bbd9
.long 0x323e3c00,0xb872bb64,0x3bd98000,0xbaa7361f,0xae46bc00,0x34a53bd9,0xba2fb9a8,0x3b0e3872
.long 0x3c00,0x8000bc00,0x3c00,0x8000bc00,0x2e46bc00,0xb4a53bd9,0x3a2fb9a8,0xbb0e3872
.long 0xb23e3c00,0x3872bb64,0xbbd90000,0x3aa7361f,0x34a5bc00,0xba2f3aa7,0x378b39a8,0x2e46bbd9
.long 0xb61f3c00,0x3b64b9a8,0x361fbc00,0xbb6439a8,0x378bbc00,0xbbf63872,0xbba839a8,0x3a2f323e
.long 0xb8723c00,0x3bd9b61f,0x3aa78000,0x323ebb64,0x3913bc00,0xbb0e323e,0xae46b9a8,0xbba83aa7
.long 0xb9a83c00,0x39a88000,0xb9a83c00,0x39a88000,0x3a2fbc00,0xb78bb23e,0x3bf6b9a8,0x34a5baa7
.long 0xbaa73c00,0x323e361f,0xb8720000,0xbbd93b64,0x3b0ebc00,0x2e46b872,0xb4a539a8,0x3913b23e
.long 0xbb643c00,0xb61f39a8,0x3b64bc00,0x361fb9a8,0x3ba8bc00,0x3913baa7,0xbb0e39a8,0xbbf63bd9
.long 0xbbd93c00,0xbaa73b64,0x323e8000,0x3872b61f,0x3bf6bc00,0x3ba8bbd9,0x3913b9a8,0x378bb872
.long 0x3c003c00,0x3c003c00,0x3c003c00,0x3c003c00,0xbb0ebb64,0xba2fbaa7,0xb4a5b61f,0xae46b23e
.long 0x387239a8,0x323e361f,0xbaa7b9a8,0xbbd9bb64,0xae46b61f,0x378b323e,0x3a2f3b64,0x34a53872
.long 0xb61f0000,0xbb64b9a8,0x361f8000,0x3b6439a8,0x3a2f361f,0x3ba83bd9,0xbbf6bb64,0xb78bbaa7
.long 0xbbd9b9a8,0xb872bb64,0x323e39a8,0xbaa7b61f,0x3ba83b64,0xae463872,0x3b0e361f,0x39133bd9
.long 0xb9a8bc00,0x39a88000,0xb9a8bc00,0x39a88000,0x34a53b64,0xbbf6b872,0xb78b361f,0xba2fbbd9
.long 0x323eb9a8,0x3aa73b64,0x3bd939a8,0xb872361f,0xb913361f,0xb4a5bbd9,0xae46bb64,0x3b0e3aa7
.long 0x3b648000,0xb61f39a8,0xbb640000,0x361fb9a8,0xbbf6b61f,0x3b0eb23e,0x39133b64,0xbba8b872
.long 0x3aa739a8,0xbbd9b61f,0x3872b9a8,0xb23e3b64,0xb78bbb64,0x39133aa7,0xbba8b61f,0x3bf6323e
.long 0x3c00,0x8000bc00,0x3c00,0x8000bc00,0x378bbb64,0xb9133aa7,0x3ba8b61f,0xbbf6323e
.long 0xbaa739a8,0x3bd9b61f,0xb872b9a8,0x323e3b64,0x3bf6b61f,0xbb0eb23e,0xb9133b64,0x3ba8b872
.long 0xbb640000,0x361f39a8,0x3b648000,0xb61fb9a8,0x3913361f,0x34a5bbd9,0x2e46bb64,0xbb0e3aa7
.long 0xb23eb9a8,0xbaa73b64,0xbbd939a8,0x3872361f,0xb4a53b64,0x3bf6b872,0x378b361f,0x3a2fbbd9
.long 0x39a8bc00,0xb9a80000,0x39a8bc00,0xb9a80000,0xbba83b64,0x2e463872,0xbb0e361f,0xb9133bd9
.long 0x3bd9b9a8,0x3872bb64,0xb23e39a8,0x3aa7b61f,0xba2f361f,0xbba83bd9,0x3bf6bb64,0x378bbaa7
.long 0x361f8000,0x3b64b9a8,0xb61f0000,0xbb6439a8,0x2e46b61f,0xb78b323e,0xba2f3b64,0xb4a53872
.long 0xb87239a8,0xb23e361f,0x3aa7b9a8,0x3bd9bb64,0x3b0ebb64,0x3a2fbaa7,0x34a5b61f,0x2e46b23e
.long 0x3c003c00,0x3c003c00,0x3c003c00,0x3c003c00,0x2e468000,0x34a5323e,0x3a2f39a8,0x3b0e3aa7
.long 0xbbd9bc00,0xbaa7bb64,0x323e8000,0x3872361f,0xb4a50000,0xba2fb872,0xb78bb9a8,0x2e46b23e
.long 0x3b643c00,0x361f39a8,0xbb64bc00,0xb61fb9a8,0x378b8000,0x3bf63aa7,0xbba8b9a8,0xba2fbbd9
.long 0xbaa7bc00,0x323eb61f,0xb8720000,0xbbd9bb64,0xb9130000,0xbb0ebbd9,0x2e4639a8,0xbba8b872
.long 0x39a83c00,0xb9a80000,0x39a83c00,0xb9a80000,0x3a2f8000,0x378b3bd9,0x3bf639a8,0xb4a53872
.long 0xb872bc00,0x3bd9361f,0x3aa78000,0x323e3b64,0xbb0e0000,0x2e46baa7,0x34a5b9a8,0x39133bd9
.long 0x361f3c00,0xbb64b9a8,0xb61fbc00,0x3b6439a8,0x3ba88000,0xb9133872,0xbb0eb9a8,0x3bf6323e
.long 0xb23ebc00,0x38723b64,0xbbd90000,0x3aa7b61f,0xbbf60000,0x3ba8b23e,0xb91339a8,0x378bbaa7
.long 0x3c00,0x8000bc00,0x3c00,0x8000bc00,0x3bf68000,0xbba8b23e,0x391339a8,0xb78bbaa7
.long 0x323ebc00,0xb8723b64,0x3bd98000,0xbaa7b61f,0xbba80000,0x39133872,0x3b0eb9a8,0xbbf6323e
.long 0xb61f3c00,0x3b64b9a8,0x361fbc00,0xbb6439a8,0x3b0e8000,0xae46baa7,0xb4a5b9a8,0xb9133bd9
.long 0x3872bc00,0xbbd9361f,0xbaa70000,0xb23e3b64,0xba2f0000,0xb78b3bd9,0xbbf639a8,0x34a53872
.long 0xb9a83c00,0x39a88000,0xb9a83c00,0x39a88000,0x39138000,0x3b0ebbd9,0xae4639a8,0x3ba8b872
.long 0x3aa7bc00,0xb23eb61f,0x38728000,0x3bd9bb64,0xb78b0000,0xbbf63aa7,0x3ba8b9a8,0x3a2fbbd9
.long 0xbb643c00,0xb61f39a8,0x3b64bc00,0x361fb9a8,0x34a58000,0x3a2fb872,0x378bb9a8,0xae46b23e
.long 0x3bd9bc00,0x3aa7bb64,0xb23e0000,0xb872361f,0xae460000,0xb4a5323e,0xba2f39a8,0xbb0e3aa7
.long 0x3c003c00,0x3c003c00,0x3c003c00,0x3c003c00,0x378b361f,0x39133872,0x3ba83b64,0x3bf63bd9
.long 0xb872b9a8,0xb23eb61f,0x3aa739a8,0x3bd93b64,0xbbf6bb64,0xbb0ebbd9,0x3913361f,0x3ba83aa7
.long 0xb61f0000,0xbb64b9a8,0x361f8000,0x3b6439a8,0x39133b64,0xb4a5323e,0x2e46b61f,0x3b0e3872
.long 0x3bd939a8,0x38723b64,0xb23eb9a8,0x3aa7361f,0x34a5b61f,0x3bf63aa7,0xb78bbb64,0x3a2f323e
.long 0xb9a8bc00,0x39a88000,0xb9a8bc00,0x39a88000,0xbba8b61f,0xae46baa7,0xbb0ebb64,0x3913b23e
.long 0xb23e39a8,0xbaa7bb64,0xbbd9b9a8,0x3872b61f,0x3a2f3b64,0xbba8b23e,0xbbf6b61f,0x378bb872
.long 0x3b648000,0xb61f39a8,0xbb640000,0x361fb9a8,0x2e46bb64,0x378b3bd9,0xba2f361f,0x34a5baa7
.long 0xbaa7b9a8,0x3bd9361f,0xb87239a8,0x323ebb64,0xbb0e361f,0x3a2fb872,0xb4a53b64,0x2e46bbd9
.long 0x3c00,0x8000bc00,0x3c00,0x8000bc00,0x3b0e361f,0xba2fb872,0x34a53b64,0xae46bbd9
.long 0x3aa7b9a8,0xbbd9361f,0x387239a8,0xb23ebb64,0xae46bb64,0xb78b3bd9,0x3a2f361f,0xb4a5baa7
.long 0xbb640000,0x361f39a8,0x3b648000,0xb61fb9a8,0xba2f3b64,0x3ba8b23e,0x3bf6b61f,0xb78bb872
.long 0x323e39a8,0x3aa7bb64,0x3bd9b9a8,0xb872b61f,0x3ba8b61f,0x2e46baa7,0x3b0ebb64,0xb913b23e
.long 0x39a8bc00,0xb9a80000,0x39a8bc00,0xb9a80000,0xb4a5b61f,0xbbf63aa7,0x378bbb64,0xba2f323e
.long 0xbbd939a8,0xb8723b64,0x323eb9a8,0xbaa7361f,0xb9133b64,0x34a5323e,0xae46b61f,0xbb0e3872
.long 0x361f8000,0x3b64b9a8,0xb61f0000,0xbb6439a8,0x3bf6bb64,0x3b0ebbd9,0xb913361f,0xbba83aa7
.long 0x3872b9a8,0x323eb61f,0xbaa739a8,0xbbd93b64,0xb78b361f,0xb9133872,0xbba83b64,0xbbf63bd9
.long 0xbc003c00,0xbc003c00,0xbc003c00,0xbc003c00,0xbbf63c00,0xbba83bd9,0xb91339a8,0xb78b3872
.long 0xbbd93c00,0xbaa73b64,0x323e0000,0x3872b61f,0xbba83c00,0xb9133aa7,0x3b0eb9a8,0x3bf6bbd9
.long 0xbb643c00,0xb61f39a8,0x3b64bc00,0x361fb9a8,0xbb0e3c00,0xae463872,0x34a5b9a8,0xb913323e
.long 0xbaa73c00,0x323e361f,0xb8728000,0xbbd93b64,0xba2f3c00,0x378b323e,0xbbf639a8,0xb4a53aa7
.long 0xb9a83c00,0x39a80000,0xb9a83c00,0x39a80000,0xb9133c00,0x3b0eb23e,0x2e4639a8,0x3ba8baa7
.long 0xb8723c00,0x3bd9b61f,0x3aa70000,0x323ebb64,0xb78b3c00,0x3bf6b872,0x3ba8b9a8,0xba2fb23e
.long 0xb61f3c00,0x3b64b9a8,0x361fbc00,0xbb6439a8,0xb4a53c00,0x3a2fbaa7,0xb78bb9a8,0xae463bd9
.long 0xb23e3c00,0x3872bb64,0xbbd98000,0x3aa7361f,0xae463c00,0x34a5bbd9,0xba2f39a8,0x3b0eb872
.long 0x80003c00,0xbc00,0x80003c00,0xbc00,0x2e463c00,0xb4a5bbd9,0x3a2f39a8,0xbb0eb872
.long 0x323e3c00,0xb872bb64,0x3bd90000,0xbaa7361f,0x34a53c00,0xba2fbaa7,0x378bb9a8,0x2e463bd9
.long 0x361f3c00,0xbb64b9a8,0xb61fbc00,0x3b6439a8,0x378b3c00,0xbbf6b872,0xbba8b9a8,0x3a2fb23e
.long 0x38723c00,0xbbd9b61f,0xbaa78000,0xb23ebb64,0x39133c00,0xbb0eb23e,0xae4639a8,0xbba8baa7
.long 0x39a83c00,0xb9a88000,0x39a83c00,0xb9a88000,0x3a2f3c00,0xb78b323e,0x3bf639a8,0x34a53aa7
.long 0x3aa73c00,0xb23e361f,0x38720000,0x3bd93b64,0x3b0e3c00,0x2e463872,0xb4a5b9a8,0x3913323e
.long 0x3b643c00,0x361f39a8,0xbb64bc00,0xb61fb9a8,0x3ba83c00,0x39133aa7,0xbb0eb9a8,0xbbf6bbd9
.long 0x3bd93c00,0x3aa73b64,0xb23e8000,0xb872b61f,0x3bf63c00,0x3ba83bd9,0x391339a8,0x378b3872
.long 0xbc003c00,0xbc003c00,0xbc003c00,0xbc003c00,0xbb0e3b64,0xba2f3aa7,0xb4a5361f,0xae46323e
.long 0xb87239a8,0xb23e361f,0x3aa7b9a8,0x3bd9bb64,0xae46361f,0x378bb23e,0x3a2fbb64,0x34a5b872
.long 0x361f0000,0x3b64b9a8,0xb61f8000,0xbb6439a8,0x3a2fb61f,0x3ba8bbd9,0xbbf63b64,0xb78b3aa7
.long 0x3bd9b9a8,0x3872bb64,0xb23e39a8,0x3aa7b61f,0x3ba8bb64,0xae46b872,0x3b0eb61f,0x3913bbd9
.long 0x39a8bc00,0xb9a88000,0x39a8bc00,0xb9a88000,0x34a5bb64,0xbbf63872,0xb78bb61f,0xba2f3bd9
.long 0xb23eb9a8,0xbaa73b64,0xbbd939a8,0x3872361f,0xb913b61f,0xb4a53bd9,0xae463b64,0x3b0ebaa7
.long 0xbb648000,0x361f39a8,0x3b640000,0xb61fb9a8,0xbbf6361f,0x3b0e323e,0x3913bb64,0xbba83872
.long 0xbaa739a8,0x3bd9b61f,0xb872b9a8,0x323e3b64,0xb78b3b64,0x3913baa7,0xbba8361f,0x3bf6b23e
.long 0x80003c00,0xbc00,0x80003c00,0xbc00,0x378b3b64,0xb913baa7,0x3ba8361f,0xbbf6b23e
.long 0x3aa739a8,0xbbd9b61f,0x3872b9a8,0xb23e3b64,0x3bf6361f,0xbb0e323e,0xb913bb64,0x3ba83872
.long 0x3b640000,0xb61f39a8,0xbb648000,0x361fb9a8,0x3913b61f,0x34a53bd9,0x2e463b64,0xbb0ebaa7
.long 0x323eb9a8,0x3aa73b64,0x3bd939a8,0xb872361f,0xb4a5bb64,0x3bf63872,0x378bb61f,0x3a2f3bd9
.long 0xb9a8bc00,0x39a80000,0xb9a8bc00,0x39a80000,0xbba8bb64,0x2e46b872,0xbb0eb61f,0xb913bbd9
.long 0xbbd9b9a8,0xb872bb64,0x323e39a8,0xbaa7b61f,0xba2fb61f,0xbba8bbd9,0x3bf63b64,0x378b3aa7
.long 0xb61f8000,0xbb64b9a8,0x361f0000,0x3b6439a8,0x2e46361f,0xb78bb23e,0xba2fbb64,0xb4a5b872
.long 0x387239a8,0x323e361f,0xbaa7b9a8,0xbbd9bb64,0x3b0e3b64,0x3a2f3aa7,0x34a5361f,0x2e46323e
.long 0xbc003c00,0xbc003c00,0xbc003c00,0xbc003c00,0x2e460000,0x34a5b23e,0x3a2fb9a8,0x3b0ebaa7
.long 0x3bd9bc00,0x3aa7bb64,0xb23e8000,0xb872361f,0xb4a58000,0xba2f3872,0xb78b39a8,0x2e46323e
.long 0xbb643c00,0xb61f39a8,0x3b64bc00,0x361fb9a8,0x378b0000,0x3bf6baa7,0xbba839a8,0xba2f3bd9
.long 0x3aa7bc00,0xb23eb61f,0x38720000,0x3bd9bb64,0xb9138000,0xbb0e3bd9,0x2e46b9a8,0xbba83872
.long 0xb9a83c00,0x39a80000,0xb9a83c00,0x39a80000,0x3a2f0000,0x378bbbd9,0x3bf6b9a8,0xb4a5b872
.long 0x3872bc00,0xbbd9361f,0xbaa78000,0xb23e3b64,0xbb0e8000,0x2e463aa7,0x34a539a8,0x3913bbd9
.long 0xb61f3c00,0x3b64b9a8,0x361fbc00,0xbb6439a8,0x3ba80000,0xb913b872,0xbb0e39a8,0x3bf6b23e
.long 0x323ebc00,0xb8723b64,0x3bd90000,0xbaa7b61f,0xbbf68000,0x3ba8323e,0xb913b9a8,0x378b3aa7
.long 0x80003c00,0xbc00,0x80003c00,0xbc00,0x3bf60000,0xbba8323e,0x3913b9a8,0xb78b3aa7
.long 0xb23ebc00,0x38723b64,0xbbd98000,0x3aa7b61f,0xbba88000,0x3913b872,0x3b0e39a8,0xbbf6b23e
.long 0x361f3c00,0xbb64b9a8,0xb61fbc00,0x3b6439a8,0x3b0e0000,0xae463aa7,0xb4a539a8,0xb913bbd9
.long 0xb872bc00,0x3bd9361f,0x3aa70000,0x323e3b64,0xba2f8000,0xb78bbbd9,0xbbf6b9a8,0x34a5b872
.long 0x39a83c00,0xb9a88000,0x39a83c00,0xb9a88000,0x39130000,0x3b0e3bd9,0xae46b9a8,0x3ba83872
.long 0xbaa7bc00,0x323eb61f,0xb8728000,0xbbd9bb64,0xb78b8000,0xbbf6baa7,0x3ba839a8,0x3a2f3bd9
.long 0x3b643c00,0x361f39a8,0xbb64bc00,0xb61fb9a8,0x34a50000,0x3a2f3872,0x378b39a8,0xae46323e
.long 0xbbd9bc00,0xbaa7bb64,0x323e0000,0x3872361f,0xae468000,0xb4a5b23e,0xba2fb9a8,0xbb0ebaa7
.long 0xbc003c00,0xbc003c00,0xbc003c00,0xbc003c00,0x378bb61f,0x3913b872,0x3ba8bb64,0x3bf6bbd9
.long 0x3872b9a8,0x323eb61f,0xbaa739a8,0xbbd93b64,0xbbf63b64,0xbb0e3bd9,0x3913b61f,0x3ba8baa7
.long 0x361f0000,0x3b64b9a8,0xb61f8000,0xbb6439a8,0x3913bb64,0xb4a5b23e,0x2e46361f,0x3b0eb872
.long 0xbbd939a8,0xb8723b64,0x323eb9a8,0xbaa7361f,0x34a5361f,0x3bf6baa7,0xb78b3b64,0x3a2fb23e
.long 0x39a8bc00,0xb9a88000,0x39a8bc00,0xb9a88000,0xbba8361f,0xae463aa7,0xbb0e3b64,0x3913323e
.long 0x323e39a8,0x3aa7bb64,0x3bd9b9a8,0xb872b61f,0x3a2fbb64,0xbba8323e,0xbbf6361f,0x378b3872
.long 0xbb648000,0x361f39a8,0x3b640000,0xb61fb9a8,0x2e463b64,0x378bbbd9,0xba2fb61f,0x34a53aa7
.long 0x3aa7b9a8,0xbbd9361f,0x387239a8,0xb23ebb64,0xbb0eb61f,0x3a2f3872,0xb4a5bb64,0x2e463bd9
.long 0x80003c00,0xbc00,0x80003c00,0xbc00,0x3b0eb61f,0xba2f3872,0x34a5bb64,0xae463bd9
.long 0xbaa7b9a8,0x3bd9361f,0xb87239a8,0x323ebb64,0xae463b64,0xb78bbbd9,0x3a2fb61f,0xb4a53aa7
.long 0x3b640000,0xb61f39a8,0xbb648000,0x361fb9a8,0xba2fbb64,0x3ba8323e,0x3bf6361f,0xb78b3872
.long 0xb23e39a8,0xbaa7bb64,0xbbd9b9a8,0x3872b61f,0x3ba8361f,0x2e463aa7,0x3b0e3b64,0xb913323e
.long 0xb9a8bc00,0x39a80000,0xb9a8bc00,0x39a80000,0xb4a5361f,0xbbf6baa7,0x378b3b64,0xba2fb23e
.long 0x3bd939a8,0x38723b64,0xb23eb9a8,0x3aa7361f,0xb913bb64,0x34a5b23e,0xae46361f,0xbb0eb872
.long 0xb61f8000,0xbb64b9a8,0x361f0000,0x3b6439a8,0x3bf63b64,0x3b0e3bd9,0xb913b61f,0xbba8baa7
.long 0xb872b9a8,0xb23eb61f,0x3aa739a8,0x3bd93b64,0xb78bb61f,0xb913b872,0xbba8bb64,0xbbf6bbd9
.long 0xbc003c00,0xbc003c00,0xbc003c00,0xbc003c00,0x3bf6bc00,0x3ba8bbd9,0x3913b9a8,0x378bb872
.long 0xbbd93c00,0xbaa73b64,0x323e0000,0x3872b61f,0x3ba8bc00,0x3913baa7,0xbb0e39a8,0xbbf63bd9
.long 0xbb643c00,0xb61f39a8,0x3b64bc00,0x361fb9a8,0x3b0ebc00,0x2e46b872,0xb4a539a8,0x3913b23e
.long 0xbaa73c00,0x323e361f,0xb8728000,0xbbd93b64,0x3a2fbc00,0xb78bb23e,0x3bf6b9a8,0x34a5baa7
.long 0xb9a83c00,0x39a80000,0xb9a83c00,0x39a80000,0x3913bc00,0xbb0e323e,0xae46b9a8,0xbba83aa7
.long 0xb8723c00,0x3bd9b61f,0x3aa70000,0x323ebb64,0x378bbc00,0xbbf63872,0xbba839a8,0x3a2f323e
.long 0xb61f3c00,0x3b64b9a8,0x361fbc00,0xbb6439a8,0x34a5bc00,0xba2f3aa7,0x378b39a8,0x2e46bbd9
.long 0xb23e3c00,0x3872bb64,0xbbd98000,0x3aa7361f,0x2e46bc00,0xb4a53bd9,0x3a2fb9a8,0xbb0e3872
.long 0x80003c00,0xbc00,0x80003c00,0xbc00,0xae46bc00,0x34a53bd9,0xba2fb9a8,0x3b0e3872
.long 0x323e3c00,0xb872bb64,0x3bd90000,0xbaa7361f,0xb4a5bc00,0x3a2f3aa7,0xb78b39a8,0xae46bbd9
.long 0x361f3c00,0xbb64b9a8,0xb61fbc00,0x3b6439a8,0xb78bbc00,0x3bf63872,0x3ba839a8,0xba2f323e
.long 0x38723c00,0xbbd9b61f,0xbaa78000,0xb23ebb64,0xb913bc00,0x3b0e323e,0x2e46b9a8,0x3ba83aa7
.long 0x39a83c00,0xb9a88000,0x39a83c00,0xb9a88000,0xba2fbc00,0x378bb23e,0xbbf6b9a8,0xb4a5baa7
.long 0x3aa73c00,0xb23e361f,0x38720000,0x3bd93b64,0xbb0ebc00,0xae46b872,0x34a539a8,0xb913b23e
.long 0x3b643c00,0x361f39a8,0xbb64bc00,0xb61fb9a8,0xbba8bc00,0xb913baa7,0x3b0e39a8,0x3bf63bd9
.long 0x3bd93c00,0x3aa73b64,0xb23e8000,0xb872b61f,0xbbf6bc00,0xbba8bbd9,0xb913b9a8,0xb78bb872
.long 0xbc003c00,0xbc003c00,0xbc003c00,0xbc003c00,0x3b0ebb64,0x3a2fbaa7,0x34a5b61f,0x2e46b23e
.long 0xb87239a8,0xb23e361f,0x3aa7b9a8,0x3bd9bb64,0x2e46b61f,0xb78b323e,0xba2f3b64,0xb4a53872
.long 0x361f0000,0x3b64b9a8,0xb61f8000,0xbb6439a8,0xba2f361f,0xbba83bd9,0x3bf6bb64,0x378bbaa7
.long 0x3bd9b9a8,0x3872bb64,0xb23e39a8,0x3aa7b61f,0xbba83b64,0x2e463872,0xbb0e361f,0xb9133bd9
.long 0x39a8bc00,0xb9a88000,0x39a8bc00,0xb9a88000,0xb4a53b64,0x3bf6b872,0x378b361f,0x3a2fbbd9
.long 0xb23eb9a8,0xbaa73b64,0xbbd939a8,0x3872361f,0x3913361f,0x34a5bbd9,0x2e46bb64,0xbb0e3aa7
.long 0xbb648000,0x361f39a8,0x3b640000,0xb61fb9a8,0x3bf6b61f,0xbb0eb23e,0xb9133b64,0x3ba8b872
.long 0xbaa739a8,0x3bd9b61f,0xb872b9a8,0x323e3b64,0x378bbb64,0xb9133aa7,0x3ba8b61f,0xbbf6323e
.long 0x80003c00,0xbc00,0x80003c00,0xbc00,0xb78bbb64,0x39133aa7,0xbba8b61f,0x3bf6323e
.long 0x3aa739a8,0xbbd9b61f,0x3872b9a8,0xb23e3b64,0xbbf6b61f,0x3b0eb23e,0x39133b64,0xbba8b872
.long 0x3b640000,0xb61f39a8,0xbb648000,0x361fb9a8,0xb913361f,0xb4a5bbd9,0xae46bb64,0x3b0e3aa7
.long 0x323eb9a8,0x3aa73b64,0x3bd939a8,0xb872361f,0x34a53b64,0xbbf6b872,0xb78b361f,0xba2fbbd9
.long 0xb9a8bc00,0x39a80000,0xb9a8bc00,0x39a80000,0x3ba83b64,0xae463872,0x3b0e361f,0x39133bd9
.long 0xbbd9b9a8,0xb872bb64,0x323e39a8,0xbaa7b61f,0x3a2f361f,0x3ba83bd9,0xbbf6bb64,0xb78bbaa7
.long 0xb61f8000,0xbb64b9a8,0x361f0000,0x3b6439a8,0xae46b61f,0x378b323e,0x3a2f3b64,0x34a53872
.long 0x387239a8,0x323e361f,0xbaa7b9a8,0xbbd9bb64,0xbb0ebb64,0xba2fbaa7,0xb4a5b61f,0xae46b23e
.long 0xbc003c00,0xbc003c00,0xbc003c00,0xbc003c00,0xae468000,0xb4a5323e,0xba2f39a8,0xbb0e3aa7
.long 0x3bd9bc00,0x3aa7bb64,0xb23e8000,0xb872361f,0x34a50000,0x3a2fb872,0x378bb9a8,0xae46b23e
.long 0xbb643c00,0xb61f39a8,0x3b64bc00,0x361fb9a8,0xb78b8000,0xbbf63aa7,0x3ba8b9a8,0x3a2fbbd9
.long 0x3aa7bc00,0xb23eb61f,0x38720000,0x3bd9bb64,0x39130000,0x3b0ebbd9,0xae4639a8,0x3ba8b872
.long 0xb9a83c00,0x39a80000,0xb9a83c00,0x39a80000,0xba2f8000,0xb78b3bd9,0xbbf639a8,0x34a53872
.long 0x3872bc00,0xbbd9361f,0xbaa78000,0xb23e3b64,0x3b0e0000,0xae46baa7,0xb4a5b9a8,0xb9133bd9
.long 0xb61f3c00,0x3b64b9a8,0x361fbc00,0xbb6439a8,0xbba88000,0x39133872,0x3b0eb9a8,0xbbf6323e
.long 0x323ebc00,0xb8723b64,0x3bd90000,0xbaa7b61f,0x3bf60000,0xbba8b23e,0x391339a8,0xb78bbaa7
.long 0x80003c00,0xbc00,0x80003c00,0xbc00,0xbbf68000,0x3ba8b23e,0xb91339a8,0x378bbaa7
.long 0xb23ebc00,0x38723b64,0xbbd98000,0x3aa7b61f,0x3ba80000,0xb9133872,0xbb0eb9a8,0x3bf6323e
.long 0x361f3c00,0xbb64b9a8,0xb61fbc00,0x3b6439a8,0xbb0e8000,0x2e46baa7,0x34a5b9a8,0x39133bd9
.long 0xb872bc00,0x3bd9361f,0x3aa70000,0x323e3b64,0x3a2f0000,0x378b3bd9,0x3bf639a8,0xb4a53872
.long 0x39a83c00,0xb9a88000,0x39a83c00,0xb9a88000,0xb9138000,0xbb0ebbd9,0x2e4639a8,0xbba8b872
.long 0xbaa7bc00,0x323eb61f,0xb8728000,0xbbd9bb64,0x378b0000,0x3bf63aa7,0xbba8b9a8,0xba2fbbd9
.long 0x3b643c00,0x361f39a8,0xbb64bc00,0xb61fb9a8,0xb4a58000,0xba2fb872,0xb78bb9a8,0x2e46b23e
.long 0xbbd9bc00,0xbaa7bb64,0x323e0000,0x3872361f,0x2e460000,0x34a5323e,0x3a2f39a8,0x3b0e3aa7
.long 0xbc003c00,0xbc003c00,0xbc003c00,0xbc003c00,0xb78b361f,0xb9133872,0xbba83b64,0xbbf63bd9
.long 0x3872b9a8,0x323eb61f,0xbaa739a8,0xbbd93b64,0x3bf6bb64,0x3b0ebbd9,0xb913361f,0xbba83aa7
.long 0x361f0000,0x3b64b9a8,0xb61f8000,0xbb6439a8,0xb9133b64,0x34a5323e,0xae46b61f,0xbb0e3872
.long 0xbbd939a8,0xb8723b64,0x323eb9a8,0xbaa7361f,0xb4a5b61f,0xbbf63aa7,0x378bbb64,0xba2f323e
.long 0x39a8bc00,0xb9a88000,0x39a8bc00,0xb9a88000,0x3ba8b61f,0x2e46baa7,0x3b0ebb64,0xb913b23e
.long 0x323e39a8,0x3aa7bb64,0x3bd9b9a8,0xb872b61f,0xba2f3b64,0x3ba8b23e,0x3bf6b61f,0xb78bb872
.long 0xbb648000,0x361f39a8,0x3b640000,0xb61fb9a8,0xae46bb64,0xb78b3bd9,0x3a2f361f,0xb4a5baa7
.long 0x3aa7b9a8,0xbbd9361f,0x387239a8,0xb23ebb64,0x3b0e361f,0xba2fb872,0x34a53b64,0xae46bbd9
.long 0x80003c00,0xbc00,0x80003c00,0xbc00,0xbb0e361f,0x3a2fb872,0xb4a53b64,0x2e46bbd9
.long 0xbaa7b9a8,0x3bd9361f,0xb87239a8,0x323ebb64,0x2e46bb64,0x378b3bd9,0xba2f361f,0x34a5baa7
.long 0x3b640000,0xb61f39a8,0xbb648000,0x361fb9a8,0x3a2f3b64,0xbba8b23e,0xbbf6b61f,0x378bb872
.long 0xb23e39a8,0xbaa7bb64,0xbbd9b9a8,0x3872b61f,0xbba8b61f,0xae46baa7,0xbb0ebb64,0x3913b23e
.long 0xb9a8bc00,0x39a80000,0xb9a8bc00,0x39a80000,0x34a5b61f,0x3bf63aa7,0xb78bbb64,0x3a2f323e
.long 0x3bd939a8,0x38723b64,0xb23eb9a8,0x3aa7361f,0x39133b64,0xb4a5323e,0x2e46b61f,0x3b0e3872
.long 0xb61f8000,0xbb64b9a8,0x361f0000,0x3b6439a8,0xbbf6bb64,0xbb0ebbd9,0x3913361f,0x3ba83aa7
.long 0xb872b9a8,0xb23eb61f,0x3aa739a8,0x3bd93b64,0x378b361f,0x39133872,0x3ba83b64,0x3bf63bd9
.long 0x0,0x0,0x0,0x0,0x2e460000,0x34a5323e,0x3a2f39a8,0x3b0e3aa7
.long 0x323e0000,0x3872361f,0x3bd93c00,0x3aa73b64,0x34a50000,0x3a2f3872,0x378b39a8,0xae46323e
.long 0x361f0000,0x3b6439a8,0xb61f0000,0xbb64b9a8,0x378b0000,0x3bf63aa7,0xbba8b9a8,0xba2fbbd9
.long 0x38720000,0x3bd93b64,0xbaa7bc00,0x323eb61f,0x39130000,0x3b0e3bd9,0xae46b9a8,0x3ba83872
.long 0x39a80000,0x39a83c00,0x39a80000,0x39a83c00,0x3a2f0000,0x378b3bd9,0x3bf639a8,0xb4a53872
.long 0x3aa70000,0x323e3b64,0x38723c00,0xbbd9b61f,0x3b0e0000,0xae463aa7,0xb4a539a8,0xb913bbd9
.long 0x3b640000,0xb61f39a8,0xbb640000,0x361fb9a8,0x3ba80000,0xb9133872,0xbb0eb9a8,0x3bf6323e
.long 0x3bd90000,0xbaa7361f,0xb23ebc00,0x38723b64,0x3bf60000,0xbba8323e,0x3913b9a8,0xb78b3aa7
.long 0x3c000000,0xbc000000,0x3c000000,0xbc000000,0x3bf60000,0xbba8b23e,0x391339a8,0xb78bbaa7
.long 0x3bd90000,0xbaa7b61f,0xb23e3c00,0x3872bb64,0x3ba80000,0xb913b872,0xbb0e39a8,0x3bf6b23e
.long 0x3b640000,0xb61fb9a8,0xbb640000,0x361f39a8,0x3b0e0000,0xae46baa7,0xb4a5b9a8,0xb9133bd9
.long 0x3aa70000,0x323ebb64,0x3872bc00,0xbbd9361f,0x3a2f0000,0x378bbbd9,0x3bf6b9a8,0xb4a5b872
.long 0x39a80000,0x39a8bc00,0x39a80000,0x39a8bc00,0x39130000,0x3b0ebbd9,0xae4639a8,0x3ba8b872
.long 0x38720000,0x3bd9bb64,0xbaa73c00,0x323e361f,0x378b0000,0x3bf6baa7,0xbba839a8,0xba2f3bd9
.long 0x361f0000,0x3b64b9a8,0xb61f0000,0xbb6439a8,0x34a50000,0x3a2fb872,0x378bb9a8,0xae46b23e
.long 0x323e0000,0x3872b61f,0x3bd9bc00,0x3aa7bb64,0x2e460000,0x34a5b23e,0x3a2fb9a8,0x3b0ebaa7
.long 0x0,0x0,0x0,0x0,0x378b361f,0x39133872,0x3ba83b64,0x3bf63bd9
.long 0x3aa739a8,0x3bd93b64,0x387239a8,0x323e361f,0x3bf63b64,0x3b0e3bd9,0xb913b61f,0xbba8baa7
.long 0x3b643c00,0x361f39a8,0xbb64bc00,0xb61fb9a8,0x39133b64,0xb4a5323e,0x2e46b61f,0x3b0e3872
.long 0x323e39a8,0xbaa7b61f,0x3bd939a8,0x38723b64,0xb4a5361f,0xbbf6baa7,0x378b3b64,0xba2fb23e
.long 0xb9a80000,0xb9a8bc00,0xb9a80000,0xb9a8bc00,0xbba8b61f,0xae46baa7,0xbb0ebb64,0x3913b23e
.long 0xbbd9b9a8,0x3872b61f,0x323eb9a8,0x3aa73b64,0xba2fbb64,0x3ba8323e,0x3bf6361f,0xb78b3872
.long 0xb61fbc00,0x3b6439a8,0x361f3c00,0xbb64b9a8,0x2e46bb64,0x378b3bd9,0xba2f361f,0x34a5baa7
.long 0x3872b9a8,0xb23e3b64,0xbaa7b9a8,0x3bd9361f,0x3b0eb61f,0xba2f3872,0x34a5bb64,0xae463bd9
.long 0x3c000000,0xbc000000,0x3c000000,0xbc000000,0x3b0e361f,0xba2fb872,0x34a53b64,0xae46bbd9
.long 0x387239a8,0xb23ebb64,0xbaa739a8,0x3bd9b61f,0x2e463b64,0x378bbbd9,0xba2fb61f,0x34a53aa7
.long 0xb61f3c00,0x3b64b9a8,0x361fbc00,0xbb6439a8,0xba2f3b64,0x3ba8b23e,0x3bf6b61f,0xb78bb872
.long 0xbbd939a8,0x3872361f,0x323e39a8,0x3aa7bb64,0xbba8361f,0xae463aa7,0xbb0e3b64,0x3913323e
.long 0xb9a80000,0xb9a83c00,0xb9a80000,0xb9a83c00,0xb4a5b61f,0xbbf63aa7,0x378bbb64,0xba2f323e
.long 0x323eb9a8,0xbaa7361f,0x3bd9b9a8,0x3872bb64,0x3913bb64,0xb4a5b23e,0x2e46361f,0x3b0eb872
.long 0x3b64bc00,0x361fb9a8,0xbb643c00,0xb61f39a8,0x3bf6bb64,0x3b0ebbd9,0xb913361f,0xbba83aa7
.long 0x3aa7b9a8,0x3bd9bb64,0x3872b9a8,0x323eb61f,0x378bb61f,0x3913b872,0x3ba8bb64,0x3bf6bbd9
.long 0x0,0x0,0x0,0x0,0x3bf63c00,0x3ba83bd9,0x391339a8,0x378b3872
.long 0xb23e0000,0xb872b61f,0xbbd9bc00,0xbaa7bb64,0xbba8bc00,0xb913baa7,0x3b0e39a8,0x3bf63bd9
.long 0x361f0000,0x3b6439a8,0xb61f0000,0xbb64b9a8,0x3b0e3c00,0x2e463872,0xb4a5b9a8,0x3913323e
.long 0xb8720000,0xbbd9bb64,0x3aa73c00,0xb23e361f,0xba2fbc00,0x378bb23e,0xbbf6b9a8,0xb4a5baa7
.long 0x39a80000,0x39a83c00,0x39a80000,0x39a83c00,0x39133c00,0xbb0eb23e,0xae4639a8,0xbba8baa7
.long 0xbaa70000,0xb23ebb64,0xb872bc00,0x3bd9361f,0xb78bbc00,0x3bf63872,0x3ba839a8,0xba2f323e
.long 0x3b640000,0xb61f39a8,0xbb640000,0x361fb9a8,0x34a53c00,0xba2fbaa7,0x378bb9a8,0x2e463bd9
.long 0xbbd90000,0x3aa7b61f,0x323e3c00,0xb872bb64,0xae46bc00,0x34a53bd9,0xba2fb9a8,0x3b0e3872
.long 0x3c000000,0xbc000000,0x3c000000,0xbc000000,0xae463c00,0x34a5bbd9,0xba2f39a8,0x3b0eb872
.long 0xbbd90000,0x3aa7361f,0x323ebc00,0xb8723b64,0x34a5bc00,0xba2f3aa7,0x378b39a8,0x2e46bbd9
.long 0x3b640000,0xb61fb9a8,0xbb640000,0x361f39a8,0xb78b3c00,0x3bf6b872,0x3ba8b9a8,0xba2fb23e
.long 0xbaa70000,0xb23e3b64,0xb8723c00,0x3bd9b61f,0x3913bc00,0xbb0e323e,0xae46b9a8,0xbba83aa7
.long 0x39a80000,0x39a8bc00,0x39a80000,0x39a8bc00,0xba2f3c00,0x378b323e,0xbbf639a8,0xb4a53aa7
.long 0xb8720000,0xbbd93b64,0x3aa7bc00,0xb23eb61f,0x3b0ebc00,0x2e46b872,0xb4a539a8,0x3913b23e
.long 0x361f0000,0x3b64b9a8,0xb61f0000,0xbb6439a8,0xbba83c00,0xb9133aa7,0x3b0eb9a8,0x3bf6bbd9
.long 0xb23e0000,0xb872361f,0xbbd93c00,0xbaa73b64,0x3bf6bc00,0x3ba8bbd9,0x3913b9a8,0x378bb872
.long 0x0,0x0,0x0,0x0,0x3b0e3b64,0x3a2f3aa7,0x34a5361f,0x2e46323e
.long 0xbaa7b9a8,0xbbd9bb64,0xb872b9a8,0xb23eb61f,0xae46b61f,0x378b323e,0x3a2f3b64,0x34a53872
.long 0x3b643c00,0x361f39a8,0xbb64bc00,0xb61fb9a8,0xba2fb61f,0xbba8bbd9,0x3bf63b64,0x378b3aa7
.long 0xb23eb9a8,0x3aa7361f,0xbbd9b9a8,0xb872bb64,0x3ba83b64,0xae463872,0x3b0e361f,0x39133bd9
.long 0xb9a80000,0xb9a8bc00,0xb9a80000,0xb9a8bc00,0xb4a5bb64,0x3bf63872,0x378bb61f,0x3a2f3bd9
.long 0x3bd939a8,0xb872361f,0xb23e39a8,0xbaa7bb64,0xb913361f,0xb4a5bbd9,0xae46bb64,0x3b0e3aa7
.long 0xb61fbc00,0x3b6439a8,0x361f3c00,0xbb64b9a8,0x3bf6361f,0xbb0e323e,0xb913bb64,0x3ba83872
.long 0xb87239a8,0x323ebb64,0x3aa739a8,0xbbd9b61f,0xb78bbb64,0x39133aa7,0xbba8b61f,0x3bf6323e
.long 0x3c000000,0xbc000000,0x3c000000,0xbc000000,0xb78b3b64,0x3913baa7,0xbba8361f,0x3bf6b23e
.long 0xb872b9a8,0x323e3b64,0x3aa7b9a8,0xbbd9361f,0x3bf6b61f,0xbb0eb23e,0xb9133b64,0x3ba8b872
.long 0xb61f3c00,0x3b64b9a8,0x361fbc00,0xbb6439a8,0xb913b61f,0xb4a53bd9,0xae463b64,0x3b0ebaa7
.long 0x3bd9b9a8,0xb872b61f,0xb23eb9a8,0xbaa73b64,0xb4a53b64,0x3bf6b872,0x378b361f,0x3a2fbbd9
.long 0xb9a80000,0xb9a83c00,0xb9a80000,0xb9a83c00,0x3ba8bb64,0xae46b872,0x3b0eb61f,0x3913bbd9
.long 0xb23e39a8,0x3aa7b61f,0xbbd939a8,0xb8723b64,0xba2f361f,0xbba83bd9,0x3bf6bb64,0x378bbaa7
.long 0x3b64bc00,0x361fb9a8,0xbb643c00,0xb61f39a8,0xae46361f,0x378bb23e,0x3a2fbb64,0x34a5b872
.long 0xbaa739a8,0xbbd93b64,0xb87239a8,0xb23e361f,0x3b0ebb64,0x3a2fbaa7,0x34a5b61f,0x2e46b23e
.long 0x0,0x0,0x0,0x0,0xae460000,0xb4a5b23e,0xba2fb9a8,0xbb0ebaa7
.long 0x323e0000,0x3872361f,0x3bd93c00,0x3aa73b64,0xb4a50000,0xba2fb872,0xb78bb9a8,0x2e46b23e
.long 0x361f0000,0x3b6439a8,0xb61f0000,0xbb64b9a8,0xb78b0000,0xbbf6baa7,0x3ba839a8,0x3a2f3bd9
.long 0x38720000,0x3bd93b64,0xbaa7bc00,0x323eb61f,0xb9130000,0xbb0ebbd9,0x2e4639a8,0xbba8b872
.long 0x39a80000,0x39a83c00,0x39a80000,0x39a83c00,0xba2f0000,0xb78bbbd9,0xbbf6b9a8,0x34a5b872
.long 0x3aa70000,0x323e3b64,0x38723c00,0xbbd9b61f,0xbb0e0000,0x2e46baa7,0x34a5b9a8,0x39133bd9
.long 0x3b640000,0xb61f39a8,0xbb640000,0x361fb9a8,0xbba80000,0x3913b872,0x3b0e39a8,0xbbf6b23e
.long 0x3bd90000,0xbaa7361f,0xb23ebc00,0x38723b64,0xbbf60000,0x3ba8b23e,0xb91339a8,0x378bbaa7
.long 0x3c000000,0xbc000000,0x3c000000,0xbc000000,0xbbf60000,0x3ba8323e,0xb913b9a8,0x378b3aa7
.long 0x3bd90000,0xbaa7b61f,0xb23e3c00,0x3872bb64,0xbba80000,0x39133872,0x3b0eb9a8,0xbbf6323e
.long 0x3b640000,0xb61fb9a8,0xbb640000,0x361f39a8,0xbb0e0000,0x2e463aa7,0x34a539a8,0x3913bbd9
.long 0x3aa70000,0x323ebb64,0x3872bc00,0xbbd9361f,0xba2f0000,0xb78b3bd9,0xbbf639a8,0x34a53872
.long 0x39a80000,0x39a8bc00,0x39a80000,0x39a8bc00,0xb9130000,0xbb0e3bd9,0x2e46b9a8,0xbba83872
.long 0x38720000,0x3bd9bb64,0xbaa73c00,0x323e361f,0xb78b0000,0xbbf63aa7,0x3ba8b9a8,0x3a2fbbd9
.long 0x361f0000,0x3b64b9a8,0xb61f0000,0xbb6439a8,0xb4a50000,0xba2f3872,0xb78b39a8,0x2e46323e
.long 0x323e0000,0x3872b61f,0x3bd9bc00,0x3aa7bb64,0xae460000,0xb4a5323e,0xba2f39a8,0xbb0e3aa7
.long 0x0,0x0,0x0,0x0,0xb78bb61f,0xb913b872,0xbba8bb64,0xbbf6bbd9
.long 0x3aa739a8,0x3bd93b64,0x387239a8,0x323e361f,0xbbf6bb64,0xbb0ebbd9,0x3913361f,0x3ba83aa7
.long 0x3b643c00,0x361f39a8,0xbb64bc00,0xb61fb9a8,0xb913bb64,0x34a5b23e,0xae46361f,0xbb0eb872
.long 0x323e39a8,0xbaa7b61f,0x3bd939a8,0x38723b64,0x34a5b61f,0x3bf63aa7,0xb78bbb64,0x3a2f323e
.long 0xb9a80000,0xb9a8bc00,0xb9a80000,0xb9a8bc00,0x3ba8361f,0x2e463aa7,0x3b0e3b64,0xb913323e
.long 0xbbd9b9a8,0x3872b61f,0x323eb9a8,0x3aa73b64,0x3a2f3b64,0xbba8b23e,0xbbf6b61f,0x378bb872
.long 0xb61fbc00,0x3b6439a8,0x361f3c00,0xbb64b9a8,0xae463b64,0xb78bbbd9,0x3a2fb61f,0xb4a53aa7
.long 0x3872b9a8,0xb23e3b64,0xbaa7b9a8,0x3bd9361f,0xbb0e361f,0x3a2fb872,0xb4a53b64,0x2e46bbd9
.long 0x3c000000,0xbc000000,0x3c000000,0xbc000000,0xbb0eb61f,0x3a2f3872,0xb4a5bb64,0x2e463bd9
.long 0x387239a8,0xb23ebb64,0xbaa739a8,0x3bd9b61f,0xae46bb64,0xb78b3bd9,0x3a2f361f,0xb4a5baa7
.long 0xb61f3c00,0x3b64b9a8,0x361fbc00,0xbb6439a8,0x3a2fbb64,0xbba8323e,0xbbf6361f,0x378b3872
.long 0xbbd939a8,0x3872361f,0x323e39a8,0x3aa7bb64,0x3ba8b61f,0x2e46baa7,0x3b0ebb64,0xb913b23e
.long 0xb9a80000,0xb9a83c00,0xb9a80000,0xb9a83c00,0x34a5361f,0x3bf6baa7,0xb78b3b64,0x3a2fb23e
.long 0x323eb9a8,0xbaa7361f,0x3bd9b9a8,0x3872bb64,0xb9133b64,0x34a5323e,0xae46b61f,0xbb0e3872
.long 0x3b64bc00,0x361fb9a8,0xbb643c00,0xb61f39a8,0xbbf63b64,0xbb0e3bd9,0x3913b61f,0x3ba8baa7
.long 0x3aa7b9a8,0x3bd9bb64,0x3872b9a8,0x323eb61f,0xb78b361f,0xb9133872,0xbba83b64,0xbbf63bd9
.long 0x0,0x0,0x0,0x0,0xbbf6bc00,0xbba8bbd9,0xb913b9a8,0xb78bb872
.long 0xb23e0000,0xb872b61f,0xbbd9bc00,0xbaa7bb64,0x3ba83c00,0x39133aa7,0xbb0eb9a8,0xbbf6bbd9
.long 0x361f0000,0x3b6439a8,0xb61f0000,0xbb64b9a8,0xbb0ebc00,0xae46b872,0x34a539a8,0xb913b23e
.long 0xb8720000,0xbbd9bb64,0x3aa73c00,0xb23e361f,0x3a2f3c00,0xb78b323e,0x3bf639a8,0x34a53aa7
.long 0x39a80000,0x39a83c00,0x39a80000,0x39a83c00,0xb913bc00,0x3b0e323e,0x2e46b9a8,0x3ba83aa7
.long 0xbaa70000,0xb23ebb64,0xb872bc00,0x3bd9361f,0x378b3c00,0xbbf6b872,0xbba8b9a8,0x3a2fb23e
.long 0x3b640000,0xb61f39a8,0xbb640000,0x361fb9a8,0xb4a5bc00,0x3a2f3aa7,0xb78b39a8,0xae46bbd9
.long 0xbbd90000,0x3aa7b61f,0x323e3c00,0xb872bb64,0x2e463c00,0xb4a5bbd9,0x3a2f39a8,0xbb0eb872
.long 0x3c000000,0xbc000000,0x3c000000,0xbc000000,0x2e46bc00,0xb4a53bd9,0x3a2fb9a8,0xbb0e3872
.long 0xbbd90000,0x3aa7361f,0x323ebc00,0xb8723b64,0xb4a53c00,0x3a2fbaa7,0xb78bb9a8,0xae463bd9
.long 0x3b640000,0xb61fb9a8,0xbb640000,0x361f39a8,0x378bbc00,0xbbf63872,0xbba839a8,0x3a2f323e
.long 0xbaa70000,0xb23e3b64,0xb8723c00,0x3bd9b61f,0xb9133c00,0x3b0eb23e,0x2e4639a8,0x3ba8baa7
.long 0x39a80000,0x39a8bc00,0x39a80000,0x39a8bc00,0x3a2fbc00,0xb78bb23e,0x3bf6b9a8,0x34a5baa7
.long 0xb8720000,0xbbd93b64,0x3aa7bc00,0xb23eb61f,0xbb0e3c00,0xae463872,0x34a5b9a8,0xb913323e
.long 0x361f0000,0x3b64b9a8,0xb61f0000,0xbb6439a8,0x3ba8bc00,0x3913baa7,0xbb0e39a8,0xbbf63bd9
.long 0xb23e0000,0xb872361f,0xbbd93c00,0xbaa73b64,0xbbf63c00,0xbba83bd9,0xb91339a8,0xb78b3872
.long 0x0,0x0,0x0,0x0,0xbb0ebb64,0xba2fbaa7,0xb4a5b61f,0xae46b23e
.long 0xbaa7b9a8,0xbbd9bb64,0xb872b9a8,0xb23eb61f,0x2e46361f,0xb78bb23e,0xba2fbb64,0xb4a5b872
.long 0x3b643c00,0x361f39a8,0xbb64bc00,0xb61fb9a8,0x3a2f361f,0x3ba83bd9,0xbbf6bb64,0xb78bbaa7
.long 0xb23eb9a8,0x3aa7361f,0xbbd9b9a8,0xb872bb64,0xbba8bb64,0x2e46b872,0xbb0eb61f,0xb913bbd9
.long 0xb9a80000,0xb9a8bc00,0xb9a80000,0xb9a8bc00,0x34a53b64,0xbbf6b872,0xb78b361f,0xba2fbbd9
.long 0x3bd939a8,0xb872361f,0xb23e39a8,0xbaa7bb64,0x3913b61f,0x34a53bd9,0x2e463b64,0xbb0ebaa7
.long 0xb61fbc00,0x3b6439a8,0x361f3c00,0xbb64b9a8,0xbbf6b61f,0x3b0eb23e,0x39133b64,0xbba8b872
.long 0xb87239a8,0x323ebb64,0x3aa739a8,0xbbd9b61f,0x378b3b64,0xb913baa7,0x3ba8361f,0xbbf6b23e
.long 0x3c000000,0xbc000000,0x3c000000,0xbc000000,0x378bbb64,0xb9133aa7,0x3ba8b61f,0xbbf6323e
.long 0xb872b9a8,0x323e3b64,0x3aa7b9a8,0xbbd9361f,0xbbf6361f,0x3b0e323e,0x3913bb64,0xbba83872
.long 0xb61f3c00,0x3b64b9a8,0x361fbc00,0xbb6439a8,0x3913361f,0x34a5bbd9,0x2e46bb64,0xbb0e3aa7
.long 0x3bd9b9a8,0xb872b61f,0xb23eb9a8,0xbaa73b64,0x34a5bb64,0xbbf63872,0xb78bb61f,0xba2f3bd9
.long 0xb9a80000,0xb9a83c00,0xb9a80000,0xb9a83c00,0xbba83b64,0x2e463872,0xbb0e361f,0xb9133bd9
.long 0xb23e39a8,0x3aa7b61f,0xbbd939a8,0xb8723b64,0x3a2fb61f,0x3ba8bbd9,0xbbf63b64,0xb78b3aa7
.long 0x3b64bc00,0x361fb9a8,0xbb643c00,0xb61f39a8,0x2e46b61f,0xb78b323e,0xba2f3b64,0xb4a53872
.long 0xbaa739a8,0xbbd93b64,0xb87239a8,0xb23e361f,0xbb0e3b64,0xba2f3aa7,0xb4a5361f,0xae46323e
.long 0x0,0x0,0x0,0x0,0xae460000,0xb4a5323e,0xba2f39a8,0xbb0e3aa7
.long 0xb23e0000,0xb872361f,0xbbd93c00,0xbaa73b64,0xb4a50000,0xba2f3872,0xb78b39a8,0x2e46323e
.long 0xb61f0000,0xbb6439a8,0x361f0000,0x3b64b9a8,0xb78b0000,0xbbf63aa7,0x3ba8b9a8,0x3a2fbbd9
.long 0xb8720000,0xbbd93b64,0x3aa7bc00,0xb23eb61f,0xb9130000,0xbb0e3bd9,0x2e46b9a8,0xbba83872
.long 0xb9a80000,0xb9a83c00,0xb9a80000,0xb9a83c00,0xba2f0000,0xb78b3bd9,0xbbf639a8,0x34a53872
.long 0xbaa70000,0xb23e3b64,0xb8723c00,0x3bd9b61f,0xbb0e0000,0x2e463aa7,0x34a539a8,0x3913bbd9
.long 0xbb640000,0x361f39a8,0x3b640000,0xb61fb9a8,0xbba80000,0x39133872,0x3b0eb9a8,0xbbf6323e
.long 0xbbd90000,0x3aa7361f,0x323ebc00,0xb8723b64,0xbbf60000,0x3ba8323e,0xb913b9a8,0x378b3aa7
.long 0xbc000000,0x3c000000,0xbc000000,0x3c000000,0xbbf60000,0x3ba8b23e,0xb91339a8,0x378bbaa7
.long 0xbbd90000,0x3aa7b61f,0x323e3c00,0xb872bb64,0xbba80000,0x3913b872,0x3b0e39a8,0xbbf6b23e
.long 0xbb640000,0x361fb9a8,0x3b640000,0xb61f39a8,0xbb0e0000,0x2e46baa7,0x34a5b9a8,0x39133bd9
.long 0xbaa70000,0xb23ebb64,0xb872bc00,0x3bd9361f,0xba2f0000,0xb78bbbd9,0xbbf6b9a8,0x34a5b872
.long 0xb9a80000,0xb9a8bc00,0xb9a80000,0xb9a8bc00,0xb9130000,0xbb0ebbd9,0x2e4639a8,0xbba8b872
.long 0xb8720000,0xbbd9bb64,0x3aa73c00,0xb23e361f,0xb78b0000,0xbbf6baa7,0x3ba839a8,0x3a2f3bd9
.long 0xb61f0000,0xbb64b9a8,0x361f0000,0x3b6439a8,0xb4a50000,0xba2fb872,0xb78bb9a8,0x2e46b23e
.long 0xb23e0000,0xb872b61f,0xbbd9bc00,0xbaa7bb64,0xae460000,0xb4a5b23e,0xba2fb9a8,0xbb0ebaa7
.long 0x0,0x0,0x0,0x0,0xb78b361f,0xb9133872,0xbba83b64,0xbbf63bd9
.long 0xbaa739a8,0xbbd93b64,0xb87239a8,0xb23e361f,0xbbf63b64,0xbb0e3bd9,0x3913b61f,0x3ba8baa7
.long 0xbb643c00,0xb61f39a8,0x3b64bc00,0x361fb9a8,0xb9133b64,0x34a5323e,0xae46b61f,0xbb0e3872
.long 0xb23e39a8,0x3aa7b61f,0xbbd939a8,0xb8723b64,0x34a5361f,0x3bf6baa7,0xb78b3b64,0x3a2fb23e
.long 0x39a80000,0x39a8bc00,0x39a80000,0x39a8bc00,0x3ba8b61f,0x2e46baa7,0x3b0ebb64,0xb913b23e
.long 0x3bd9b9a8,0xb872b61f,0xb23eb9a8,0xbaa73b64,0x3a2fbb64,0xbba8323e,0xbbf6361f,0x378b3872
.long 0x361fbc00,0xbb6439a8,0xb61f3c00,0x3b64b9a8,0xae46bb64,0xb78b3bd9,0x3a2f361f,0xb4a5baa7
.long 0xb872b9a8,0x323e3b64,0x3aa7b9a8,0xbbd9361f,0xbb0eb61f,0x3a2f3872,0xb4a5bb64,0x2e463bd9
.long 0xbc000000,0x3c000000,0xbc000000,0x3c000000,0xbb0e361f,0x3a2fb872,0xb4a53b64,0x2e46bbd9
.long 0xb87239a8,0x323ebb64,0x3aa739a8,0xbbd9b61f,0xae463b64,0xb78bbbd9,0x3a2fb61f,0xb4a53aa7
.long 0x361f3c00,0xbb64b9a8,0xb61fbc00,0x3b6439a8,0x3a2f3b64,0xbba8b23e,0xbbf6b61f,0x378bb872
.long 0x3bd939a8,0xb872361f,0xb23e39a8,0xbaa7bb64,0x3ba8361f,0x2e463aa7,0x3b0e3b64,0xb913323e
.long 0x39a80000,0x39a83c00,0x39a80000,0x39a83c00,0x34a5b61f,0x3bf63aa7,0xb78bbb64,0x3a2f323e
.long 0xb23eb9a8,0x3aa7361f,0xbbd9b9a8,0xb872bb64,0xb913bb64,0x34a5b23e,0xae46361f,0xbb0eb872
.long 0xbb64bc00,0xb61fb9a8,0x3b643c00,0x361f39a8,0xbbf6bb64,0xbb0ebbd9,0x3913361f,0x3ba83aa7
.long 0xbaa7b9a8,0xbbd9bb64,0xb872b9a8,0xb23eb61f,0xb78bb61f,0xb913b872,0xbba8bb64,0xbbf6bbd9
.long 0x0,0x0,0x0,0x0,0xbbf63c00,0xbba83bd9,0xb91339a8,0xb78b3872
.long 0x323e0000,0x3872b61f,0x3bd9bc00,0x3aa7bb64,0x3ba8bc00,0x3913baa7,0xbb0e39a8,0xbbf63bd9
.long 0xb61f0000,0xbb6439a8,0x361f0000,0x3b64b9a8,0xbb0e3c00,0xae463872,0x34a5b9a8,0xb913323e
.long 0x38720000,0x3bd9bb64,0xbaa73c00,0x323e361f,0x3a2fbc00,0xb78bb23e,0x3bf6b9a8,0x34a5baa7
.long 0xb9a80000,0xb9a83c00,0xb9a80000,0xb9a83c00,0xb9133c00,0x3b0eb23e,0x2e4639a8,0x3ba8baa7
.long 0x3aa70000,0x323ebb64,0x3872bc00,0xbbd9361f,0x378bbc00,0xbbf63872,0xbba839a8,0x3a2f323e
.long 0xbb640000,0x361f39a8,0x3b640000,0xb61fb9a8,0xb4a53c00,0x3a2fbaa7,0xb78bb9a8,0xae463bd9
.long 0x3bd90000,0xbaa7b61f,0xb23e3c00,0x3872bb64,0x2e46bc00,0xb4a53bd9,0x3a2fb9a8,0xbb0e3872
.long 0xbc000000,0x3c000000,0xbc000000,0x3c000000,0x2e463c00,0xb4a5bbd9,0x3a2f39a8,0xbb0eb872
.long 0x3bd90000,0xbaa7361f,0xb23ebc00,0x38723b64,0xb4a5bc00,0x3a2f3aa7,0xb78b39a8,0xae46bbd9
.long 0xbb640000,0x361fb9a8,0x3b640000,0xb61f39a8,0x378b3c00,0xbbf6b872,0xbba8b9a8,0x3a2fb23e
.long 0x3aa70000,0x323e3b64,0x38723c00,0xbbd9b61f,0xb913bc00,0x3b0e323e,0x2e46b9a8,0x3ba83aa7
.long 0xb9a80000,0xb9a8bc00,0xb9a80000,0xb9a8bc00,0x3a2f3c00,0xb78b323e,0x3bf639a8,0x34a53aa7
.long 0x38720000,0x3bd93b64,0xbaa7bc00,0x323eb61f,0xbb0ebc00,0xae46b872,0x34a539a8,0xb913b23e
.long 0xb61f0000,0xbb64b9a8,0x361f0000,0x3b6439a8,0x3ba83c00,0x39133aa7,0xbb0eb9a8,0xbbf6bbd9
.long 0x323e0000,0x3872361f,0x3bd93c00,0x3aa73b64,0xbbf6bc00,0xbba8bbd9,0xb913b9a8,0xb78bb872
.long 0x0,0x0,0x0,0x0,0xbb0e3b64,0xba2f3aa7,0xb4a5361f,0xae46323e
.long 0x3aa7b9a8,0x3bd9bb64,0x3872b9a8,0x323eb61f,0x2e46b61f,0xb78b323e,0xba2f3b64,0xb4a53872
.long 0xbb643c00,0xb61f39a8,0x3b64bc00,0x361fb9a8,0x3a2fb61f,0x3ba8bbd9,0xbbf63b64,0xb78b3aa7
.long 0x323eb9a8,0xbaa7361f,0x3bd9b9a8,0x3872bb64,0xbba83b64,0x2e463872,0xbb0e361f,0xb9133bd9
.long 0x39a80000,0x39a8bc00,0x39a80000,0x39a8bc00,0x34a5bb64,0xbbf63872,0xb78bb61f,0xba2f3bd9
.long 0xbbd939a8,0x3872361f,0x323e39a8,0x3aa7bb64,0x3913361f,0x34a5bbd9,0x2e46bb64,0xbb0e3aa7
.long 0x361fbc00,0xbb6439a8,0xb61f3c00,0x3b64b9a8,0xbbf6361f,0x3b0e323e,0x3913bb64,0xbba83872
.long 0x387239a8,0xb23ebb64,0xbaa739a8,0x3bd9b61f,0x378bbb64,0xb9133aa7,0x3ba8b61f,0xbbf6323e
.long 0xbc000000,0x3c000000,0xbc000000,0x3c000000,0x378b3b64,0xb913baa7,0x3ba8361f,0xbbf6b23e
.long 0x3872b9a8,0xb23e3b64,0xbaa7b9a8,0x3bd9361f,0xbbf6b61f,0x3b0eb23e,0x39133b64,0xbba8b872
.long 0x361f3c00,0xbb64b9a8,0xb61fbc00,0x3b6439a8,0x3913b61f,0x34a53bd9,0x2e463b64,0xbb0ebaa7
.long 0xbbd9b9a8,0x3872b61f,0x323eb9a8,0x3aa73b64,0x34a53b64,0xbbf6b872,0xb78b361f,0xba2fbbd9
.long 0x39a80000,0x39a83c00,0x39a80000,0x39a83c00,0xbba8bb64,0x2e46b872,0xbb0eb61f,0xb913bbd9
.long 0x323e39a8,0xbaa7b61f,0x3bd939a8,0x38723b64,0x3a2f361f,0x3ba83bd9,0xbbf6bb64,0xb78bbaa7
.long 0xbb64bc00,0xb61fb9a8,0x3b643c00,0x361f39a8,0x2e46361f,0xb78bb23e,0xba2fbb64,0xb4a5b872
.long 0x3aa739a8,0x3bd93b64,0x387239a8,0x323e361f,0xbb0ebb64,0xba2fbaa7,0xb4a5b61f,0xae46b23e
.long 0x0,0x0,0x0,0x0,0x2e460000,0x34a5b23e,0x3a2fb9a8,0x3b0ebaa7
.long 0xb23e0000,0xb872361f,0xbbd93c00,0xbaa73b64,0x34a50000,0x3a2fb872,0x378bb9a8,0xae46b23e
.long 0xb61f0000,0xbb6439a8,0x361f0000,0x3b64b9a8,0x378b0000,0x3bf6baa7,0xbba839a8,0xba2f3bd9
.long 0xb8720000,0xbbd93b64,0x3aa7bc00,0xb23eb61f,0x39130000,0x3b0ebbd9,0xae4639a8,0x3ba8b872
.long 0xb9a80000,0xb9a83c00,0xb9a80000,0xb9a83c00,0x3a2f0000,0x378bbbd9,0x3bf6b9a8,0xb4a5b872
.long 0xbaa70000,0xb23e3b64,0xb8723c00,0x3bd9b61f,0x3b0e0000,0xae46baa7,0xb4a5b9a8,0xb9133bd9
.long 0xbb640000,0x361f39a8,0x3b640000,0xb61fb9a8,0x3ba80000,0xb913b872,0xbb0e39a8,0x3bf6b23e
.long 0xbbd90000,0x3aa7361f,0x323ebc00,0xb8723b64,0x3bf60000,0xbba8b23e,0x391339a8,0xb78bbaa7
.long 0xbc000000,0x3c000000,0xbc000000,0x3c000000,0x3bf60000,0xbba8323e,0x3913b9a8,0xb78b3aa7
.long 0xbbd90000,0x3aa7b61f,0x323e3c00,0xb872bb64,0x3ba80000,0xb9133872,0xbb0eb9a8,0x3bf6323e
.long 0xbb640000,0x361fb9a8,0x3b640000,0xb61f39a8,0x3b0e0000,0xae463aa7,0xb4a539a8,0xb913bbd9
.long 0xbaa70000,0xb23ebb64,0xb872bc00,0x3bd9361f,0x3a2f0000,0x378b3bd9,0x3bf639a8,0xb4a53872
.long 0xb9a80000,0xb9a8bc00,0xb9a80000,0xb9a8bc00,0x39130000,0x3b0e3bd9,0xae46b9a8,0x3ba83872
.long 0xb8720000,0xbbd9bb64,0x3aa73c00,0xb23e361f,0x378b0000,0x3bf63aa7,0xbba8b9a8,0xba2fbbd9
.long 0xb61f0000,0xbb64b9a8,0x361f0000,0x3b6439a8,0x34a50000,0x3a2f3872,0x378b39a8,0xae46323e
.long 0xb23e0000,0xb872b61f,0xbbd9bc00,0xbaa7bb64,0x2e460000,0x34a5323e,0x3a2f39a8,0x3b0e3aa7
.long 0x0,0x0,0x0,0x0,0x378bb61f,0x3913b872,0x3ba8bb64,0x3bf6bbd9
.long 0xbaa739a8,0xbbd93b64,0xb87239a8,0xb23e361f,0x3bf6bb64,0x3b0ebbd9,0xb913361f,0xbba83aa7
.long 0xbb643c00,0xb61f39a8,0x3b64bc00,0x361fb9a8,0x3913bb64,0xb4a5b23e,0x2e46361f,0x3b0eb872
.long 0xb23e39a8,0x3aa7b61f,0xbbd939a8,0xb8723b64,0xb4a5b61f,0xbbf63aa7,0x378bbb64,0xba2f323e
.long 0x39a80000,0x39a8bc00,0x39a80000,0x39a8bc00,0xbba8361f,0xae463aa7,0xbb0e3b64,0x3913323e
.long 0x3bd9b9a8,0xb872b61f,0xb23eb9a8,0xbaa73b64,0xba2f3b64,0x3ba8b23e,0x3bf6b61f,0xb78bb872
.long 0x361fbc00,0xbb6439a8,0xb61f3c00,0x3b64b9a8,0x2e463b64,0x378bbbd9,0xba2fb61f,0x34a53aa7
.long 0xb872b9a8,0x323e3b64,0x3aa7b9a8,0xbbd9361f,0x3b0e361f,0xba2fb872,0x34a53b64,0xae46bbd9
.long 0xbc000000,0x3c000000,0xbc000000,0x3c000000,0x3b0eb61f,0xba2f3872,0x34a5bb64,0xae463bd9
.long 0xb87239a8,0x323ebb64,0x3aa739a8,0xbbd9b61f,0x2e46bb64,0x378b3bd9,0xba2f361f,0x34a5baa7
.long 0x361f3c00,0xbb64b9a8,0xb61fbc00,0x3b6439a8,0xba2fbb64,0x3ba8323e,0x3bf6361f,0xb78b3872
.long 0x3bd939a8,0xb872361f,0xb23e39a8,0xbaa7bb64,0xbba8b61f,0xae46baa7,0xbb0ebb64,0x3913b23e
.long 0x39a80000,0x39a83c00,0x39a80000,0x39a83c00,0xb4a5361f,0xbbf6baa7,0x378b3b64,0xba2fb23e
.long 0xb23eb9a8,0x3aa7361f,0xbbd9b9a8,0xb872bb64,0x39133b64,0xb4a5323e,0x2e46b61f,0x3b0e3872
.long 0xbb64bc00,0xb61fb9a8,0x3b643c00,0x361f39a8,0x3bf63b64,0x3b0e3bd9,0xb913b61f,0xbba8baa7
.long 0xbaa7b9a8,0xbbd9bb64,0xb872b9a8,0xb23eb61f,0x378b361f,0x39133872,0x3ba83b64,0x3bf63bd9
.long 0x0,0x0,0x0,0x0,0x3bf6bc00,0x3ba8bbd9,0x3913b9a8,0x378bb872
.long 0x323e0000,0x3872b61f,0x3bd9bc00,0x3aa7bb64,0xbba83c00,0xb9133aa7,0x3b0eb9a8,0x3bf6bbd9
.long 0xb61f0000,0xbb6439a8,0x361f0000,0x3b64b9a8,0x3b0ebc00,0x2e46b872,0xb4a539a8,0x3913b23e
.long 0x38720000,0x3bd9bb64,0xbaa73c00,0x323e361f,0xba2f3c00,0x378b323e,0xbbf639a8,0xb4a53aa7
.long 0xb9a80000,0xb9a83c00,0xb9a80000,0xb9a83c00,0x3913bc00,0xbb0e323e,0xae46b9a8,0xbba83aa7
.long 0x3aa70000,0x323ebb64,0x3872bc00,0xbbd9361f,0xb78b3c00,0x3bf6b872,0x3ba8b9a8,0xba2fb23e
.long 0xbb640000,0x361f39a8,0x3b640000,0xb61fb9a8,0x34a5bc00,0xba2f3aa7,0x378b39a8,0x2e46bbd9
.long 0x3bd90000,0xbaa7b61f,0xb23e3c00,0x3872bb64,0xae463c00,0x34a5bbd9,0xba2f39a8,0x3b0eb872
.long 0xbc000000,0x3c000000,0xbc000000,0x3c000000,0xae46bc00,0x34a53bd9,0xba2fb9a8,0x3b0e3872
.long 0x3bd90000,0xbaa7361f,0xb23ebc00,0x38723b64,0x34a53c00,0xba2fbaa7,0x378bb9a8,0x2e463bd9
.long 0xbb640000,0x361fb9a8,0x3b640000,0xb61f39a8,0xb78bbc00,0x3bf63872,0x3ba839a8,0xba2f323e
.long 0x3aa70000,0x323e3b64,0x38723c00,0xbbd9b61f,0x39133c00,0xbb0eb23e,0xae4639a8,0xbba8baa7
.long 0xb9a80000,0xb9a8bc00,0xb9a80000,0xb9a8bc00,0xba2fbc00,0x378bb23e,0xbbf6b9a8,0xb4a5baa7
.long 0x38720000,0x3bd93b64,0xbaa7bc00,0x323eb61f,0x3b0e3c00,0x2e463872,0xb4a5b9a8,0x3913323e
.long 0xb61f0000,0xbb64b9a8,0x361f0000,0x3b6439a8,0xbba8bc00,0xb913baa7,0x3b0e39a8,0x3bf63bd9
.long 0x323e0000,0x3872361f,0x3bd93c00,0x3aa73b64,0x3bf63c00,0x3ba83bd9,0x391339a8,0x378b3872
.long 0x0,0x0,0x0,0x0,0x3b0ebb64,0x3a2fbaa7,0x34a5b61f,0x2e46b23e
.long 0x3aa7b9a8,0x3bd9bb64,0x3872b9a8,0x323eb61f,0xae46361f,0x378bb23e,0x3a2fbb64,0x34a5b872
.long 0xbb643c00,0xb61f39a8,0x3b64bc00,0x361fb9a8,0xba2f361f,0xbba83bd9,0x3bf6bb64,0x378bbaa7
.long 0x323eb9a8,0xbaa7361f,0x3bd9b9a8,0x3872bb64,0x3ba8bb64,0xae46b872,0x3b0eb61f,0x3913bbd9
.long 0x39a80000,0x39a8bc00,0x39a80000,0x39a8bc00,0xb4a53b64,0x3bf6b872,0x378b361f,0x3a2fbbd9
.long 0xbbd939a8,0x3872361f,0x323e39a8,0x3aa7bb64,0xb913b61f,0xb4a53bd9,0xae463b64,0x3b0ebaa7
.long 0x361fbc00,0xbb6439a8,0xb61f3c00,0x3b64b9a8,0x3bf6b61f,0xbb0eb23e,0xb9133b64,0x3ba8b872
.long 0x387239a8,0xb23ebb64,0xbaa739a8,0x3bd9b61f,0xb78b3b64,0x3913baa7,0xbba8361f,0x3bf6b23e
.long 0xbc000000,0x3c000000,0xbc000000,0x3c000000,0xb78bbb64,0x39133aa7,0xbba8b61f,0x3bf6323e
.long 0x3872b9a8,0xb23e3b64,0xbaa7b9a8,0x3bd9361f,0x3bf6361f,0xbb0e323e,0xb913bb64,0x3ba83872
.long 0x361f3c00,0xbb64b9a8,0xb61fbc00,0x3b6439a8,0xb913361f,0xb4a5bbd9,0xae46bb64,0x3b0e3aa7
.long 0xbbd9b9a8,0x3872b61f,0x323eb9a8,0x3aa73b64,0xb4a5bb64,0x3bf63872,0x378bb61f,0x3a2f3bd9
.long 0x39a80000,0x39a83c00,0x39a80000,0x39a83c00,0x3ba83b64,0xae463872,0x3b0e361f,0x39133bd9
.long 0x323e39a8,0xbaa7b61f,0x3bd939a8,0x38723b64,0xba2fb61f,0xbba8bbd9,0x3bf63b64,0x378b3aa7
.long 0xbb64bc00,0xb61fb9a8,0x3b643c00,0x361f39a8,0xae46b61f,0x378b323e,0x3a2f3b64,0x34a53872
.long 0x3aa739a8,0x3bd93b64,0x387239a8,0x323e361f,0x3b0e3b64,0x3a2f3aa7,0x34a5361f,0x2e46323e
.long 0x80008000,0x80008000,0x80008000,0x80008000,0xae468000,0xb4a5b23e,0xba2fb9a8,0xbb0ebaa7
.long 0xb23e8000,0xb872b61f,0xbbd9bc00,0xbaa7bb64,0xb4a58000,0xba2fb872,0xb78bb9a8,0x2e46b23e
.long 0xb61f8000,0xbb64b9a8,0x361f8000,0x3b6439a8,0xb78b8000,0xbbf6baa7,0x3ba839a8,0x3a2f3bd9
.long 0xb8728000,0xbbd9bb64,0x3aa73c00,0xb23e361f,0xb9138000,0xbb0ebbd9,0x2e4639a8,0xbba8b872
.long 0xb9a88000,0xb9a8bc00,0xb9a88000,0xb9a8bc00,0xba2f8000,0xb78bbbd9,0xbbf6b9a8,0x34a5b872
.long 0xbaa78000,0xb23ebb64,0xb872bc00,0x3bd9361f,0xbb0e8000,0x2e46baa7,0x34a5b9a8,0x39133bd9
.long 0xbb648000,0x361fb9a8,0x3b648000,0xb61f39a8,0xbba88000,0x3913b872,0x3b0e39a8,0xbbf6b23e
.long 0xbbd98000,0x3aa7b61f,0x323e3c00,0xb872bb64,0xbbf68000,0x3ba8b23e,0xb91339a8,0x378bbaa7
.long 0xbc008000,0x3c008000,0xbc008000,0x3c008000,0xbbf68000,0x3ba8323e,0xb913b9a8,0x378b3aa7
.long 0xbbd98000,0x3aa7361f,0x323ebc00,0xb8723b64,0xbba88000,0x39133872,0x3b0eb9a8,0xbbf6323e
.long 0xbb648000,0x361f39a8,0x3b648000,0xb61fb9a8,0xbb0e8000,0x2e463aa7,0x34a539a8,0x3913bbd9
.long 0xbaa78000,0xb23e3b64,0xb8723c00,0x3bd9b61f,0xba2f8000,0xb78b3bd9,0xbbf639a8,0x34a53872
.long 0xb9a88000,0xb9a83c00,0xb9a88000,0xb9a83c00,0xb9138000,0xbb0e3bd9,0x2e46b9a8,0xbba83872
.long 0xb8728000,0xbbd93b64,0x3aa7bc00,0xb23eb61f,0xb78b8000,0xbbf63aa7,0x3ba8b9a8,0x3a2fbbd9
.long 0xb61f8000,0xbb6439a8,0x361f8000,0x3b64b9a8,0xb4a58000,0xba2f3872,0xb78b39a8,0x2e46323e
.long 0xb23e8000,0xb872361f,0xbbd93c00,0xbaa73b64,0xae468000,0xb4a5323e,0xba2f39a8,0xbb0e3aa7
.long 0x80008000,0x80008000,0x80008000,0x80008000,0xb78bb61f,0xb913b872,0xbba8bb64,0xbbf6bbd9
.long 0xbaa7b9a8,0xbbd9bb64,0xb872b9a8,0xb23eb61f,0xbbf6bb64,0xbb0ebbd9,0x3913361f,0x3ba83aa7
.long 0xbb64bc00,0xb61fb9a8,0x3b643c00,0x361f39a8,0xb913bb64,0x34a5b23e,0xae46361f,0xbb0eb872
.long 0xb23eb9a8,0x3aa7361f,0xbbd9b9a8,0xb872bb64,0x34a5b61f,0x3bf63aa7,0xb78bbb64,0x3a2f323e
.long 0x39a88000,0x39a83c00,0x39a88000,0x39a83c00,0x3ba8361f,0x2e463aa7,0x3b0e3b64,0xb913323e
.long 0x3bd939a8,0xb872361f,0xb23e39a8,0xbaa7bb64,0x3a2f3b64,0xbba8b23e,0xbbf6b61f,0x378bb872
.long 0x361f3c00,0xbb64b9a8,0xb61fbc00,0x3b6439a8,0xae463b64,0xb78bbbd9,0x3a2fb61f,0xb4a53aa7
.long 0xb87239a8,0x323ebb64,0x3aa739a8,0xbbd9b61f,0xbb0e361f,0x3a2fb872,0xb4a53b64,0x2e46bbd9
.long 0xbc008000,0x3c008000,0xbc008000,0x3c008000,0xbb0eb61f,0x3a2f3872,0xb4a5bb64,0x2e463bd9
.long 0xb872b9a8,0x323e3b64,0x3aa7b9a8,0xbbd9361f,0xae46bb64,0xb78b3bd9,0x3a2f361f,0xb4a5baa7
.long 0x361fbc00,0xbb6439a8,0xb61f3c00,0x3b64b9a8,0x3a2fbb64,0xbba8323e,0xbbf6361f,0x378b3872
.long 0x3bd9b9a8,0xb872b61f,0xb23eb9a8,0xbaa73b64,0x3ba8b61f,0x2e46baa7,0x3b0ebb64,0xb913b23e
.long 0x39a88000,0x39a8bc00,0x39a88000,0x39a8bc00,0x34a5361f,0x3bf6baa7,0xb78b3b64,0x3a2fb23e
.long 0xb23e39a8,0x3aa7b61f,0xbbd939a8,0xb8723b64,0xb9133b64,0x34a5323e,0xae46b61f,0xbb0e3872
.long 0xbb643c00,0xb61f39a8,0x3b64bc00,0x361fb9a8,0xbbf63b64,0xbb0e3bd9,0x3913b61f,0x3ba8baa7
.long 0xbaa739a8,0xbbd93b64,0xb87239a8,0xb23e361f,0xb78b361f,0xb9133872,0xbba83b64,0xbbf63bd9
.long 0x80008000,0x80008000,0x80008000,0x80008000,0xbbf6bc00,0xbba8bbd9,0xb913b9a8,0xb78bb872
.long 0x323e8000,0x3872361f,0x3bd93c00,0x3aa73b64,0x3ba83c00,0x39133aa7,0xbb0eb9a8,0xbbf6bbd9
.long 0xb61f8000,0xbb64b9a8,0x361f8000,0x3b6439a8,0xbb0ebc00,0xae46b872,0x34a539a8,0xb913b23e
.long 0x38728000,0x3bd93b64,0xbaa7bc00,0x323eb61f,0x3a2f3c00,0xb78b323e,0x3bf639a8,0x34a53aa7
.long 0xb9a88000,0xb9a8bc00,0xb9a88000,0xb9a8bc00,0xb913bc00,0x3b0e323e,0x2e46b9a8,0x3ba83aa7
.long 0x3aa78000,0x323e3b64,0x38723c00,0xbbd9b61f,0x378b3c00,0xbbf6b872,0xbba8b9a8,0x3a2fb23e
.long 0xbb648000,0x361fb9a8,0x3b648000,0xb61f39a8,0xb4a5bc00,0x3a2f3aa7,0xb78b39a8,0xae46bbd9
.long 0x3bd98000,0xbaa7361f,0xb23ebc00,0x38723b64,0x2e463c00,0xb4a5bbd9,0x3a2f39a8,0xbb0eb872
.long 0xbc008000,0x3c008000,0xbc008000,0x3c008000,0x2e46bc00,0xb4a53bd9,0x3a2fb9a8,0xbb0e3872
.long 0x3bd98000,0xbaa7b61f,0xb23e3c00,0x3872bb64,0xb4a53c00,0x3a2fbaa7,0xb78bb9a8,0xae463bd9
.long 0xbb648000,0x361f39a8,0x3b648000,0xb61fb9a8,0x378bbc00,0xbbf63872,0xbba839a8,0x3a2f323e
.long 0x3aa78000,0x323ebb64,0x3872bc00,0xbbd9361f,0xb9133c00,0x3b0eb23e,0x2e4639a8,0x3ba8baa7
.long 0xb9a88000,0xb9a83c00,0xb9a88000,0xb9a83c00,0x3a2fbc00,0xb78bb23e,0x3bf6b9a8,0x34a5baa7
.long 0x38728000,0x3bd9bb64,0xbaa73c00,0x323e361f,0xbb0e3c00,0xae463872,0x34a5b9a8,0xb913323e
.long 0xb61f8000,0xbb6439a8,0x361f8000,0x3b64b9a8,0x3ba8bc00,0x3913baa7,0xbb0e39a8,0xbbf63bd9
.long 0x323e8000,0x3872b61f,0x3bd9bc00,0x3aa7bb64,0xbbf63c00,0xbba83bd9,0xb91339a8,0xb78b3872
.long 0x80008000,0x80008000,0x80008000,0x80008000,0xbb0ebb64,0xba2fbaa7,0xb4a5b61f,0xae46b23e
.long 0x3aa739a8,0x3bd93b64,0x387239a8,0x323e361f,0x2e46361f,0xb78bb23e,0xba2fbb64,0xb4a5b872
.long 0xbb64bc00,0xb61fb9a8,0x3b643c00,0x361f39a8,0x3a2f361f,0x3ba83bd9,0xbbf6bb64,0xb78bbaa7
.long 0x323e39a8,0xbaa7b61f,0x3bd939a8,0x38723b64,0xbba8bb64,0x2e46b872,0xbb0eb61f,0xb913bbd9
.long 0x39a88000,0x39a83c00,0x39a88000,0x39a83c00,0x34a53b64,0xbbf6b872,0xb78b361f,0xba2fbbd9
.long 0xbbd9b9a8,0x3872b61f,0x323eb9a8,0x3aa73b64,0x3913b61f,0x34a53bd9,0x2e463b64,0xbb0ebaa7
.long 0x361f3c00,0xbb64b9a8,0xb61fbc00,0x3b6439a8,0xbbf6b61f,0x3b0eb23e,0x39133b64,0xbba8b872
.long 0x3872b9a8,0xb23e3b64,0xbaa7b9a8,0x3bd9361f,0x378b3b64,0xb913baa7,0x3ba8361f,0xbbf6b23e
.long 0xbc008000,0x3c008000,0xbc008000,0x3c008000,0x378bbb64,0xb9133aa7,0x3ba8b61f,0xbbf6323e
.long 0x387239a8,0xb23ebb64,0xbaa739a8,0x3bd9b61f,0xbbf6361f,0x3b0e323e,0x3913bb64,0xbba83872
.long 0x361fbc00,0xbb6439a8,0xb61f3c00,0x3b64b9a8,0x3913361f,0x34a5bbd9,0x2e46bb64,0xbb0e3aa7
.long 0xbbd939a8,0x3872361f,0x323e39a8,0x3aa7bb64,0x34a5bb64,0xbbf63872,0xb78bb61f,0xba2f3bd9
.long 0x39a88000,0x39a8bc00,0x39a88000,0x39a8bc00,0xbba83b64,0x2e463872,0xbb0e361f,0xb9133bd9
.long 0x323eb9a8,0xbaa7361f,0x3bd9b9a8,0x3872bb64,0x3a2fb61f,0x3ba8bbd9,0xbbf63b64,0xb78b3aa7
.long 0xbb643c00,0xb61f39a8,0x3b64bc00,0x361fb9a8,0x2e46b61f,0xb78b323e,0xba2f3b64,0xb4a53872
.long 0x3aa7b9a8,0x3bd9bb64,0x3872b9a8,0x323eb61f,0xbb0e3b64,0xba2f3aa7,0xb4a5361f,0xae46323e
.long 0x80008000,0x80008000,0x80008000,0x80008000,0x2e468000,0x34a5323e,0x3a2f39a8,0x3b0e3aa7
.long 0xb23e8000,0xb872b61f,0xbbd9bc00,0xbaa7bb64,0x34a58000,0x3a2f3872,0x378b39a8,0xae46323e
.long 0xb61f8000,0xbb64b9a8,0x361f8000,0x3b6439a8,0x378b8000,0x3bf63aa7,0xbba8b9a8,0xba2fbbd9
.long 0xb8728000,0xbbd9bb64,0x3aa73c00,0xb23e361f,0x39138000,0x3b0e3bd9,0xae46b9a8,0x3ba83872
.long 0xb9a88000,0xb9a8bc00,0xb9a88000,0xb9a8bc00,0x3a2f8000,0x378b3bd9,0x3bf639a8,0xb4a53872
.long 0xbaa78000,0xb23ebb64,0xb872bc00,0x3bd9361f,0x3b0e8000,0xae463aa7,0xb4a539a8,0xb913bbd9
.long 0xbb648000,0x361fb9a8,0x3b648000,0xb61f39a8,0x3ba88000,0xb9133872,0xbb0eb9a8,0x3bf6323e
.long 0xbbd98000,0x3aa7b61f,0x323e3c00,0xb872bb64,0x3bf68000,0xbba8323e,0x3913b9a8,0xb78b3aa7
.long 0xbc008000,0x3c008000,0xbc008000,0x3c008000,0x3bf68000,0xbba8b23e,0x391339a8,0xb78bbaa7
.long 0xbbd98000,0x3aa7361f,0x323ebc00,0xb8723b64,0x3ba88000,0xb913b872,0xbb0e39a8,0x3bf6b23e
.long 0xbb648000,0x361f39a8,0x3b648000,0xb61fb9a8,0x3b0e8000,0xae46baa7,0xb4a5b9a8,0xb9133bd9
.long 0xbaa78000,0xb23e3b64,0xb8723c00,0x3bd9b61f,0x3a2f8000,0x378bbbd9,0x3bf6b9a8,0xb4a5b872
.long 0xb9a88000,0xb9a83c00,0xb9a88000,0xb9a83c00,0x39138000,0x3b0ebbd9,0xae4639a8,0x3ba8b872
.long 0xb8728000,0xbbd93b64,0x3aa7bc00,0xb23eb61f,0x378b8000,0x3bf6baa7,0xbba839a8,0xba2f3bd9
.long 0xb61f8000,0xbb6439a8,0x361f8000,0x3b64b9a8,0x34a58000,0x3a2fb872,0x378bb9a8,0xae46b23e
.long 0xb23e8000,0xb872361f,0xbbd93c00,0xbaa73b64,0x2e468000,0x34a5b23e,0x3a2fb9a8,0x3b0ebaa7
.long 0x80008000,0x80008000,0x80008000,0x80008000,0x378b361f,0x39133872,0x3ba83b64,0x3bf63bd9
.long 0xbaa7b9a8,0xbbd9bb64,0xb872b9a8,0xb23eb61f,0x3bf63b64,0x3b0e3bd9,0xb913b61f,0xbba8baa7
.long 0xbb64bc00,0xb61fb9a8,0x3b643c00,0x361f39a8,0x39133b64,0xb4a5323e,0x2e46b61f,0x3b0e3872
.long 0xb23eb9a8,0x3aa7361f,0xbbd9b9a8,0xb872bb64,0xb4a5361f,0xbbf6baa7,0x378b3b64,0xba2fb23e
.long 0x39a88000,0x39a83c00,0x39a88000,0x39a83c00,0xbba8b61f,0xae46baa7,0xbb0ebb64,0x3913b23e
.long 0x3bd939a8,0xb872361f,0xb23e39a8,0xbaa7bb64,0xba2fbb64,0x3ba8323e,0x3bf6361f,0xb78b3872
.long 0x361f3c00,0xbb64b9a8,0xb61fbc00,0x3b6439a8,0x2e46bb64,0x378b3bd9,0xba2f361f,0x34a5baa7
.long 0xb87239a8,0x323ebb64,0x3aa739a8,0xbbd9b61f,0x3b0eb61f,0xba2f3872,0x34a5bb64,0xae463bd9
.long 0xbc008000,0x3c008000,0xbc008000,0x3c008000,0x3b0e361f,0xba2fb872,0x34a53b64,0xae46bbd9
.long 0xb872b9a8,0x323e3b64,0x3aa7b9a8,0xbbd9361f,0x2e463b64,0x378bbbd9,0xba2fb61f,0x34a53aa7
.long 0x361fbc00,0xbb6439a8,0xb61f3c00,0x3b64b9a8,0xba2f3b64,0x3ba8b23e,0x3bf6b61f,0xb78bb872
.long 0x3bd9b9a8,0xb872b61f,0xb23eb9a8,0xbaa73b64,0xbba8361f,0xae463aa7,0xbb0e3b64,0x3913323e
.long 0x39a88000,0x39a8bc00,0x39a88000,0x39a8bc00,0xb4a5b61f,0xbbf63aa7,0x378bbb64,0xba2f323e
.long 0xb23e39a8,0x3aa7b61f,0xbbd939a8,0xb8723b64,0x3913bb64,0xb4a5b23e,0x2e46361f,0x3b0eb872
.long 0xbb643c00,0xb61f39a8,0x3b64bc00,0x361fb9a8,0x3bf6bb64,0x3b0ebbd9,0xb913361f,0xbba83aa7
.long 0xbaa739a8,0xbbd93b64,0xb87239a8,0xb23e361f,0x378bb61f,0x3913b872,0x3ba8bb64,0x3bf6bbd9
.long 0x80008000,0x80008000,0x80008000,0x80008000,0x3bf63c00,0x3ba83bd9,0x391339a8,0x378b3872
.long 0x323e8000,0x3872361f,0x3bd93c00,0x3aa73b64,0xbba8bc00,0xb913baa7,0x3b0e39a8,0x3bf63bd9
.long 0xb61f8000,0xbb64b9a8,0x361f8000,0x3b6439a8,0x3b0e3c00,0x2e463872,0xb4a5b9a8,0x3913323e
.long 0x38728000,0x3bd93b64,0xbaa7bc00,0x323eb61f,0xba2fbc00,0x378bb23e,0xbbf6b9a8,0xb4a5baa7
.long 0xb9a88000,0xb9a8bc00,0xb9a88000,0xb9a8bc00,0x39133c00,0xbb0eb23e,0xae4639a8,0xbba8baa7
.long 0x3aa78000,0x323e3b64,0x38723c00,0xbbd9b61f,0xb78bbc00,0x3bf63872,0x3ba839a8,0xba2f323e
.long 0xbb648000,0x361fb9a8,0x3b648000,0xb61f39a8,0x34a53c00,0xba2fbaa7,0x378bb9a8,0x2e463bd9
.long 0x3bd98000,0xbaa7361f,0xb23ebc00,0x38723b64,0xae46bc00,0x34a53bd9,0xba2fb9a8,0x3b0e3872
.long 0xbc008000,0x3c008000,0xbc008000,0x3c008000,0xae463c00,0x34a5bbd9,0xba2f39a8,0x3b0eb872
.long 0x3bd98000,0xbaa7b61f,0xb23e3c00,0x3872bb64,0x34a5bc00,0xba2f3aa7,0x378b39a8,0x2e46bbd9
.long 0xbb648000,0x361f39a8,0x3b648000,0xb61fb9a8,0xb78b3c00,0x3bf6b872,0x3ba8b9a8,0xba2fb23e
.long 0x3aa78000,0x323ebb64,0x3872bc00,0xbbd9361f,0x3913bc00,0xbb0e323e,0xae46b9a8,0xbba83aa7
.long 0xb9a88000,0xb9a83c00,0xb9a88000,0xb9a83c00,0xba2f3c00,0x378b323e,0xbbf639a8,0xb4a53aa7
.long 0x38728000,0x3bd9bb64,0xbaa73c00,0x323e361f,0x3b0ebc00,0x2e46b872,0xb4a539a8,0x3913b23e
.long 0xb61f8000,0xbb6439a8,0x361f8000,0x3b64b9a8,0xbba83c00,0xb9133aa7,0x3b0eb9a8,0x3bf6bbd9
.long 0x323e8000,0x3872b61f,0x3bd9bc00,0x3aa7bb64,0x3bf6bc00,0x3ba8bbd9,0x3913b9a8,0x378bb872
.long 0x80008000,0x80008000,0x80008000,0x80008000,0x3b0e3b64,0x3a2f3aa7,0x34a5361f,0x2e46323e
.long 0x3aa739a8,0x3bd93b64,0x387239a8,0x323e361f,0xae46b61f,0x378b323e,0x3a2f3b64,0x34a53872
.long 0xbb64bc00,0xb61fb9a8,0x3b643c00,0x361f39a8,0xba2fb61f,0xbba8bbd9,0x3bf63b64,0x378b3aa7
.long 0x323e39a8,0xbaa7b61f,0x3bd939a8,0x38723b64,0x3ba83b64,0xae463872,0x3b0e361f,0x39133bd9
.long 0x39a88000,0x39a83c00,0x39a88000,0x39a83c00,0xb4a5bb64,0x3bf63872,0x378bb61f,0x3a2f3bd9
.long 0xbbd9b9a8,0x3872b61f,0x323eb9a8,0x3aa73b64,0xb913361f,0xb4a5bbd9,0xae46bb64,0x3b0e3aa7
.long 0x361f3c00,0xbb64b9a8,0xb61fbc00,0x3b6439a8,0x3bf6361f,0xbb0e323e,0xb913bb64,0x3ba83872
.long 0x3872b9a8,0xb23e3b64,0xbaa7b9a8,0x3bd9361f,0xb78bbb64,0x39133aa7,0xbba8b61f,0x3bf6323e
.long 0xbc008000,0x3c008000,0xbc008000,0x3c008000,0xb78b3b64,0x3913baa7,0xbba8361f,0x3bf6b23e
.long 0x387239a8,0xb23ebb64,0xbaa739a8,0x3bd9b61f,0x3bf6b61f,0xbb0eb23e,0xb9133b64,0x3ba8b872
.long 0x361fbc00,0xbb6439a8,0xb61f3c00,0x3b64b9a8,0xb913b61f,0xb4a53bd9,0xae463b64,0x3b0ebaa7
.long 0xbbd939a8,0x3872361f,0x323e39a8,0x3aa7bb64,0xb4a53b64,0x3bf6b872,0x378b361f,0x3a2fbbd9
.long 0x39a88000,0x39a8bc00,0x39a88000,0x39a8bc00,0x3ba8bb64,0xae46b872,0x3b0eb61f,0x3913bbd9
.long 0x323eb9a8,0xbaa7361f,0x3bd9b9a8,0x3872bb64,0xba2f361f,0xbba83bd9,0x3bf6bb64,0x378bbaa7
.long 0xbb643c00,0xb61f39a8,0x3b64bc00,0x361fb9a8,0xae46361f,0x378bb23e,0x3a2fbb64,0x34a5b872
.long 0x3aa7b9a8,0x3bd9bb64,0x3872b9a8,0x323eb61f,0x3b0ebb64,0x3a2fbaa7,0x34a5b61f,0x2e46b23e
.long 0x80008000,0x80008000,0x80008000,0x80008000,0x2e468000,0x34a5b23e,0x3a2fb9a8,0x3b0ebaa7
.long 0x323e8000,0x3872b61f,0x3bd9bc00,0x3aa7bb64,0x34a58000,0x3a2fb872,0x378bb9a8,0xae46b23e
.long 0x361f8000,0x3b64b9a8,0xb61f8000,0xbb6439a8,0x378b8000,0x3bf6baa7,0xbba839a8,0xba2f3bd9
.long 0x38728000,0x3bd9bb64,0xbaa73c00,0x323e361f,0x39138000,0x3b0ebbd9,0xae4639a8,0x3ba8b872
.long 0x39a88000,0x39a8bc00,0x39a88000,0x39a8bc00,0x3a2f8000,0x378bbbd9,0x3bf6b9a8,0xb4a5b872
.long 0x3aa78000,0x323ebb64,0x3872bc00,0xbbd9361f,0x3b0e8000,0xae46baa7,0xb4a5b9a8,0xb9133bd9
.long 0x3b648000,0xb61fb9a8,0xbb648000,0x361f39a8,0x3ba88000,0xb913b872,0xbb0e39a8,0x3bf6b23e
.long 0x3bd98000,0xbaa7b61f,0xb23e3c00,0x3872bb64,0x3bf68000,0xbba8b23e,0x391339a8,0xb78bbaa7
.long 0x3c008000,0xbc008000,0x3c008000,0xbc008000,0x3bf68000,0xbba8323e,0x3913b9a8,0xb78b3aa7
.long 0x3bd98000,0xbaa7361f,0xb23ebc00,0x38723b64,0x3ba88000,0xb9133872,0xbb0eb9a8,0x3bf6323e
.long 0x3b648000,0xb61f39a8,0xbb648000,0x361fb9a8,0x3b0e8000,0xae463aa7,0xb4a539a8,0xb913bbd9
.long 0x3aa78000,0x323e3b64,0x38723c00,0xbbd9b61f,0x3a2f8000,0x378b3bd9,0x3bf639a8,0xb4a53872
.long 0x39a88000,0x39a83c00,0x39a88000,0x39a83c00,0x39138000,0x3b0e3bd9,0xae46b9a8,0x3ba83872
.long 0x38728000,0x3bd93b64,0xbaa7bc00,0x323eb61f,0x378b8000,0x3bf63aa7,0xbba8b9a8,0xba2fbbd9
.long 0x361f8000,0x3b6439a8,0xb61f8000,0xbb64b9a8,0x34a58000,0x3a2f3872,0x378b39a8,0xae46323e
.long 0x323e8000,0x3872361f,0x3bd93c00,0x3aa73b64,0x2e468000,0x34a5323e,0x3a2f39a8,0x3b0e3aa7
.long 0x80008000,0x80008000,0x80008000,0x80008000,0x378bb61f,0x3913b872,0x3ba8bb64,0x3bf6bbd9
.long 0x3aa7b9a8,0x3bd9bb64,0x3872b9a8,0x323eb61f,0x3bf6bb64,0x3b0ebbd9,0xb913361f,0xbba83aa7
.long 0x3b64bc00,0x361fb9a8,0xbb643c00,0xb61f39a8,0x3913bb64,0xb4a5b23e,0x2e46361f,0x3b0eb872
.long 0x323eb9a8,0xbaa7361f,0x3bd9b9a8,0x3872bb64,0xb4a5b61f,0xbbf63aa7,0x378bbb64,0xba2f323e
.long 0xb9a88000,0xb9a83c00,0xb9a88000,0xb9a83c00,0xbba8361f,0xae463aa7,0xbb0e3b64,0x3913323e
.long 0xbbd939a8,0x3872361f,0x323e39a8,0x3aa7bb64,0xba2f3b64,0x3ba8b23e,0x3bf6b61f,0xb78bb872
.long 0xb61f3c00,0x3b64b9a8,0x361fbc00,0xbb6439a8,0x2e463b64,0x378bbbd9,0xba2fb61f,0x34a53aa7
.long 0x387239a8,0xb23ebb64,0xbaa739a8,0x3bd9b61f,0x3b0e361f,0xba2fb872,0x34a53b64,0xae46bbd9
.long 0x3c008000,0xbc008000,0x3c008000,0xbc008000,0x3b0eb61f,0xba2f3872,0x34a5bb64,0xae463bd9
.long 0x3872b9a8,0xb23e3b64,0xbaa7b9a8,0x3bd9361f,0x2e46bb64,0x378b3bd9,0xba2f361f,0x34a5baa7
.long 0xb61fbc00,0x3b6439a8,0x361f3c00,0xbb64b9a8,0xba2fbb64,0x3ba8323e,0x3bf6361f,0xb78b3872
.long 0xbbd9b9a8,0x3872b61f,0x323eb9a8,0x3aa73b64,0xbba8b61f,0xae46baa7,0xbb0ebb64,0x3913b23e
.long 0xb9a88000,0xb9a8bc00,0xb9a88000,0xb9a8bc00,0xb4a5361f,0xbbf6baa7,0x378b3b64,0xba2fb23e
.long 0x323e39a8,0xbaa7b61f,0x3bd939a8,0x38723b64,0x39133b64,0xb4a5323e,0x2e46b61f,0x3b0e3872
.long 0x3b643c00,0x361f39a8,0xbb64bc00,0xb61fb9a8,0x3bf63b64,0x3b0e3bd9,0xb913b61f,0xbba8baa7
.long 0x3aa739a8,0x3bd93b64,0x387239a8,0x323e361f,0x378b361f,0x39133872,0x3ba83b64,0x3bf63bd9
.long 0x80008000,0x80008000,0x80008000,0x80008000,0x3bf6bc00,0x3ba8bbd9,0x3913b9a8,0x378bb872
.long 0xb23e8000,0xb872361f,0xbbd93c00,0xbaa73b64,0xbba83c00,0xb9133aa7,0x3b0eb9a8,0x3bf6bbd9
.long 0x361f8000,0x3b64b9a8,0xb61f8000,0xbb6439a8,0x3b0ebc00,0x2e46b872,0xb4a539a8,0x3913b23e
.long 0xb8728000,0xbbd93b64,0x3aa7bc00,0xb23eb61f,0xba2f3c00,0x378b323e,0xbbf639a8,0xb4a53aa7
.long 0x39a88000,0x39a8bc00,0x39a88000,0x39a8bc00,0x3913bc00,0xbb0e323e,0xae46b9a8,0xbba83aa7
.long 0xbaa78000,0xb23e3b64,0xb8723c00,0x3bd9b61f,0xb78b3c00,0x3bf6b872,0x3ba8b9a8,0xba2fb23e
.long 0x3b648000,0xb61fb9a8,0xbb648000,0x361f39a8,0x34a5bc00,0xba2f3aa7,0x378b39a8,0x2e46bbd9
.long 0xbbd98000,0x3aa7361f,0x323ebc00,0xb8723b64,0xae463c00,0x34a5bbd9,0xba2f39a8,0x3b0eb872
.long 0x3c008000,0xbc008000,0x3c008000,0xbc008000,0xae46bc00,0x34a53bd9,0xba2fb9a8,0x3b0e3872
.long 0xbbd98000,0x3aa7b61f,0x323e3c00,0xb872bb64,0x34a53c00,0xba2fbaa7,0x378bb9a8,0x2e463bd9
.long 0x3b648000,0xb61f39a8,0xbb648000,0x361fb9a8,0xb78bbc00,0x3bf63872,0x3ba839a8,0xba2f323e
.long 0xbaa78000,0xb23ebb64,0xb872bc00,0x3bd9361f,0x39133c00,0xbb0eb23e,0xae4639a8,0xbba8baa7
.long 0x39a88000,0x39a83c00,0x39a88000,0x39a83c00,0xba2fbc00,0x378bb23e,0xbbf6b9a8,0xb4a5baa7
.long 0xb8728000,0xbbd9bb64,0x3aa73c00,0xb23e361f,0x3b0e3c00,0x2e463872,0xb4a5b9a8,0x3913323e
.long 0x361f8000,0x3b6439a8,0xb61f8000,0xbb64b9a8,0xbba8bc00,0xb913baa7,0x3b0e39a8,0x3bf63bd9
.long 0xb23e8000,0xb872b61f,0xbbd9bc00,0xbaa7bb64,0x3bf63c00,0x3ba83bd9,0x391339a8,0x378b3872
.long 0x80008000,0x80008000,0x80008000,0x80008000,0x3b0ebb64,0x3a2fbaa7,0x34a5b61f,0x2e46b23e
.long 0xbaa739a8,0xbbd93b64,0xb87239a8,0xb23e361f,0xae46361f,0x378bb23e,0x3a2fbb64,0x34a5b872
.long 0x3b64bc00,0x361fb9a8,0xbb643c00,0xb61f39a8,0xba2f361f,0xbba83bd9,0x3bf6bb64,0x378bbaa7
.long 0xb23e39a8,0x3aa7b61f,0xbbd939a8,0xb8723b64,0x3ba8bb64,0xae46b872,0x3b0eb61f,0x3913bbd9
.long 0xb9a88000,0xb9a83c00,0xb9a88000,0xb9a83c00,0xb4a53b64,0x3bf6b872,0x378b361f,0x3a2fbbd9
.long 0x3bd9b9a8,0xb872b61f,0xb23eb9a8,0xbaa73b64,0xb913b61f,0xb4a53bd9,0xae463b64,0x3b0ebaa7
.long 0xb61f3c00,0x3b64b9a8,0x361fbc00,0xbb6439a8,0x3bf6b61f,0xbb0eb23e,0xb9133b64,0x3ba8b872
.long 0xb872b9a8,0x323e3b64,0x3aa7b9a8,0xbbd9361f,0xb78b3b64,0x3913baa7,0xbba8361f,0x3bf6b23e
.long 0x3c008000,0xbc008000,0x3c008000,0xbc008000,0xb78bbb64,0x39133aa7,0xbba8b61f,0x3bf6323e
.long 0xb87239a8,0x323ebb64,0x3aa739a8,0xbbd9b61f,0x3bf6361f,0xbb0e323e,0xb913bb64,0x3ba83872
.long 0xb61fbc00,0x3b6439a8,0x361f3c00,0xbb64b9a8,0xb913361f,0xb4a5bbd9,0xae46bb64,0x3b0e3aa7
.long 0x3bd939a8,0xb872361f,0xb23e39a8,0xbaa7bb64,0xb4a5bb64,0x3bf63872,0x378bb61f,0x3a2f3bd9
.long 0xb9a88000,0xb9a8bc00,0xb9a88000,0xb9a8bc00,0x3ba83b64,0xae463872,0x3b0e361f,0x39133bd9
.long 0xb23eb9a8,0x3aa7361f,0xbbd9b9a8,0xb872bb64,0xba2fb61f,0xbba8bbd9,0x3bf63b64,0x378b3aa7
.long 0x3b643c00,0x361f39a8,0xbb64bc00,0xb61fb9a8,0xae46b61f,0x378b323e,0x3a2f3b64,0x34a53872
.long 0xbaa7b9a8,0xbbd9bb64,0xb872b9a8,0xb23eb61f,0x3b0e3b64,0x3a2f3aa7,0x34a5361f,0x2e46323e
.long 0x80008000,0x80008000,0x80008000,0x80008000,0xae468000,0xb4a5323e,0xba2f39a8,0xbb0e3aa7
.long 0x323e8000,0x3872b61f,0x3bd9bc00,0x3aa7bb64,0xb4a58000,0xba2f3872,0xb78b39a8,0x2e46323e
.long 0x361f8000,0x3b64b9a8,0xb61f8000,0xbb6439a8,0xb78b8000,0xbbf63aa7,0x3ba8b9a8,0x3a2fbbd9
.long 0x38728000,0x3bd9bb64,0xbaa73c00,0x323e361f,0xb9138000,0xbb0e3bd9,0x2e46b9a8,0xbba83872
.long 0x39a88000,0x39a8bc00,0x39a88000,0x39a8bc00,0xba2f8000,0xb78b3bd9,0xbbf639a8,0x34a53872
.long 0x3aa78000,0x323ebb64,0x3872bc00,0xbbd9361f,0xbb0e8000,0x2e463aa7,0x34a539a8,0x3913bbd9
.long 0x3b648000,0xb61fb9a8,0xbb648000,0x361f39a8,0xbba88000,0x39133872,0x3b0eb9a8,0xbbf6323e
.long 0x3bd98000,0xbaa7b61f,0xb23e3c00,0x3872bb64,0xbbf68000,0x3ba8323e,0xb913b9a8,0x378b3aa7
.long 0x3c008000,0xbc008000,0x3c008000,0xbc008000,0xbbf68000,0x3ba8b23e,0xb91339a8,0x378bbaa7
.long 0x3bd98000,0xbaa7361f,0xb23ebc00,0x38723b64,0xbba88000,0x3913b872,0x3b0e39a8,0xbbf6b23e
.long 0x3b648000,0xb61f39a8,0xbb648000,0x361fb9a8,0xbb0e8000,0x2e46baa7,0x34a5b9a8,0x39133bd9
.long 0x3aa78000,0x323e3b64,0x38723c00,0xbbd9b61f,0xba2f8000,0xb78bbbd9,0xbbf6b9a8,0x34a5b872
.long 0x39a88000,0x39a83c00,0x39a88000,0x39a83c00,0xb9138000,0xbb0ebbd9,0x2e4639a8,0xbba8b872
.long 0x38728000,0x3bd93b64,0xbaa7bc00,0x323eb61f,0xb78b8000,0xbbf6baa7,0x3ba839a8,0x3a2f3bd9
.long 0x361f8000,0x3b6439a8,0xb61f8000,0xbb64b9a8,0xb4a58000,0xba2fb872,0xb78bb9a8,0x2e46b23e
.long 0x323e8000,0x3872361f,0x3bd93c00,0x3aa73b64,0xae468000,0xb4a5b23e,0xba2fb9a8,0xbb0ebaa7
.long 0x80008000,0x80008000,0x80008000,0x80008000,0xb78b361f,0xb9133872,0xbba83b64,0xbbf63bd9
.long 0x3aa7b9a8,0x3bd9bb64,0x3872b9a8,0x323eb61f,0xbbf63b64,0xbb0e3bd9,0x3913b61f,0x3ba8baa7
.long 0x3b64bc00,0x361fb9a8,0xbb643c00,0xb61f39a8,0xb9133b64,0x34a5323e,0xae46b61f,0xbb0e3872
.long 0x323eb9a8,0xbaa7361f,0x3bd9b9a8,0x3872bb64,0x34a5361f,0x3bf6baa7,0xb78b3b64,0x3a2fb23e
.long 0xb9a88000,0xb9a83c00,0xb9a88000,0xb9a83c00,0x3ba8b61f,0x2e46baa7,0x3b0ebb64,0xb913b23e
.long 0xbbd939a8,0x3872361f,0x323e39a8,0x3aa7bb64,0x3a2fbb64,0xbba8323e,0xbbf6361f,0x378b3872
.long 0xb61f3c00,0x3b64b9a8,0x361fbc00,0xbb6439a8,0xae46bb64,0xb78b3bd9,0x3a2f361f,0xb4a5baa7
.long 0x387239a8,0xb23ebb64,0xbaa739a8,0x3bd9b61f,0xbb0eb61f,0x3a2f3872,0xb4a5bb64,0x2e463bd9
.long 0x3c008000,0xbc008000,0x3c008000,0xbc008000,0xbb0e361f,0x3a2fb872,0xb4a53b64,0x2e46bbd9
.long 0x3872b9a8,0xb23e3b64,0xbaa7b9a8,0x3bd9361f,0xae463b64,0xb78bbbd9,0x3a2fb61f,0xb4a53aa7
.long 0xb61fbc00,0x3b6439a8,0x361f3c00,0xbb64b9a8,0x3a2f3b64,0xbba8b23e,0xbbf6b61f,0x378bb872
.long 0xbbd9b9a8,0x3872b61f,0x323eb9a8,0x3aa73b64,0x3ba8361f,0x2e463aa7,0x3b0e3b64,0xb913323e
.long 0xb9a88000,0xb9a8bc00,0xb9a88000,0xb9a8bc00,0x34a5b61f,0x3bf63aa7,0xb78bbb64,0x3a2f323e
.long 0x323e39a8,0xbaa7b61f,0x3bd939a8,0x38723b64,0xb913bb64,0x34a5b23e,0xae46361f,0xbb0eb872
.long 0x3b643c00,0x361f39a8,0xbb64bc00,0xb61fb9a8,0xbbf6bb64,0xbb0ebbd9,0x3913361f,0x3ba83aa7
.long 0x3aa739a8,0x3bd93b64,0x387239a8,0x323e361f,0xb78bb61f,0xb913b872,0xbba8bb64,0xbbf6bbd9
.long 0x80008000,0x80008000,0x80008000,0x80008000,0xbbf63c00,0xbba83bd9,0xb91339a8,0xb78b3872
.long 0xb23e8000,0xb872361f,0xbbd93c00,0xbaa73b64,0x3ba8bc00,0x3913baa7,0xbb0e39a8,0xbbf63bd9
.long 0x361f8000,0x3b64b9a8,0xb61f8000,0xbb6439a8,0xbb0e3c00,0xae463872,0x34a5b9a8,0xb913323e
.long 0xb8728000,0xbbd93b64,0x3aa7bc00,0xb23eb61f,0x3a2fbc00,0xb78bb23e,0x3bf6b9a8,0x34a5baa7
.long 0x39a88000,0x39a8bc00,0x39a88000,0x39a8bc00,0xb9133c00,0x3b0eb23e,0x2e4639a8,0x3ba8baa7
.long 0xbaa78000,0xb23e3b64,0xb8723c00,0x3bd9b61f,0x378bbc00,0xbbf63872,0xbba839a8,0x3a2f323e
.long 0x3b648000,0xb61fb9a8,0xbb648000,0x361f39a8,0xb4a53c00,0x3a2fbaa7,0xb78bb9a8,0xae463bd9
.long 0xbbd98000,0x3aa7361f,0x323ebc00,0xb8723b64,0x2e46bc00,0xb4a53bd9,0x3a2fb9a8,0xbb0e3872
.long 0x3c008000,0xbc008000,0x3c008000,0xbc008000,0x2e463c00,0xb4a5bbd9,0x3a2f39a8,0xbb0eb872
.long 0xbbd98000,0x3aa7b61f,0x323e3c00,0xb872bb64,0xb4a5bc00,0x3a2f3aa7,0xb78b39a8,0xae46bbd9
.long 0x3b648000,0xb61f39a8,0xbb648000,0x361fb9a8,0x378b3c00,0xbbf6b872,0xbba8b9a8,0x3a2fb23e
.long 0xbaa78000,0xb23ebb64,0xb872bc00,0x3bd9361f,0xb913bc00,0x3b0e323e,0x2e46b9a8,0x3ba83aa7
.long 0x39a88000,0x39a83c00,0x39a88000,0x39a83c00,0x3a2f3c00,0xb78b323e,0x3bf639a8,0x34a53aa7
.long 0xb8728000,0xbbd9bb64,0x3aa73c00,0xb23e361f,0xbb0ebc00,0xae46b872,0x34a539a8,0xb913b23e
.long 0x361f8000,0x3b6439a8,0xb61f8000,0xbb64b9a8,0x3ba83c00,0x39133aa7,0xbb0eb9a8,0xbbf6bbd9
.long 0xb23e8000,0xb872b61f,0xbbd9bc00,0xbaa7bb64,0xbbf6bc00,0xbba8bbd9,0xb913b9a8,0xb78bb872
.long 0x80008000,0x80008000,0x80008000,0x80008000,0xbb0e3b64,0xba2f3aa7,0xb4a5361f,0xae46323e
.long 0xbaa739a8,0xbbd93b64,0xb87239a8,0xb23e361f,0x2e46b61f,0xb78b323e,0xba2f3b64,0xb4a53872
.long 0x3b64bc00,0x361fb9a8,0xbb643c00,0xb61f39a8,0x3a2fb61f,0x3ba8bbd9,0xbbf63b64,0xb78b3aa7
.long 0xb23e39a8,0x3aa7b61f,0xbbd939a8,0xb8723b64,0xbba83b64,0x2e463872,0xbb0e361f,0xb9133bd9
.long 0xb9a88000,0xb9a83c00,0xb9a88000,0xb9a83c00,0x34a5bb64,0xbbf63872,0xb78bb61f,0xba2f3bd9
.long 0x3bd9b9a8,0xb872b61f,0xb23eb9a8,0xbaa73b64,0x3913361f,0x34a5bbd9,0x2e46bb64,0xbb0e3aa7
.long 0xb61f3c00,0x3b64b9a8,0x361fbc00,0xbb6439a8,0xbbf6361f,0x3b0e323e,0x3913bb64,0xbba83872
.long 0xb872b9a8,0x323e3b64,0x3aa7b9a8,0xbbd9361f,0x378bbb64,0xb9133aa7,0x3ba8b61f,0xbbf6323e
.long 0x3c008000,0xbc008000,0x3c008000,0xbc008000,0x378b3b64,0xb913baa7,0x3ba8361f,0xbbf6b23e
.long 0xb87239a8,0x323ebb64,0x3aa739a8,0xbbd9b61f,0xbbf6b61f,0x3b0eb23e,0x39133b64,0xbba8b872
.long 0xb61fbc00,0x3b6439a8,0x361f3c00,0xbb64b9a8,0x3913b61f,0x34a53bd9,0x2e463b64,0xbb0ebaa7
.long 0x3bd939a8,0xb872361f,0xb23e39a8,0xbaa7bb64,0x34a53b64,0xbbf6b872,0xb78b361f,0xba2fbbd9
.long 0xb9a88000,0xb9a8bc00,0xb9a88000,0xb9a8bc00,0xbba8bb64,0x2e46b872,0xbb0eb61f,0xb913bbd9
.long 0xb23eb9a8,0x3aa7361f,0xbbd9b9a8,0xb872bb64,0x3a2f361f,0x3ba83bd9,0xbbf6bb64,0xb78bbaa7
.long 0x3b643c00,0x361f39a8,0xbb64bc00,0xb61fb9a8,0x2e46361f,0xb78bb23e,0xba2fbb64,0xb4a5b872
.long 0xbaa7b9a8,0xbbd9bb64,0xb872b9a8,0xb23eb61f,0xbb0ebb64,0xba2fbaa7,0xb4a5b61f,0xae46b23e
.long 0x3e000000,0x3e000000,0x3e000000,0x3e000000,0x3e000000,0x3dffffb1,0x3dfffec4,0x3dfffd39
.long 0x3e000000,0x3dfffec4,0x3dfffb11,0x3dfff4e6,0x3e000000,0x3dfffd39,0x3dfff4e6,0x3dffe705
.long 0x3e000000,0x3dfffb11,0x3dffec43,0x3dffd397,0x3e000000,0x3dfff84a,0x3dffe129,0x3dffba9e
.long 0x3e000000,0x3dfff4e6,0x3dffd397,0x3dff9c18,0x3e000000,0x3dfff0e3,0x3dffc38f,0x3dff7808
.long 0x3e000000,0x3dffec43,0x3dffb10f,0x3dff4e6d,0x3e000000,0x3dffe705,0x3dff9c18,0x3dff1f49
.long 0x3e000000,0x3dffe129,0x3dff84ab,0x3dfeea9d,0x3e000000,0x3dffdaaf,0x3dff6ac7,0x3dfeb069
.long 0x3e000000,0x3dffd397,0x3dff4e6d,0x3dfe70b0,0x3e000000,0x3dffcbe2,0x3dff2f9d,0x3dfe2b72
.long 0x3e000000,0x3dffc38f,0x3dff0e58,0x3dfde0b1,0x3e000000,0x3dffba9e,0x3dfeea9d,0x3dfd906e
.long 0x3e000000,0x3dffb10f,0x3dfec46d,0x3dfd3aac,0x3e000000,0x3dffa6e3,0x3dfe9bc9,0x3dfcdf6c
.long 0x3e000000,0x3dff9c18,0x3dfe70b0,0x3dfc7eb0,0x3e000000,0x3dff90b1,0x3dfe4323,0x3dfc187a
.long 0x3e000000,0x3dff84ab,0x3dfe1324,0x3dfbaccd,0x3e000000,0x3dff7808,0x3dfde0b1,0x3dfb3bab
.long 0x3e000000,0x3dff6ac7,0x3dfdabcc,0x3dfac516,0x3e000000,0x3dff5ce9,0x3dfd7474,0x3dfa4910
.long 0x3e000000,0x3dff4e6d,0x3dfd3aac,0x3df9c79d,0x3e000000,0x3dff3f54,0x3dfcfe73,0x3df940c0
.long 0x3e000000,0x3dff2f9d,0x3dfcbfc9,0x3df8b47b,0x3e000000,0x3dff1f49,0x3dfc7eb0,0x3df822d1
.long 0x3e000000,0x3dff0e58,0x3dfc3b28,0x3df78bc5,0x3e000000,0x3dfefcc9,0x3dfbf531,0x3df6ef5b
.long 0x3e000000,0x3dfeea9d,0x3dfbaccd,0x3df64d97,0x3e000000,0x3dfed7d4,0x3dfb61fc,0x3df5a67b
.long 0x3e000000,0x3e000000,0x3e000000,0x3e000000,0x3dfffb11,0x3dfff84a,0x3dfff4e6,0x3dfff0e3
.long 0x3dffec43,0x3dffe129,0x3dffd397,0x3dffc38f,0x3dffd397,0x3dffba9e,0x3dff9c18,0x3dff7808
.long 0x3dffb10f,0x3dff84ab,0x3dff4e6d,0x3dff0e58,0x3dff84ab,0x3dff3f54,0x3dfeea9d,0x3dfe868b
.long 0x3dff4e6d,0x3dfeea9d,0x3dfe70b0,0x3dfde0b1,0x3dff0e58,0x3dfe868b,0x3dfde0b1,0x3dfd1cdd
.long 0x3dfec46d,0x3dfe1324,0x3dfd3aac,0x3dfc3b28,0x3dfe70b0,0x3dfd906e,0x3dfc7eb0,0x3dfb3bab
.long 0x3dfe1324,0x3dfcfe73,0x3dfbaccd,0x3dfa1e84,0x3dfdabcc,0x3dfc5d3a,0x3dfac516,0x3df8e3d6
.long 0x3dfd3aac,0x3dfbaccd,0x3df9c79d,0x3df78bc5,0x3dfcbfc9,0x3dfaed37,0x3df8b47b,0x3df6167a
.long 0x3dfc3b28,0x3dfa1e84,0x3df78bc5,0x3df48422,0x3dfbaccd,0x3df940c0,0x3df64d97,0x3df2d4eb
.long 0x3dfb14be,0x3df853f8,0x3df4fa0b,0x3df10908,0x3dfa7302,0x3df7583a,0x3df3913f,0x3def20b0
.long 0x3df9c79d,0x3df64d97,0x3df21352,0x3ded1c1d,0x3df91298,0x3df5341d,0x3df08066,0x3deafb8c
.long 0x3df853f8,0x3df40bdd,0x3deed89e,0x3de8bf3c,0x3df78bc5,0x3df2d4eb,0x3ded1c1d,0x3de66771
.long 0x3df6ba07,0x3df18f57,0x3deb4b0c,0x3de3f473,0x3df5dec6,0x3df03b37,0x3de96591,0x3de1668a
.long 0x3df4fa0b,0x3deed89e,0x3de76bd8,0x3ddebe05,0x3df40bdd,0x3ded67a1,0x3de55e0b,0x3ddbfb34
.long 0x3df31447,0x3debe858,0x3de33c5a,0x3dd91e6a,0x3df21352,0x3dea5ad9,0x3de106f2,0x3dd627fe
.long 0x3df10908,0x3de8bf3c,0x3ddebe05,0x3dd31849,0x3deff573,0x3de71599,0x3ddc61c7,0x3dcfefa8
.long 0x3deed89e,0x3de55e0b,0x3dd9f26a,0x3dccae79,0x3dedb293,0x3de398ac,0x3dd77026,0x3dc95521
.long 0x0,0x0,0x0,0x0,0x0,0x39c90fc6,0x3a490f88,0x3a96cb58
.long 0x0,0x3a490f88,0x3ac90e90,0x3b16c9b6,0x0,0x3a96cb58,0x3b16c9b6,0x3b622a7a
.long 0x0,0x3ac90e90,0x3b490ab0,0x3b96c32c,0x0,0x3afb514b,0x3b7b49ba,0x3bbc6dd5
.long 0x0,0x3b16c9b6,0x3b96c32c,0x3be21469,0x0,0x3b2fea69,0x3bafe007,0x3c03db0a
.long 0x0,0x3b490ab0,0x3bc8fb30,0x3c16a905,0x0,0x3b622a7a,0x3be21469,0x3c2973ba
.long 0x0,0x3b7b49ba,0x3bfb2b74,0x3c3c3ac3,0x0,0x3b8a342f,0x3c0a200a,0x3c4efdb7
.long 0x0,0x3b96c32c,0x3c16a905,0x3c61bc2e,0x0,0x3ba351cb,0x3c23308c,0x3c7475c0
.long 0x0,0x3bafe007,0x3c2fb680,0x3c839502,0x0,0x3bbc6dd5,0x3c3c3ac3,0x3c8cec4a
.long 0x0,0x3bc8fb30,0x3c48bd36,0x3c964083,0x0,0x3bd5880e,0x3c553db9,0x3c9f917b
.long 0x0,0x3be21469,0x3c61bc2e,0x3ca8defc,0x0,0x3beea038,0x3c6e3876,0x3cb228d4
.long 0x0,0x3bfb2b74,0x3c7ab273,0x3cbb6ecf,0x0,0x3c03db0a,0x3c839502,0x3cc4b0b9
.long 0x0,0x3c0a200a,0x3c89cf86,0x3ccdee60,0x0,0x3c1064b4,0x3c9008b7,0x3cd7278f
.long 0x0,0x3c16a905,0x3c964083,0x3ce05c13,0x0,0x3c1cecf9,0x3c9c76de,0x3ce98bba
.long 0x0,0x3c23308c,0x3ca2abb6,0x3cf2b651,0x0,0x3c2973ba,0x3ca8defc,0x3cfbdba4
.long 0x0,0x3c2fb680,0x3caf10a2,0x3d027dc0,0x0,0x3c35f8da,0x3cb54098,0x3d070ada
.long 0x0,0x3c3c3ac3,0x3cbb6ecf,0x3d0b9507,0x0,0x3c427c39,0x3cc19b37,0x3d101c2c
.long 0x0,0x0,0x0,0x0,0x3ac90e90,0x3afb514b,0x3b16c9b6,0x3b2fea69
.long 0x3b490ab0,0x3b7b49ba,0x3b96c32c,0x3bafe007,0x3b96c32c,0x3bbc6dd5,0x3be21469,0x3c03db0a
.long 0x3bc8fb30,0x3bfb2b74,0x3c16a905,0x3c2fb680,0x3bfb2b74,0x3c1cecf9,0x3c3c3ac3,0x3c5b7d37
.long 0x3c16a905,0x3c3c3ac3,0x3c61bc2e,0x3c839502,0x3c2fb680,0x3c5b7d37,0x3c839502,0x3c995be0
.long 0x3c48bd36,0x3c7ab273,0x3c964083,0x3caf10a2,0x3c61bc2e,0x3c8cec4a,0x3ca8defc,0x3cc4b0b9
.long 0x3c7ab273,0x3c9c76de,0x3cbb6ecf,0x3cda3997,0x3c89cf86,0x3cabf804,0x3ccdee60,0x3cefa8b2
.long 0x3c964083,0x3cbb6ecf,0x3ce05c13,0x3d027dc0,0x3ca2abb6,0x3ccada4f,0x3cf2b651,0x3d0d17c0
.long 0x3caf10a2,0x3cda3997,0x3d027dc0,0x3d17a117,0x3cbb6ecf,0x3ce98bba,0x3d0b9507,0x3d221887
.long 0x3cc7c5c2,0x3cf8cfcc,0x3d14a031,0x3d2c7cd4,0x3cd41501,0x3d040270,0x3d1d9e78,0x3d36ccc3
.long 0x3ce05c13,0x3d0b9507,0x3d268f12,0x3d41071e,0x3cec9a7f,0x3d131f35,0x3d2f713a,0x3d4b2aae
.long 0x3cf8cfcc,0x3d1aa086,0x3d38442a,0x3d553641,0x3d027dc0,0x3d221887,0x3d41071e,0x3d5f28a9
.long 0x3d088e93,0x3d2986c4,0x3d49b953,0x3d6900b7,0x3d0e9a22,0x3d30eacb,0x3d525a09,0x3d72bd43
.long 0x3d14a031,0x3d38442a,0x3d5ae880,0x3d7c5d27,0x3d1aa086,0x3d3f926f,0x3d6363fa,0x3d82ef9f
.long 0x3d209ae5,0x3d46d529,0x3d6bcbbb,0x3d87a136,0x3d268f12,0x3d4e0bea,0x3d741f07,0x3d8c42c9
.long 0x3d2c7cd4,0x3d553641,0x3d7c5d27,0x3d90d3cd,0x3d3263ef,0x3d5c53c1,0x3d8242b1,0x3d9553b7
.long 0x3d38442a,0x3d6363fa,0x3d864b82,0x3d99c200,0x3d3e1d4a,0x3d6a6681,0x3d8a48ad,0x3d9e1e22
.long 0x3e000000,0x3e000000,0x3e000000,0x3e000000,0x3dffec43,0x3dffe705,0x3dffe129,0x3dffdaaf
.long 0x3dffb10f,0x3dff9c18,0x3dff84ab,0x3dff6ac7,0x3dff4e6d,0x3dff1f49,0x3dfeea9d,0x3dfeb069
.long 0x3dfec46d,0x3dfe70b0,0x3dfe1324,0x3dfdabcc,0x3dfe1324,0x3dfd906e,0x3dfcfe73,0x3dfc5d3a
.long 0x3dfd3aac,0x3dfc7eb0,0x3dfbaccd,0x3dfac516,0x3dfc3b28,0x3dfb3bab,0x3dfa1e84,0x3df8e3d6
.long 0x3dfb14be,0x3df9c79d,0x3df853f8,0x3df6ba07,0x3df9c79d,0x3df822d1,0x3df64d97,0x3df4484b
.long 0x3df853f8,0x3df64d97,0x3df40bdd,0x3df18f57,0x3df6ba07,0x3df4484b,0x3df18f57,0x3dee8ff8
.long 0x3df4fa0b,0x3df21352,0x3deed89e,0x3deb4b0c,0x3df31447,0x3defaf1b,0x3debe858,0x3de7c187
.long 0x3df10908,0x3ded1c1d,0x3de8bf3c,0x3de3f473,0x3deed89e,0x3dea5ad9,0x3de55e0b,0x3ddfe4e9
.long 0x3dec835e,0x3de76bd8,0x3de1c598,0x3ddb941a,0x3dea09a7,0x3de44fac,0x3dddf6be,0x3dd70348
.long 0x3de76bd8,0x3de106f2,0x3dd9f26a,0x3dd233c6,0x3de4aa59,0x3ddd924d,0x3dd5b993,0x3dcd26fd
.long 0x3de1c598,0x3dd9f26a,0x3dd14d3d,0x3dc7de65,0x3ddebe05,0x3dd627fe,0x3dccae79,0x3dc25b89
.long 0x3ddb941a,0x3dd233c6,0x3dc7de65,0x3dbca003,0x3dd84853,0x3dce1689,0x3dc2de29,0x3db6ad7f
.long 0x3dd4db31,0x3dc9d112,0x3dbdaef9,0x3db085bb,0x3dd14d3d,0x3dc56439,0x3db85216,0x3daa2a80
.long 0x3dcd9f02,0x3dc0d0da,0x3db2c8c9,0x3da39da9,0x3dc9d112,0x3dbc17d9,0x3dad1469,0x3d9ce11f
.long 0x3dc5e403,0x3db73a23,0x3da73656,0x3d95f6d9,0x3dc1d870,0x3db238aa,0x3da12ff9,0x3d8ee0db
.long 0x3dbdaef9,0x3dad1469,0x3d9b02c6,0x3d87a136,0x3db96842,0x3da7ce61,0x3d94b039,0x3d803a06
.long 0x3e000000,0x3e000000,0x3e000000,0x3e000000,0x3dffd397,0x3dffcbe2,0x3dffc38f,0x3dffba9e
.long 0x3dff4e6d,0x3dff2f9d,0x3dff0e58,0x3dfeea9d,0x3dfe70b0,0x3dfe2b72,0x3dfde0b1,0x3dfd906e
.long 0x3dfd3aac,0x3dfcbfc9,0x3dfc3b28,0x3dfbaccd,0x3dfbaccd,0x3dfaed37,0x3dfa1e84,0x3df940c0
.long 0x3df9c79d,0x3df8b47b,0x3df78bc5,0x3df64d97,0x3df78bc5,0x3df6167a,0x3df48422,0x3df2d4eb
.long 0x3df4fa0b,0x3df31447,0x3df10908,0x3deed89e,0x3df21352,0x3defaf1b,0x3ded1c1d,0x3dea5ad9
.long 0x3deed89e,0x3debe858,0x3de8bf3c,0x3de55e0b,0x3deb4b0c,0x3de7c187,0x3de3f473,0x3ddfe4e9
.long 0x3de76bd8,0x3de33c5a,0x3ddebe05,0x3dd9f26a,0x3de33c5a,0x3dde5aa6,0x3dd91e6a,0x3dd389c7
.long 0x3ddebe05,0x3dd91e6a,0x3dd31849,0x3dccae79,0x3dd9f26a,0x3dd389c7,0x3dccae79,0x3dc56439
.long 0x3dd4db31,0x3dcd9f02,0x3dc5e403,0x3dbdaef9,0x3dcf7a1f,0x3dc76085,0x3dbebc1b,0x3db592e7
.long 0x3dc9d112,0x3dc0d0da,0x3db73a23,0x3dad1469,0x3dc3e200,0x3db9f2ac,0x3daf61a5,0x3da4381a
.long 0x3dbdaef9,0x3db2c8c9,0x3da73656,0x3d9b02c6,0x3db73a23,0x3dab561b,0x3d9ebc12,0x3d91796b
.long 0x3db085bb,0x3da39da9,0x3d95f6d9,0x3d87a136,0x3da99415,0x3d9ba299,0x3d8cead0,0x3d7afef7
.long 0x3da26799,0x3d93682a,0x3d839c3d,0x3d663375,0x3d9b02c6,0x3d8af1b7,0x3d741f07,0x3d50eb2a
.long 0x3d93682a,0x3d8242b1,0x3d60924f,0x3d3b31a0,0x3d8b9a6b,0x3d72bd43,0x3d4c9b8b,0x3d25129f
.long 0x3d839c3d,0x3d60924f,0x3d38442a,0x3d0e9a22,0x3d76e0cb,0x3d4e0bea,0x3d2395c5,0x3cefa8b2
.long 0x3d663375,0x3d3b31a0,0x3d0e9a22,0x3cc19b37,0x3d553641,0x3d280b1f,0x3cf2b651,0x3c9324ca
.long 0x0,0x0,0x0,0x0,0x3b490ab0,0x3b622a7a,0x3b7b49ba,0x3b8a342f
.long 0x3bc8fb30,0x3be21469,0x3bfb2b74,0x3c0a200a,0x3c16a905,0x3c2973ba,0x3c3c3ac3,0x3c4efdb7
.long 0x3c48bd36,0x3c61bc2e,0x3c7ab273,0x3c89cf86,0x3c7ab273,0x3c8cec4a,0x3c9c76de,0x3cabf804
.long 0x3c964083,0x3ca8defc,0x3cbb6ecf,0x3ccdee60,0x3caf10a2,0x3cc4b0b9,0x3cda3997,0x3cefa8b2
.long 0x3cc7c5c2,0x3ce05c13,0x3cf8cfcc,0x3d088e93,0x3ce05c13,0x3cfbdba4,0x3d0b9507,0x3d1920fe
.long 0x3cf8cfcc,0x3d0b9507,0x3d1aa086,0x3d2986c4,0x3d088e93,0x3d1920fe,0x3d2986c4,0x3d39bb1e
.long 0x3d14a031,0x3d268f12,0x3d38442a,0x3d49b953,0x3d209ae5,0x3d33dca5,0x3d46d529,0x3d597cb9
.long 0x3d2c7cd4,0x3d41071e,0x3d553641,0x3d6900b7,0x3d38442a,0x3d4e0bea,0x3d6363fa,0x3d7840c8
.long 0x3d43ef15,0x3d5ae880,0x3d715aea,0x3d839c3d,0x3d4f7bca,0x3d679a5d,0x3d7f17b2,0x3d8af1b7
.long 0x3d5ae880,0x3d741f07,0x3d864b82,0x3d921eb0,0x3d663375,0x3d803a06,0x3d8cead0,0x3d99210f
.long 0x3d715aea,0x3d864b82,0x3d93682a,0x3d9ff6cb,0x3d7c5d27,0x3d8c42c9,0x3d99c200,0x3da69de3
.long 0x3d839c3d,0x3d921eb0,0x3d9ff6cb,0x3dad1469,0x3d88f59b,0x3d97de12,0x3da6050a,0x3db3587a
.long 0x3d8e39da,0x3d9d7fd1,0x3dabeb4a,0x3db96842,0x3d93682a,0x3da302d3,0x3db1a81d,0x3dbf41fc
.long 0x3d987fc0,0x3da86605,0x3db73a23,0x3dc4e3f5,0x3d9d7fd1,0x3dada859,0x3dbca003,0x3dca4c87
.long 0x3da26799,0x3db2c8c9,0x3dc1d870,0x3dcf7a1f,0x3da73656,0x3db7c655,0x3dc6e22a,0x3dd46b3b
.long 0x3dabeb4a,0x3dbca003,0x3dcbbbf8,0x3dd91e6a,0x3db085bb,0x3dc154e1,0x3dd064af,0x3ddd924d
.long 0x0,0x0,0x0,0x0,0x3b96c32c,0x3ba351cb,0x3bafe007,0x3bbc6dd5
.long 0x3c16a905,0x3c23308c,0x3c2fb680,0x3c3c3ac3,0x3c61bc2e,0x3c7475c0,0x3c839502,0x3c8cec4a
.long 0x3c964083,0x3ca2abb6,0x3caf10a2,0x3cbb6ecf,0x3cbb6ecf,0x3ccada4f,0x3cda3997,0x3ce98bba
.long 0x3ce05c13,0x3cf2b651,0x3d027dc0,0x3d0b9507,0x3d027dc0,0x3d0d17c0,0x3d17a117,0x3d221887
.long 0x3d14a031,0x3d209ae5,0x3d2c7cd4,0x3d38442a,0x3d268f12,0x3d33dca5,0x3d41071e,0x3d4e0bea
.long 0x3d38442a,0x3d46d529,0x3d553641,0x3d6363fa,0x3d49b953,0x3d597cb9,0x3d6900b7,0x3d7840c8
.long 0x3d5ae880,0x3d6bcbbb,0x3d7c5d27,0x3d864b82,0x3d6bcbbb,0x3d7dbabb,0x3d87a136,0x3d902dd5
.long 0x3d7c5d27,0x3d87a136,0x3d90d3cd,0x3d99c200,0x3d864b82,0x3d902dd5,0x3d99c200,0x3da302d3
.long 0x3d8e39da,0x3d987fc0,0x3da26799,0x3dabeb4a,0x3d95f6d9,0x3da09393,0x3daac082,0x3db4768f
.long 0x3d9d7fd1,0x3da86605,0x3db2c8c9,0x3dbca003,0x3da4d225,0x3daff3e6,0x3dba7ca4,0x3dc46337
.long 0x3dabeb4a,0x3db73a23,0x3dc1d870,0x3dcbbbf8,0x3db2c8c9,0x3dbe35c5,0x3dc8d8b3,0x3dd2a649
.long 0x3db96842,0x3dc4e3f5,0x3dcf7a1f,0x3dd91e6a,0x3dbfc767,0x3dcb41fa,0x3dd5b993,0x3ddf20db
.long 0x3dc5e403,0x3dd14d3d,0x3ddb941a,0x3de4aa59,0x3dcbbbf8,0x3dd70348,0x3de106f2,0x3de9b7e4
.long 0x3dd14d3d,0x3ddc61c7,0x3de60f88,0x3dee46be,0x3dd695e5,0x3de1668a,0x3deaab7b,0x3df25470
.long 0x3ddb941a,0x3de60f88,0x3deed89e,0x3df5dec6,0x3de04621,0x3dea5ad9,0x3df294f8,0x3df8e3d6
.long 0x3de4aa59,0x3dee46be,0x3df5dec6,0x3dfb61fc,0x3de8bf3c,0x3df1d19f,0x3df8b47b,0x3dfd57de
.long 0x3e000000,0x3e000000,0x3e000000,0x3e000000,0x3dffb10f,0x3dffa6e3,0x3dff9c18,0x3dff90b1
.long 0x3dfec46d,0x3dfe9bc9,0x3dfe70b0,0x3dfe4323,0x3dfd3aac,0x3dfcdf6c,0x3dfc7eb0,0x3dfc187a
.long 0x3dfb14be,0x3dfa7302,0x3df9c79d,0x3df91298,0x3df853f8,0x3df7583a,0x3df64d97,0x3df5341d
.long 0x3df4fa0b,0x3df3913f,0x3df21352,0x3df08066,0x3df10908,0x3def20b0,0x3ded1c1d,0x3deafb8c
.long 0x3dec835e,0x3dea09a7,0x3de76bd8,0x3de4aa59,0x3de76bd8,0x3de44fac,0x3de106f2,0x3ddd924d
.long 0x3de1c598,0x3dddf6be,0x3dd9f26a,0x3dd5b993,0x3ddb941a,0x3dd70348,0x3dd233c6,0x3dcd26fd
.long 0x3dd4db31,0x3dcf7a1f,0x3dc9d112,0x3dc3e200,0x3dcd9f02,0x3dc76085,0x3dc0d0da,0x3db9f2ac
.long 0x3dc5e403,0x3dbebc1b,0x3db73a23,0x3daf61a5,0x3dbdaef9,0x3db592e7,0x3dad1469,0x3da4381a
.long 0x3db504f3,0x3dabeb4a,0x3da26799,0x3d987fc0,0x3dabeb4a,0x3da1cbfb,0x3d973c07,0x3d8c42c9
.long 0x3da26799,0x3d973c07,0x3d8b9a6b,0x3d7f17b2,0x3d987fc0,0x3d8c42c9,0x3d7f17b2,0x3d64cbfe
.long 0x3d8e39da,0x3d80e7e4,0x3d663375,0x3d49b953,0x3d839c3d,0x3d6a6681,0x3d4c9b8b,0x3d2df73c
.long 0x3d715aea,0x3d525a09,0x3d3263ef,0x3d119ddd,0x3d5ae880,0x3d39bb1e,0x3d17a117,0x3ce98bba
.long 0x3d43ef15,0x3d209ae5,0x3cf8cfcc,0x3caf10a2,0x3d2c7cd4,0x3d070ada,0x3cc19b37,0x3c67fa9a
.long 0x3d14a031,0x3cda3997,0x3c89cf86,0x3be21469,0x3cf8cfcc,0x3ca5c58c,0x3c23308c,0xb9c90fc6
.long 0x3cc7c5c2,0x3c61bc2e,0x3b490ab0,0xbbfb2b74,0x3c964083,0x3beea038,0xbb7b49ba,0xbc7475c0
.long 0x3c48bd36,0x3a490f88,0xbc2fb680,0xbcb54098,0x3bc8fb30,0xbbbc6dd5,0xbc9008b7,0xbcefa8b2
.long 0x3e000000,0x3e000000,0x3e000000,0x3e000000,0x3dff84ab,0x3dff7808,0x3dff6ac7,0x3dff5ce9
.long 0x3dfe1324,0x3dfde0b1,0x3dfdabcc,0x3dfd7474,0x3dfbaccd,0x3dfb3bab,0x3dfac516,0x3dfa4910
.long 0x3df853f8,0x3df78bc5,0x3df6ba07,0x3df5dec6,0x3df40bdd,0x3df2d4eb,0x3df18f57,0x3df03b37
.long 0x3deed89e,0x3ded1c1d,0x3deb4b0c,0x3de96591,0x3de8bf3c,0x3de66771,0x3de3f473,0x3de1668a
.long 0x3de1c598,0x3ddebe05,0x3ddb941a,0x3dd84853,0x3dd9f26a,0x3dd627fe,0x3dd233c6,0x3dce1689
.long 0x3dd14d3d,0x3dccae79,0x3dc7de65,0x3dc2de29,0x3dc7de65,0x3dc25b89,0x3dbca003,0x3db6ad7f
.long 0x3dbdaef9,0x3db73a23,0x3db085bb,0x3da99415,0x3db2c8c9,0x3dab561b,0x3da39da9,0x3d9ba299
.long 0x3da73656,0x3d9ebc12,0x3d95f6d9,0x3d8cead0,0x3d9b02c6,0x3d91796b,0x3d87a136,0x3d7afef7
.long 0x3d8e39da,0x3d839c3d,0x3d715aea,0x3d5ae880,0x3d80e7e4,0x3d6a6681,0x3d525a09,0x3d39bb1e
.long 0x3d663375,0x3d4c9b8b,0x3d3263ef,0x3d17a117,0x3d49b953,0x3d2df73c,0x3d119ddd,0x3ce98bba
.long 0x3d2c7cd4,0x3d0e9a22,0x3ce05c13,0x3ca2abb6,0x3d0e9a22,0x3cdd4b1a,0x3c9c76de,0x3c35f8da
.long 0x3ce05c13,0x3c9c76de,0x3c2fb680,0x3b16c9b6,0x3ca2abb6,0x3c35f8da,0x3b16c9b6,0xbbd5880e
.long 0x3c48bd36,0x3b490ab0,0xbbc8fb30,0xbc7ab273,0x3b96c32c,0xbba351cb,0xbc6e3876,0xbcc4b0b9
.long 0xbb490ab0,0xbc553db9,0xbcbb6ecf,0xbd0586ce,0xbc2fb680,0xbcabf804,0xbcfee6e1,0xbd280b1f
.long 0xbc964083,0xbcec9a7f,0xbd209ae5,0xbd49b953,0xbcd41501,0xbd1620d2,0xbd41071e,0xbd6a6681
.long 0xbd088e93,0xbd3554ec,0xbd60924f,0xbd84f484,0xbd268f12,0xbd53c867,0xbd7f17b2,0xbd940c5f
.long 0x0,0x0,0x0,0x0,0x3bc8fb30,0x3bd5880e,0x3be21469,0x3beea038
.long 0x3c48bd36,0x3c553db9,0x3c61bc2e,0x3c6e3876,0x3c964083,0x3c9f917b,0x3ca8defc,0x3cb228d4
.long 0x3cc7c5c2,0x3cd41501,0x3ce05c13,0x3cec9a7f,0x3cf8cfcc,0x3d040270,0x3d0b9507,0x3d131f35
.long 0x3d14a031,0x3d1d9e78,0x3d268f12,0x3d2f713a,0x3d2c7cd4,0x3d36ccc3,0x3d41071e,0x3d4b2aae
.long 0x3d43ef15,0x3d4f7bca,0x3d5ae880,0x3d663375,0x3d5ae880,0x3d679a5d,0x3d741f07,0x3d803a06
.long 0x3d715aea,0x3d7f17b2,0x3d864b82,0x3d8cead0,0x3d839c3d,0x3d8af1b7,0x3d921eb0,0x3d99210f
.long 0x3d8e39da,0x3d95f6d9,0x3d9d7fd1,0x3da4d225,0x3d987fc0,0x3da09393,0x3da86605,0x3daff3e6
.long 0x3da26799,0x3daac082,0x3db2c8c9,0x3dba7ca4,0x3dabeb4a,0x3db4768f,0x3dbca003,0x3dc46337
.long 0x3db504f3,0x3dbdaef9,0x3dc5e403,0x3dcd9f02,0x3dbdaef9,0x3dc66354,0x3dce8d90,0x3dd627fe
.long 0x3dc5e403,0x3dce8d90,0x3dd695e5,0x3dddf6be,0x3dcd9f02,0x3dd627fe,0x3dddf6be,0x3de50479
.long 0x3dd4db31,0x3ddd2d53,0x3de4aa59,0x3deb4b0c,0x3ddb941a,0x3de398ac,0x3deaab7b,0x3df0c501
.long 0x3de1c598,0x3de96591,0x3deff573,0x3df56d97,0x3de76bd8,0x3dee8ff8,0x3df48422,0x3df940c0
.long 0x3dec835e,0x3df31447,0x3df853f8,0x3dfc3b28,0x3df10908,0x3df6ef5b,0x3dfb61fc,0x3dfe5a38
.long 0x3df4fa0b,0x3dfa1e84,0x3dfdabcc,0x3dff9c18,0x3df853f8,0x3dfc9f8a,0x3dff2f9d,0x3dffffb1
.long 0x3dfb14be,0x3dfe70b0,0x3dffec43,0x3dff84ab,0x3dfd3aac,0x3dff90b1,0x3dffe129,0x3dfe2b72
.long 0x3dfec46d,0x3dfffec4,0x3dff0e58,0x3dfbf531,0x3dffb10f,0x3dffba9e,0x3dfd7474,0x3df8e3d6
.long 0x0,0x0,0x0,0x0,0x3bfb2b74,0x3c03db0a,0x3c0a200a,0x3c1064b4
.long 0x3c7ab273,0x3c839502,0x3c89cf86,0x3c9008b7,0x3cbb6ecf,0x3cc4b0b9,0x3ccdee60,0x3cd7278f
.long 0x3cf8cfcc,0x3d027dc0,0x3d088e93,0x3d0e9a22,0x3d1aa086,0x3d221887,0x3d2986c4,0x3d30eacb
.long 0x3d38442a,0x3d41071e,0x3d49b953,0x3d525a09,0x3d553641,0x3d5f28a9,0x3d6900b7,0x3d72bd43
.long 0x3d715aea,0x3d7c5d27,0x3d839c3d,0x3d88f59b,0x3d864b82,0x3d8c42c9,0x3d921eb0,0x3d97de12
.long 0x3d93682a,0x3d99c200,0x3d9ff6cb,0x3da6050a,0x3d9ff6cb,0x3da69de3,0x3dad1469,0x3db3587a
.long 0x3dabeb4a,0x3db2c8c9,0x3db96842,0x3dbfc767,0x3db73a23,0x3dbe35c5,0x3dc4e3f5,0x3dcb41fa
.long 0x3dc1d870,0x3dc8d8b3,0x3dcf7a1f,0x3dd5b993,0x3dcbbbf8,0x3dd2a649,0x3dd91e6a,0x3ddf20db
.long 0x3dd4db31,0x3ddb941a,0x3de1c598,0x3de76bd8,0x3ddd2d53,0x3de398ac,0x3de96591,0x3dee8ff8
.long 0x3de4aa59,0x3deaab7b,0x3deff573,0x3df48422,0x3deb4b0c,0x3df0c501,0x3df56d97,0x3df940c0
.long 0x3df10908,0x3df5dec6,0x3df9c79d,0x3dfcbfc9,0x3df5dec6,0x3df9f35e,0x3dfcfe73,0x3dfefcc9
.long 0x3df9c79d,0x3dfcfe73,0x3dff0e58,0x3dfff4e6,0x3dfcbfc9,0x3dfefcc9,0x3dfff4e6,0x3dffa6e3
.long 0x3dfec46d,0x3dffec43,0x3dffb10f,0x3dfe1324,0x3dffd397,0x3dffcbe2,0x3dfe4323,0x3dfb3bab
.long 0x3dffec43,0x3dfe9bc9,0x3dfbaccd,0x3df72417,0x3dff0e58,0x3dfc5d3a,0x3df7f110,0x3df1d19f
.long 0x3dfd3aac,0x3df91298,0x3df31447,0x3deb4b0c,0x3dfa7302,0x3df4bf62,0x3ded1c1d,0x3de398ac
.long 0x3df6ba07,0x3def6830,0x3de60f88,0x3ddac450,0x3df21352,0x3de912ae,0x3dddf6be,0x3dd0d937
.long 0x3e000000,0x3e000000,0x3e000000,0x3e000000,0x3dff4e6d,0x3dff3f54,0x3dff2f9d,0x3dff1f49
.long 0x3dfd3aac,0x3dfcfe73,0x3dfcbfc9,0x3dfc7eb0,0x3df9c79d,0x3df940c0,0x3df8b47b,0x3df822d1
.long 0x3df4fa0b,0x3df40bdd,0x3df31447,0x3df21352,0x3deed89e,0x3ded67a1,0x3debe858,0x3dea5ad9
.long 0x3de76bd8,0x3de55e0b,0x3de33c5a,0x3de106f2,0x3ddebe05,0x3ddbfb34,0x3dd91e6a,0x3dd627fe
.long 0x3dd4db31,0x3dd14d3d,0x3dcd9f02,0x3dc9d112,0x3dc9d112,0x3dc56439,0x3dc0d0da,0x3dbc17d9
.long 0x3dbdaef9,0x3db85216,0x3db2c8c9,0x3dad1469,0x3db085bb,0x3daa2a80,0x3da39da9,0x3d9ce11f
.long 0x3da26799,0x3d9b02c6,0x3d93682a,0x3d8b9a6b,0x3d93682a,0x3d8af1b7,0x3d8242b1,0x3d72bd43
.long 0x3d839c3d,0x3d741f07,0x3d60924f,0x3d4c9b8b,0x3d663375,0x3d50eb2a,0x3d3b31a0,0x3d25129f
.long 0x3d43ef15,0x3d2c7cd4,0x3d14a031,0x3cf8cfcc,0x3d209ae5,0x3d070ada,0x3cda3997,0x3ca5c58c
.long 0x3cf8cfcc,0x3cc19b37,0x3c89cf86,0x3c23308c,0x3caf10a2,0x3c67fa9a,0x3be21469,0xb9c90fc6
.long 0x3c48bd36,0x3b96c32c,0xbb490ab0,0xbc2fb680,0x3b490ab0,0xbba351cb,0xbc553db9,0xbcabf804
.long 0xbbc8fb30,0xbc6e3876,0xbcbb6ecf,0xbcfee6e1,0xbc7ab273,0xbcc4b0b9,0xbd0586ce,0xbd280b1f
.long 0xbcc7c5c2,0xbd088e93,0xbd2c7cd4,0xbd4f7bca,0xbd088e93,0xbd2df73c,0xbd525a09,0xbd758035
.long 0xbd2c7cd4,0xbd525a09,0xbd76e0cb,0xbd8cead0,0xbd4f7bca,0xbd758035,0xbd8cead0,0xbd9e1e22
.long 0xbd715aea,0xbd8b9a6b,0xbd9d7fd1,0xbdae3bde,0xbd88f59b,0xbd9ba299,0xbdad1469,0xbdbd27b8
.long 0xbd987fc0,0xbdaac082,0xbdbb8f3b,0xbdcac77f,0xbda73656,0xbdb8dd65,0xbdc8d8b3,0xbdd70348
.long 0x3e000000,0x3e000000,0x3e000000,0x3e000000,0x3dff0e58,0x3dfefcc9,0x3dfeea9d,0x3dfed7d4
.long 0x3dfc3b28,0x3dfbf531,0x3dfbaccd,0x3dfb61fc,0x3df78bc5,0x3df6ef5b,0x3df64d97,0x3df5a67b
.long 0x3df10908,0x3deff573,0x3deed89e,0x3dedb293,0x3de8bf3c,0x3de71599,0x3de55e0b,0x3de398ac
.long 0x3ddebe05,0x3ddc61c7,0x3dd9f26a,0x3dd77026,0x3dd31849,0x3dcfefa8,0x3dccae79,0x3dc95521
.long 0x3dc5e403,0x3dc1d870,0x3dbdaef9,0x3db96842,0x3db73a23,0x3db238aa,0x3dad1469,0x3da7ce61
.long 0x3da73656,0x3da12ff9,0x3d9b02c6,0x3d94b039,0x3d95f6d9,0x3d8ee0db,0x3d87a136,0x3d803a06
.long 0x3d839c3d,0x3d76e0cb,0x3d663375,0x3d553641,0x3d60924f,0x3d4e0bea,0x3d3b31a0,0x3d280b1f
.long 0x3d38442a,0x3d2395c5,0x3d0e9a22,0x3cf2b651,0x3d0e9a22,0x3cefa8b2,0x3cc19b37,0x3c9324ca
.long 0x3cc7c5c2,0x3c964083,0x3c48bd36,0x3bc8fb30,0x3c61bc2e,0x3beea038,0x3a490f88,0xbbbc6dd5
.long 0x3b490ab0,0xbb7b49ba,0xbc2fb680,0xbc9008b7,0xbbfb2b74,0xbc7475c0,0xbcb54098,0xbcefa8b2
.long 0xbc964083,0xbcd41501,0xbd088e93,0xbd268f12,0xbcec9a7f,0xbd1620d2,0xbd3554ec,0xbd53c867
.long 0xbd209ae5,0xbd41071e,0xbd60924f,0xbd7f17b2,0xbd49b953,0xbd6a6681,0xbd84f484,0xbd940c5f
.long 0xbd715aea,0xbd88f59b,0xbd987fc0,0xbda73656,0xbd8b9a6b,0xbd9ba299,0xbdaac082,0xbdb8dd65
.long 0xbd9d7fd1,0xbdad1469,0xbdbb8f3b,0xbdc8d8b3,0xbdae3bde,0xbdbd27b8,0xbdcac77f,0xbdd70348
.long 0xbdbdaef9,0xbdcbbbf8,0xbdd84853,0xbde33c5a,0xbdcbbbf8,0xbdd8b3a1,0xbde3f473,0xbded67a1
.long 0xbdd84853,0xbde3f473,0xbdedb293,0xbdf56d97,0xbde33c5a,0xbded67a1,0xbdf56d97,0xbdfb3bab
.long 0x0,0x0,0x0,0x0,0x3c16a905,0x3c1cecf9,0x3c23308c,0x3c2973ba
.long 0x3c964083,0x3c9c76de,0x3ca2abb6,0x3ca8defc,0x3ce05c13,0x3ce98bba,0x3cf2b651,0x3cfbdba4
.long 0x3d14a031,0x3d1aa086,0x3d209ae5,0x3d268f12,0x3d38442a,0x3d3f926f,0x3d46d529,0x3d4e0bea
.long 0x3d5ae880,0x3d6363fa,0x3d6bcbbb,0x3d741f07,0x3d7c5d27,0x3d82ef9f,0x3d87a136,0x3d8c42c9
.long 0x3d8e39da,0x3d93682a,0x3d987fc0,0x3d9d7fd1,0x3d9d7fd1,0x3da302d3,0x3da86605,0x3dada859
.long 0x3dabeb4a,0x3db1a81d,0x3db73a23,0x3dbca003,0x3db96842,0x3dbf41fc,0x3dc4e3f5,0x3dca4c87
.long 0x3dc5e403,0x3dcbbbf8,0x3dd14d3d,0x3dd695e5,0x3dd14d3d,0x3dd70348,0x3ddc61c7,0x3de1668a
.long 0x3ddb941a,0x3de106f2,0x3de60f88,0x3deaab7b,0x3de4aa59,0x3de9b7e4,0x3dee46be,0x3df25470
.long 0x3dec835e,0x3df10908,0x3df4fa0b,0x3df853f8,0x3df31447,0x3df6ef5b,0x3dfa1e84,0x3dfc9f8a
.long 0x3df853f8,0x3dfb61fc,0x3dfdabcc,0x3dff2f9d,0x3dfc3b28,0x3dfe5a38,0x3dff9c18,0x3dffffb1
.long 0x3dfec46d,0x3dffd397,0x3dffec43,0x3dff0e58,0x3dffec43,0x3dffcbe2,0x3dfe9bc9,0x3dfc5d3a
.long 0x3dffb10f,0x3dfe4323,0x3dfbaccd,0x3df7f110,0x3dfe1324,0x3dfb3bab,0x3df72417,0x3df1d19f
.long 0x3dfb14be,0x3df6ba07,0x3df10908,0x3dea09a7,0x3df6ba07,0x3df0c501,0x3de96591,0x3de0a6cf
.long 0x3df10908,0x3de96591,0x3de04621,0x3dd5b993,0x3dea09a7,0x3de0a6cf,0x3dd5b993,0x3dc95521
.long 0x3de1c598,0x3dd695e5,0x3dc9d112,0x3dbb8f3b,0x3dd84853,0x3dcb41fa,0x3dbca003,0x3dac800f
.long 0x3dcd9f02,0x3dbebc1b,0x3dae3bde,0x3d9c420c,0x3dc1d870,0x3db11722,0x3d9ebc12,0x3d8af1b7
.long 0x0,0x0,0x0,0x0,0x3c2fb680,0x3c35f8da,0x3c3c3ac3,0x3c427c39
.long 0x3caf10a2,0x3cb54098,0x3cbb6ecf,0x3cc19b37,0x3d027dc0,0x3d070ada,0x3d0b9507,0x3d101c2c
.long 0x3d2c7cd4,0x3d3263ef,0x3d38442a,0x3d3e1d4a,0x3d553641,0x3d5c53c1,0x3d6363fa,0x3d6a6681
.long 0x3d7c5d27,0x3d8242b1,0x3d864b82,0x3d8a48ad,0x3d90d3cd,0x3d9553b7,0x3d99c200,0x3d9e1e22
.long 0x3da26799,0x3da73656,0x3dabeb4a,0x3db085bb,0x3db2c8c9,0x3db7c655,0x3dbca003,0x3dc154e1
.long 0x3dc1d870,0x3dc6e22a,0x3dcbbbf8,0x3dd064af,0x3dcf7a1f,0x3dd46b3b,0x3dd91e6a,0x3ddd924d
.long 0x3ddb941a,0x3de04621,0x3de4aa59,0x3de8bf3c,0x3de60f88,0x3dea5ad9,0x3dee46be,0x3df1d19f
.long 0x3deed89e,0x3df294f8,0x3df5dec6,0x3df8b47b,0x3df5dec6,0x3df8e3d6,0x3dfb61fc,0x3dfd57de
.long 0x3dfb14be,0x3dfd3aac,0x3dfec46d,0x3dffb10f,0x3dfe70b0,0x3dff90b1,0x3dfffec4,0x3dffba9e
.long 0x3dffec43,0x3dffe129,0x3dff0e58,0x3dfd7474,0x3dff84ab,0x3dfe2b72,0x3dfbf531,0x3df8e3d6
.long 0x3dfd3aac,0x3dfa7302,0x3df6ba07,0x3df21352,0x3df91298,0x3df4bf62,0x3def6830,0x3de912ae
.long 0x3df31447,0x3ded1c1d,0x3de60f88,0x3dddf6be,0x3deb4b0c,0x3de398ac,0x3ddac450,0x3dd0d937
.long 0x3de1c598,0x3dd84853,0x3dcd9f02,0x3dc1d870,0x3dd695e5,0x3dcb41fa,0x3dbebc1b,0x3db11722
.long 0x3dc9d112,0x3dbca003,0x3dae3bde,0x3d9ebc12,0x3dbb8f3b,0x3dac800f,0x3d9c420c,0x3d8af1b7
.long 0x3dabeb4a,0x3d9b02c6,0x3d88f59b,0x3d6bcbbb,0x3d9b02c6,0x3d884b92,0x3d6900b7,0x3d3f926f
.long 0x3d88f59b,0x3d6900b7,0x3d3e1d4a,0x3d119ddd,0x3d6bcbbb,0x3d3f926f,0x3d119ddd,0x3cc4b0b9
.long 0x3e000000,0x3e000000,0x3e000000,0x3e000000,0x3dfec46d,0x3dfeb069,0x3dfe9bc9,0x3dfe868b
.long 0x3dfb14be,0x3dfac516,0x3dfa7302,0x3dfa1e84,0x3df4fa0b,0x3df4484b,0x3df3913f,0x3df2d4eb
.long 0x3dec835e,0x3deb4b0c,0x3dea09a7,0x3de8bf3c,0x3de1c598,0x3ddfe4e9,0x3dddf6be,0x3ddbfb34
.long 0x3dd4db31,0x3dd233c6,0x3dcf7a1f,0x3dccae79,0x3dc5e403,0x3dc25b89,0x3dbebc1b,0x3dbb0629
.long 0x3db504f3,0x3db085bb,0x3dabeb4a,0x3da73656,0x3da26799,0x3d9ce11f,0x3d973c07,0x3d91796b
.long 0x3d8e39da,0x3d87a136,0x3d80e7e4,0x3d741f07,0x3d715aea,0x3d61fb6a,0x3d525a09,0x3d427b55
.long 0x3d43ef15,0x3d3263ef,0x3d209ae5,0x3d0e9a22,0x3d14a031,0x3d00f8c0,0x3cda3997,0x3cb228d4
.long 0x3cc7c5c2,0x3c9c76de,0x3c61bc2e,0x3c0a200a,0x3c48bd36,0x3bd5880e,0x3a490f88,0xbba351cb
.long 0x230d3132,0xbbc8fb30,0xbc48bd36,0xbc964083,0xbc48bd36,0xbc995be0,0xbccdee60,0xbd00f8c0
.long 0xbcc7c5c2,0xbcfee6e1,0xbd1aa086,0xbd3554ec,0xbd14a031,0xbd30eacb,0xbd4c9b8b,0xbd679a5d
.long 0xbd43ef15,0xbd60924f,0xbd7c5d27,0xbd8b9a6b,0xbd715aea,0xbd86f686,0xbd94b039,0xbda1cbfb
.long 0xbd8e39da,0xbd9c420c,0xbda99415,0xbdb6206c,0xbda26799,0xbdaff3e6,0xbdbca003,0xbdc85bca
.long 0xbdb504f3,0xbdc1d870,0xbdcd9f02,0xbdd84853,0xbdc5e403,0xbdd1c0c2,0xbddc61c7,0xbde5b710
.long 0xbdd4db31,0xbddf8327,0xbde8bf3c,0xbdf08066,0xbde1c598,0xbdeafb8c,0xbdf294f8,0xbdf88486
.long 0xbdec835e,0xbdf40bdd,0xbdf9c79d,0xbdfdabcc,0xbdf4fa0b,0xbdfa9c59,0xbdfe4323,0xbdffe705
.long 0xbdfb14be,0xbdfe9bc9,0xbdfffb11,0xbdff2f9d,0xbdfec46d,0xbdffffb1,0xbdfeea9d,0xbdfb87b2
.long 0x3e000000,0x3e000000,0x3e000000,0x3e000000,0x3dfe70b0,0x3dfe5a38,0x3dfe4323,0x3dfe2b72
.long 0x3df9c79d,0x3df96e4e,0x3df91298,0x3df8b47b,0x3df21352,0x3df14c7a,0x3df08066,0x3defaf1b
.long 0x3de76bd8,0x3de60f88,0x3de4aa59,0x3de33c5a,0x3dd9f26a,0x3dd7dc7f,0x3dd5b993,0x3dd389c7
.long 0x3dc9d112,0x3dc6e22a,0x3dc3e200,0x3dc0d0da,0x3db73a23,0x3db3587a,0x3daf61a5,0x3dab561b
.long 0x3da26799,0x3d9d7fd1,0x3d987fc0,0x3d93682a,0x3d8b9a6b,0x3d85a02c,0x3d7f17b2,0x3d72bd43
.long 0x3d663375,0x3d58106b,0x3d49b953,0x3d3b31a0,0x3d3263ef,0x3d221887,0x3d119ddd,0x3d00f8c0
.long 0x3cf8cfcc,0x3cd41501,0x3caf10a2,0x3c89cf86,0x3c89cf86,0x3c427c39,0x3be21469,0x3afb514b
.long 0x3b490ab0,0xbb16c9b6,0xbbfb2b74,0xbc553db9,0xbc2fb680,0xbc86b26e,0xbcb54098,0xbce36c83
.long 0xbcc7c5c2,0xbcf8cfcc,0xbd14a031,0xbd2c7cd4,0xbd1aa086,0xbd33dca5,0xbd4c9b8b,0xbd64cbfe
.long 0xbd4f7bca,0xbd6900b7,0xbd80e7e4,0xbd8cead0,0xbd80e7e4,0xbd8d9281,0xbd99c200,0xbda56bcb
.long 0xbd987fc0,0xbda4d225,0xbdb085bb,0xbdbb8f3b,0xbdae3bde,0xbdb9f2ac,0xbdc4e3f5,0xbdcf0417
.long 0xbdc1d870,0xbdccae79,0xbdd695e5,0xbddf8327,0xbdd31849,0xbddcc7d1,0xbde55e0b,0xbdecd007
.long 0xbde1c598,0xbdea09a7,0xbdf10908,0xbdf6ba07,0xbdedb293,0xbdf4484b,0xbdf96e4e,0xbdfd1cdd
.long 0xbdf6ba07,0xbdfb61fc,0xbdfe70b0,0xbdffe129,0xbdfcbfc9,0xbdff3f54,0xbdfffec4,0xbdfefcc9
.long 0xbdffb10f,0xbdffd397,0xbdfe1324,0xbdfa7302,0xbdff84ab,0xbdfd1cdd,0xbdf8b47b,0xbdf25470
.long 0xbdfc3b28,0xbdf72417,0xbdeff573,0xbde6becc,0xbdf5dec6,0xbdedfcf2,0xbde3f473,0xbdd7dc7f
.long 0x0,0x0,0x0,0x0,0x3c48bd36,0x3c4efdb7,0x3c553db9,0x3c5b7d37
.long 0x3cc7c5c2,0x3ccdee60,0x3cd41501,0x3cda3997,0x3d14a031,0x3d1920fe,0x3d1d9e78,0x3d221887
.long 0x3d43ef15,0x3d49b953,0x3d4f7bca,0x3d553641,0x3d715aea,0x3d7840c8,0x3d7f17b2,0x3d82ef9f
.long 0x3d8e39da,0x3d921eb0,0x3d95f6d9,0x3d99c200,0x3da26799,0x3da69de3,0x3daac082,0x3daecef7
.long 0x3db504f3,0x3db96842,0x3dbdaef9,0x3dc1d870,0x3dc5e403,0x3dca4c87,0x3dce8d90,0x3dd2a649
.long 0x3dd4db31,0x3dd91e6a,0x3ddd2d53,0x3de106f2,0x3de1c598,0x3de5b710,0x3de96591,0x3decd007
.long 0x3dec835e,0x3deff573,0x3df31447,0x3df5dec6,0x3df4fa0b,0x3df7beb7,0x3dfa1e84,0x3dfc187a
.long 0x3dfb14be,0x3dfcfe73,0x3dfe70b0,0x3dff6ac7,0x3dfec46d,0x3dffa6e3,0x3dfffec4,0x3dffcbe2
.long 0x3e000000,0x3dffb10f,0x3dfec46d,0x3dfd3aac,0x3dfec46d,0x3dfd1cdd,0x3dfac516,0x3df7beb7
.long 0x3dfb14be,0x3df7f110,0x3df40bdd,0x3def6830,0x3df4fa0b,0x3df03b37,0x3deaab7b,0x3de44fac
.long 0x3dec835e,0x3de60f88,0x3ddebe05,0x3dd695e5,0x3de1c598,0x3dd988ad,0x3dd064af,0x3dc66354
.long 0x3dd4db31,0x3dcac77f,0x3dbfc767,0x3db3e7bc,0x3dc5e403,0x3db9f2ac,0x3dad1469,0x3d9f599f
.long 0x3db504f3,0x3da73656,0x3d987fc0,0x3d88f59b,0x3da26799,0x3d92c39a,0x3d8242b1,0x3d61fb6a
.long 0x3d8e39da,0x3d79a02d,0x3d553641,0x3d2f713a,0x3d715aea,0x3d4b2aae,0x3d2395c5,0x3cf5c35a
.long 0x3d43ef15,0x3d1aa086,0x3ce05c13,0x3c89cf86,0x3d14a031,0x3cd101f1,0x3c6e3876,0x3b622a7a
.long 0x3cc7c5c2,0x3c553db9,0x3ac90e90,0xbc23308c,0x3c48bd36,0x39c90fc6,0xbc3c3ac3,0xbcbe853e
.long 0x0,0x0,0x0,0x0,0x3c61bc2e,0x3c67fa9a,0x3c6e3876,0x3c7475c0
.long 0x3ce05c13,0x3ce67c66,0x3cec9a7f,0x3cf2b651,0x3d268f12,0x3d2b0201,0x3d2f713a,0x3d33dca5
.long 0x3d5ae880,0x3d60924f,0x3d663375,0x3d6bcbbb,0x3d864b82,0x3d899f4e,0x3d8cead0,0x3d902dd5
.long 0x3d9d7fd1,0x3da12ff9,0x3da4d225,0x3da86605,0x3db2c8c9,0x3db6ad7f,0x3dba7ca4,0x3dbe35c5
.long 0x3dc5e403,0x3dc9d112,0x3dcd9f02,0x3dd14d3d,0x3dd695e5,0x3dda5ba0,0x3dddf6be,0x3de1668a
.long 0x3de4aa59,0x3de816a8,0x3deb4b0c,0x3dee46be,0x3deff573,0x3df2d4eb,0x3df56d97,0x3df7beb7
.long 0x3df853f8,0x3dfa7302,0x3dfc3b28,0x3dfdabcc,0x3dfdabcc,0x3dfed7d4,0x3dff9c18,0x3dfff84a
.long 0x3dffec43,0x3dfff4e6,0x3dff84ab,0x3dfe9bc9,0x3dff0e58,0x3dfdc68c,0x3dfbf531,0x3df99b43
.long 0x3dfb14be,0x3df853f8,0x3df4fa0b,0x3df10908,0x3df40bdd,0x3defaf1b,0x3deaab7b,0x3de50479
.long 0x3dea09a7,0x3de3f473,0x3ddd2d53,0x3dd5b993,0x3ddd2d53,0x3dd54aa4,0x3dccae79,0x3dc36051
.long 0x3dcd9f02,0x3dc3e200,0x3db96842,0x3dae3bde,0x3dbb8f3b,0x3daff3e6,0x3da39da9,0x3d96999f
.long 0x3da73656,0x3d99c200,0x3d8b9a6b,0x3d79a02d,0x3d90d3cd,0x3d819573,0x3d6363fa,0x3d427b55
.long 0x3d715aea,0x3d4f7bca,0x3d2c7cd4,0x3d088e93,0x3d3e1d4a,0x3d1920fe,0x3ce67c66,0x3c995be0
.long 0x3d088e93,0x3cc19b37,0x3c61bc2e,0x3b7b49ba,0x3ca2abb6,0x3c1cecf9,0xba490f88,0xbc35f8da
.long 0x3bc8fb30,0xbb96c32c,0xbc7ab273,0xbcd41501,0xbbfb2b74,0xbc995be0,0xbcf2b651,0xbd25129f
.long 0xbcaf10a2,0xbd0586ce,0xbd3263ef,0xbd5dbe79,0xbd0e9a22,0xbd3ca7af,0xbd6900b7,0xbd899f4e
.long 0x3e000000,0x3e000000,0x3e000000,0x3e000000,0x3dfe1324,0x3dfdfa38,0x3dfde0b1,0x3dfdc68c
.long 0x3df853f8,0x3df7f110,0x3df78bc5,0x3df72417,0x3deed89e,0x3dedfcf2,0x3ded1c1d,0x3dec3624
.long 0x3de1c598,0x3de04621,0x3ddebe05,0x3ddd2d53,0x3dd14d3d,0x3dcf0417,0x3dccae79,0x3dca4c87
.long 0x3dbdaef9,0x3dba7ca4,0x3db73a23,0x3db3e7bc,0x3da73656,0x3da302d3,0x3d9ebc12,0x3d9a6293
.long 0x3d8e39da,0x3d88f59b,0x3d839c3d,0x3d7c5d27,0x3d663375,0x3d597cb9,0x3d4c9b8b,0x3d3f926f
.long 0x3d2c7cd4,0x3d1d9e78,0x3d0e9a22,0x3cfee6e1,0x3ce05c13,0x3cbe853e,0x3c9c76de,0x3c7475c0
.long 0x3c48bd36,0x3bfb2b74,0x3b490ab0,0xbac90e90,0xbb490ab0,0xbc03db0a,0xbc553db9,0xbc9324ca
.long 0xbc964083,0xbcc19b37,0xbcec9a7f,0xbd0b9507,0xbd088e93,0xbd1f1cdf,0xbd3554ec,0xbd4b2aae
.long 0xbd43ef15,0xbd5ae880,0xbd715aea,0xbd839c3d,0xbd7c5d27,0xbd899f4e,0xbd94b039,0xbd9f599f
.long 0xbd987fc0,0xbda39da9,0xbdae3bde,0xbdb85216,0xbdb085bb,0xbdbb0629,0xbdc4e3f5,0xbdce1689
.long 0xbdc5e403,0xbdcf7a1f,0xbdd84853,0xbde04621,0xbdd84853,0xbde0a6cf,0xbde816a8,0xbdee8ff8
.long 0xbde76bd8,0xbdee46be,0xbdf40bdd,0xbdf8b47b,0xbdf31447,0xbdf822d1,0xbdfbf531,0xbdfe868b
.long 0xbdfb14be,0xbdfe1324,0xbdffb10f,0xbdffec43,0xbdff4e6d,0xbdffffb1,0xbdff2f9d,0xbdfcdf6c
.long 0xbdffb10f,0xbdfde0b1,0xbdfa7302,0xbdf56d97,0xbdfc3b28,0xbdf7beb7,0xbdf18f57,0xbde9b7e4
.long 0xbdf4fa0b,0xbdedb293,0xbde4aa59,0xbdd9f26a,0xbdea09a7,0xbddfe4e9,0xbdd3fac3,0xbdc66354
.long 0xbddb941a,0xbdce8d90,0xbdbfc767,0xbdaf61a5,0xbdc9d112,0xbdb9f2ac,0xbda86605,0xbd9553b7
.long 0x3e000000,0x3e000000,0x3e000000,0x3e000000,0x3dfdabcc,0x3dfd906e,0x3dfd7474,0x3dfd57de
.long 0x3df6ba07,0x3df64d97,0x3df5dec6,0x3df56d97,0x3deb4b0c,0x3dea5ad9,0x3de96591,0x3de86b39
.long 0x3ddb941a,0x3dd9f26a,0x3dd84853,0x3dd695e5,0x3dc7de65,0x3dc56439,0x3dc2de29,0x3dc04c5c
.long 0x3db085bb,0x3dad1469,0x3da99415,0x3da6050a,0x3d95f6d9,0x3d91796b,0x3d8cead0,0x3d884b92
.long 0x3d715aea,0x3d663375,0x3d5ae880,0x3d4f7bca,0x3d3263ef,0x3d25129f,0x3d17a117,0x3d0a11f7
.long 0x3ce05c13,0x3cc19b37,0x3ca2abb6,0x3c839502,0x3c2fb680,0x3bd5880e,0x3b16c9b6,0xbafb514b
.long 0xbbc8fb30,0xbc2fb680,0xbc7ab273,0xbca2abb6,0xbcbb6ecf,0xbce36c83,0xbd0586ce,0xbd1920fe
.long 0xbd209ae5,0xbd3554ec,0xbd49b953,0xbd5dbe79,0xbd60924f,0xbd758035,0xbd84f484,0xbd8ee0db
.long 0xbd8e39da,0xbd987fc0,0xbda26799,0xbdabeb4a,0xbda99415,0xbdb3587a,0xbdbca003,0xbdc56439
.long 0xbdc1d870,0xbdcac77f,0xbdd31849,0xbddac450,0xbdd695e5,0xbdde5aa6,0xbde55e0b,0xbdeb99fb
.long 0xbde76bd8,0xbdedb293,0xbdf31447,0xbdf78bc5,0xbdf40bdd,0xbdf88486,0xbdfbf531,0xbdfe5a38
.long 0xbdfc3b28,0xbdfe9bc9,0xbdffd397,0xbdffe129,0xbdffd397,0xbdffdaaf,0xbdfe9bc9,0xbdfc187a
.long 0xbdfec46d,0xbdfc3b28,0xbdf853f8,0xbdf31447,0xbdf91298,0xbdf3ced9,0xbded1c1d,0xbde50479
.long 0xbdeed89e,0xbde6becc,0xbddd2d53,0xbdd233c6,0xbde04621,0xbdd54aa4,0xbdc8d8b3,0xbdbb0629
.long 0xbdcd9f02,0xbdbfc767,0xbdb085bb,0xbd9ff6cb,0xbdb73a23,0xbda69de3,0xbd94b039,0xbd819573
.long 0xbd9d7fd1,0xbd8a48ad,0xbd6bcbbb,0xbd41071e,0xbd80e7e4,0xbd56a399,0xbd2986c4,0xbcf5c35a
.long 0x0,0x0,0x0,0x0,0x3c7ab273,0x3c807745,0x3c839502,0x3c86b26e
.long 0x3cf8cfcc,0x3cfee6e1,0x3d027dc0,0x3d0586ce,0x3d38442a,0x3d3ca7af,0x3d41071e,0x3d45625c
.long 0x3d715aea,0x3d76e0cb,0x3d7c5d27,0x3d80e7e4,0x3d93682a,0x3d96999f,0x3d99c200,0x3d9ce11f
.long 0x3dabeb4a,0x3daf61a5,0x3db2c8c9,0x3db6206c,0x3dc1d870,0x3dc56439,0x3dc8d8b3,0x3dcc3578
.long 0x3dd4db31,0x3dd84853,0x3ddb941a,0x3ddebe05,0x3de4aa59,0x3de7c187,0x3deaab7b,0x3ded67a1
.long 0x3df10908,0x3df3913f,0x3df5dec6,0x3df7f110,0x3df9c79d,0x3dfb87b2,0x3dfcfe73,0x3dfe2b72
.long 0x3dfec46d,0x3dff84ab,0x3dffec43,0x3dfffb11,0x3dffec43,0x3dff7808,0x3dfe9bc9,0x3dfd57de
.long 0x3dfd3aac,0x3dfb61fc,0x3df91298,0x3df64d97,0x3df6ba07,0x3df3530e,0x3def6830,0x3deafb8c
.long 0x3dec835e,0x3de76bd8,0x3de1c598,0x3ddb941a,0x3ddebe05,0x3dd7dc7f,0x3dd064af,0x3dc85bca
.long 0x3dcd9f02,0x3dc4e3f5,0x3dbb8f3b,0x3db1a81d,0x3db96842,0x3daecef7,0x3da39da9,0x3d97de12
.long 0x3da26799,0x3d95f6d9,0x3d88f59b,0x3d76e0cb,0x3d88f59b,0x3d758035,0x3d58106b,0x3d39bb1e
.long 0x3d5ae880,0x3d3b31a0,0x3d1aa086,0x3cf2b651,0x3d209ae5,0x3cfbdba4,0x3cb54098,0x3c5b7d37
.long 0x3cc7c5c2,0x3c7ab273,0x3bc8fb30,0xbb490ab0,0x3c16a905,0xb9c90fc6,0xbc23308c,0xbc9f917b
.long 0xbbc8fb30,0xbc839502,0xbcd41501,0xbd119ddd,0xbcaf10a2,0xbd00f8c0,0xbd2986c4,0xbd50eb2a
.long 0xbd14a031,0xbd3e1d4a,0xbd663375,0xbd864b82,0xbd4f7bca,0xbd7840c8,0xbd8f8784,0xbda1cbfb
.long 0xbd839c3d,0xbd973c07,0xbda99415,0xbdba7ca4,0xbd9d7fd1,0xbdaff3e6,0xbdc0d0da,0xbdcfefa8
.long 0x0,0x0,0x0,0x0,0x3c89cf86,0x3c8cec4a,0x3c9008b7,0x3c9324ca
.long 0x3d088e93,0x3d0b9507,0x3d0e9a22,0x3d119ddd,0x3d49b953,0x3d4e0bea,0x3d525a09,0x3d56a399
.long 0x3d839c3d,0x3d864b82,0x3d88f59b,0x3d8b9a6b,0x3d9ff6cb,0x3da302d3,0x3da6050a,0x3da8fd41
.long 0x3db96842,0x3dbca003,0x3dbfc767,0x3dc2de29,0x3dcf7a1f,0x3dd2a649,0x3dd5b993,0x3dd8b3a1
.long 0x3de1c598,0x3de4aa59,0x3de76bd8,0x3dea09a7,0x3deff573,0x3df25470,0x3df48422,0x3df6841b
.long 0x3df9c79d,0x3dfb61fc,0x3dfcbfc9,0x3dfde0b1,0x3dff0e58,0x3dffa6e3,0x3dfff4e6,0x3dfff84a
.long 0x3dffb10f,0x3dff0e58,0x3dfe1324,0x3dfcbfc9,0x3dfbaccd,0x3df99b43,0x3df72417,0x3df4484b
.long 0x3df31447,0x3def6830,0x3deb4b0c,0x3de6becc,0x3de60f88,0x3de0a6cf,0x3ddac450,0x3dd46b3b
.long 0x3dd4db31,0x3dcd9f02,0x3dc5e403,0x3dbdaef9,0x3dbfc767,0x3db6ad7f,0x3dad1469,0x3da302d3
.long 0x3da73656,0x3d9c420c,0x3d90d3cd,0x3d84f484,0x3d8b9a6b,0x3d7dbabb,0x3d6363fa,0x3d48477c
.long 0x3d5ae880,0x3d3e1d4a,0x3d209ae5,0x3d027dc0,0x3d1aa086,0x3cf5c35a,0x3cb54098,0x3c67fa9a
.long 0x3caf10a2,0x3c553db9,0x3b96c32c,0xbb7b49ba,0x3b96c32c,0xbb8a342f,0xbc553db9,0xbcb228d4
.long 0xbc48bd36,0xbcaf10a2,0xbcf8cfcc,0xbd209ae5,0xbcec9a7f,0xbd1c1faf,0xbd41071e,0xbd64cbfe
.long 0xbd38442a,0xbd5dbe79,0xbd80e7e4,0xbd921eb0,0xbd76e0cb,0xbd8d9281,0xbd9ebc12,0xbdaecef7
.long 0xbd987fc0,0xbda99415,0xbdb96842,0xbdc7de65,0xbdb2c8c9,0xbdc25b89,0xbdd064af,0xbddcc7d1
.long 0xbdc9d112,0xbdd77026,0xbde33c5a,0xbded1c1d,0xbddd2d53,0xbde86b39,0xbdf18f57,0xbdf88486
.long 0x3e000000,0x3e000000,0x3e000000,0x3e000000,0x3dfd3aac,0x3dfd1cdd,0x3dfcfe73,0x3dfcdf6c
.long 0x3df4fa0b,0x3df48422,0x3df40bdd,0x3df3913f,0x3de76bd8,0x3de66771,0x3de55e0b,0x3de44fac
.long 0x3dd4db31,0x3dd31849,0x3dd14d3d,0x3dcf7a1f,0x3dbdaef9,0x3dbb0629,0x3db85216,0x3db592e7
.long 0x3da26799,0x3d9ebc12,0x3d9b02c6,0x3d973c07,0x3d839c3d,0x3d7dbabb,0x3d741f07,0x3d6a6681
.long 0x3d43ef15,0x3d38442a,0x3d2c7cd4,0x3d209ae5,0x3cf8cfcc,0x3cdd4b1a,0x3cc19b37,0x3ca5c58c
.long 0x3c48bd36,0x3c0a200a,0x3b96c32c,0x3a490f88,0xbbc8fb30,0xbc2973ba,0xbc6e3876,0xbc995be0
.long 0xbcc7c5c2,0xbcec9a7f,0xbd088e93,0xbd1aa086,0xbd2c7cd4,0xbd3f926f,0xbd525a09,0xbd64cbfe
.long 0xbd715aea,0xbd8242b1,0xbd8b9a6b,0xbd94b039,0xbd987fc0,0xbda1cbfb,0xbdaac082,0xbdb3587a
.long 0xbdb504f3,0xbdbdaef9,0xbdc5e403,0xbdcd9f02,0xbdcd9f02,0xbdd54aa4,0xbddc61c7,0xbde2df7b
.long 0xbde1c598,0xbde816a8,0xbdedb293,0xbdf294f8,0xbdf10908,0xbdf5a67b,0xbdf96e4e,0xbdfc5d3a
.long 0xbdfb14be,0xbdfdabcc,0xbdff4e6d,0xbdfffb11,0xbdffb10f,0xbdfff84a,0xbdff2f9d,0xbdfd57de
.long 0xbdfec46d,0xbdfc7eb0,0xbdf91298,0xbdf48422,0xbdf853f8,0xbdf3530e,0xbded1c1d,0xbde5b710
.long 0xbdec835e,0xbde4aa59,0xbddb941a,0xbdd14d3d,0xbddb941a,0xbdd0d937,0xbdc4e3f5,0xbdb7c655
.long 0xbdc5e403,0xbdb85216,0xbda99415,0xbd99c200,0xbdabeb4a,0xbd9ba299,0xbd8a48ad,0xbd6ff7fb
.long 0xbd8e39da,0xbd76e0cb,0xbd4f7bca,0xbd268f12,0xbd5ae880,0xbd30eacb,0xbd0586ce,0xbcb228d4
.long 0xbd14a031,0xbccdee60,0xbc61bc2e,0xbb16c9b6,0xbc964083,0xbbd5880e,0x3bafe007,0x3c8cec4a
.long 0x3e000000,0x3e000000,0x3e000000,0x3e000000,0x3dfcbfc9,0x3dfc9f8a,0x3dfc7eb0,0x3dfc5d3a
.long 0x3df31447,0x3df294f8,0x3df21352,0x3df18f57,0x3de33c5a,0x3de2241a,0x3de106f2,0x3ddfe4e9
.long 0x3dcd9f02,0x3dcbbbf8,0x3dc9d112,0x3dc7de65,0x3db2c8c9,0x3daff3e6,0x3dad1469,0x3daa2a80
.long 0x3d93682a,0x3d8f8784,0x3d8b9a6b,0x3d87a136,0x3d60924f,0x3d56a399,0x3d4c9b8b,0x3d427b55
.long 0x3d14a031,0x3d088e93,0x3cf8cfcc,0x3ce05c13,0x3c89cf86,0x3c5b7d37,0x3c23308c,0x3bd5880e
.long 0xbb490ab0,0xbbe21469,0xbc2fb680,0xbc6e3876,0xbcbb6ecf,0xbcdd4b1a,0xbcfee6e1,0xbd101c2c
.long 0xbd2c7cd4,0xbd3e1d4a,0xbd4f7bca,0xbd60924f,0xbd76e0cb,0xbd844889,0xbd8cead0,0xbd9553b7
.long 0xbd9d7fd1,0xbda6050a,0xbdae3bde,0xbdb6206c,0xbdbb8f3b,0xbdc36051,0xbdcac77f,0xbdd1c0c2
.long 0xbdd4db31,0xbddb941a,0xbde1c598,0xbde76bd8,0xbde8bf3c,0xbdedfcf2,0xbdf294f8,0xbdf6841b
.long 0xbdf6ba07,0xbdfa1e84,0xbdfcbfc9,0xbdfe9bc9,0xbdfe70b0,0xbdffa6e3,0xbdfffec4,0xbdff7808
.long 0xbdffb10f,0xbdfe70b0,0xbdfc3b28,0xbdf91298,0xbdfa7302,0xbdf6841b,0xbdf18f57,0xbdeb99fb
.long 0xbdeed89e,0xbde816a8,0xbde04621,0xbdd77026,0xbddd2d53,0xbdd389c7,0xbdc8d8b3,0xbdbd27b8
.long 0xbdc5e403,0xbdb96842,0xbdabeb4a,0xbd9d7fd1,0xbda99415,0xbd9a6293,0xbd8a48ad,0xbd72bd43
.long 0xbd88f59b,0xbd6e9479,0xbd49b953,0xbd2395c5,0xbd49b953,0xbd221887,0xbcf2b651,0xbc9f917b
.long 0xbcf8cfcc,0xbca2abb6,0xbc16a905,0x3ac90e90,0xbc2fb680,0x39c90fc6,0x3c3c3ac3,0x3cb857ec
.long 0x3c16a905,0x3ca8defc,0x3d027dc0,0x3d2f713a,0x3cec9a7f,0x3d25129f,0x3d525a09,0x3d7dbabb
.long 0x0,0x0,0x0,0x0,0x3c964083,0x3c995be0,0x3c9c76de,0x3c9f917b
.long 0x3d14a031,0x3d17a117,0x3d1aa086,0x3d1d9e78,0x3d5ae880,0x3d5f28a9,0x3d6363fa,0x3d679a5d
.long 0x3d8e39da,0x3d90d3cd,0x3d93682a,0x3d95f6d9,0x3dabeb4a,0x3daecef7,0x3db1a81d,0x3db4768f
.long 0x3dc5e403,0x3dc8d8b3,0x3dcbbbf8,0x3dce8d90,0x3ddb941a,0x3dde5aa6,0x3de106f2,0x3de398ac
.long 0x3dec835e,0x3deed89e,0x3df10908,0x3df31447,0x3df853f8,0x3df9f35e,0x3dfb61fc,0x3dfc9f8a
.long 0x3dfec46d,0x3dff6ac7,0x3dffd397,0x3dfffec4,0x3dffb10f,0x3dff1f49,0x3dfe4323,0x3dfd1cdd
.long 0x3dfb14be,0x3df91298,0x3df6ba07,0x3df40bdd,0x3df10908,0x3ded67a1,0x3de96591,0x3de50479
.long 0x3de1c598,0x3ddc61c7,0x3dd695e5,0x3dd064af,0x3dcd9f02,0x3dc66354,0x3dbebc1b,0x3db6ad7f
.long 0x3db504f3,0x3dabeb4a,0x3da26799,0x3d987fc0,0x3d987fc0,0x3d8d9281,0x3d8242b1,0x3d6d3063
.long 0x3d715aea,0x3d58106b,0x3d3e1d4a,0x3d2395c5,0x3d2c7cd4,0x3d101c2c,0x3ce67c66,0x3cabf804
.long 0x3cc7c5c2,0x3c89cf86,0x3c16a905,0x3ac90e90,0x3bc8fb30,0xbafb514b,0xbc23308c,0xbc9324ca
.long 0xbc48bd36,0xbca8defc,0xbcec9a7f,0xbd17a117,0xbcf8cfcc,0xbd1f1cdf,0xbd41071e,0xbd61fb6a
.long 0xbd43ef15,0xbd663375,0xbd839c3d,0xbd93682a,0xbd839c3d,0xbd940c5f,0xbda39da9,0xbdb238aa
.long 0xbda26799,0xbdb1a81d,0xbdbfc767,0xbdccae79,0xbdbdaef9,0xbdcb41fa,0xbdd77026,0xbde2241a
.long 0xbdd4db31,0xbde04621,0xbdea09a7,0xbdf21352,0xbde76bd8,0xbdf03b37,0xbdf72417,0xbdfc187a
.long 0xbdf4fa0b,0xbdfac516,0xbdfe70b0,0xbdfff4e6,0xbdfd3aac,0xbdffa6e3,0xbdffc38f,0xbdfd906e
.long 0x0,0x0,0x0,0x0,0x3ca2abb6,0x3ca5c58c,0x3ca8defc,0x3cabf804
.long 0x3d209ae5,0x3d2395c5,0x3d268f12,0x3d2986c4,0x3d6bcbbb,0x3d6ff7fb,0x3d741f07,0x3d7840c8
.long 0x3d987fc0,0x3d9b02c6,0x3d9d7fd1,0x3d9ff6cb,0x3db73a23,0x3db9f2ac,0x3dbca003,0x3dbf41fc
.long 0x3dd14d3d,0x3dd3fac3,0x3dd695e5,0x3dd91e6a,0x3de60f88,0x3de86b39,0x3deaab7b,0x3decd007
.long 0x3df4fa0b,0x3df6ba07,0x3df853f8,0x3df9c79d,0x3dfdabcc,0x3dfe868b,0x3dff2f9d,0x3dffa6e3
.long 0x3dffec43,0x3dff9c18,0x3dff0e58,0x3dfe4323,0x3dfbaccd,0x3df9f35e,0x3df7f110,0x3df5a67b
.long 0x3df10908,0x3dedb293,0x3dea09a7,0x3de60f88,0x3de04621,0x3ddb2c79,0x3dd5b993,0x3dcfefa8
.long 0x3dc9d112,0x3dc2de29,0x3dbb8f3b,0x3db3e7bc,0x3dae3bde,0x3da56bcb,0x3d9c420c,0x3d92c39a
.long 0x3d8e39da,0x3d839c3d,0x3d715aea,0x3d5ae880,0x3d553641,0x3d3ca7af,0x3d2395c5,0x3d0a11f7
.long 0x3d088e93,0x3cda3997,0x3ca2abb6,0x3c553db9,0x3c61bc2e,0x3bd5880e,0xba490f88,0xbc03db0a
.long 0xbbc8fb30,0xbc61bc2e,0xbcaf10a2,0xbcec9a7f,0xbcd41501,0xbd0a11f7,0xbd2986c4,0xbd48477c
.long 0xbd38442a,0xbd58106b,0xbd76e0cb,0xbd8a48ad,0xbd80e7e4,0xbd902dd5,0xbd9ebc12,0xbdac800f
.long 0xbda26799,0xbdb085bb,0xbdbdaef9,0xbdc9d112,0xbdbfc767,0xbdcc3578,0xbdd77026,0xbde1668a
.long 0xbdd84853,0xbde28210,0xbdeb4b0c,0xbdf294f8,0xbdeb4b0c,0xbdf2d4eb,0xbdf8b47b,0xbdfcdf6c
.long 0xbdf853f8,0xbdfcbfc9,0xbdff4e6d,0xbdfffb11,0xbdff0e58,0xbdffffb1,0xbdfeea9d,0xbdfbd14d
.long 0xbdff4e6d,0xbdfc7eb0,0xbdf78bc5,0xbdf08066,0xbdf91298,0xbdf25470,0xbde96591,0xbdde5aa6
.long 0x3e000000,0x3e000000,0x3e000000,0x3e000000,0x3dfc3b28,0x3dfc187a,0x3dfbf531,0x3dfbd14d
.long 0x3df10908,0x3df08066,0x3deff573,0x3def6830,0x3ddebe05,0x3ddd924d,0x3ddc61c7,0x3ddb2c79
.long 0x3dc5e403,0x3dc3e200,0x3dc1d870,0x3dbfc767,0x3da73656,0x3da4381a,0x3da12ff9,0x3d9e1e22
.long 0x3d839c3d,0x3d7f17b2,0x3d76e0cb,0x3d6e9479,0x3d38442a,0x3d2df73c,0x3d2395c5,0x3d1920fe
.long 0x3cc7c5c2,0x3caf10a2,0x3c964083,0x3c7ab273,0x3b490ab0,0xb9c90fc6,0xbb7b49ba,0xbbeea038
.long 0xbc964083,0xbcb54098,0xbcd41501,0xbcf2b651,0xbd209ae5,0xbd30eacb,0xbd41071e,0xbd50eb2a
.long 0xbd715aea,0xbd80e7e4,0xbd88f59b,0xbd90d3cd,0xbd9d7fd1,0xbda56bcb,0xbdad1469,0xbdb4768f
.long 0xbdbdaef9,0xbdc4e3f5,0xbdcbbbf8,0xbdd233c6,0xbdd84853,0xbdde5aa6,0xbde3f473,0xbde912ae
.long 0xbdec835e,0xbdf10908,0xbdf4fa0b,0xbdf853f8,0xbdf9c79d,0xbdfc5d3a,0xbdfe4323,0xbdff7808
.long 0xbdffb10f,0xbdfffec4,0xbdff84ab,0xbdfe4323,0xbdfe1324,0xbdfbd14d,0xbdf8b47b,0xbdf4bf62
.long 0xbdf4fa0b,0xbdeff573,0xbdea09a7,0xbde33c5a,0xbde4aa59,0xbddcc7d1,0xbdd3fac3,0xbdca4c87
.long 0xbdcd9f02,0xbdc2de29,0xbdb73a23,0xbdaac082,0xbdb085bb,0xbda302d3,0xbd94b039,0xbd85a02c
.long 0xbd8e39da,0xbd7c5d27,0xbd5ae880,0xbd38442a,0xbd4f7bca,0xbd2b0201,0xbd0586ce,0xbcbe853e
.long 0xbcf8cfcc,0xbca8defc,0xbc2fb680,0xba490f88,0xbc16a905,0x3a96cb58,0x3c3c3ac3,0x3cb228d4
.long 0x3c48bd36,0x3cbb6ecf,0x3d088e93,0x3d3263ef,0x3d088e93,0x3d33dca5,0x3d5dbe79,0x3d82ef9f
.long 0x3d5ae880,0x3d8242b1,0x3d95f6d9,0x3da86605,0x3d93682a,0x3da69de3,0x3db85216,0x3dc85bca
.long 0x3e000000,0x3e000000,0x3e000000,0x3e000000,0x3dfbaccd,0x3dfb87b2,0x3dfb61fc,0x3dfb3bab
.long 0x3deed89e,0x3dee46be,0x3dedb293,0x3ded1c1d,0x3dd9f26a,0x3dd8b3a1,0x3dd77026,0x3dd627fe
.long 0x3dbdaef9,0x3dbb8f3b,0x3db96842,0x3db73a23,0x3d9b02c6,0x3d97de12,0x3d94b039,0x3d91796b
.long 0x3d663375,0x3d5dbe79,0x3d553641,0x3d4c9b8b,0x3d0e9a22,0x3d040270,0x3cf2b651,0x3cdd4b1a
.long 0x3c48bd36,0x3c16a905,0x3bc8fb30,0x3b490ab0,0xbc2fb680,0xbc67fa9a,0xbc9008b7,0xbcabf804
.long 0xbd088e93,0xbd17a117,0xbd268f12,0xbd3554ec,0xbd60924f,0xbd6ff7fb,0xbd7f17b2,0xbd86f686
.long 0xbd987fc0,0xbd9ff6cb,0xbda73656,0xbdae3bde,0xbdbb8f3b,0xbdc25b89,0xbdc8d8b3,0xbdcf0417
.long 0xbdd84853,0xbdddf6be,0xbde33c5a,0xbde816a8,0xbdedb293,0xbdf1d19f,0xbdf56d97,0xbdf88486
.long 0xbdfb14be,0xbdfd3aac,0xbdfec46d,0xbdffb10f,0xbdfffb11,0xbdffcbe2,0xbdfeea9d,0xbdfd57de
.long 0xbdfc3b28,0xbdf96e4e,0xbdf5dec6,0xbdf18f57,0xbdeff573,0xbdea5ad9,0xbde3f473,0xbddcc7d1
.long 0xbddb941a,0xbdd31849,0xbdc9d112,0xbdbfc767,0xbdbfc767,0xbdb4768f,0xbda86605,0xbd9ba299
.long 0xbd9d7fd1,0xbd8f8784,0xbd80e7e4,0xbd6363fa,0xbd6bcbbb,0xbd4b2aae,0xbd2986c4,0xbd070ada
.long 0xbd14a031,0xbce05c13,0xbc964083,0xbc16a905,0xbc61bc2e,0xbb8a342f,0x3bafe007,0x3c7475c0
.long 0x3c16a905,0x3c9c76de,0x3cec9a7f,0x3d1d9e78,0x3d027dc0,0x3d2b0201,0x3d525a09,0x3d7840c8
.long 0x3d5ae880,0x3d80e7e4,0x3d93682a,0x3da4d225,0x3d95f6d9,0x3da7ce61,0x3db85216,0x3dc76085
.long 0x3db96842,0x3dc8d8b3,0x3dd695e5,0x3de28210,0x3dd695e5,0x3de2df7b,0x3ded1c1d,0x3df5341d
.long 0x0,0x0,0x0,0x0,0x3caf10a2,0x3cb228d4,0x3cb54098,0x3cb857ec
.long 0x3d2c7cd4,0x3d2f713a,0x3d3263ef,0x3d3554ec,0x3d7c5d27,0x3d803a06,0x3d8242b1,0x3d844889
.long 0x3da26799,0x3da4d225,0x3da73656,0x3da99415,0x3dc1d870,0x3dc46337,0x3dc6e22a,0x3dc95521
.long 0x3ddb941a,0x3dddf6be,0x3de04621,0x3de28210,0x3deed89e,0x3df0c501,0x3df294f8,0x3df4484b
.long 0x3dfb14be,0x3dfc3b28,0x3dfd3aac,0x3dfe1324,0x3dffec43,0x3dffffb1,0x3dffe129,0x3dff90b1
.long 0x3dfd3aac,0x3dfbf531,0x3dfa7302,0x3df8b47b,0x3df31447,0x3df03b37,0x3ded1c1d,0x3de9b7e4
.long 0x3de1c598,0x3ddd2d53,0x3dd84853,0x3dd31849,0x3dc9d112,0x3dc36051,0x3dbca003,0x3db592e7
.long 0x3dabeb4a,0x3da39da9,0x3d9b02c6,0x3d921eb0,0x3d88f59b,0x3d7dbabb,0x3d6900b7,0x3d53c867
.long 0x3d43ef15,0x3d2c7cd4,0x3d14a031,0x3cf8cfcc,0x3ce05c13,0x3cabf804,0x3c6e3876,0x3c03db0a
.long 0x3bc8fb30,0xba490f88,0xbbfb2b74,0xbc6e3876,0xbc7ab273,0xbcb857ec,0xbcf2b651,0xbd1620d2
.long 0xbd14a031,0xbd3263ef,0xbd4f7bca,0xbd6bcbbb,0xbd663375,0xbd819573,0xbd8f8784,0xbd9ce11f
.long 0xbd987fc0,0xbda6050a,0xbdb2c8c9,0xbdbebc1b,0xbdb96842,0xbdc56439,0xbdd064af,0xbdda5ba0
.long 0xbdd4db31,0xbddebe05,0xbde76bd8,0xbdeed89e,0xbdea09a7,0xbdf14c7a,0xbdf72417,0xbdfb87b2
.long 0xbdf853f8,0xbdfc7eb0,0xbdff0e58,0xbdfffec4,0xbdff4e6d,0xbdfffd39,0xbdfeea9d,0xbdfc187a
.long 0xbdfec46d,0xbdfbaccd,0xbdf6ba07,0xbdeff573,0xbdf6ba07,0xbdefaf1b,0xbde6becc,0xbddbfb34
.long 0xbde76bd8,0xbddc61c7,0xbdcf7a1f,0xbdc0d0da,0xbdd14d3d,0xbdc25b89,0xbdb1a81d,0xbd9f599f
.long 0x0,0x0,0x0,0x0,0x3cbb6ecf,0x3cbe853e,0x3cc19b37,0x3cc4b0b9
.long 0x3d38442a,0x3d3b31a0,0x3d3e1d4a,0x3d41071e,0x3d864b82,0x3d884b92,0x3d8a48ad,0x3d8c42c9
.long 0x3dabeb4a,0x3dae3bde,0x3db085bb,0x3db2c8c9,0x3dcbbbf8,0x3dce1689,0x3dd064af,0x3dd2a649
.long 0x3de4aa59,0x3de6becc,0x3de8bf3c,0x3deaab7b,0x3df5dec6,0x3df7583a,0x3df8b47b,0x3df9f35e
.long 0x3dfec46d,0x3dff4e6d,0x3dffb10f,0x3dffec43,0x3dff0e58,0x3dfe5a38,0x3dfd7474,0x3dfc5d3a
.long 0x3df6ba07,0x3df48422,0x3df21352,0x3def6830,0x3de60f88,0x3de2241a,0x3dddf6be,0x3dd988ad
.long 0x3dcd9f02,0x3dc7de65,0x3dc1d870,0x3dbb8f3b,0x3dae3bde,0x3da69de3,0x3d9ebc12,0x3d96999f
.long 0x3d88f59b,0x3d7f17b2,0x3d6bcbbb,0x3d58106b,0x3d3e1d4a,0x3d280b1f,0x3d119ddd,0x3cf5c35a
.long 0x3cc7c5c2,0x3c964083,0x3c48bd36,0x3bc8fb30,0x3ac90e90,0xbba351cb,0xbc3c3ac3,0xbc9324ca
.long 0xbcaf10a2,0xbce67c66,0xbd0e9a22,0xbd2986c4,0xbd3263ef,0xbd4e0bea,0xbd6900b7,0xbd819573
.long 0xbd839c3d,0xbd90d3cd,0xbd9d7fd1,0xbda99415,0xbda99415,0xbdb592e7,0xbdc0d0da,0xbdcb41fa
.long 0xbdc9d112,0xbdd3fac3,0xbddd2d53,0xbde55e0b,0xbde33c5a,0xbdeafb8c,0xbdf18f57,0xbdf6ef5b
.long 0xbdf4fa0b,0xbdf9c79d,0xbdfd3aac,0xbdff4e6d,0xbdfe70b0,0xbdffdaaf,0xbdffc38f,0xbdfe2b72
.long 0xbdff4e6d,0xbdfcfe73,0xbdf91298,0xbdf3913f,0xbdf78bc5,0xbdf14c7a,0xbde96591,0xbddfe4e9
.long 0xbde76bd8,0xbddd2d53,0xbdd14d3d,0xbdc3e200,0xbdcf7a1f,0xbdc154e1,0xbdb1a81d,0xbda09393
.long 0xbdb085bb,0xbd9ebc12,0xbd8b9a6b,0xbd6e9479,0xbd8b9a6b,0xbd6d3063,0xbd41071e,0xbd131f35
.long 0x3e000000,0x3e000000,0x3e000000,0x3e000000,0x3e000000,0x3dffffb1,0x3dfffec4,0x3dfffd39
.long 0x3e000000,0x3dfffec4,0x3dfffb11,0x3dfff4e6,0x3e000000,0x3dfffd39,0x3dfff4e6,0x3dffe705
.long 0x3e000000,0x3dfffb11,0x3dffec43,0x3dffd397,0x3e000000,0x3dfff84a,0x3dffe129,0x3dffba9e
.long 0x3e000000,0x3dfff4e6,0x3dffd397,0x3dff9c18,0x3e000000,0x3dfff0e3,0x3dffc38f,0x3dff7808
.long 0x3e000000,0x3dffec43,0x3dffb10f,0x3dff4e6d,0x3e000000,0x3dffe705,0x3dff9c18,0x3dff1f49
.long 0x3e000000,0x3dffe129,0x3dff84ab,0x3dfeea9d,0x3e000000,0x3dffdaaf,0x3dff6ac7,0x3dfeb069
.long 0x3e000000,0x3dffd397,0x3dff4e6d,0x3dfe70b0,0x3e000000,0x3dffcbe2,0x3dff2f9d,0x3dfe2b72
.long 0x3e000000,0x3dffc38f,0x3dff0e58,0x3dfde0b1,0x3e000000,0x3dffba9e,0x3dfeea9d,0x3dfd906e
.long 0x3e000000,0x3dffb10f,0x3dfec46d,0x3dfd3aac,0x3e000000,0x3dffa6e3,0x3dfe9bc9,0x3dfcdf6c
.long 0x3e000000,0x3dff9c18,0x3dfe70b0,0x3dfc7eb0,0x3e000000,0x3dff90b1,0x3dfe4323,0x3dfc187a
.long 0x3e000000,0x3dff84ab,0x3dfe1324,0x3dfbaccd,0x3e000000,0x3dff7808,0x3dfde0b1,0x3dfb3bab
.long 0x3e000000,0x3dff6ac7,0x3dfdabcc,0x3dfac516,0x3e000000,0x3dff5ce9,0x3dfd7474,0x3dfa4910
.long 0x3e000000,0x3dff4e6d,0x3dfd3aac,0x3df9c79d,0x3e000000,0x3dff3f54,0x3dfcfe73,0x3df940c0
.long 0x3e000000,0x3dff2f9d,0x3dfcbfc9,0x3df8b47b,0x3e000000,0x3dff1f49,0x3dfc7eb0,0x3df822d1
.long 0x3e000000,0x3dff0e58,0x3dfc3b28,0x3df78bc5,0x3e000000,0x3dfefcc9,0x3dfbf531,0x3df6ef5b
.long 0x3e000000,0x3dfeea9d,0x3dfbaccd,0x3df64d97,0x3e000000,0x3dfed7d4,0x3dfb61fc,0x3df5a67b
.long 0x3e000000,0x3e000000,0x3e000000,0x3e000000,0x3dfffb11,0x3dfff84a,0x3dfff4e6,0x3dfff0e3
.long 0x3dffec43,0x3dffe129,0x3dffd397,0x3dffc38f,0x3dffd397,0x3dffba9e,0x3dff9c18,0x3dff7808
.long 0x3dffb10f,0x3dff84ab,0x3dff4e6d,0x3dff0e58,0x3dff84ab,0x3dff3f54,0x3dfeea9d,0x3dfe868b
.long 0x3dff4e6d,0x3dfeea9d,0x3dfe70b0,0x3dfde0b1,0x3dff0e58,0x3dfe868b,0x3dfde0b1,0x3dfd1cdd
.long 0x3dfec46d,0x3dfe1324,0x3dfd3aac,0x3dfc3b28,0x3dfe70b0,0x3dfd906e,0x3dfc7eb0,0x3dfb3bab
.long 0x3dfe1324,0x3dfcfe73,0x3dfbaccd,0x3dfa1e84,0x3dfdabcc,0x3dfc5d3a,0x3dfac516,0x3df8e3d6
.long 0x3dfd3aac,0x3dfbaccd,0x3df9c79d,0x3df78bc5,0x3dfcbfc9,0x3dfaed37,0x3df8b47b,0x3df6167a
.long 0x3dfc3b28,0x3dfa1e84,0x3df78bc5,0x3df48422,0x3dfbaccd,0x3df940c0,0x3df64d97,0x3df2d4eb
.long 0x3dfb14be,0x3df853f8,0x3df4fa0b,0x3df10908,0x3dfa7302,0x3df7583a,0x3df3913f,0x3def20b0
.long 0x3df9c79d,0x3df64d97,0x3df21352,0x3ded1c1d,0x3df91298,0x3df5341d,0x3df08066,0x3deafb8c
.long 0x3df853f8,0x3df40bdd,0x3deed89e,0x3de8bf3c,0x3df78bc5,0x3df2d4eb,0x3ded1c1d,0x3de66771
.long 0x3df6ba07,0x3df18f57,0x3deb4b0c,0x3de3f473,0x3df5dec6,0x3df03b37,0x3de96591,0x3de1668a
.long 0x3df4fa0b,0x3deed89e,0x3de76bd8,0x3ddebe05,0x3df40bdd,0x3ded67a1,0x3de55e0b,0x3ddbfb34
.long 0x3df31447,0x3debe858,0x3de33c5a,0x3dd91e6a,0x3df21352,0x3dea5ad9,0x3de106f2,0x3dd627fe
.long 0x3df10908,0x3de8bf3c,0x3ddebe05,0x3dd31849,0x3deff573,0x3de71599,0x3ddc61c7,0x3dcfefa8
.long 0x3deed89e,0x3de55e0b,0x3dd9f26a,0x3dccae79,0x3dedb293,0x3de398ac,0x3dd77026,0x3dc95521
.long 0x0,0x0,0x0,0x0,0x0,0x39c90fc6,0x3a490f88,0x3a96cb58
.long 0x0,0x3a490f88,0x3ac90e90,0x3b16c9b6,0x0,0x3a96cb58,0x3b16c9b6,0x3b622a7a
.long 0x0,0x3ac90e90,0x3b490ab0,0x3b96c32c,0x0,0x3afb514b,0x3b7b49ba,0x3bbc6dd5
.long 0x0,0x3b16c9b6,0x3b96c32c,0x3be21469,0x0,0x3b2fea69,0x3bafe007,0x3c03db0a
.long 0x0,0x3b490ab0,0x3bc8fb30,0x3c16a905,0x0,0x3b622a7a,0x3be21469,0x3c2973ba
.long 0x0,0x3b7b49ba,0x3bfb2b74,0x3c3c3ac3,0x0,0x3b8a342f,0x3c0a200a,0x3c4efdb7
.long 0x0,0x3b96c32c,0x3c16a905,0x3c61bc2e,0x0,0x3ba351cb,0x3c23308c,0x3c7475c0
.long 0x0,0x3bafe007,0x3c2fb680,0x3c839502,0x0,0x3bbc6dd5,0x3c3c3ac3,0x3c8cec4a
.long 0x0,0x3bc8fb30,0x3c48bd36,0x3c964083,0x0,0x3bd5880e,0x3c553db9,0x3c9f917b
.long 0x0,0x3be21469,0x3c61bc2e,0x3ca8defc,0x0,0x3beea038,0x3c6e3876,0x3cb228d4
.long 0x0,0x3bfb2b74,0x3c7ab273,0x3cbb6ecf,0x0,0x3c03db0a,0x3c839502,0x3cc4b0b9
.long 0x0,0x3c0a200a,0x3c89cf86,0x3ccdee60,0x0,0x3c1064b4,0x3c9008b7,0x3cd7278f
.long 0x0,0x3c16a905,0x3c964083,0x3ce05c13,0x0,0x3c1cecf9,0x3c9c76de,0x3ce98bba
.long 0x0,0x3c23308c,0x3ca2abb6,0x3cf2b651,0x0,0x3c2973ba,0x3ca8defc,0x3cfbdba4
.long 0x0,0x3c2fb680,0x3caf10a2,0x3d027dc0,0x0,0x3c35f8da,0x3cb54098,0x3d070ada
.long 0x0,0x3c3c3ac3,0x3cbb6ecf,0x3d0b9507,0x0,0x3c427c39,0x3cc19b37,0x3d101c2c
.long 0x0,0x0,0x0,0x0,0x3ac90e90,0x3afb514b,0x3b16c9b6,0x3b2fea69
.long 0x3b490ab0,0x3b7b49ba,0x3b96c32c,0x3bafe007,0x3b96c32c,0x3bbc6dd5,0x3be21469,0x3c03db0a
.long 0x3bc8fb30,0x3bfb2b74,0x3c16a905,0x3c2fb680,0x3bfb2b74,0x3c1cecf9,0x3c3c3ac3,0x3c5b7d37
.long 0x3c16a905,0x3c3c3ac3,0x3c61bc2e,0x3c839502,0x3c2fb680,0x3c5b7d37,0x3c839502,0x3c995be0
.long 0x3c48bd36,0x3c7ab273,0x3c964083,0x3caf10a2,0x3c61bc2e,0x3c8cec4a,0x3ca8defc,0x3cc4b0b9
.long 0x3c7ab273,0x3c9c76de,0x3cbb6ecf,0x3cda3997,0x3c89cf86,0x3cabf804,0x3ccdee60,0x3cefa8b2
.long 0x3c964083,0x3cbb6ecf,0x3ce05c13,0x3d027dc0,0x3ca2abb6,0x3ccada4f,0x3cf2b651,0x3d0d17c0
.long 0x3caf10a2,0x3cda3997,0x3d027dc0,0x3d17a117,0x3cbb6ecf,0x3ce98bba,0x3d0b9507,0x3d221887
.long 0x3cc7c5c2,0x3cf8cfcc,0x3d14a031,0x3d2c7cd4,0x3cd41501,0x3d040270,0x3d1d9e78,0x3d36ccc3
.long 0x3ce05c13,0x3d0b9507,0x3d268f12,0x3d41071e,0x3cec9a7f,0x3d131f35,0x3d2f713a,0x3d4b2aae
.long 0x3cf8cfcc,0x3d1aa086,0x3d38442a,0x3d553641,0x3d027dc0,0x3d221887,0x3d41071e,0x3d5f28a9
.long 0x3d088e93,0x3d2986c4,0x3d49b953,0x3d6900b7,0x3d0e9a22,0x3d30eacb,0x3d525a09,0x3d72bd43
.long 0x3d14a031,0x3d38442a,0x3d5ae880,0x3d7c5d27,0x3d1aa086,0x3d3f926f,0x3d6363fa,0x3d82ef9f
.long 0x3d209ae5,0x3d46d529,0x3d6bcbbb,0x3d87a136,0x3d268f12,0x3d4e0bea,0x3d741f07,0x3d8c42c9
.long 0x3d2c7cd4,0x3d553641,0x3d7c5d27,0x3d90d3cd,0x3d3263ef,0x3d5c53c1,0x3d8242b1,0x3d9553b7
.long 0x3d38442a,0x3d6363fa,0x3d864b82,0x3d99c200,0x3d3e1d4a,0x3d6a6681,0x3d8a48ad,0x3d9e1e22
.long 0x3e000000,0x3e000000,0x3e000000,0x3e000000,0x3dffec43,0x3dffe705,0x3dffe129,0x3dffdaaf
.long 0x3dffb10f,0x3dff9c18,0x3dff84ab,0x3dff6ac7,0x3dff4e6d,0x3dff1f49,0x3dfeea9d,0x3dfeb069
.long 0x3dfec46d,0x3dfe70b0,0x3dfe1324,0x3dfdabcc,0x3dfe1324,0x3dfd906e,0x3dfcfe73,0x3dfc5d3a
.long 0x3dfd3aac,0x3dfc7eb0,0x3dfbaccd,0x3dfac516,0x3dfc3b28,0x3dfb3bab,0x3dfa1e84,0x3df8e3d6
.long 0x3dfb14be,0x3df9c79d,0x3df853f8,0x3df6ba07,0x3df9c79d,0x3df822d1,0x3df64d97,0x3df4484b
.long 0x3df853f8,0x3df64d97,0x3df40bdd,0x3df18f57,0x3df6ba07,0x3df4484b,0x3df18f57,0x3dee8ff8
.long 0x3df4fa0b,0x3df21352,0x3deed89e,0x3deb4b0c,0x3df31447,0x3defaf1b,0x3debe858,0x3de7c187
.long 0x3df10908,0x3ded1c1d,0x3de8bf3c,0x3de3f473,0x3deed89e,0x3dea5ad9,0x3de55e0b,0x3ddfe4e9
.long 0x3dec835e,0x3de76bd8,0x3de1c598,0x3ddb941a,0x3dea09a7,0x3de44fac,0x3dddf6be,0x3dd70348
.long 0x3de76bd8,0x3de106f2,0x3dd9f26a,0x3dd233c6,0x3de4aa59,0x3ddd924d,0x3dd5b993,0x3dcd26fd
.long 0x3de1c598,0x3dd9f26a,0x3dd14d3d,0x3dc7de65,0x3ddebe05,0x3dd627fe,0x3dccae79,0x3dc25b89
.long 0x3ddb941a,0x3dd233c6,0x3dc7de65,0x3dbca003,0x3dd84853,0x3dce1689,0x3dc2de29,0x3db6ad7f
.long 0x3dd4db31,0x3dc9d112,0x3dbdaef9,0x3db085bb,0x3dd14d3d,0x3dc56439,0x3db85216,0x3daa2a80
.long 0x3dcd9f02,0x3dc0d0da,0x3db2c8c9,0x3da39da9,0x3dc9d112,0x3dbc17d9,0x3dad1469,0x3d9ce11f
.long 0x3dc5e403,0x3db73a23,0x3da73656,0x3d95f6d9,0x3dc1d870,0x3db238aa,0x3da12ff9,0x3d8ee0db
.long 0x3dbdaef9,0x3dad1469,0x3d9b02c6,0x3d87a136,0x3db96842,0x3da7ce61,0x3d94b039,0x3d803a06
.long 0x3e000000,0x3e000000,0x3e000000,0x3e000000,0x3dffd397,0x3dffcbe2,0x3dffc38f,0x3dffba9e
.long 0x3dff4e6d,0x3dff2f9d,0x3dff0e58,0x3dfeea9d,0x3dfe70b0,0x3dfe2b72,0x3dfde0b1,0x3dfd906e
.long 0x3dfd3aac,0x3dfcbfc9,0x3dfc3b28,0x3dfbaccd,0x3dfbaccd,0x3dfaed37,0x3dfa1e84,0x3df940c0
.long 0x3df9c79d,0x3df8b47b,0x3df78bc5,0x3df64d97,0x3df78bc5,0x3df6167a,0x3df48422,0x3df2d4eb
.long 0x3df4fa0b,0x3df31447,0x3df10908,0x3deed89e,0x3df21352,0x3defaf1b,0x3ded1c1d,0x3dea5ad9
.long 0x3deed89e,0x3debe858,0x3de8bf3c,0x3de55e0b,0x3deb4b0c,0x3de7c187,0x3de3f473,0x3ddfe4e9
.long 0x3de76bd8,0x3de33c5a,0x3ddebe05,0x3dd9f26a,0x3de33c5a,0x3dde5aa6,0x3dd91e6a,0x3dd389c7
.long 0x3ddebe05,0x3dd91e6a,0x3dd31849,0x3dccae79,0x3dd9f26a,0x3dd389c7,0x3dccae79,0x3dc56439
.long 0x3dd4db31,0x3dcd9f02,0x3dc5e403,0x3dbdaef9,0x3dcf7a1f,0x3dc76085,0x3dbebc1b,0x3db592e7
.long 0x3dc9d112,0x3dc0d0da,0x3db73a23,0x3dad1469,0x3dc3e200,0x3db9f2ac,0x3daf61a5,0x3da4381a
.long 0x3dbdaef9,0x3db2c8c9,0x3da73656,0x3d9b02c6,0x3db73a23,0x3dab561b,0x3d9ebc12,0x3d91796b
.long 0x3db085bb,0x3da39da9,0x3d95f6d9,0x3d87a136,0x3da99415,0x3d9ba299,0x3d8cead0,0x3d7afef7
.long 0x3da26799,0x3d93682a,0x3d839c3d,0x3d663375,0x3d9b02c6,0x3d8af1b7,0x3d741f07,0x3d50eb2a
.long 0x3d93682a,0x3d8242b1,0x3d60924f,0x3d3b31a0,0x3d8b9a6b,0x3d72bd43,0x3d4c9b8b,0x3d25129f
.long 0x3d839c3d,0x3d60924f,0x3d38442a,0x3d0e9a22,0x3d76e0cb,0x3d4e0bea,0x3d2395c5,0x3cefa8b2
.long 0x3d663375,0x3d3b31a0,0x3d0e9a22,0x3cc19b37,0x3d553641,0x3d280b1f,0x3cf2b651,0x3c9324ca
.long 0x0,0x0,0x0,0x0,0x3b490ab0,0x3b622a7a,0x3b7b49ba,0x3b8a342f
.long 0x3bc8fb30,0x3be21469,0x3bfb2b74,0x3c0a200a,0x3c16a905,0x3c2973ba,0x3c3c3ac3,0x3c4efdb7
.long 0x3c48bd36,0x3c61bc2e,0x3c7ab273,0x3c89cf86,0x3c7ab273,0x3c8cec4a,0x3c9c76de,0x3cabf804
.long 0x3c964083,0x3ca8defc,0x3cbb6ecf,0x3ccdee60,0x3caf10a2,0x3cc4b0b9,0x3cda3997,0x3cefa8b2
.long 0x3cc7c5c2,0x3ce05c13,0x3cf8cfcc,0x3d088e93,0x3ce05c13,0x3cfbdba4,0x3d0b9507,0x3d1920fe
.long 0x3cf8cfcc,0x3d0b9507,0x3d1aa086,0x3d2986c4,0x3d088e93,0x3d1920fe,0x3d2986c4,0x3d39bb1e
.long 0x3d14a031,0x3d268f12,0x3d38442a,0x3d49b953,0x3d209ae5,0x3d33dca5,0x3d46d529,0x3d597cb9
.long 0x3d2c7cd4,0x3d41071e,0x3d553641,0x3d6900b7,0x3d38442a,0x3d4e0bea,0x3d6363fa,0x3d7840c8
.long 0x3d43ef15,0x3d5ae880,0x3d715aea,0x3d839c3d,0x3d4f7bca,0x3d679a5d,0x3d7f17b2,0x3d8af1b7
.long 0x3d5ae880,0x3d741f07,0x3d864b82,0x3d921eb0,0x3d663375,0x3d803a06,0x3d8cead0,0x3d99210f
.long 0x3d715aea,0x3d864b82,0x3d93682a,0x3d9ff6cb,0x3d7c5d27,0x3d8c42c9,0x3d99c200,0x3da69de3
.long 0x3d839c3d,0x3d921eb0,0x3d9ff6cb,0x3dad1469,0x3d88f59b,0x3d97de12,0x3da6050a,0x3db3587a
.long 0x3d8e39da,0x3d9d7fd1,0x3dabeb4a,0x3db96842,0x3d93682a,0x3da302d3,0x3db1a81d,0x3dbf41fc
.long 0x3d987fc0,0x3da86605,0x3db73a23,0x3dc4e3f5,0x3d9d7fd1,0x3dada859,0x3dbca003,0x3dca4c87
.long 0x3da26799,0x3db2c8c9,0x3dc1d870,0x3dcf7a1f,0x3da73656,0x3db7c655,0x3dc6e22a,0x3dd46b3b
.long 0x3dabeb4a,0x3dbca003,0x3dcbbbf8,0x3dd91e6a,0x3db085bb,0x3dc154e1,0x3dd064af,0x3ddd924d
.long 0x0,0x0,0x0,0x0,0x3b96c32c,0x3ba351cb,0x3bafe007,0x3bbc6dd5
.long 0x3c16a905,0x3c23308c,0x3c2fb680,0x3c3c3ac3,0x3c61bc2e,0x3c7475c0,0x3c839502,0x3c8cec4a
.long 0x3c964083,0x3ca2abb6,0x3caf10a2,0x3cbb6ecf,0x3cbb6ecf,0x3ccada4f,0x3cda3997,0x3ce98bba
.long 0x3ce05c13,0x3cf2b651,0x3d027dc0,0x3d0b9507,0x3d027dc0,0x3d0d17c0,0x3d17a117,0x3d221887
.long 0x3d14a031,0x3d209ae5,0x3d2c7cd4,0x3d38442a,0x3d268f12,0x3d33dca5,0x3d41071e,0x3d4e0bea
.long 0x3d38442a,0x3d46d529,0x3d553641,0x3d6363fa,0x3d49b953,0x3d597cb9,0x3d6900b7,0x3d7840c8
.long 0x3d5ae880,0x3d6bcbbb,0x3d7c5d27,0x3d864b82,0x3d6bcbbb,0x3d7dbabb,0x3d87a136,0x3d902dd5
.long 0x3d7c5d27,0x3d87a136,0x3d90d3cd,0x3d99c200,0x3d864b82,0x3d902dd5,0x3d99c200,0x3da302d3
.long 0x3d8e39da,0x3d987fc0,0x3da26799,0x3dabeb4a,0x3d95f6d9,0x3da09393,0x3daac082,0x3db4768f
.long 0x3d9d7fd1,0x3da86605,0x3db2c8c9,0x3dbca003,0x3da4d225,0x3daff3e6,0x3dba7ca4,0x3dc46337
.long 0x3dabeb4a,0x3db73a23,0x3dc1d870,0x3dcbbbf8,0x3db2c8c9,0x3dbe35c5,0x3dc8d8b3,0x3dd2a649
.long 0x3db96842,0x3dc4e3f5,0x3dcf7a1f,0x3dd91e6a,0x3dbfc767,0x3dcb41fa,0x3dd5b993,0x3ddf20db
.long 0x3dc5e403,0x3dd14d3d,0x3ddb941a,0x3de4aa59,0x3dcbbbf8,0x3dd70348,0x3de106f2,0x3de9b7e4
.long 0x3dd14d3d,0x3ddc61c7,0x3de60f88,0x3dee46be,0x3dd695e5,0x3de1668a,0x3deaab7b,0x3df25470
.long 0x3ddb941a,0x3de60f88,0x3deed89e,0x3df5dec6,0x3de04621,0x3dea5ad9,0x3df294f8,0x3df8e3d6
.long 0x3de4aa59,0x3dee46be,0x3df5dec6,0x3dfb61fc,0x3de8bf3c,0x3df1d19f,0x3df8b47b,0x3dfd57de
.long 0x3e000000,0x3e000000,0x3e000000,0x3e000000,0x3dffb10f,0x3dffa6e3,0x3dff9c18,0x3dff90b1
.long 0x3dfec46d,0x3dfe9bc9,0x3dfe70b0,0x3dfe4323,0x3dfd3aac,0x3dfcdf6c,0x3dfc7eb0,0x3dfc187a
.long 0x3dfb14be,0x3dfa7302,0x3df9c79d,0x3df91298,0x3df853f8,0x3df7583a,0x3df64d97,0x3df5341d
.long 0x3df4fa0b,0x3df3913f,0x3df21352,0x3df08066,0x3df10908,0x3def20b0,0x3ded1c1d,0x3deafb8c
.long 0x3dec835e,0x3dea09a7,0x3de76bd8,0x3de4aa59,0x3de76bd8,0x3de44fac,0x3de106f2,0x3ddd924d
.long 0x3de1c598,0x3dddf6be,0x3dd9f26a,0x3dd5b993,0x3ddb941a,0x3dd70348,0x3dd233c6,0x3dcd26fd
.long 0x3dd4db31,0x3dcf7a1f,0x3dc9d112,0x3dc3e200,0x3dcd9f02,0x3dc76085,0x3dc0d0da,0x3db9f2ac
.long 0x3dc5e403,0x3dbebc1b,0x3db73a23,0x3daf61a5,0x3dbdaef9,0x3db592e7,0x3dad1469,0x3da4381a
.long 0x3db504f3,0x3dabeb4a,0x3da26799,0x3d987fc0,0x3dabeb4a,0x3da1cbfb,0x3d973c07,0x3d8c42c9
.long 0x3da26799,0x3d973c07,0x3d8b9a6b,0x3d7f17b2,0x3d987fc0,0x3d8c42c9,0x3d7f17b2,0x3d64cbfe
.long 0x3d8e39da,0x3d80e7e4,0x3d663375,0x3d49b953,0x3d839c3d,0x3d6a6681,0x3d4c9b8b,0x3d2df73c
.long 0x3d715aea,0x3d525a09,0x3d3263ef,0x3d119ddd,0x3d5ae880,0x3d39bb1e,0x3d17a117,0x3ce98bba
.long 0x3d43ef15,0x3d209ae5,0x3cf8cfcc,0x3caf10a2,0x3d2c7cd4,0x3d070ada,0x3cc19b37,0x3c67fa9a
.long 0x3d14a031,0x3cda3997,0x3c89cf86,0x3be21469,0x3cf8cfcc,0x3ca5c58c,0x3c23308c,0xb9c90fc6
.long 0x3cc7c5c2,0x3c61bc2e,0x3b490ab0,0xbbfb2b74,0x3c964083,0x3beea038,0xbb7b49ba,0xbc7475c0
.long 0x3c48bd36,0x3a490f88,0xbc2fb680,0xbcb54098,0x3bc8fb30,0xbbbc6dd5,0xbc9008b7,0xbcefa8b2
.long 0x3e000000,0x3e000000,0x3e000000,0x3e000000,0x3dff84ab,0x3dff7808,0x3dff6ac7,0x3dff5ce9
.long 0x3dfe1324,0x3dfde0b1,0x3dfdabcc,0x3dfd7474,0x3dfbaccd,0x3dfb3bab,0x3dfac516,0x3dfa4910
.long 0x3df853f8,0x3df78bc5,0x3df6ba07,0x3df5dec6,0x3df40bdd,0x3df2d4eb,0x3df18f57,0x3df03b37
.long 0x3deed89e,0x3ded1c1d,0x3deb4b0c,0x3de96591,0x3de8bf3c,0x3de66771,0x3de3f473,0x3de1668a
.long 0x3de1c598,0x3ddebe05,0x3ddb941a,0x3dd84853,0x3dd9f26a,0x3dd627fe,0x3dd233c6,0x3dce1689
.long 0x3dd14d3d,0x3dccae79,0x3dc7de65,0x3dc2de29,0x3dc7de65,0x3dc25b89,0x3dbca003,0x3db6ad7f
.long 0x3dbdaef9,0x3db73a23,0x3db085bb,0x3da99415,0x3db2c8c9,0x3dab561b,0x3da39da9,0x3d9ba299
.long 0x3da73656,0x3d9ebc12,0x3d95f6d9,0x3d8cead0,0x3d9b02c6,0x3d91796b,0x3d87a136,0x3d7afef7
.long 0x3d8e39da,0x3d839c3d,0x3d715aea,0x3d5ae880,0x3d80e7e4,0x3d6a6681,0x3d525a09,0x3d39bb1e
.long 0x3d663375,0x3d4c9b8b,0x3d3263ef,0x3d17a117,0x3d49b953,0x3d2df73c,0x3d119ddd,0x3ce98bba
.long 0x3d2c7cd4,0x3d0e9a22,0x3ce05c13,0x3ca2abb6,0x3d0e9a22,0x3cdd4b1a,0x3c9c76de,0x3c35f8da
.long 0x3ce05c13,0x3c9c76de,0x3c2fb680,0x3b16c9b6,0x3ca2abb6,0x3c35f8da,0x3b16c9b6,0xbbd5880e
.long 0x3c48bd36,0x3b490ab0,0xbbc8fb30,0xbc7ab273,0x3b96c32c,0xbba351cb,0xbc6e3876,0xbcc4b0b9
.long 0xbb490ab0,0xbc553db9,0xbcbb6ecf,0xbd0586ce,0xbc2fb680,0xbcabf804,0xbcfee6e1,0xbd280b1f
.long 0xbc964083,0xbcec9a7f,0xbd209ae5,0xbd49b953,0xbcd41501,0xbd1620d2,0xbd41071e,0xbd6a6681
.long 0xbd088e93,0xbd3554ec,0xbd60924f,0xbd84f484,0xbd268f12,0xbd53c867,0xbd7f17b2,0xbd940c5f
.long 0x0,0x0,0x0,0x0,0x3bc8fb30,0x3bd5880e,0x3be21469,0x3beea038
.long 0x3c48bd36,0x3c553db9,0x3c61bc2e,0x3c6e3876,0x3c964083,0x3c9f917b,0x3ca8defc,0x3cb228d4
.long 0x3cc7c5c2,0x3cd41501,0x3ce05c13,0x3cec9a7f,0x3cf8cfcc,0x3d040270,0x3d0b9507,0x3d131f35
.long 0x3d14a031,0x3d1d9e78,0x3d268f12,0x3d2f713a,0x3d2c7cd4,0x3d36ccc3,0x3d41071e,0x3d4b2aae
.long 0x3d43ef15,0x3d4f7bca,0x3d5ae880,0x3d663375,0x3d5ae880,0x3d679a5d,0x3d741f07,0x3d803a06
.long 0x3d715aea,0x3d7f17b2,0x3d864b82,0x3d8cead0,0x3d839c3d,0x3d8af1b7,0x3d921eb0,0x3d99210f
.long 0x3d8e39da,0x3d95f6d9,0x3d9d7fd1,0x3da4d225,0x3d987fc0,0x3da09393,0x3da86605,0x3daff3e6
.long 0x3da26799,0x3daac082,0x3db2c8c9,0x3dba7ca4,0x3dabeb4a,0x3db4768f,0x3dbca003,0x3dc46337
.long 0x3db504f3,0x3dbdaef9,0x3dc5e403,0x3dcd9f02,0x3dbdaef9,0x3dc66354,0x3dce8d90,0x3dd627fe
.long 0x3dc5e403,0x3dce8d90,0x3dd695e5,0x3dddf6be,0x3dcd9f02,0x3dd627fe,0x3dddf6be,0x3de50479
.long 0x3dd4db31,0x3ddd2d53,0x3de4aa59,0x3deb4b0c,0x3ddb941a,0x3de398ac,0x3deaab7b,0x3df0c501
.long 0x3de1c598,0x3de96591,0x3deff573,0x3df56d97,0x3de76bd8,0x3dee8ff8,0x3df48422,0x3df940c0
.long 0x3dec835e,0x3df31447,0x3df853f8,0x3dfc3b28,0x3df10908,0x3df6ef5b,0x3dfb61fc,0x3dfe5a38
.long 0x3df4fa0b,0x3dfa1e84,0x3dfdabcc,0x3dff9c18,0x3df853f8,0x3dfc9f8a,0x3dff2f9d,0x3dffffb1
.long 0x3dfb14be,0x3dfe70b0,0x3dffec43,0x3dff84ab,0x3dfd3aac,0x3dff90b1,0x3dffe129,0x3dfe2b72
.long 0x3dfec46d,0x3dfffec4,0x3dff0e58,0x3dfbf531,0x3dffb10f,0x3dffba9e,0x3dfd7474,0x3df8e3d6
.long 0x0,0x0,0x0,0x0,0x3bfb2b74,0x3c03db0a,0x3c0a200a,0x3c1064b4
.long 0x3c7ab273,0x3c839502,0x3c89cf86,0x3c9008b7,0x3cbb6ecf,0x3cc4b0b9,0x3ccdee60,0x3cd7278f
.long 0x3cf8cfcc,0x3d027dc0,0x3d088e93,0x3d0e9a22,0x3d1aa086,0x3d221887,0x3d2986c4,0x3d30eacb
.long 0x3d38442a,0x3d41071e,0x3d49b953,0x3d525a09,0x3d553641,0x3d5f28a9,0x3d6900b7,0x3d72bd43
.long 0x3d715aea,0x3d7c5d27,0x3d839c3d,0x3d88f59b,0x3d864b82,0x3d8c42c9,0x3d921eb0,0x3d97de12
.long 0x3d93682a,0x3d99c200,0x3d9ff6cb,0x3da6050a,0x3d9ff6cb,0x3da69de3,0x3dad1469,0x3db3587a
.long 0x3dabeb4a,0x3db2c8c9,0x3db96842,0x3dbfc767,0x3db73a23,0x3dbe35c5,0x3dc4e3f5,0x3dcb41fa
.long 0x3dc1d870,0x3dc8d8b3,0x3dcf7a1f,0x3dd5b993,0x3dcbbbf8,0x3dd2a649,0x3dd91e6a,0x3ddf20db
.long 0x3dd4db31,0x3ddb941a,0x3de1c598,0x3de76bd8,0x3ddd2d53,0x3de398ac,0x3de96591,0x3dee8ff8
.long 0x3de4aa59,0x3deaab7b,0x3deff573,0x3df48422,0x3deb4b0c,0x3df0c501,0x3df56d97,0x3df940c0
.long 0x3df10908,0x3df5dec6,0x3df9c79d,0x3dfcbfc9,0x3df5dec6,0x3df9f35e,0x3dfcfe73,0x3dfefcc9
.long 0x3df9c79d,0x3dfcfe73,0x3dff0e58,0x3dfff4e6,0x3dfcbfc9,0x3dfefcc9,0x3dfff4e6,0x3dffa6e3
.long 0x3dfec46d,0x3dffec43,0x3dffb10f,0x3dfe1324,0x3dffd397,0x3dffcbe2,0x3dfe4323,0x3dfb3bab
.long 0x3dffec43,0x3dfe9bc9,0x3dfbaccd,0x3df72417,0x3dff0e58,0x3dfc5d3a,0x3df7f110,0x3df1d19f
.long 0x3dfd3aac,0x3df91298,0x3df31447,0x3deb4b0c,0x3dfa7302,0x3df4bf62,0x3ded1c1d,0x3de398ac
.long 0x3df6ba07,0x3def6830,0x3de60f88,0x3ddac450,0x3df21352,0x3de912ae,0x3dddf6be,0x3dd0d937
.long 0x3e000000,0x3e000000,0x3e000000,0x3e000000,0x3dff4e6d,0x3dff3f54,0x3dff2f9d,0x3dff1f49
.long 0x3dfd3aac,0x3dfcfe73,0x3dfcbfc9,0x3dfc7eb0,0x3df9c79d,0x3df940c0,0x3df8b47b,0x3df822d1
.long 0x3df4fa0b,0x3df40bdd,0x3df31447,0x3df21352,0x3deed89e,0x3ded67a1,0x3debe858,0x3dea5ad9
.long 0x3de76bd8,0x3de55e0b,0x3de33c5a,0x3de106f2,0x3ddebe05,0x3ddbfb34,0x3dd91e6a,0x3dd627fe
.long 0x3dd4db31,0x3dd14d3d,0x3dcd9f02,0x3dc9d112,0x3dc9d112,0x3dc56439,0x3dc0d0da,0x3dbc17d9
.long 0x3dbdaef9,0x3db85216,0x3db2c8c9,0x3dad1469,0x3db085bb,0x3daa2a80,0x3da39da9,0x3d9ce11f
.long 0x3da26799,0x3d9b02c6,0x3d93682a,0x3d8b9a6b,0x3d93682a,0x3d8af1b7,0x3d8242b1,0x3d72bd43
.long 0x3d839c3d,0x3d741f07,0x3d60924f,0x3d4c9b8b,0x3d663375,0x3d50eb2a,0x3d3b31a0,0x3d25129f
.long 0x3d43ef15,0x3d2c7cd4,0x3d14a031,0x3cf8cfcc,0x3d209ae5,0x3d070ada,0x3cda3997,0x3ca5c58c
.long 0x3cf8cfcc,0x3cc19b37,0x3c89cf86,0x3c23308c,0x3caf10a2,0x3c67fa9a,0x3be21469,0xb9c90fc6
.long 0x3c48bd36,0x3b96c32c,0xbb490ab0,0xbc2fb680,0x3b490ab0,0xbba351cb,0xbc553db9,0xbcabf804
.long 0xbbc8fb30,0xbc6e3876,0xbcbb6ecf,0xbcfee6e1,0xbc7ab273,0xbcc4b0b9,0xbd0586ce,0xbd280b1f
.long 0xbcc7c5c2,0xbd088e93,0xbd2c7cd4,0xbd4f7bca,0xbd088e93,0xbd2df73c,0xbd525a09,0xbd758035
.long 0xbd2c7cd4,0xbd525a09,0xbd76e0cb,0xbd8cead0,0xbd4f7bca,0xbd758035,0xbd8cead0,0xbd9e1e22
.long 0xbd715aea,0xbd8b9a6b,0xbd9d7fd1,0xbdae3bde,0xbd88f59b,0xbd9ba299,0xbdad1469,0xbdbd27b8
.long 0xbd987fc0,0xbdaac082,0xbdbb8f3b,0xbdcac77f,0xbda73656,0xbdb8dd65,0xbdc8d8b3,0xbdd70348
.long 0x3e000000,0x3e000000,0x3e000000,0x3e000000,0x3dff0e58,0x3dfefcc9,0x3dfeea9d,0x3dfed7d4
.long 0x3dfc3b28,0x3dfbf531,0x3dfbaccd,0x3dfb61fc,0x3df78bc5,0x3df6ef5b,0x3df64d97,0x3df5a67b
.long 0x3df10908,0x3deff573,0x3deed89e,0x3dedb293,0x3de8bf3c,0x3de71599,0x3de55e0b,0x3de398ac
.long 0x3ddebe05,0x3ddc61c7,0x3dd9f26a,0x3dd77026,0x3dd31849,0x3dcfefa8,0x3dccae79,0x3dc95521
.long 0x3dc5e403,0x3dc1d870,0x3dbdaef9,0x3db96842,0x3db73a23,0x3db238aa,0x3dad1469,0x3da7ce61
.long 0x3da73656,0x3da12ff9,0x3d9b02c6,0x3d94b039,0x3d95f6d9,0x3d8ee0db,0x3d87a136,0x3d803a06
.long 0x3d839c3d,0x3d76e0cb,0x3d663375,0x3d553641,0x3d60924f,0x3d4e0bea,0x3d3b31a0,0x3d280b1f
.long 0x3d38442a,0x3d2395c5,0x3d0e9a22,0x3cf2b651,0x3d0e9a22,0x3cefa8b2,0x3cc19b37,0x3c9324ca
.long 0x3cc7c5c2,0x3c964083,0x3c48bd36,0x3bc8fb30,0x3c61bc2e,0x3beea038,0x3a490f88,0xbbbc6dd5
.long 0x3b490ab0,0xbb7b49ba,0xbc2fb680,0xbc9008b7,0xbbfb2b74,0xbc7475c0,0xbcb54098,0xbcefa8b2
.long 0xbc964083,0xbcd41501,0xbd088e93,0xbd268f12,0xbcec9a7f,0xbd1620d2,0xbd3554ec,0xbd53c867
.long 0xbd209ae5,0xbd41071e,0xbd60924f,0xbd7f17b2,0xbd49b953,0xbd6a6681,0xbd84f484,0xbd940c5f
.long 0xbd715aea,0xbd88f59b,0xbd987fc0,0xbda73656,0xbd8b9a6b,0xbd9ba299,0xbdaac082,0xbdb8dd65
.long 0xbd9d7fd1,0xbdad1469,0xbdbb8f3b,0xbdc8d8b3,0xbdae3bde,0xbdbd27b8,0xbdcac77f,0xbdd70348
.long 0xbdbdaef9,0xbdcbbbf8,0xbdd84853,0xbde33c5a,0xbdcbbbf8,0xbdd8b3a1,0xbde3f473,0xbded67a1
.long 0xbdd84853,0xbde3f473,0xbdedb293,0xbdf56d97,0xbde33c5a,0xbded67a1,0xbdf56d97,0xbdfb3bab
.long 0x0,0x0,0x0,0x0,0x3c16a905,0x3c1cecf9,0x3c23308c,0x3c2973ba
.long 0x3c964083,0x3c9c76de,0x3ca2abb6,0x3ca8defc,0x3ce05c13,0x3ce98bba,0x3cf2b651,0x3cfbdba4
.long 0x3d14a031,0x3d1aa086,0x3d209ae5,0x3d268f12,0x3d38442a,0x3d3f926f,0x3d46d529,0x3d4e0bea
.long 0x3d5ae880,0x3d6363fa,0x3d6bcbbb,0x3d741f07,0x3d7c5d27,0x3d82ef9f,0x3d87a136,0x3d8c42c9
.long 0x3d8e39da,0x3d93682a,0x3d987fc0,0x3d9d7fd1,0x3d9d7fd1,0x3da302d3,0x3da86605,0x3dada859
.long 0x3dabeb4a,0x3db1a81d,0x3db73a23,0x3dbca003,0x3db96842,0x3dbf41fc,0x3dc4e3f5,0x3dca4c87
.long 0x3dc5e403,0x3dcbbbf8,0x3dd14d3d,0x3dd695e5,0x3dd14d3d,0x3dd70348,0x3ddc61c7,0x3de1668a
.long 0x3ddb941a,0x3de106f2,0x3de60f88,0x3deaab7b,0x3de4aa59,0x3de9b7e4,0x3dee46be,0x3df25470
.long 0x3dec835e,0x3df10908,0x3df4fa0b,0x3df853f8,0x3df31447,0x3df6ef5b,0x3dfa1e84,0x3dfc9f8a
.long 0x3df853f8,0x3dfb61fc,0x3dfdabcc,0x3dff2f9d,0x3dfc3b28,0x3dfe5a38,0x3dff9c18,0x3dffffb1
.long 0x3dfec46d,0x3dffd397,0x3dffec43,0x3dff0e58,0x3dffec43,0x3dffcbe2,0x3dfe9bc9,0x3dfc5d3a
.long 0x3dffb10f,0x3dfe4323,0x3dfbaccd,0x3df7f110,0x3dfe1324,0x3dfb3bab,0x3df72417,0x3df1d19f
.long 0x3dfb14be,0x3df6ba07,0x3df10908,0x3dea09a7,0x3df6ba07,0x3df0c501,0x3de96591,0x3de0a6cf
.long 0x3df10908,0x3de96591,0x3de04621,0x3dd5b993,0x3dea09a7,0x3de0a6cf,0x3dd5b993,0x3dc95521
.long 0x3de1c598,0x3dd695e5,0x3dc9d112,0x3dbb8f3b,0x3dd84853,0x3dcb41fa,0x3dbca003,0x3dac800f
.long 0x3dcd9f02,0x3dbebc1b,0x3dae3bde,0x3d9c420c,0x3dc1d870,0x3db11722,0x3d9ebc12,0x3d8af1b7
.long 0x0,0x0,0x0,0x0,0x3c2fb680,0x3c35f8da,0x3c3c3ac3,0x3c427c39
.long 0x3caf10a2,0x3cb54098,0x3cbb6ecf,0x3cc19b37,0x3d027dc0,0x3d070ada,0x3d0b9507,0x3d101c2c
.long 0x3d2c7cd4,0x3d3263ef,0x3d38442a,0x3d3e1d4a,0x3d553641,0x3d5c53c1,0x3d6363fa,0x3d6a6681
.long 0x3d7c5d27,0x3d8242b1,0x3d864b82,0x3d8a48ad,0x3d90d3cd,0x3d9553b7,0x3d99c200,0x3d9e1e22
.long 0x3da26799,0x3da73656,0x3dabeb4a,0x3db085bb,0x3db2c8c9,0x3db7c655,0x3dbca003,0x3dc154e1
.long 0x3dc1d870,0x3dc6e22a,0x3dcbbbf8,0x3dd064af,0x3dcf7a1f,0x3dd46b3b,0x3dd91e6a,0x3ddd924d
.long 0x3ddb941a,0x3de04621,0x3de4aa59,0x3de8bf3c,0x3de60f88,0x3dea5ad9,0x3dee46be,0x3df1d19f
.long 0x3deed89e,0x3df294f8,0x3df5dec6,0x3df8b47b,0x3df5dec6,0x3df8e3d6,0x3dfb61fc,0x3dfd57de
.long 0x3dfb14be,0x3dfd3aac,0x3dfec46d,0x3dffb10f,0x3dfe70b0,0x3dff90b1,0x3dfffec4,0x3dffba9e
.long 0x3dffec43,0x3dffe129,0x3dff0e58,0x3dfd7474,0x3dff84ab,0x3dfe2b72,0x3dfbf531,0x3df8e3d6
.long 0x3dfd3aac,0x3dfa7302,0x3df6ba07,0x3df21352,0x3df91298,0x3df4bf62,0x3def6830,0x3de912ae
.long 0x3df31447,0x3ded1c1d,0x3de60f88,0x3dddf6be,0x3deb4b0c,0x3de398ac,0x3ddac450,0x3dd0d937
.long 0x3de1c598,0x3dd84853,0x3dcd9f02,0x3dc1d870,0x3dd695e5,0x3dcb41fa,0x3dbebc1b,0x3db11722
.long 0x3dc9d112,0x3dbca003,0x3dae3bde,0x3d9ebc12,0x3dbb8f3b,0x3dac800f,0x3d9c420c,0x3d8af1b7
.long 0x3dabeb4a,0x3d9b02c6,0x3d88f59b,0x3d6bcbbb,0x3d9b02c6,0x3d884b92,0x3d6900b7,0x3d3f926f
.long 0x3d88f59b,0x3d6900b7,0x3d3e1d4a,0x3d119ddd,0x3d6bcbbb,0x3d3f926f,0x3d119ddd,0x3cc4b0b9
.long 0x3e000000,0x3dfec46d,0x3dfb14be,0x3df4fa0b,0x3e000000,0x3dfeb069,0x3dfac516,0x3df4484b
.long 0x3e000000,0x3dfe9bc9,0x3dfa7302,0x3df3913f,0x3e000000,0x3dfe868b,0x3dfa1e84,0x3df2d4eb
.long 0x3e000000,0x3dfe70b0,0x3df9c79d,0x3df21352,0x3e000000,0x3dfe5a38,0x3df96e4e,0x3df14c7a
.long 0x3e000000,0x3dfe4323,0x3df91298,0x3df08066,0x3e000000,0x3dfe2b72,0x3df8b47b,0x3defaf1b
.long 0x3e000000,0x3dfe1324,0x3df853f8,0x3deed89e,0x3e000000,0x3dfdfa38,0x3df7f110,0x3dedfcf2
.long 0x3e000000,0x3dfde0b1,0x3df78bc5,0x3ded1c1d,0x3e000000,0x3dfdc68c,0x3df72417,0x3dec3624
.long 0x3e000000,0x3dfdabcc,0x3df6ba07,0x3deb4b0c,0x3e000000,0x3dfd906e,0x3df64d97,0x3dea5ad9
.long 0x3e000000,0x3dfd7474,0x3df5dec6,0x3de96591,0x3e000000,0x3dfd57de,0x3df56d97,0x3de86b39
.long 0x3e000000,0x3dfd3aac,0x3df4fa0b,0x3de76bd8,0x3e000000,0x3dfd1cdd,0x3df48422,0x3de66771
.long 0x3e000000,0x3dfcfe73,0x3df40bdd,0x3de55e0b,0x3e000000,0x3dfcdf6c,0x3df3913f,0x3de44fac
.long 0x3e000000,0x3dfcbfc9,0x3df31447,0x3de33c5a,0x3e000000,0x3dfc9f8a,0x3df294f8,0x3de2241a
.long 0x3e000000,0x3dfc7eb0,0x3df21352,0x3de106f2,0x3e000000,0x3dfc5d3a,0x3df18f57,0x3ddfe4e9
.long 0x3e000000,0x3dfc3b28,0x3df10908,0x3ddebe05,0x3e000000,0x3dfc187a,0x3df08066,0x3ddd924d
.long 0x3e000000,0x3dfbf531,0x3deff573,0x3ddc61c7,0x3e000000,0x3dfbd14d,0x3def6830,0x3ddb2c79
.long 0x3e000000,0x3dfbaccd,0x3deed89e,0x3dd9f26a,0x3e000000,0x3dfb87b2,0x3dee46be,0x3dd8b3a1
.long 0x3e000000,0x3dfb61fc,0x3dedb293,0x3dd77026,0x3e000000,0x3dfb3bab,0x3ded1c1d,0x3dd627fe
.long 0x3dec835e,0x3de1c598,0x3dd4db31,0x3dc5e403,0x3deb4b0c,0x3ddfe4e9,0x3dd233c6,0x3dc25b89
.long 0x3dea09a7,0x3dddf6be,0x3dcf7a1f,0x3dbebc1b,0x3de8bf3c,0x3ddbfb34,0x3dccae79,0x3dbb0629
.long 0x3de76bd8,0x3dd9f26a,0x3dc9d112,0x3db73a23,0x3de60f88,0x3dd7dc7f,0x3dc6e22a,0x3db3587a
.long 0x3de4aa59,0x3dd5b993,0x3dc3e200,0x3daf61a5,0x3de33c5a,0x3dd389c7,0x3dc0d0da,0x3dab561b
.long 0x3de1c598,0x3dd14d3d,0x3dbdaef9,0x3da73656,0x3de04621,0x3dcf0417,0x3dba7ca4,0x3da302d3
.long 0x3ddebe05,0x3dccae79,0x3db73a23,0x3d9ebc12,0x3ddd2d53,0x3dca4c87,0x3db3e7bc,0x3d9a6293
.long 0x3ddb941a,0x3dc7de65,0x3db085bb,0x3d95f6d9,0x3dd9f26a,0x3dc56439,0x3dad1469,0x3d91796b
.long 0x3dd84853,0x3dc2de29,0x3da99415,0x3d8cead0,0x3dd695e5,0x3dc04c5c,0x3da6050a,0x3d884b92
.long 0x3dd4db31,0x3dbdaef9,0x3da26799,0x3d839c3d,0x3dd31849,0x3dbb0629,0x3d9ebc12,0x3d7dbabb
.long 0x3dd14d3d,0x3db85216,0x3d9b02c6,0x3d741f07,0x3dcf7a1f,0x3db592e7,0x3d973c07,0x3d6a6681
.long 0x3dcd9f02,0x3db2c8c9,0x3d93682a,0x3d60924f,0x3dcbbbf8,0x3daff3e6,0x3d8f8784,0x3d56a399
.long 0x3dc9d112,0x3dad1469,0x3d8b9a6b,0x3d4c9b8b,0x3dc7de65,0x3daa2a80,0x3d87a136,0x3d427b55
.long 0x3dc5e403,0x3da73656,0x3d839c3d,0x3d38442a,0x3dc3e200,0x3da4381a,0x3d7f17b2,0x3d2df73c
.long 0x3dc1d870,0x3da12ff9,0x3d76e0cb,0x3d2395c5,0x3dbfc767,0x3d9e1e22,0x3d6e9479,0x3d1920fe
.long 0x3dbdaef9,0x3d9b02c6,0x3d663375,0x3d0e9a22,0x3dbb8f3b,0x3d97de12,0x3d5dbe79,0x3d040270
.long 0x3db96842,0x3d94b039,0x3d553641,0x3cf2b651,0x3db73a23,0x3d91796b,0x3d4c9b8b,0x3cdd4b1a
.long 0x0,0x3c48bd36,0x3cc7c5c2,0x3d14a031,0x0,0x3c4efdb7,0x3ccdee60,0x3d1920fe
.long 0x0,0x3c553db9,0x3cd41501,0x3d1d9e78,0x0,0x3c5b7d37,0x3cda3997,0x3d221887
.long 0x0,0x3c61bc2e,0x3ce05c13,0x3d268f12,0x0,0x3c67fa9a,0x3ce67c66,0x3d2b0201
.long 0x0,0x3c6e3876,0x3cec9a7f,0x3d2f713a,0x0,0x3c7475c0,0x3cf2b651,0x3d33dca5
.long 0x0,0x3c7ab273,0x3cf8cfcc,0x3d38442a,0x0,0x3c807745,0x3cfee6e1,0x3d3ca7af
.long 0x0,0x3c839502,0x3d027dc0,0x3d41071e,0x0,0x3c86b26e,0x3d0586ce,0x3d45625c
.long 0x0,0x3c89cf86,0x3d088e93,0x3d49b953,0x0,0x3c8cec4a,0x3d0b9507,0x3d4e0bea
.long 0x0,0x3c9008b7,0x3d0e9a22,0x3d525a09,0x0,0x3c9324ca,0x3d119ddd,0x3d56a399
.long 0x0,0x3c964083,0x3d14a031,0x3d5ae880,0x0,0x3c995be0,0x3d17a117,0x3d5f28a9
.long 0x0,0x3c9c76de,0x3d1aa086,0x3d6363fa,0x0,0x3c9f917b,0x3d1d9e78,0x3d679a5d
.long 0x0,0x3ca2abb6,0x3d209ae5,0x3d6bcbbb,0x0,0x3ca5c58c,0x3d2395c5,0x3d6ff7fb
.long 0x0,0x3ca8defc,0x3d268f12,0x3d741f07,0x0,0x3cabf804,0x3d2986c4,0x3d7840c8
.long 0x0,0x3caf10a2,0x3d2c7cd4,0x3d7c5d27,0x0,0x3cb228d4,0x3d2f713a,0x3d803a06
.long 0x0,0x3cb54098,0x3d3263ef,0x3d8242b1,0x0,0x3cb857ec,0x3d3554ec,0x3d844889
.long 0x0,0x3cbb6ecf,0x3d38442a,0x3d864b82,0x0,0x3cbe853e,0x3d3b31a0,0x3d884b92
.long 0x0,0x3cc19b37,0x3d3e1d4a,0x3d8a48ad,0x0,0x3cc4b0b9,0x3d41071e,0x3d8c42c9
.long 0x3d43ef15,0x3d715aea,0x3d8e39da,0x3da26799,0x3d49b953,0x3d7840c8,0x3d921eb0,0x3da69de3
.long 0x3d4f7bca,0x3d7f17b2,0x3d95f6d9,0x3daac082,0x3d553641,0x3d82ef9f,0x3d99c200,0x3daecef7
.long 0x3d5ae880,0x3d864b82,0x3d9d7fd1,0x3db2c8c9,0x3d60924f,0x3d899f4e,0x3da12ff9,0x3db6ad7f
.long 0x3d663375,0x3d8cead0,0x3da4d225,0x3dba7ca4,0x3d6bcbbb,0x3d902dd5,0x3da86605,0x3dbe35c5
.long 0x3d715aea,0x3d93682a,0x3dabeb4a,0x3dc1d870,0x3d76e0cb,0x3d96999f,0x3daf61a5,0x3dc56439
.long 0x3d7c5d27,0x3d99c200,0x3db2c8c9,0x3dc8d8b3,0x3d80e7e4,0x3d9ce11f,0x3db6206c,0x3dcc3578
.long 0x3d839c3d,0x3d9ff6cb,0x3db96842,0x3dcf7a1f,0x3d864b82,0x3da302d3,0x3dbca003,0x3dd2a649
.long 0x3d88f59b,0x3da6050a,0x3dbfc767,0x3dd5b993,0x3d8b9a6b,0x3da8fd41,0x3dc2de29,0x3dd8b3a1
.long 0x3d8e39da,0x3dabeb4a,0x3dc5e403,0x3ddb941a,0x3d90d3cd,0x3daecef7,0x3dc8d8b3,0x3dde5aa6
.long 0x3d93682a,0x3db1a81d,0x3dcbbbf8,0x3de106f2,0x3d95f6d9,0x3db4768f,0x3dce8d90,0x3de398ac
.long 0x3d987fc0,0x3db73a23,0x3dd14d3d,0x3de60f88,0x3d9b02c6,0x3db9f2ac,0x3dd3fac3,0x3de86b39
.long 0x3d9d7fd1,0x3dbca003,0x3dd695e5,0x3deaab7b,0x3d9ff6cb,0x3dbf41fc,0x3dd91e6a,0x3decd007
.long 0x3da26799,0x3dc1d870,0x3ddb941a,0x3deed89e,0x3da4d225,0x3dc46337,0x3dddf6be,0x3df0c501
.long 0x3da73656,0x3dc6e22a,0x3de04621,0x3df294f8,0x3da99415,0x3dc95521,0x3de28210,0x3df4484b
.long 0x3dabeb4a,0x3dcbbbf8,0x3de4aa59,0x3df5dec6,0x3dae3bde,0x3dce1689,0x3de6becc,0x3df7583a
.long 0x3db085bb,0x3dd064af,0x3de8bf3c,0x3df8b47b,0x3db2c8c9,0x3dd2a649,0x3deaab7b,0x3df9f35e
.long 0x3db504f3,0x3da26799,0x3d8e39da,0x3d715aea,0x3db085bb,0x3d9ce11f,0x3d87a136,0x3d61fb6a
.long 0x3dabeb4a,0x3d973c07,0x3d80e7e4,0x3d525a09,0x3da73656,0x3d91796b,0x3d741f07,0x3d427b55
.long 0x3da26799,0x3d8b9a6b,0x3d663375,0x3d3263ef,0x3d9d7fd1,0x3d85a02c,0x3d58106b,0x3d221887
.long 0x3d987fc0,0x3d7f17b2,0x3d49b953,0x3d119ddd,0x3d93682a,0x3d72bd43,0x3d3b31a0,0x3d00f8c0
.long 0x3d8e39da,0x3d663375,0x3d2c7cd4,0x3ce05c13,0x3d88f59b,0x3d597cb9,0x3d1d9e78,0x3cbe853e
.long 0x3d839c3d,0x3d4c9b8b,0x3d0e9a22,0x3c9c76de,0x3d7c5d27,0x3d3f926f,0x3cfee6e1,0x3c7475c0
.long 0x3d715aea,0x3d3263ef,0x3ce05c13,0x3c2fb680,0x3d663375,0x3d25129f,0x3cc19b37,0x3bd5880e
.long 0x3d5ae880,0x3d17a117,0x3ca2abb6,0x3b16c9b6,0x3d4f7bca,0x3d0a11f7,0x3c839502,0xbafb514b
.long 0x3d43ef15,0x3cf8cfcc,0x3c48bd36,0xbbc8fb30,0x3d38442a,0x3cdd4b1a,0x3c0a200a,0xbc2973ba
.long 0x3d2c7cd4,0x3cc19b37,0x3b96c32c,0xbc6e3876,0x3d209ae5,0x3ca5c58c,0x3a490f88,0xbc995be0
.long 0x3d14a031,0x3c89cf86,0xbb490ab0,0xbcbb6ecf,0x3d088e93,0x3c5b7d37,0xbbe21469,0xbcdd4b1a
.long 0x3cf8cfcc,0x3c23308c,0xbc2fb680,0xbcfee6e1,0x3ce05c13,0x3bd5880e,0xbc6e3876,0xbd101c2c
.long 0x3cc7c5c2,0x3b490ab0,0xbc964083,0xbd209ae5,0x3caf10a2,0xb9c90fc6,0xbcb54098,0xbd30eacb
.long 0x3c964083,0xbb7b49ba,0xbcd41501,0xbd41071e,0x3c7ab273,0xbbeea038,0xbcf2b651,0xbd50eb2a
.long 0x3c48bd36,0xbc2fb680,0xbd088e93,0xbd60924f,0x3c16a905,0xbc67fa9a,0xbd17a117,0xbd6ff7fb
.long 0x3bc8fb30,0xbc9008b7,0xbd268f12,0xbd7f17b2,0x3b490ab0,0xbcabf804,0xbd3554ec,0xbd86f686
.long 0x3d43ef15,0x3d14a031,0x3cc7c5c2,0x3c48bd36,0x3d3263ef,0x3d00f8c0,0x3c9c76de,0x3bd5880e
.long 0x3d209ae5,0x3cda3997,0x3c61bc2e,0x3a490f88,0x3d0e9a22,0x3cb228d4,0x3c0a200a,0xbba351cb
.long 0x3cf8cfcc,0x3c89cf86,0x3b490ab0,0xbc2fb680,0x3cd41501,0x3c427c39,0xbb16c9b6,0xbc86b26e
.long 0x3caf10a2,0x3be21469,0xbbfb2b74,0xbcb54098,0x3c89cf86,0x3afb514b,0xbc553db9,0xbce36c83
.long 0x3c48bd36,0xbb490ab0,0xbc964083,0xbd088e93,0x3bfb2b74,0xbc03db0a,0xbcc19b37,0xbd1f1cdf
.long 0x3b490ab0,0xbc553db9,0xbcec9a7f,0xbd3554ec,0xbac90e90,0xbc9324ca,0xbd0b9507,0xbd4b2aae
.long 0xbbc8fb30,0xbcbb6ecf,0xbd209ae5,0xbd60924f,0xbc2fb680,0xbce36c83,0xbd3554ec,0xbd758035
.long 0xbc7ab273,0xbd0586ce,0xbd49b953,0xbd84f484,0xbca2abb6,0xbd1920fe,0xbd5dbe79,0xbd8ee0db
.long 0xbcc7c5c2,0xbd2c7cd4,0xbd715aea,0xbd987fc0,0xbcec9a7f,0xbd3f926f,0xbd8242b1,0xbda1cbfb
.long 0xbd088e93,0xbd525a09,0xbd8b9a6b,0xbdaac082,0xbd1aa086,0xbd64cbfe,0xbd94b039,0xbdb3587a
.long 0xbd2c7cd4,0xbd76e0cb,0xbd9d7fd1,0xbdbb8f3b,0xbd3e1d4a,0xbd844889,0xbda6050a,0xbdc36051
.long 0xbd4f7bca,0xbd8cead0,0xbdae3bde,0xbdcac77f,0xbd60924f,0xbd9553b7,0xbdb6206c,0xbdd1c0c2
.long 0xbd715aea,0xbd9d7fd1,0xbdbdaef9,0xbdd84853,0xbd80e7e4,0xbda56bcb,0xbdc4e3f5,0xbdde5aa6
.long 0xbd88f59b,0xbdad1469,0xbdcbbbf8,0xbde3f473,0xbd90d3cd,0xbdb4768f,0xbdd233c6,0xbde912ae
.long 0xbd987fc0,0xbdbb8f3b,0xbdd84853,0xbdedb293,0xbd9ff6cb,0xbdc25b89,0xbdddf6be,0xbdf1d19f
.long 0xbda73656,0xbdc8d8b3,0xbde33c5a,0xbdf56d97,0xbdae3bde,0xbdcf0417,0xbde816a8,0xbdf88486
.long 0x3db504f3,0x3dc5e403,0x3dd4db31,0x3de1c598,0x3db96842,0x3dca4c87,0x3dd91e6a,0x3de5b710
.long 0x3dbdaef9,0x3dce8d90,0x3ddd2d53,0x3de96591,0x3dc1d870,0x3dd2a649,0x3de106f2,0x3decd007
.long 0x3dc5e403,0x3dd695e5,0x3de4aa59,0x3deff573,0x3dc9d112,0x3dda5ba0,0x3de816a8,0x3df2d4eb
.long 0x3dcd9f02,0x3dddf6be,0x3deb4b0c,0x3df56d97,0x3dd14d3d,0x3de1668a,0x3dee46be,0x3df7beb7
.long 0x3dd4db31,0x3de4aa59,0x3df10908,0x3df9c79d,0x3dd84853,0x3de7c187,0x3df3913f,0x3dfb87b2
.long 0x3ddb941a,0x3deaab7b,0x3df5dec6,0x3dfcfe73,0x3ddebe05,0x3ded67a1,0x3df7f110,0x3dfe2b72
.long 0x3de1c598,0x3deff573,0x3df9c79d,0x3dff0e58,0x3de4aa59,0x3df25470,0x3dfb61fc,0x3dffa6e3
.long 0x3de76bd8,0x3df48422,0x3dfcbfc9,0x3dfff4e6,0x3dea09a7,0x3df6841b,0x3dfde0b1,0x3dfff84a
.long 0x3dec835e,0x3df853f8,0x3dfec46d,0x3dffb10f,0x3deed89e,0x3df9f35e,0x3dff6ac7,0x3dff1f49
.long 0x3df10908,0x3dfb61fc,0x3dffd397,0x3dfe4323,0x3df31447,0x3dfc9f8a,0x3dfffec4,0x3dfd1cdd
.long 0x3df4fa0b,0x3dfdabcc,0x3dffec43,0x3dfbaccd,0x3df6ba07,0x3dfe868b,0x3dff9c18,0x3df9f35e
.long 0x3df853f8,0x3dff2f9d,0x3dff0e58,0x3df7f110,0x3df9c79d,0x3dffa6e3,0x3dfe4323,0x3df5a67b
.long 0x3dfb14be,0x3dffec43,0x3dfd3aac,0x3df31447,0x3dfc3b28,0x3dffffb1,0x3dfbf531,0x3df03b37
.long 0x3dfd3aac,0x3dffe129,0x3dfa7302,0x3ded1c1d,0x3dfe1324,0x3dff90b1,0x3df8b47b,0x3de9b7e4
.long 0x3dfec46d,0x3dff0e58,0x3df6ba07,0x3de60f88,0x3dff4e6d,0x3dfe5a38,0x3df48422,0x3de2241a
.long 0x3dffb10f,0x3dfd7474,0x3df21352,0x3dddf6be,0x3dffec43,0x3dfc5d3a,0x3def6830,0x3dd988ad
.long 0x3dec835e,0x3df4fa0b,0x3dfb14be,0x3dfec46d,0x3deff573,0x3df7beb7,0x3dfcfe73,0x3dffa6e3
.long 0x3df31447,0x3dfa1e84,0x3dfe70b0,0x3dfffec4,0x3df5dec6,0x3dfc187a,0x3dff6ac7,0x3dffcbe2
.long 0x3df853f8,0x3dfdabcc,0x3dffec43,0x3dff0e58,0x3dfa7302,0x3dfed7d4,0x3dfff4e6,0x3dfdc68c
.long 0x3dfc3b28,0x3dff9c18,0x3dff84ab,0x3dfbf531,0x3dfdabcc,0x3dfff84a,0x3dfe9bc9,0x3df99b43
.long 0x3dfec46d,0x3dffec43,0x3dfd3aac,0x3df6ba07,0x3dff84ab,0x3dff7808,0x3dfb61fc,0x3df3530e
.long 0x3dffec43,0x3dfe9bc9,0x3df91298,0x3def6830,0x3dfffb11,0x3dfd57de,0x3df64d97,0x3deafb8c
.long 0x3dffb10f,0x3dfbaccd,0x3df31447,0x3de60f88,0x3dff0e58,0x3df99b43,0x3def6830,0x3de0a6cf
.long 0x3dfe1324,0x3df72417,0x3deb4b0c,0x3ddac450,0x3dfcbfc9,0x3df4484b,0x3de6becc,0x3dd46b3b
.long 0x3dfb14be,0x3df10908,0x3de1c598,0x3dcd9f02,0x3df91298,0x3ded67a1,0x3ddc61c7,0x3dc66354
.long 0x3df6ba07,0x3de96591,0x3dd695e5,0x3dbebc1b,0x3df40bdd,0x3de50479,0x3dd064af,0x3db6ad7f
.long 0x3df10908,0x3de04621,0x3dc9d112,0x3dae3bde,0x3dedb293,0x3ddb2c79,0x3dc2de29,0x3da56bcb
.long 0x3dea09a7,0x3dd5b993,0x3dbb8f3b,0x3d9c420c,0x3de60f88,0x3dcfefa8,0x3db3e7bc,0x3d92c39a
.long 0x3de1c598,0x3dc9d112,0x3dabeb4a,0x3d88f59b,0x3ddd2d53,0x3dc36051,0x3da39da9,0x3d7dbabb
.long 0x3dd84853,0x3dbca003,0x3d9b02c6,0x3d6900b7,0x3dd31849,0x3db592e7,0x3d921eb0,0x3d53c867
.long 0x3dcd9f02,0x3dae3bde,0x3d88f59b,0x3d3e1d4a,0x3dc7de65,0x3da69de3,0x3d7f17b2,0x3d280b1f
.long 0x3dc1d870,0x3d9ebc12,0x3d6bcbbb,0x3d119ddd,0x3dbb8f3b,0x3d96999f,0x3d58106b,0x3cf5c35a
.long 0x230d3132,0xbc48bd36,0xbcc7c5c2,0xbd14a031,0xbbc8fb30,0xbc995be0,0xbcfee6e1,0xbd30eacb
.long 0xbc48bd36,0xbccdee60,0xbd1aa086,0xbd4c9b8b,0xbc964083,0xbd00f8c0,0xbd3554ec,0xbd679a5d
.long 0xbcc7c5c2,0xbd1aa086,0xbd4f7bca,0xbd80e7e4,0xbcf8cfcc,0xbd33dca5,0xbd6900b7,0xbd8d9281
.long 0xbd14a031,0xbd4c9b8b,0xbd80e7e4,0xbd99c200,0xbd2c7cd4,0xbd64cbfe,0xbd8cead0,0xbda56bcb
.long 0xbd43ef15,0xbd7c5d27,0xbd987fc0,0xbdb085bb,0xbd5ae880,0xbd899f4e,0xbda39da9,0xbdbb0629
.long 0xbd715aea,0xbd94b039,0xbdae3bde,0xbdc4e3f5,0xbd839c3d,0xbd9f599f,0xbdb85216,0xbdce1689
.long 0xbd8e39da,0xbda99415,0xbdc1d870,0xbdd695e5,0xbd987fc0,0xbdb3587a,0xbdcac77f,0xbdde5aa6
.long 0xbda26799,0xbdbca003,0xbdd31849,0xbde55e0b,0xbdabeb4a,0xbdc56439,0xbddac450,0xbdeb99fb
.long 0xbdb504f3,0xbdcd9f02,0xbde1c598,0xbdf10908,0xbdbdaef9,0xbdd54aa4,0xbde816a8,0xbdf5a67b
.long 0xbdc5e403,0xbddc61c7,0xbdedb293,0xbdf96e4e,0xbdcd9f02,0xbde2df7b,0xbdf294f8,0xbdfc5d3a
.long 0xbdd4db31,0xbde8bf3c,0xbdf6ba07,0xbdfe70b0,0xbddb941a,0xbdedfcf2,0xbdfa1e84,0xbdffa6e3
.long 0xbde1c598,0xbdf294f8,0xbdfcbfc9,0xbdfffec4,0xbde76bd8,0xbdf6841b,0xbdfe9bc9,0xbdff7808
.long 0xbdec835e,0xbdf9c79d,0xbdffb10f,0xbdfe1324,0xbdf10908,0xbdfc5d3a,0xbdfffec4,0xbdfbd14d
.long 0xbdf4fa0b,0xbdfe4323,0xbdff84ab,0xbdf8b47b,0xbdf853f8,0xbdff7808,0xbdfe4323,0xbdf4bf62
.long 0xbdfb14be,0xbdfffb11,0xbdfc3b28,0xbdeff573,0xbdfd3aac,0xbdffcbe2,0xbdf96e4e,0xbdea5ad9
.long 0xbdfec46d,0xbdfeea9d,0xbdf5dec6,0xbde3f473,0xbdffb10f,0xbdfd57de,0xbdf18f57,0xbddcc7d1
.long 0xbd43ef15,0xbd715aea,0xbd8e39da,0xbda26799,0xbd60924f,0xbd86f686,0xbd9c420c,0xbdaff3e6
.long 0xbd7c5d27,0xbd94b039,0xbda99415,0xbdbca003,0xbd8b9a6b,0xbda1cbfb,0xbdb6206c,0xbdc85bca
.long 0xbd987fc0,0xbdae3bde,0xbdc1d870,0xbdd31849,0xbda4d225,0xbdb9f2ac,0xbdccae79,0xbddcc7d1
.long 0xbdb085bb,0xbdc4e3f5,0xbdd695e5,0xbde55e0b,0xbdbb8f3b,0xbdcf0417,0xbddf8327,0xbdecd007
.long 0xbdc5e403,0xbdd84853,0xbde76bd8,0xbdf31447,0xbdcf7a1f,0xbde0a6cf,0xbdee46be,0xbdf822d1
.long 0xbdd84853,0xbde816a8,0xbdf40bdd,0xbdfbf531,0xbde04621,0xbdee8ff8,0xbdf8b47b,0xbdfe868b
.long 0xbde76bd8,0xbdf40bdd,0xbdfc3b28,0xbdffd397,0xbdedb293,0xbdf88486,0xbdfe9bc9,0xbdffdaaf
.long 0xbdf31447,0xbdfbf531,0xbdffd397,0xbdfe9bc9,0xbdf78bc5,0xbdfe5a38,0xbdffe129,0xbdfc187a
.long 0xbdfb14be,0xbdffb10f,0xbdfec46d,0xbdf853f8,0xbdfdabcc,0xbdfff84a,0xbdfc7eb0,0xbdf3530e
.long 0xbdff4e6d,0xbdff2f9d,0xbdf91298,0xbded1c1d,0xbdfffb11,0xbdfd57de,0xbdf48422,0xbde5b710
.long 0xbdffb10f,0xbdfa7302,0xbdeed89e,0xbddd2d53,0xbdfe70b0,0xbdf6841b,0xbde816a8,0xbdd389c7
.long 0xbdfc3b28,0xbdf18f57,0xbde04621,0xbdc8d8b3,0xbdf91298,0xbdeb99fb,0xbdd77026,0xbdbd27b8
.long 0xbdf4fa0b,0xbde4aa59,0xbdcd9f02,0xbdb085bb,0xbdeff573,0xbddcc7d1,0xbdc2de29,0xbda302d3
.long 0xbdea09a7,0xbdd3fac3,0xbdb73a23,0xbd94b039,0xbde33c5a,0xbdca4c87,0xbdaac082,0xbd85a02c
.long 0xbddb941a,0xbdbfc767,0xbd9d7fd1,0xbd6bcbbb,0xbdd31849,0xbdb4768f,0xbd8f8784,0xbd4b2aae
.long 0xbdc9d112,0xbda86605,0xbd80e7e4,0xbd2986c4,0xbdbfc767,0xbd9ba299,0xbd6363fa,0xbd070ada
.long 0x3e000000,0x3dfec46d,0x3dfb14be,0x3df4fa0b,0x3dffb10f,0x3dfd1cdd,0x3df7f110,0x3df03b37
.long 0x3dfec46d,0x3dfac516,0x3df40bdd,0x3deaab7b,0x3dfd3aac,0x3df7beb7,0x3def6830,0x3de44fac
.long 0x3dfb14be,0x3df40bdd,0x3dea09a7,0x3ddd2d53,0x3df853f8,0x3defaf1b,0x3de3f473,0x3dd54aa4
.long 0x3df4fa0b,0x3deaab7b,0x3ddd2d53,0x3dccae79,0x3df10908,0x3de50479,0x3dd5b993,0x3dc36051
.long 0x3dec835e,0x3ddebe05,0x3dcd9f02,0x3db96842,0x3de76bd8,0x3dd7dc7f,0x3dc4e3f5,0x3daecef7
.long 0x3de1c598,0x3dd064af,0x3dbb8f3b,0x3da39da9,0x3ddb941a,0x3dc85bca,0x3db1a81d,0x3d97de12
.long 0x3dd4db31,0x3dbfc767,0x3da73656,0x3d8b9a6b,0x3dcd9f02,0x3db6ad7f,0x3d9c420c,0x3d7dbabb
.long 0x3dc5e403,0x3dad1469,0x3d90d3cd,0x3d6363fa,0x3dbdaef9,0x3da302d3,0x3d84f484,0x3d48477c
.long 0x3db504f3,0x3d987fc0,0x3d715aea,0x3d2c7cd4,0x3dabeb4a,0x3d8d9281,0x3d58106b,0x3d101c2c
.long 0x3da26799,0x3d8242b1,0x3d3e1d4a,0x3ce67c66,0x3d987fc0,0x3d6d3063,0x3d2395c5,0x3cabf804
.long 0x3d8e39da,0x3d553641,0x3d088e93,0x3c61bc2e,0x3d839c3d,0x3d3ca7af,0x3cda3997,0x3bd5880e
.long 0x3d715aea,0x3d2395c5,0x3ca2abb6,0xba490f88,0x3d5ae880,0x3d0a11f7,0x3c553db9,0xbc03db0a
.long 0x3d43ef15,0x3ce05c13,0x3bc8fb30,0xbc7ab273,0x3d2c7cd4,0x3cabf804,0xba490f88,0xbcb857ec
.long 0x3d14a031,0x3c6e3876,0xbbfb2b74,0xbcf2b651,0x3cf8cfcc,0x3c03db0a,0xbc6e3876,0xbd1620d2
.long 0x3cc7c5c2,0x3ac90e90,0xbcaf10a2,0xbd3263ef,0x3c964083,0xbba351cb,0xbce67c66,0xbd4e0bea
.long 0x3c48bd36,0xbc3c3ac3,0xbd0e9a22,0xbd6900b7,0x3bc8fb30,0xbc9324ca,0xbd2986c4,0xbd819573
.long 0x3dec835e,0x3de1c598,0x3dd4db31,0x3dc5e403,0x3de60f88,0x3dd988ad,0x3dcac77f,0x3db9f2ac
.long 0x3ddebe05,0x3dd064af,0x3dbfc767,0x3dad1469,0x3dd695e5,0x3dc66354,0x3db3e7bc,0x3d9f599f
.long 0x3dcd9f02,0x3dbb8f3b,0x3da73656,0x3d90d3cd,0x3dc3e200,0x3daff3e6,0x3d99c200,0x3d819573
.long 0x3db96842,0x3da39da9,0x3d8b9a6b,0x3d6363fa,0x3dae3bde,0x3d96999f,0x3d79a02d,0x3d427b55
.long 0x3da26799,0x3d88f59b,0x3d5ae880,0x3d209ae5,0x3d95f6d9,0x3d758035,0x3d3b31a0,0x3cfbdba4
.long 0x3d88f59b,0x3d58106b,0x3d1aa086,0x3cb54098,0x3d76e0cb,0x3d39bb1e,0x3cf2b651,0x3c5b7d37
.long 0x3d5ae880,0x3d1aa086,0x3caf10a2,0x3b96c32c,0x3d3e1d4a,0x3cf5c35a,0x3c553db9,0xbb8a342f
.long 0x3d209ae5,0x3cb54098,0x3b96c32c,0xbc553db9,0x3d027dc0,0x3c67fa9a,0xbb7b49ba,0xbcb228d4
.long 0x3cc7c5c2,0x3bc8fb30,0xbc48bd36,0xbcf8cfcc,0x3c89cf86,0xbafb514b,0xbca8defc,0xbd1f1cdf
.long 0x3c16a905,0xbc23308c,0xbcec9a7f,0xbd41071e,0x3ac90e90,0xbc9324ca,0xbd17a117,0xbd61fb6a
.long 0xbbc8fb30,0xbcd41501,0xbd38442a,0xbd80e7e4,0xbc61bc2e,0xbd0a11f7,0xbd58106b,0xbd902dd5
.long 0xbcaf10a2,0xbd2986c4,0xbd76e0cb,0xbd9ebc12,0xbcec9a7f,0xbd48477c,0xbd8a48ad,0xbdac800f
.long 0xbd14a031,0xbd663375,0xbd987fc0,0xbdb96842,0xbd3263ef,0xbd819573,0xbda6050a,0xbdc56439
.long 0xbd4f7bca,0xbd8f8784,0xbdb2c8c9,0xbdd064af,0xbd6bcbbb,0xbd9ce11f,0xbdbebc1b,0xbdda5ba0
.long 0xbd839c3d,0xbda99415,0xbdc9d112,0xbde33c5a,0xbd90d3cd,0xbdb592e7,0xbdd3fac3,0xbdeafb8c
.long 0xbd9d7fd1,0xbdc0d0da,0xbddd2d53,0xbdf18f57,0xbda99415,0xbdcb41fa,0xbde55e0b,0xbdf6ef5b
.long 0xbdb504f3,0xbdc5e403,0xbdd4db31,0xbde1c598,0xbdc1d870,0xbdd1c0c2,0xbddf8327,0xbdeafb8c
.long 0xbdcd9f02,0xbddc61c7,0xbde8bf3c,0xbdf294f8,0xbdd84853,0xbde5b710,0xbdf08066,0xbdf88486
.long 0xbde1c598,0xbdedb293,0xbdf6ba07,0xbdfcbfc9,0xbdea09a7,0xbdf4484b,0xbdfb61fc,0xbdff3f54
.long 0xbdf10908,0xbdf96e4e,0xbdfe70b0,0xbdfffec4,0xbdf6ba07,0xbdfd1cdd,0xbdffe129,0xbdfefcc9
.long 0xbdfb14be,0xbdff4e6d,0xbdffb10f,0xbdfc3b28,0xbdfe1324,0xbdffffb1,0xbdfde0b1,0xbdf7beb7
.long 0xbdffb10f,0xbdff2f9d,0xbdfa7302,0xbdf18f57,0xbdffec43,0xbdfcdf6c,0xbdf56d97,0xbde9b7e4
.long 0xbdfec46d,0xbdf91298,0xbdeed89e,0xbde04621,0xbdfc3b28,0xbdf3ced9,0xbde6becc,0xbdd54aa4
.long 0xbdf853f8,0xbded1c1d,0xbddd2d53,0xbdc8d8b3,0xbdf31447,0xbde50479,0xbdd233c6,0xbdbb0629
.long 0xbdec835e,0xbddb941a,0xbdc5e403,0xbdabeb4a,0xbde4aa59,0xbdd0d937,0xbdb85216,0xbd9ba299
.long 0xbddb941a,0xbdc4e3f5,0xbda99415,0xbd8a48ad,0xbdd14d3d,0xbdb7c655,0xbd99c200,0xbd6ff7fb
.long 0xbdc5e403,0xbda99415,0xbd88f59b,0xbd49b953,0xbdb96842,0xbd9a6293,0xbd6e9479,0xbd221887
.long 0xbdabeb4a,0xbd8a48ad,0xbd49b953,0xbcf2b651,0xbd9d7fd1,0xbd72bd43,0xbd2395c5,0xbc9f917b
.long 0xbd8e39da,0xbd4f7bca,0xbcf8cfcc,0xbc16a905,0xbd7c5d27,0xbd2b0201,0xbca8defc,0x3a96cb58
.long 0xbd5ae880,0xbd0586ce,0xbc2fb680,0x3c3c3ac3,0xbd38442a,0xbcbe853e,0xba490f88,0x3cb228d4
.long 0xbd14a031,0xbc61bc2e,0x3c16a905,0x3d027dc0,0xbce05c13,0xbb8a342f,0x3c9c76de,0x3d2b0201
.long 0xbc964083,0x3bafe007,0x3cec9a7f,0x3d525a09,0xbc16a905,0x3c7475c0,0x3d1d9e78,0x3d7840c8
.long 0xbdec835e,0xbdf4fa0b,0xbdfb14be,0xbdfec46d,0xbdf40bdd,0xbdfa9c59,0xbdfe9bc9,0xbdffffb1
.long 0xbdf9c79d,0xbdfe4323,0xbdfffb11,0xbdfeea9d,0xbdfdabcc,0xbdffe705,0xbdff2f9d,0xbdfb87b2
.long 0xbdffb10f,0xbdff84ab,0xbdfc3b28,0xbdf5dec6,0xbdffd397,0xbdfd1cdd,0xbdf72417,0xbdedfcf2
.long 0xbdfe1324,0xbdf8b47b,0xbdeff573,0xbde3f473,0xbdfa7302,0xbdf25470,0xbde6becc,0xbdd7dc7f
.long 0xbdf4fa0b,0xbdea09a7,0xbddb941a,0xbdc9d112,0xbdedb293,0xbddfe4e9,0xbdce8d90,0xbdb9f2ac
.long 0xbde4aa59,0xbdd3fac3,0xbdbfc767,0xbda86605,0xbdd9f26a,0xbdc66354,0xbdaf61a5,0xbd9553b7
.long 0xbdcd9f02,0xbdb73a23,0xbd9d7fd1,0xbd80e7e4,0xbdbfc767,0xbda69de3,0xbd8a48ad,0xbd56a399
.long 0xbdb085bb,0xbd94b039,0xbd6bcbbb,0xbd2986c4,0xbd9ff6cb,0xbd819573,0xbd41071e,0xbcf5c35a
.long 0xbd8e39da,0xbd5ae880,0xbd14a031,0xbc964083,0xbd76e0cb,0xbd30eacb,0xbccdee60,0xbbd5880e
.long 0xbd4f7bca,0xbd0586ce,0xbc61bc2e,0x3bafe007,0xbd268f12,0xbcb228d4,0xbb16c9b6,0x3c8cec4a
.long 0xbcf8cfcc,0xbc2fb680,0x3c16a905,0x3cec9a7f,0xbca2abb6,0x39c90fc6,0x3ca8defc,0x3d25129f
.long 0xbc16a905,0x3c3c3ac3,0x3d027dc0,0x3d525a09,0x3ac90e90,0x3cb857ec,0x3d2f713a,0x3d7dbabb
.long 0x3c48bd36,0x3d088e93,0x3d5ae880,0x3d93682a,0x3cbb6ecf,0x3d33dca5,0x3d8242b1,0x3da69de3
.long 0x3d088e93,0x3d5dbe79,0x3d95f6d9,0x3db85216,0x3d3263ef,0x3d82ef9f,0x3da86605,0x3dc85bca
.long 0x3d5ae880,0x3d95f6d9,0x3db96842,0x3dd695e5,0x3d80e7e4,0x3da7ce61,0x3dc8d8b3,0x3de2df7b
.long 0x3d93682a,0x3db85216,0x3dd695e5,0x3ded1c1d,0x3da4d225,0x3dc76085,0x3de28210,0x3df5341d
.long 0x3db504f3,0x3da26799,0x3d8e39da,0x3d715aea,0x3da73656,0x3d92c39a,0x3d79a02d,0x3d4b2aae
.long 0x3d987fc0,0x3d8242b1,0x3d553641,0x3d2395c5,0x3d88f59b,0x3d61fb6a,0x3d2f713a,0x3cf5c35a
.long 0x3d715aea,0x3d3e1d4a,0x3d088e93,0x3ca2abb6,0x3d4f7bca,0x3d1920fe,0x3cc19b37,0x3c1cecf9
.long 0x3d2c7cd4,0x3ce67c66,0x3c61bc2e,0xba490f88,0x3d088e93,0x3c995be0,0x3b7b49ba,0xbc35f8da
.long 0x3cc7c5c2,0x3c16a905,0xbbc8fb30,0xbcaf10a2,0x3c7ab273,0xb9c90fc6,0xbc839502,0xbd00f8c0
.long 0x3bc8fb30,0xbc23308c,0xbcd41501,0xbd2986c4,0xbb490ab0,0xbc9f917b,0xbd119ddd,0xbd50eb2a
.long 0xbc48bd36,0xbcec9a7f,0xbd38442a,0xbd76e0cb,0xbcaf10a2,0xbd1c1faf,0xbd5dbe79,0xbd8d9281
.long 0xbcf8cfcc,0xbd41071e,0xbd80e7e4,0xbd9ebc12,0xbd209ae5,0xbd64cbfe,0xbd921eb0,0xbdaecef7
.long 0xbd43ef15,0xbd839c3d,0xbda26799,0xbdbdaef9,0xbd663375,0xbd940c5f,0xbdb1a81d,0xbdcb41fa
.long 0xbd839c3d,0xbda39da9,0xbdbfc767,0xbdd77026,0xbd93682a,0xbdb238aa,0xbdccae79,0xbde2241a
.long 0xbda26799,0xbdbfc767,0xbdd84853,0xbdeb4b0c,0xbdb085bb,0xbdcc3578,0xbde28210,0xbdf2d4eb
.long 0xbdbdaef9,0xbdd77026,0xbdeb4b0c,0xbdf8b47b,0xbdc9d112,0xbde1668a,0xbdf294f8,0xbdfcdf6c
.long 0xbdd4db31,0xbdea09a7,0xbdf853f8,0xbdff4e6d,0xbddebe05,0xbdf14c7a,0xbdfc7eb0,0xbdfffd39
.long 0xbde76bd8,0xbdf72417,0xbdff0e58,0xbdfeea9d,0xbdeed89e,0xbdfb87b2,0xbdfffec4,0xbdfc187a
.long 0xbdf4fa0b,0xbdfe70b0,0xbdff4e6d,0xbdf78bc5,0xbdf9c79d,0xbdffdaaf,0xbdfcfe73,0xbdf14c7a
.long 0xbdfd3aac,0xbdffc38f,0xbdf91298,0xbde96591,0xbdff4e6d,0xbdfe2b72,0xbdf3913f,0xbddfe4e9
.long 0x3d43ef15,0x3d14a031,0x3cc7c5c2,0x3c48bd36,0x3d1aa086,0x3cd101f1,0x3c553db9,0x39c90fc6
.long 0x3ce05c13,0x3c6e3876,0x3ac90e90,0xbc3c3ac3,0x3c89cf86,0x3b622a7a,0xbc23308c,0xbcbe853e
.long 0x3bc8fb30,0xbbfb2b74,0xbcaf10a2,0xbd0e9a22,0xbb96c32c,0xbc995be0,0xbd0586ce,0xbd3ca7af
.long 0xbc7ab273,0xbcf2b651,0xbd3263ef,0xbd6900b7,0xbcd41501,0xbd25129f,0xbd5dbe79,0xbd899f4e
.long 0xbd14a031,0xbd4f7bca,0xbd839c3d,0xbd9d7fd1,0xbd3e1d4a,0xbd7840c8,0xbd973c07,0xbdaff3e6
.long 0xbd663375,0xbd8f8784,0xbda99415,0xbdc0d0da,0xbd864b82,0xbda1cbfb,0xbdba7ca4,0xbdcfefa8
.long 0xbd987fc0,0xbdb2c8c9,0xbdc9d112,0xbddd2d53,0xbda99415,0xbdc25b89,0xbdd77026,0xbde86b39
.long 0xbdb96842,0xbdd064af,0xbde33c5a,0xbdf18f57,0xbdc7de65,0xbddcc7d1,0xbded1c1d,0xbdf88486
.long 0xbdd4db31,0xbde76bd8,0xbdf4fa0b,0xbdfd3aac,0xbde04621,0xbdf03b37,0xbdfac516,0xbdffa6e3
.long 0xbdea09a7,0xbdf72417,0xbdfe70b0,0xbdffc38f,0xbdf21352,0xbdfc187a,0xbdfff4e6,0xbdfd906e
.long 0xbdf853f8,0xbdff0e58,0xbdff4e6d,0xbdf91298,0xbdfcbfc9,0xbdffffb1,0xbdfc7eb0,0xbdf25470
.long 0xbdff4e6d,0xbdfeea9d,0xbdf78bc5,0xbde96591,0xbdfffb11,0xbdfbd14d,0xbdf08066,0xbdde5aa6
.long 0xbdfec46d,0xbdf6ba07,0xbde76bd8,0xbdd14d3d,0xbdfbaccd,0xbdefaf1b,0xbddc61c7,0xbdc25b89
.long 0xbdf6ba07,0xbde6becc,0xbdcf7a1f,0xbdb1a81d,0xbdeff573,0xbddbfb34,0xbdc0d0da,0xbd9f599f
.long 0xbde76bd8,0xbdcf7a1f,0xbdb085bb,0xbd8b9a6b,0xbddd2d53,0xbdc154e1,0xbd9ebc12,0xbd6d3063
.long 0xbdd14d3d,0xbdb1a81d,0xbd8b9a6b,0xbd41071e,0xbdc3e200,0xbda09393,0xbd6e9479,0xbd131f35
```
